```python
import torch

def _softmax(x, axis=-1):
    return torch.softmax(x, dim=axis)
def _gelu(x):
    return torch.nn.functional.gelu(x, approximate="tanh")
def _silu(x):
    return torch.nn.functional.silu(x)
def _sigmoid(x):
    return torch.sigmoid(x)
def _layernorm(x, axis=-1, eps=1e-5):
    m = x.mean(dim=axis, keepdim=True)
    v = x.var(dim=axis, keepdim=True, unbiased=False)
    return (x - m) / torch.sqrt(v + eps)
def _scatter_add(tgt, idx, src, axis=0):
    return tgt.clone().index_add_(axis, idx, src)
def _segment_sum(src, seg, n):
    out = torch.zeros((n,) + src.shape[1:], dtype=src.dtype)
    return out.index_add_(0, seg, src)
def _pad(x, pw):
    flat = tuple(v for pair in reversed(pw) for v in pair)
    return torch.nn.functional.pad(x, flat)

kernel_name = 'recurrent_scan__ssm_conv_s5__dense_activation_mish__prompt'

def setup_inputs():

    _w = (lambda a: (lambda t: t.to(torch.bfloat16) if t.is_floating_point() else t)(torch.as_tensor(a)))
    def _A_setup():
        B, S, D = 1, 2048, 576
        P = D
        Lambda_re = -0.5 * (lambda _x: torch.exp(torch.as_tensor(_x)))((lambda *s: torch.randn(*s, dtype=torch.bfloat16) * 0.4)(P))
        Lambda_im = (lambda *s: torch.randn(*s, dtype=torch.bfloat16) * 0.8)(P) * 1.0
        B_re = (lambda *s: torch.randn(*s, dtype=torch.bfloat16) * 0.4)(P, D) * (D ** -0.5)
        B_im = (lambda *s: torch.randn(*s, dtype=torch.bfloat16) * 0.8)(P, D) * (D ** -0.5)
        C_re = (lambda *s: torch.randn(*s, dtype=torch.bfloat16) * 0.8)(D, P) * (P ** -0.5)
        C_im = (lambda *s: torch.randn(*s, dtype=torch.bfloat16) * 0.8)(D, P) * (P ** -0.5)
        log_dt = (lambda *s: torch.randn(*s, dtype=torch.bfloat16) * 0.4)(P) * 0.3 - 2.0
        Dskip = (lambda *s: torch.randn(*s, dtype=torch.bfloat16) * 0.2)(D)
        return {
            "x": _w((lambda *s: torch.randn(*s, dtype=torch.bfloat16) * 0.05)(B, S, D)),
            "Lambda_re": _w(Lambda_re),
            "Lambda_im": _w(Lambda_im),
            "B_re": _w(B_re),
            "B_im": _w(B_im),
            "C_re": _w(C_re),
            "C_im": _w(C_im),
            "log_dt": _w(log_dt),
            "Dskip": _w(Dskip),
        }
    _A_in = _A_setup()

    def _B_setup():
        B, S, D, F = 1, 2048, 576, 4608
        return {
            "x": _w((lambda *s: torch.randn(*s, dtype=torch.bfloat16) * 0.05)(B, S, D)),
            "w1": _w((lambda *s: torch.randn(*s, dtype=torch.bfloat16) * 0.8)(D, F) * (D ** -0.5)),
            "b1": _w((lambda *s: torch.randn(*s, dtype=torch.bfloat16) * 0.4)(F)),
            "w2": _w((lambda *s: torch.randn(*s, dtype=torch.bfloat16) * 0.1)(F, D) * (F ** -0.5)),
        }
    _B_in = _B_setup()

    return {
        "A_x": _A_in["x"],
        "A_Lambda_re": _A_in["Lambda_re"],
        "A_Lambda_im": _A_in["Lambda_im"],
        "A_B_re": _A_in["B_re"],
        "A_B_im": _A_in["B_im"],
        "A_C_re": _A_in["C_re"],
        "A_C_im": _A_in["C_im"],
        "A_log_dt": _A_in["log_dt"],
        "A_Dskip": _A_in["Dskip"],
        "B_x": _B_in["x"],
        "B_w1": _B_in["w1"],
        "B_b1": _B_in["b1"],
        "B_w2": _B_in["w2"],
    }

def reference(A_x, A_Lambda_re, A_Lambda_im, A_B_re, A_B_im, A_C_re, A_C_im, A_log_dt, A_Dskip, B_x, B_w1, B_b1, B_w2):
    def _A_ref(x, Lambda_re, Lambda_im, B_re, B_im, C_re, C_im, log_dt, Dskip):
        Bsz, L, H = x.shape
        Lam = Lambda_re + 1j * Lambda_im
        Bmat = B_re + 1j * B_im
        Cmat = C_re + 1j * C_im
        dt = torch.exp(log_dt)
        Lam_bar = torch.exp(dt * Lam)
        B_bar = ((Lam_bar - 1.0) / Lam)[:, None] * Bmat
        Bu = torch.einsum("bld,pd->blp", x + 0j, B_bar)
        h = torch.zeros_like(Bu[:, 0, :])
        hs = []
        for t in range(L):
            h = Lam_bar[None, :] * h + Bu[:, t, :]
            hs.append(h)
        hseq = torch.stack(hs, 1)
        y = 2.0 * torch.einsum("blp,dp->bld", hseq, Cmat).real + x * Dskip[None, None, :]
        return y

    def _B_ref(x, w1, b1, w2):
        h = torch.einsum("bsd,df->bsf", x, w1) + b1
        sp = torch.log1p(torch.exp(-torch.abs(h))) + torch.where(h > 0, h, torch.zeros_like(h))
        act = h * torch.tanh(sp)
        return torch.einsum("bsf,fd->bsd", act, w2)

    x = A_x
    xn = _layernorm(x, axis=-1)
    s = _A_ref(xn, A_Lambda_re, A_Lambda_im, A_B_re, A_B_im, A_C_re, A_C_im, A_log_dt, A_Dskip)
    g = _silu(_B_ref(xn, B_w1, B_b1, B_w2))
    return x + s * g
```

```asm
; @launch kernel=recurrent_scan__ssm_conv_s5__dense_activation_mish__prompt_kernel grid=(256,1,1) block=(512,1,1) lds=163840
.amdgcn_target "amdgcn-amd-amdhsa--gfx950"
.text
.globl recurrent_scan__ssm_conv_s5__dense_activation_mish__prompt_kernel
.p2align 8
.type recurrent_scan__ssm_conv_s5__dense_activation_mish__prompt_kernel,@function
recurrent_scan__ssm_conv_s5__dense_activation_mish__prompt_kernel:
    s_cmp_ge_u32 s2, 256
    s_cbranch_scc1 .Lk1_end
    s_load_dwordx16 s[16:31], s[0:1], 0
    s_load_dwordx16 s[32:47], s[0:1], 64
    v_lshrrev_b32 v1, 6, v0
    v_and_b32 v0, 63, v0
    v_readfirstlane_b32 s4, v1
    s_and_b32 s3, s2, 7
    s_lshr_b32 s10, s2, 3
    s_and_b32 s7, s10, 7
    s_and_b32 s11, s3, 1
    s_lshl_b32 s11, s11, 3
    s_add_u32 s7, s7, s11
    s_lshr_b32 s10, s10, 3
    s_lshr_b32 s3, s3, 1
    s_and_b32 s5, s4, 3
    s_lshr_b32 s6, s4, 2
    s_lshl_b32 s9, s4, 10
    s_add_u32 s9, s9, 98304
    s_mov_b32 s12, 0x3f803f80
    s_mov_b32 s13, 0xffff0000
    s_mov_b32 s14, 9216
    s_mov_b32 s92, 0x00003f80
    s_mov_b32 s93, 0x3f800000
    s_lshl_b32 s11, s7, 7
    s_lshl_b32 s73, s4, 4
    s_add_u32 s11, s11, s73
    v_lshrrev_b32 v8, 3, v0
    v_and_b32 v9, 7, v0
    v_add_u32 v10, s11, v8
    v_mul_u32_u24 v11, 0x480, v10
    v_lshl_add_u32 v11, v9, 4, v11
    s_waitcnt lgkmcnt(0)
    s_mov_b32 s48, s16
    s_and_b32 s49, s17, 0xffff
    s_mov_b32 s50, 2359296
    s_mov_b32 s51, 0x00020000
    s_mov_b32 s60, s46
    s_and_b32 s61, s47, 0xffff
    s_mov_b32 s62, 268435456
    s_mov_b32 s63, 0x00020000
    buffer_load_dwordx4 v[112:115], v11, s[48:51], 0 offen offset:0
    buffer_load_dwordx4 v[116:119], v11, s[48:51], 0 offen offset:128
    buffer_load_dwordx4 v[120:123], v11, s[48:51], 0 offen offset:256
    buffer_load_dwordx4 v[124:127], v11, s[48:51], 0 offen offset:384
    buffer_load_dwordx4 v[128:131], v11, s[48:51], 0 offen offset:512
    buffer_load_dwordx4 v[132:135], v11, s[48:51], 0 offen offset:640
    buffer_load_dwordx4 v[136:139], v11, s[48:51], 0 offen offset:768
    buffer_load_dwordx4 v[140:143], v11, s[48:51], 0 offen offset:896
    buffer_load_dwordx4 v[144:147], v11, s[48:51], 0 offen offset:1024
    buffer_load_dwordx4 v[148:151], v11, s[48:51], s14 offen offset:0
    buffer_load_dwordx4 v[152:155], v11, s[48:51], s14 offen offset:128
    buffer_load_dwordx4 v[156:159], v11, s[48:51], s14 offen offset:256
    buffer_load_dwordx4 v[160:163], v11, s[48:51], s14 offen offset:384
    buffer_load_dwordx4 v[164:167], v11, s[48:51], s14 offen offset:512
    buffer_load_dwordx4 v[168:171], v11, s[48:51], s14 offen offset:640
    buffer_load_dwordx4 v[172:175], v11, s[48:51], s14 offen offset:768
    buffer_load_dwordx4 v[176:179], v11, s[48:51], s14 offen offset:896
    buffer_load_dwordx4 v[180:183], v11, s[48:51], s14 offen offset:1024
    s_getpc_b64 s[84:85]
.Lpc0:
    s_lshr_b32 s11, s2, 3
    s_lshl_b32 s11, s11, 3
    s_add_u32 s11, s11, s4
    s_lshl_b32 s11, s11, 9
    v_and_b32 v30, 3, v0
    v_lshl_add_u32 v30, v30, 7, s11
    v_min_u32 v30, .Lcode_end-.Lpc0-4, v30
    global_load_dword v31, v30, s[84:85]
    s_cmp_lt_u32 s10, 3
    s_cbranch_scc0 .Lk1_ssm
    s_mul_i32 s8, s3, 3
    s_add_u32 s8, s8, s10
    s_mov_b32 s77, s10
    s_mov_b32 s78, s3
    s_mov_b32 s68, s44
    s_and_b32 s69, s45, 0xffff
    s_mov_b32 s70, 256
    s_mov_b32 s71, 0x00020000
    s_mul_i32 s11, s7, 12
    s_add_u32 s11, s11, s8
    s_lshl_b32 s11, s11, 7
    s_add_u32 s11, s11, 262144
    s_cmp_eq_u32 s4, 0
    s_cselect_b32 s11, s11, 0x40000000
    v_and_b32 v24, 31, v0
    v_lshl_add_u32 v24, v24, 2, s11
    v_mov_b32 v25, 0
    buffer_store_dword v25, v24, s[60:63], 0 offen sc1
    s_mov_b32 s52, s36
    s_and_b32 s53, s37, 0xffff
    s_mov_b32 s54, 5308416
    s_mov_b32 s55, 0x00020000
    s_mov_b32 s56, s40
    s_and_b32 s57, s41, 0xffff
    s_mov_b32 s58, 5308416
    s_mov_b32 s59, 0x00020000
    s_mov_b32 s64, s38
    s_and_b32 s65, s39, 0xffff
    s_mov_b32 s66, 9216
    s_mov_b32 s67, 0x00020000
    s_mul_i32 s15, s8, 768
    s_mul_i32 s72, s8, 442368
    s_mov_b32 s79, s8
    s_lshl_b32 s11, s4, 3
    v_add_u32 v20, s11, v8
    v_bfe_u32 v21, v0, 4, 1
    v_lshlrev_b32 v21, 2, v21
    v_xor_b32 v21, v21, v9
    v_lshlrev_b32 v21, 4, v21
    v_mul_u32_u24 v22, 0x2400, v20
    s_and_b32 s11, s4, 1
    s_lshl_b32 s11, s11, 4
    v_xor_b32 v23, s11, v21
    v_add_u32 v3, v22, v23
    v_lshrrev_b32 v23, 5, v0
    v_lshlrev_b32 v23, 4, v23
    v_xor_b32 v21, v21, v23
    v_mul_u32_u24 v22, 0x480, v20
    v_add_u32 v4, v22, v21
    s_add_u32 m0, s9, 49152
    s_add_u32 s10, s15, 0
    buffer_load_dwordx4 v3, s[52:55], s10 offen lds
    s_add_u32 m0, s9, 57344
    s_add_u32 s10, s15, 589824
    buffer_load_dwordx4 v3, s[52:55], s10 offen lds
    v_lshrrev_b32 v20, 5, v0
    v_lshlrev_b32 v20, 7, v20
    v_and_b32 v21, 31, v0
    v_lshl_add_u32 v20, v21, 1, v20
    s_lshl_b32 s11, s6, 6
    v_add_u32 v20, s11, v20
    buffer_load_ushort v60, v20, s[64:67], s15 offen offset:0
    buffer_load_ushort v61, v20, s[64:67], s15 offen offset:256
    buffer_load_ushort v62, v20, s[64:67], s15 offen offset:512
    v_bfe_u32 v20, v0, 2, 2
    v_lshrrev_b32 v21, 1, v20
    v_xor_b32 v21, s6, v21
    v_lshlrev_b32 v21, 6, v21
    v_bfe_u32 v22, v0, 4, 1
    v_lshl_add_u32 v21, v22, 4, v21
    v_and_b32 v23, 1, v0
    v_lshl_add_u32 v21, v23, 3, v21
    v_bfe_u32 v23, v0, 1, 1
    v_lshl_add_u32 v21, v23, 5, v21
    v_lshl_add_u32 v21, v20, 7, v21
    v_add_u32 v21, 98304, v21
    v_lshrrev_b32 v23, 4, v0
    v_lshl_add_u32 v1, v23, 10, v21
    v_xor_b32 v2, 16, v1
    v_lshrrev_b32 v23, 5, v0
    v_lshl_add_u32 v22, v23, 2, v22
    s_mul_i32 s11, s5, 24576
    v_lshlrev_b32 v7, 4, v0
    v_add_u32 v7, s11, v7
    s_lshl_b32 s73, s6, 11
    v_add_u32 v6, s73, v7
    s_add_u32 s74, s11, s73
    s_add_u32 s74, s74, 20480
    v_lshl_add_u32 v59, v22, 4, s74
    s_add_u32 s75, s11, 21504
    s_cmp_eq_u32 s6, 0
    s_cselect_b64 s[94:95], -1, 0
    s_lshl_b32 s11, s7, 2
    s_add_u32 s11, s11, s5
    s_mul_i32 s11, s11, 18
    s_add_u32 s11, s11, s6
    s_lshl_b32 s11, s11, 5
    s_add_u32 s11, s11, s79
    s_lshl_b32 s11, s11, 10
    s_add_u32 s11, s11, 1048576
    v_and_b32 v5, 15, v0
    v_lshl_add_u32 v5, v5, 4, s11
    v_bfe_u32 v24, v0, 4, 1
    v_lshl_add_u32 v5, v24, 8, v5
    v_lshrrev_b32 v24, 5, v0
    v_lshl_add_u32 v5, v24, 14, v5
    s_lshr_b32 s11, s4, 1
    s_mul_i32 s11, s11, 36864
    s_and_b32 s73, s4, 1
    s_lshl_b32 s73, s73, 4
    v_add_u32 v12, s73, v8
    v_lshlrev_b32 v13, 1, v9
    v_xor_b32 v12, v12, v13
    v_lshlrev_b32 v12, 4, v12
    v_lshrrev_b32 v13, 1, v9
    v_lshl_add_u32 v12, v13, 10, v12
    v_and_b32 v13, 1, v9
    v_lshl_add_u32 v12, v13, 9, v12
    v_add_u32 v12, s11, v12
    v_xor_b32 v13, 0x80, v12
    v_and_b32 v18, 31, v0
    v_lshrrev_b32 v19, 5, v0
    v_mov_b32 v20, v18
    v_lshlrev_b32 v21, 1, v19
    v_xor_b32 v20, v20, v21
    s_mul_i32 s11, s5, 36864
    v_lshlrev_b32 v21, 9, v19
    v_add_u32 v21, s11, v21
    v_lshrrev_b32 v19, 4, v0
    v_and_b32 v20, 15, v0
    v_lshlrev_b32 v21, 1, v19
    v_xor_b32 v20, v20, v21
    v_lshl_add_u32 v21, v19, 9, s11
    v_xor_b32 v22, 0, v20
    v_lshl_add_u32 v14, v22, 4, v21
    v_xor_b32 v22, 16, v20
    v_lshl_add_u32 v15, v22, 4, v21
    v_xor_b32 v22, 8, v20
    v_lshl_add_u32 v16, v22, 4, v21
    v_xor_b32 v22, 24, v20
    v_lshl_add_u32 v17, v22, 4, v21
    s_waitcnt vmcnt(24)
    v_dot2_f32_bf16 v32, v112, s12, 0
    v_dot2_f32_bf16 v34, v112, v112, 0
    v_dot2_f32_bf16 v33, v113, s12, 0
    v_dot2_f32_bf16 v35, v113, v113, 0
    v_dot2_f32_bf16 v32, v114, s12, v32
    v_dot2_f32_bf16 v34, v114, v114, v34
    v_dot2_f32_bf16 v33, v115, s12, v33
    v_dot2_f32_bf16 v35, v115, v115, v35
    s_waitcnt vmcnt(23)
    v_dot2_f32_bf16 v32, v116, s12, v32
    v_dot2_f32_bf16 v34, v116, v116, v34
    v_dot2_f32_bf16 v33, v117, s12, v33
    v_dot2_f32_bf16 v35, v117, v117, v35
    v_dot2_f32_bf16 v32, v118, s12, v32
    v_dot2_f32_bf16 v34, v118, v118, v34
    v_dot2_f32_bf16 v33, v119, s12, v33
    v_dot2_f32_bf16 v35, v119, v119, v35
    s_waitcnt vmcnt(22)
    v_dot2_f32_bf16 v32, v120, s12, v32
    v_dot2_f32_bf16 v34, v120, v120, v34
    v_dot2_f32_bf16 v33, v121, s12, v33
    v_dot2_f32_bf16 v35, v121, v121, v35
    v_dot2_f32_bf16 v32, v122, s12, v32
    v_dot2_f32_bf16 v34, v122, v122, v34
    v_dot2_f32_bf16 v33, v123, s12, v33
    v_dot2_f32_bf16 v35, v123, v123, v35
    s_waitcnt vmcnt(21)
    v_dot2_f32_bf16 v32, v124, s12, v32
    v_dot2_f32_bf16 v34, v124, v124, v34
    v_dot2_f32_bf16 v33, v125, s12, v33
    v_dot2_f32_bf16 v35, v125, v125, v35
    v_dot2_f32_bf16 v32, v126, s12, v32
    v_dot2_f32_bf16 v34, v126, v126, v34
    v_dot2_f32_bf16 v33, v127, s12, v33
    v_dot2_f32_bf16 v35, v127, v127, v35
    s_waitcnt vmcnt(20)
    v_dot2_f32_bf16 v32, v128, s12, v32
    v_dot2_f32_bf16 v34, v128, v128, v34
    v_dot2_f32_bf16 v33, v129, s12, v33
    v_dot2_f32_bf16 v35, v129, v129, v35
    v_dot2_f32_bf16 v32, v130, s12, v32
    v_dot2_f32_bf16 v34, v130, v130, v34
    v_dot2_f32_bf16 v33, v131, s12, v33
    v_dot2_f32_bf16 v35, v131, v131, v35
    s_waitcnt vmcnt(19)
    v_dot2_f32_bf16 v32, v132, s12, v32
    v_dot2_f32_bf16 v34, v132, v132, v34
    v_dot2_f32_bf16 v33, v133, s12, v33
    v_dot2_f32_bf16 v35, v133, v133, v35
    v_dot2_f32_bf16 v32, v134, s12, v32
    v_dot2_f32_bf16 v34, v134, v134, v34
    v_dot2_f32_bf16 v33, v135, s12, v33
    v_dot2_f32_bf16 v35, v135, v135, v35
    s_waitcnt vmcnt(18)
    v_dot2_f32_bf16 v32, v136, s12, v32
    v_dot2_f32_bf16 v34, v136, v136, v34
    v_dot2_f32_bf16 v33, v137, s12, v33
    v_dot2_f32_bf16 v35, v137, v137, v35
    v_dot2_f32_bf16 v32, v138, s12, v32
    v_dot2_f32_bf16 v34, v138, v138, v34
    v_dot2_f32_bf16 v33, v139, s12, v33
    v_dot2_f32_bf16 v35, v139, v139, v35
    s_waitcnt vmcnt(17)
    v_dot2_f32_bf16 v32, v140, s12, v32
    v_dot2_f32_bf16 v34, v140, v140, v34
    v_dot2_f32_bf16 v33, v141, s12, v33
    v_dot2_f32_bf16 v35, v141, v141, v35
    v_dot2_f32_bf16 v32, v142, s12, v32
    v_dot2_f32_bf16 v34, v142, v142, v34
    v_dot2_f32_bf16 v33, v143, s12, v33
    v_dot2_f32_bf16 v35, v143, v143, v35
    s_waitcnt vmcnt(16)
    v_dot2_f32_bf16 v32, v144, s12, v32
    v_dot2_f32_bf16 v34, v144, v144, v34
    v_dot2_f32_bf16 v33, v145, s12, v33
    v_dot2_f32_bf16 v35, v145, v145, v35
    v_dot2_f32_bf16 v32, v146, s12, v32
    v_dot2_f32_bf16 v34, v146, v146, v34
    v_dot2_f32_bf16 v33, v147, s12, v33
    v_dot2_f32_bf16 v35, v147, v147, v35
    s_nop 2
    v_add_f32 v32, v32, v33
    v_add_f32 v34, v34, v35
    s_waitcnt vmcnt(15)
    v_dot2_f32_bf16 v36, v148, s12, 0
    v_dot2_f32_bf16 v38, v148, v148, 0
    v_dot2_f32_bf16 v37, v149, s12, 0
    v_dot2_f32_bf16 v39, v149, v149, 0
    v_dot2_f32_bf16 v36, v150, s12, v36
    v_dot2_f32_bf16 v38, v150, v150, v38
    v_dot2_f32_bf16 v37, v151, s12, v37
    v_dot2_f32_bf16 v39, v151, v151, v39
    s_waitcnt vmcnt(14)
    v_dot2_f32_bf16 v36, v152, s12, v36
    v_dot2_f32_bf16 v38, v152, v152, v38
    v_dot2_f32_bf16 v37, v153, s12, v37
    v_dot2_f32_bf16 v39, v153, v153, v39
    v_dot2_f32_bf16 v36, v154, s12, v36
    v_dot2_f32_bf16 v38, v154, v154, v38
    v_dot2_f32_bf16 v37, v155, s12, v37
    v_dot2_f32_bf16 v39, v155, v155, v39
    s_waitcnt vmcnt(13)
    v_dot2_f32_bf16 v36, v156, s12, v36
    v_dot2_f32_bf16 v38, v156, v156, v38
    v_dot2_f32_bf16 v37, v157, s12, v37
    v_dot2_f32_bf16 v39, v157, v157, v39
    v_dot2_f32_bf16 v36, v158, s12, v36
    v_dot2_f32_bf16 v38, v158, v158, v38
    v_dot2_f32_bf16 v37, v159, s12, v37
    v_dot2_f32_bf16 v39, v159, v159, v39
    s_waitcnt vmcnt(12)
    v_dot2_f32_bf16 v36, v160, s12, v36
    v_dot2_f32_bf16 v38, v160, v160, v38
    v_dot2_f32_bf16 v37, v161, s12, v37
    v_dot2_f32_bf16 v39, v161, v161, v39
    v_dot2_f32_bf16 v36, v162, s12, v36
    v_dot2_f32_bf16 v38, v162, v162, v38
    v_dot2_f32_bf16 v37, v163, s12, v37
    v_dot2_f32_bf16 v39, v163, v163, v39
    s_waitcnt vmcnt(11)
    v_dot2_f32_bf16 v36, v164, s12, v36
    v_dot2_f32_bf16 v38, v164, v164, v38
    v_dot2_f32_bf16 v37, v165, s12, v37
    v_dot2_f32_bf16 v39, v165, v165, v39
    v_dot2_f32_bf16 v36, v166, s12, v36
    v_dot2_f32_bf16 v38, v166, v166, v38
    v_dot2_f32_bf16 v37, v167, s12, v37
    v_dot2_f32_bf16 v39, v167, v167, v39
    s_waitcnt vmcnt(10)
    v_dot2_f32_bf16 v36, v168, s12, v36
    v_dot2_f32_bf16 v38, v168, v168, v38
    v_dot2_f32_bf16 v37, v169, s12, v37
    v_dot2_f32_bf16 v39, v169, v169, v39
    v_dot2_f32_bf16 v36, v170, s12, v36
    v_dot2_f32_bf16 v38, v170, v170, v38
    v_dot2_f32_bf16 v37, v171, s12, v37
    v_dot2_f32_bf16 v39, v171, v171, v39
    s_waitcnt vmcnt(9)
    v_dot2_f32_bf16 v36, v172, s12, v36
    v_dot2_f32_bf16 v38, v172, v172, v38
    v_dot2_f32_bf16 v37, v173, s12, v37
    v_dot2_f32_bf16 v39, v173, v173, v39
    v_dot2_f32_bf16 v36, v174, s12, v36
    v_dot2_f32_bf16 v38, v174, v174, v38
    v_dot2_f32_bf16 v37, v175, s12, v37
    v_dot2_f32_bf16 v39, v175, v175, v39
    s_waitcnt vmcnt(8)
    v_dot2_f32_bf16 v36, v176, s12, v36
    v_dot2_f32_bf16 v38, v176, v176, v38
    v_dot2_f32_bf16 v37, v177, s12, v37
    v_dot2_f32_bf16 v39, v177, v177, v39
    v_dot2_f32_bf16 v36, v178, s12, v36
    v_dot2_f32_bf16 v38, v178, v178, v38
    v_dot2_f32_bf16 v37, v179, s12, v37
    v_dot2_f32_bf16 v39, v179, v179, v39
    s_waitcnt vmcnt(7)
    v_dot2_f32_bf16 v36, v180, s12, v36
    v_dot2_f32_bf16 v38, v180, v180, v38
    v_dot2_f32_bf16 v37, v181, s12, v37
    v_dot2_f32_bf16 v39, v181, v181, v39
    v_dot2_f32_bf16 v36, v182, s12, v36
    v_dot2_f32_bf16 v38, v182, v182, v38
    v_dot2_f32_bf16 v37, v183, s12, v37
    v_dot2_f32_bf16 v39, v183, v183, v39
    s_nop 2
    v_add_f32 v36, v36, v37
    v_add_f32 v38, v38, v39
    s_nop 0
    v_add_f32_dpp v32, v32, v32 quad_perm:[1,0,3,2] row_mask:0xf bank_mask:0xf
    v_add_f32_dpp v34, v34, v34 quad_perm:[1,0,3,2] row_mask:0xf bank_mask:0xf
    v_add_f32_dpp v36, v36, v36 quad_perm:[1,0,3,2] row_mask:0xf bank_mask:0xf
    v_add_f32_dpp v38, v38, v38 quad_perm:[1,0,3,2] row_mask:0xf bank_mask:0xf
    s_nop 0
    v_add_f32_dpp v32, v32, v32 quad_perm:[2,3,0,1] row_mask:0xf bank_mask:0xf
    v_add_f32_dpp v34, v34, v34 quad_perm:[2,3,0,1] row_mask:0xf bank_mask:0xf
    v_add_f32_dpp v36, v36, v36 quad_perm:[2,3,0,1] row_mask:0xf bank_mask:0xf
    v_add_f32_dpp v38, v38, v38 quad_perm:[2,3,0,1] row_mask:0xf bank_mask:0xf
    s_nop 0
    v_add_f32_dpp v32, v32, v32 row_half_mirror row_mask:0xf bank_mask:0xf
    v_add_f32_dpp v34, v34, v34 row_half_mirror row_mask:0xf bank_mask:0xf
    v_add_f32_dpp v36, v36, v36 row_half_mirror row_mask:0xf bank_mask:0xf
    v_add_f32_dpp v38, v38, v38 row_half_mirror row_mask:0xf bank_mask:0xf
    v_mul_f32 v32, 0x3ae38e39, v32
    v_mul_f32 v34, 0x3ae38e39, v34
    v_fma_f32 v34, -v32, v32, v34
    v_max_f32 v34, 0, v34
    v_cvt_pk_bf16_f32 v40, v32, v34
    v_and_b32 v34, s13, v40
    v_lshlrev_b32 v40, 16, v40
    v_add_f32 v34, 0x3727c5ac, v34
    v_cvt_pk_bf16_f32 v34, v34, v34
    v_and_b32 v34, s13, v34
    v_sqrt_f32 v34, v34
    s_nop 0
    v_cvt_pk_bf16_f32 v34, v34, v34
    v_and_b32 v34, s13, v34
    v_rcp_f32 v41, v34
    s_nop 0
    v_fma_f32 v44, -v34, v41, 1.0
    v_fma_f32 v41, v41, v44, v41
    v_mul_f32 v36, 0x3ae38e39, v36
    v_mul_f32 v38, 0x3ae38e39, v38
    v_fma_f32 v38, -v36, v36, v38
    v_max_f32 v38, 0, v38
    v_cvt_pk_bf16_f32 v42, v36, v38
    v_and_b32 v38, s13, v42
    v_lshlrev_b32 v42, 16, v42
    v_add_f32 v38, 0x3727c5ac, v38
    v_cvt_pk_bf16_f32 v38, v38, v38
    v_and_b32 v38, s13, v38
    v_sqrt_f32 v38, v38
    s_nop 0
    v_cvt_pk_bf16_f32 v38, v38, v38
    v_and_b32 v38, s13, v38
    v_rcp_f32 v43, v38
    s_nop 0
    v_fma_f32 v44, -v38, v43, 1.0
    v_fma_f32 v43, v43, v44, v43
    v_xor_b32 v44, 0x80000000, v40
    v_xor_b32 v45, 0x80000000, v42
    v_dot2_f32_bf16 v46, v112, s92, v44
    v_dot2_f32_bf16 v47, v112, s93, v44
    v_dot2_f32_bf16 v48, v113, s92, v44
    v_dot2_f32_bf16 v49, v113, s93, v44
    v_dot2_f32_bf16 v50, v114, s92, v44
    v_dot2_f32_bf16 v51, v114, s93, v44
    v_dot2_f32_bf16 v52, v115, s92, v44
    v_dot2_f32_bf16 v53, v115, s93, v44
    v_cvt_pk_bf16_f32 v112, v46, v47
    v_cvt_pk_bf16_f32 v113, v48, v49
    v_cvt_pk_bf16_f32 v114, v50, v51
    v_cvt_pk_bf16_f32 v115, v52, v53
    ds_write_b128 v12, v[112:115] offset:0
    v_dot2_f32_bf16 v46, v116, s92, v44
    v_dot2_f32_bf16 v47, v116, s93, v44
    v_dot2_f32_bf16 v48, v117, s92, v44
    v_dot2_f32_bf16 v49, v117, s93, v44
    v_dot2_f32_bf16 v50, v118, s92, v44
    v_dot2_f32_bf16 v51, v118, s93, v44
    v_dot2_f32_bf16 v52, v119, s92, v44
    v_dot2_f32_bf16 v53, v119, s93, v44
    v_cvt_pk_bf16_f32 v116, v46, v47
    v_cvt_pk_bf16_f32 v117, v48, v49
    v_cvt_pk_bf16_f32 v118, v50, v51
    v_cvt_pk_bf16_f32 v119, v52, v53
    ds_write_b128 v12, v[116:119] offset:4096
    v_dot2_f32_bf16 v46, v120, s92, v44
    v_dot2_f32_bf16 v47, v120, s93, v44
    v_dot2_f32_bf16 v48, v121, s92, v44
    v_dot2_f32_bf16 v49, v121, s93, v44
    v_dot2_f32_bf16 v50, v122, s92, v44
    v_dot2_f32_bf16 v51, v122, s93, v44
    v_dot2_f32_bf16 v52, v123, s92, v44
    v_dot2_f32_bf16 v53, v123, s93, v44
    v_cvt_pk_bf16_f32 v120, v46, v47
    v_cvt_pk_bf16_f32 v121, v48, v49
    v_cvt_pk_bf16_f32 v122, v50, v51
    v_cvt_pk_bf16_f32 v123, v52, v53
    ds_write_b128 v12, v[120:123] offset:8192
    v_dot2_f32_bf16 v46, v124, s92, v44
    v_dot2_f32_bf16 v47, v124, s93, v44
    v_dot2_f32_bf16 v48, v125, s92, v44
    v_dot2_f32_bf16 v49, v125, s93, v44
    v_dot2_f32_bf16 v50, v126, s92, v44
    v_dot2_f32_bf16 v51, v126, s93, v44
    v_dot2_f32_bf16 v52, v127, s92, v44
    v_dot2_f32_bf16 v53, v127, s93, v44
    v_cvt_pk_bf16_f32 v124, v46, v47
    v_cvt_pk_bf16_f32 v125, v48, v49
    v_cvt_pk_bf16_f32 v126, v50, v51
    v_cvt_pk_bf16_f32 v127, v52, v53
    ds_write_b128 v12, v[124:127] offset:12288
    v_dot2_f32_bf16 v46, v128, s92, v44
    v_dot2_f32_bf16 v47, v128, s93, v44
    v_dot2_f32_bf16 v48, v129, s92, v44
    v_dot2_f32_bf16 v49, v129, s93, v44
    v_dot2_f32_bf16 v50, v130, s92, v44
    v_dot2_f32_bf16 v51, v130, s93, v44
    v_dot2_f32_bf16 v52, v131, s92, v44
    v_dot2_f32_bf16 v53, v131, s93, v44
    v_cvt_pk_bf16_f32 v128, v46, v47
    v_cvt_pk_bf16_f32 v129, v48, v49
    v_cvt_pk_bf16_f32 v130, v50, v51
    v_cvt_pk_bf16_f32 v131, v52, v53
    ds_write_b128 v12, v[128:131] offset:16384
    v_dot2_f32_bf16 v46, v132, s92, v44
    v_dot2_f32_bf16 v47, v132, s93, v44
    v_dot2_f32_bf16 v48, v133, s92, v44
    v_dot2_f32_bf16 v49, v133, s93, v44
    v_dot2_f32_bf16 v50, v134, s92, v44
    v_dot2_f32_bf16 v51, v134, s93, v44
    v_dot2_f32_bf16 v52, v135, s92, v44
    v_dot2_f32_bf16 v53, v135, s93, v44
    v_cvt_pk_bf16_f32 v132, v46, v47
    v_cvt_pk_bf16_f32 v133, v48, v49
    v_cvt_pk_bf16_f32 v134, v50, v51
    v_cvt_pk_bf16_f32 v135, v52, v53
    ds_write_b128 v12, v[132:135] offset:20480
    v_dot2_f32_bf16 v46, v136, s92, v44
    v_dot2_f32_bf16 v47, v136, s93, v44
    v_dot2_f32_bf16 v48, v137, s92, v44
    v_dot2_f32_bf16 v49, v137, s93, v44
    v_dot2_f32_bf16 v50, v138, s92, v44
    v_dot2_f32_bf16 v51, v138, s93, v44
    v_dot2_f32_bf16 v52, v139, s92, v44
    v_dot2_f32_bf16 v53, v139, s93, v44
    v_cvt_pk_bf16_f32 v136, v46, v47
    v_cvt_pk_bf16_f32 v137, v48, v49
    v_cvt_pk_bf16_f32 v138, v50, v51
    v_cvt_pk_bf16_f32 v139, v52, v53
    ds_write_b128 v12, v[136:139] offset:24576
    v_dot2_f32_bf16 v46, v140, s92, v44
    v_dot2_f32_bf16 v47, v140, s93, v44
    v_dot2_f32_bf16 v48, v141, s92, v44
    v_dot2_f32_bf16 v49, v141, s93, v44
    v_dot2_f32_bf16 v50, v142, s92, v44
    v_dot2_f32_bf16 v51, v142, s93, v44
    v_dot2_f32_bf16 v52, v143, s92, v44
    v_dot2_f32_bf16 v53, v143, s93, v44
    v_cvt_pk_bf16_f32 v140, v46, v47
    v_cvt_pk_bf16_f32 v141, v48, v49
    v_cvt_pk_bf16_f32 v142, v50, v51
    v_cvt_pk_bf16_f32 v143, v52, v53
    ds_write_b128 v12, v[140:143] offset:28672
    v_dot2_f32_bf16 v46, v144, s92, v44
    v_dot2_f32_bf16 v47, v144, s93, v44
    v_dot2_f32_bf16 v48, v145, s92, v44
    v_dot2_f32_bf16 v49, v145, s93, v44
    v_dot2_f32_bf16 v50, v146, s92, v44
    v_dot2_f32_bf16 v51, v146, s93, v44
    v_dot2_f32_bf16 v52, v147, s92, v44
    v_dot2_f32_bf16 v53, v147, s93, v44
    v_cvt_pk_bf16_f32 v144, v46, v47
    v_cvt_pk_bf16_f32 v145, v48, v49
    v_cvt_pk_bf16_f32 v146, v50, v51
    v_cvt_pk_bf16_f32 v147, v52, v53
    ds_write_b128 v12, v[144:147] offset:32768
    v_dot2_f32_bf16 v46, v148, s92, v45
    v_dot2_f32_bf16 v47, v148, s93, v45
    v_dot2_f32_bf16 v48, v149, s92, v45
    v_dot2_f32_bf16 v49, v149, s93, v45
    v_dot2_f32_bf16 v50, v150, s92, v45
    v_dot2_f32_bf16 v51, v150, s93, v45
    v_dot2_f32_bf16 v52, v151, s92, v45
    v_dot2_f32_bf16 v53, v151, s93, v45
    v_cvt_pk_bf16_f32 v148, v46, v47
    v_cvt_pk_bf16_f32 v149, v48, v49
    v_cvt_pk_bf16_f32 v150, v50, v51
    v_cvt_pk_bf16_f32 v151, v52, v53
    ds_write_b128 v13, v[148:151] offset:0
    v_dot2_f32_bf16 v46, v152, s92, v45
    v_dot2_f32_bf16 v47, v152, s93, v45
    v_dot2_f32_bf16 v48, v153, s92, v45
    v_dot2_f32_bf16 v49, v153, s93, v45
    v_dot2_f32_bf16 v50, v154, s92, v45
    v_dot2_f32_bf16 v51, v154, s93, v45
    v_dot2_f32_bf16 v52, v155, s92, v45
    v_dot2_f32_bf16 v53, v155, s93, v45
    v_cvt_pk_bf16_f32 v152, v46, v47
    v_cvt_pk_bf16_f32 v153, v48, v49
    v_cvt_pk_bf16_f32 v154, v50, v51
    v_cvt_pk_bf16_f32 v155, v52, v53
    ds_write_b128 v13, v[152:155] offset:4096
    v_dot2_f32_bf16 v46, v156, s92, v45
    v_dot2_f32_bf16 v47, v156, s93, v45
    v_dot2_f32_bf16 v48, v157, s92, v45
    v_dot2_f32_bf16 v49, v157, s93, v45
    v_dot2_f32_bf16 v50, v158, s92, v45
    v_dot2_f32_bf16 v51, v158, s93, v45
    v_dot2_f32_bf16 v52, v159, s92, v45
    v_dot2_f32_bf16 v53, v159, s93, v45
    v_cvt_pk_bf16_f32 v156, v46, v47
    v_cvt_pk_bf16_f32 v157, v48, v49
    v_cvt_pk_bf16_f32 v158, v50, v51
    v_cvt_pk_bf16_f32 v159, v52, v53
    ds_write_b128 v13, v[156:159] offset:8192
    v_dot2_f32_bf16 v46, v160, s92, v45
    v_dot2_f32_bf16 v47, v160, s93, v45
    v_dot2_f32_bf16 v48, v161, s92, v45
    v_dot2_f32_bf16 v49, v161, s93, v45
    v_dot2_f32_bf16 v50, v162, s92, v45
    v_dot2_f32_bf16 v51, v162, s93, v45
    v_dot2_f32_bf16 v52, v163, s92, v45
    v_dot2_f32_bf16 v53, v163, s93, v45
    v_cvt_pk_bf16_f32 v160, v46, v47
    v_cvt_pk_bf16_f32 v161, v48, v49
    v_cvt_pk_bf16_f32 v162, v50, v51
    v_cvt_pk_bf16_f32 v163, v52, v53
    ds_write_b128 v13, v[160:163] offset:12288
    v_dot2_f32_bf16 v46, v164, s92, v45
    v_dot2_f32_bf16 v47, v164, s93, v45
    v_dot2_f32_bf16 v48, v165, s92, v45
    v_dot2_f32_bf16 v49, v165, s93, v45
    v_dot2_f32_bf16 v50, v166, s92, v45
    v_dot2_f32_bf16 v51, v166, s93, v45
    v_dot2_f32_bf16 v52, v167, s92, v45
    v_dot2_f32_bf16 v53, v167, s93, v45
    v_cvt_pk_bf16_f32 v164, v46, v47
    v_cvt_pk_bf16_f32 v165, v48, v49
    v_cvt_pk_bf16_f32 v166, v50, v51
    v_cvt_pk_bf16_f32 v167, v52, v53
    ds_write_b128 v13, v[164:167] offset:16384
    v_dot2_f32_bf16 v46, v168, s92, v45
    v_dot2_f32_bf16 v47, v168, s93, v45
    v_dot2_f32_bf16 v48, v169, s92, v45
    v_dot2_f32_bf16 v49, v169, s93, v45
    v_dot2_f32_bf16 v50, v170, s92, v45
    v_dot2_f32_bf16 v51, v170, s93, v45
    v_dot2_f32_bf16 v52, v171, s92, v45
    v_dot2_f32_bf16 v53, v171, s93, v45
    v_cvt_pk_bf16_f32 v168, v46, v47
    v_cvt_pk_bf16_f32 v169, v48, v49
    v_cvt_pk_bf16_f32 v170, v50, v51
    v_cvt_pk_bf16_f32 v171, v52, v53
    ds_write_b128 v13, v[168:171] offset:20480
    v_dot2_f32_bf16 v46, v172, s92, v45
    v_dot2_f32_bf16 v47, v172, s93, v45
    v_dot2_f32_bf16 v48, v173, s92, v45
    v_dot2_f32_bf16 v49, v173, s93, v45
    v_dot2_f32_bf16 v50, v174, s92, v45
    v_dot2_f32_bf16 v51, v174, s93, v45
    v_dot2_f32_bf16 v52, v175, s92, v45
    v_dot2_f32_bf16 v53, v175, s93, v45
    v_cvt_pk_bf16_f32 v172, v46, v47
    v_cvt_pk_bf16_f32 v173, v48, v49
    v_cvt_pk_bf16_f32 v174, v50, v51
    v_cvt_pk_bf16_f32 v175, v52, v53
    ds_write_b128 v13, v[172:175] offset:24576
    v_dot2_f32_bf16 v46, v176, s92, v45
    v_dot2_f32_bf16 v47, v176, s93, v45
    v_dot2_f32_bf16 v48, v177, s92, v45
    v_dot2_f32_bf16 v49, v177, s93, v45
    v_dot2_f32_bf16 v50, v178, s92, v45
    v_dot2_f32_bf16 v51, v178, s93, v45
    v_dot2_f32_bf16 v52, v179, s92, v45
    v_dot2_f32_bf16 v53, v179, s93, v45
    v_cvt_pk_bf16_f32 v176, v46, v47
    v_cvt_pk_bf16_f32 v177, v48, v49
    v_cvt_pk_bf16_f32 v178, v50, v51
    v_cvt_pk_bf16_f32 v179, v52, v53
    ds_write_b128 v13, v[176:179] offset:28672
    v_dot2_f32_bf16 v46, v180, s92, v45
    v_dot2_f32_bf16 v47, v180, s93, v45
    v_dot2_f32_bf16 v48, v181, s92, v45
    v_dot2_f32_bf16 v49, v181, s93, v45
    v_dot2_f32_bf16 v50, v182, s92, v45
    v_dot2_f32_bf16 v51, v182, s93, v45
    v_dot2_f32_bf16 v52, v183, s92, v45
    v_dot2_f32_bf16 v53, v183, s93, v45
    v_cvt_pk_bf16_f32 v180, v46, v47
    v_cvt_pk_bf16_f32 v181, v48, v49
    v_cvt_pk_bf16_f32 v182, v50, v51
    v_cvt_pk_bf16_f32 v183, v52, v53
    ds_write_b128 v13, v[180:183] offset:32768
    s_waitcnt lgkmcnt(0)
    s_barrier
    ds_read_b128 v[112:115], v14 offset:0
    ds_read_b128 v[116:119], v15 offset:0
    ds_read_b128 v[120:123], v16 offset:2048
    ds_read_b128 v[124:127], v17 offset:2048
    ds_read_b128 v[128:131], v14 offset:4096
    ds_read_b128 v[132:135], v15 offset:4096
    ds_read_b128 v[136:139], v16 offset:6144
    ds_read_b128 v[140:143], v17 offset:6144
    ds_read_b128 v[144:147], v14 offset:8192
    ds_read_b128 v[148:151], v15 offset:8192
    ds_read_b128 v[152:155], v16 offset:10240
    ds_read_b128 v[156:159], v17 offset:10240
    ds_read_b128 v[160:163], v14 offset:12288
    ds_read_b128 v[164:167], v15 offset:12288
    ds_read_b128 v[168:171], v16 offset:14336
    ds_read_b128 v[172:175], v17 offset:14336
    ds_read_b128 v[176:179], v14 offset:16384
    ds_read_b128 v[180:183], v15 offset:16384
    ds_read_b128 v[184:187], v16 offset:18432
    ds_read_b128 v[188:191], v17 offset:18432
    ds_read_b128 v[192:195], v14 offset:20480
    ds_read_b128 v[196:199], v15 offset:20480
    ds_read_b128 v[200:203], v16 offset:22528
    ds_read_b128 v[204:207], v17 offset:22528
    ds_read_b128 v[208:211], v14 offset:24576
    ds_read_b128 v[212:215], v15 offset:24576
    ds_read_b128 v[216:219], v16 offset:26624
    ds_read_b128 v[220:223], v17 offset:26624
    ds_read_b128 v[224:227], v14 offset:28672
    ds_read_b128 v[228:231], v15 offset:28672
    ds_read_b128 v[232:235], v16 offset:30720
    ds_read_b128 v[236:239], v17 offset:30720
    ds_read_b128 v[240:243], v14 offset:32768
    ds_read_b128 v[244:247], v15 offset:32768
    ds_read_b128 v[248:251], v16 offset:34816
    ds_read_b128 v[252:255], v17 offset:34816
    s_waitcnt vmcnt(2)
    v_lshlrev_b32 v60, 16, v60
    s_waitcnt vmcnt(1)
    v_lshlrev_b32 v61, 16, v61
    s_waitcnt vmcnt(0)
    v_lshlrev_b32 v62, 16, v62
    v_mul_f32 v60, 0x3fb8aa3b, v60
    v_mul_f32 v61, 0x3fb8aa3b, v61
    v_mul_f32 v62, 0x3fb8aa3b, v62
    v_lshl_add_u32 v63, v0, 2, s74
    s_lshr_b32 s11, s4, 1
    s_mul_i32 s11, s11, 24576
    s_and_b32 s73, s4, 1
    s_lshl_b32 s73, s73, 6
    s_add_u32 s11, s11, s73
    s_add_u32 s11, s11, 21504
    s_mov_b64 vcc, s[94:95]
    s_waitcnt lgkmcnt(0)
    s_barrier
    ds_read_b64_tr_b16 v[64:65], v1 offset:49152
    ds_read_b64_tr_b16 v[66:67], v1 offset:49664
    ds_read_b64_tr_b16 v[68:69], v2 offset:49152
    ds_read_b64_tr_b16 v[70:71], v2 offset:49664
    ds_read_b64_tr_b16 v[72:73], v1 offset:53248
    ds_read_b64_tr_b16 v[74:75], v1 offset:53760
    ds_read_b64_tr_b16 v[76:77], v2 offset:53248
    ds_read_b64_tr_b16 v[78:79], v2 offset:53760
    s_add_u32 m0, s9, 0
    s_add_u32 s10, s15, 1179648
    buffer_load_dwordx4 v3, s[52:55], s10 offen lds
    s_add_u32 m0, s9, 8192
    s_add_u32 s10, s15, 1769472
    buffer_load_dwordx4 v3, s[52:55], s10 offen lds
    s_add_u32 m0, s9, 16384
    s_add_u32 s10, s15, 2359296
    buffer_load_dwordx4 v3, s[52:55], s10 offen lds
    s_add_u32 m0, s9, 24576
    s_add_u32 s10, s15, 2949120
    buffer_load_dwordx4 v3, s[52:55], s10 offen lds
    s_add_u32 m0, s9, 32768
    s_add_u32 s10, s15, 3538944
    buffer_load_dwordx4 v3, s[52:55], s10 offen lds
    v_lshlrev_b32 v44, 2, v8
    v_add_u32 v44, s11, v44
    ds_write2_b32 v44, v41, v40 offset0:0 offset1:32
    ds_write2_b32 v44, v43, v42 offset0:8 offset1:40
    ds_write_b32 v63, v60 offset:0
    ds_write_b32 v63, v61 offset:256
    ds_write_b32 v63, v62 offset:512
    v_and_b32 v63, 31, v0
    v_lshl_add_u32 v63, v63, 2, s75
    s_lshr_b32 s11, s7, 2
    s_lshl_b32 s11, s11, 6
    s_add_u32 s11, s11, 60
    s_cmp_eq_u32 s4, 0
    s_cselect_b32 s11, s11, 0x1000
    v_lshl_add_u32 v24, v0, 12, s11
    s_and_b32 s11, s7, 3
    s_lshl_b32 s11, s11, 3
    s_lshl_b32 s11, 1, s11
    v_mov_b32 v25, s11
    buffer_atomic_add v25, v24, s[68:71], 0 offen sc1
    s_barrier
    s_waitcnt lgkmcnt(11)
    v_mfma_f32_16x16x32_bf16 v[80:83], v[64:67], v[112:115], 0
    v_mfma_f32_16x16x32_bf16 v[88:91], v[64:67], v[116:119], 0
    ds_read_b64_tr_b16 v[64:65], v1 offset:57344
    s_add_u32 m0, s9, 40960
    s_add_u32 s10, s15, 4128768
    buffer_load_dwordx4 v3, s[52:55], s10 offen lds
    s_waitcnt lgkmcnt(10)
    v_mfma_f32_16x16x32_bf16 v[84:87], v[68:71], v[112:115], 0
    ds_read_b64_tr_b16 v[66:67], v1 offset:57856
    v_mfma_f32_16x16x32_bf16 v[92:95], v[68:71], v[116:119], 0
    ds_read_b64_tr_b16 v[68:69], v2 offset:57344
    s_waitcnt lgkmcnt(10)
    v_mfma_f32_16x16x32_bf16 v[80:83], v[72:75], v[120:123], v[80:83]
    ds_read_b64_tr_b16 v[70:71], v2 offset:57856
    v_mfma_f32_16x16x32_bf16 v[88:91], v[72:75], v[124:127], v[88:91]
    ds_read_b64_tr_b16 v[72:73], v1 offset:61440
    s_waitcnt lgkmcnt(10)
    v_mfma_f32_16x16x32_bf16 v[84:87], v[76:79], v[120:123], v[84:87]
    ds_read_b64_tr_b16 v[74:75], v1 offset:61952
    v_mfma_f32_16x16x32_bf16 v[92:95], v[76:79], v[124:127], v[92:95]
    ds_read_b64_tr_b16 v[76:77], v2 offset:61440
    ds_read_b64_tr_b16 v[78:79], v2 offset:61952
    s_waitcnt lgkmcnt(8)
    s_waitcnt vmcnt(6)
    s_barrier
    s_waitcnt lgkmcnt(6)
    v_mfma_f32_16x16x32_bf16 v[80:83], v[64:67], v[128:131], v[80:83]
    v_mfma_f32_16x16x32_bf16 v[88:91], v[64:67], v[132:135], v[88:91]
    ds_read_b64_tr_b16 v[64:65], v1 offset:0
    s_add_u32 m0, s9, 49152
    s_add_u32 s10, s15, 4718592
    buffer_load_dwordx4 v3, s[52:55], s10 offen lds
    s_waitcnt lgkmcnt(5)
    v_mfma_f32_16x16x32_bf16 v[84:87], v[68:71], v[128:131], v[84:87]
    ds_read_b64_tr_b16 v[66:67], v1 offset:512
    v_mfma_f32_16x16x32_bf16 v[92:95], v[68:71], v[132:135], v[92:95]
    ds_read_b64_tr_b16 v[68:69], v2 offset:0
    s_waitcnt lgkmcnt(5)
    v_mfma_f32_16x16x32_bf16 v[80:83], v[72:75], v[136:139], v[80:83]
    ds_read_b64_tr_b16 v[70:71], v2 offset:512
    v_mfma_f32_16x16x32_bf16 v[88:91], v[72:75], v[140:143], v[88:91]
    ds_read_b64_tr_b16 v[72:73], v1 offset:4096
    s_waitcnt lgkmcnt(5)
    v_mfma_f32_16x16x32_bf16 v[84:87], v[76:79], v[136:139], v[84:87]
    ds_read_b64_tr_b16 v[74:75], v1 offset:4608
    v_mfma_f32_16x16x32_bf16 v[92:95], v[76:79], v[140:143], v[92:95]
    ds_read_b64_tr_b16 v[76:77], v2 offset:4096
    ds_read_b64_tr_b16 v[78:79], v2 offset:4608
    s_waitcnt vmcnt(6)
    s_barrier
    s_waitcnt lgkmcnt(6)
    v_mfma_f32_16x16x32_bf16 v[80:83], v[64:67], v[144:147], v[80:83]
    v_mfma_f32_16x16x32_bf16 v[88:91], v[64:67], v[148:151], v[88:91]
    ds_read_b64_tr_b16 v[64:65], v1 offset:8192
    s_add_u32 m0, s9, 57344
    s_add_u32 s10, s15, 128
    buffer_load_dwordx4 v3, s[52:55], s10 offen lds
    ds_read2_b32 v[56:57], v63 offset0:0 offset1:32
    s_waitcnt lgkmcnt(6)
    v_mfma_f32_16x16x32_bf16 v[84:87], v[68:71], v[144:147], v[84:87]
    ds_read_b64_tr_b16 v[66:67], v1 offset:8704
    v_mfma_f32_16x16x32_bf16 v[92:95], v[68:71], v[148:151], v[92:95]
    ds_read_b64_tr_b16 v[68:69], v2 offset:8192
    v_and_b32 v62, 15, v0
    v_lshl_add_u32 v62, v62, 2, s75
    s_waitcnt lgkmcnt(6)
    v_mfma_f32_16x16x32_bf16 v[80:83], v[72:75], v[152:155], v[80:83]
    ds_read_b64_tr_b16 v[70:71], v2 offset:8704
    v_mfma_f32_16x16x32_bf16 v[88:91], v[72:75], v[156:159], v[88:91]
    ds_read_b64_tr_b16 v[72:73], v1 offset:12288
    ds_read2_b32 v[60:61], v62 offset0:0 offset1:16
    s_waitcnt lgkmcnt(7)
    v_mfma_f32_16x16x32_bf16 v[84:87], v[76:79], v[152:155], v[84:87]
    ds_read_b64_tr_b16 v[74:75], v1 offset:12800
    v_mfma_f32_16x16x32_bf16 v[92:95], v[76:79], v[156:159], v[92:95]
    ds_read_b64_tr_b16 v[76:77], v2 offset:12288
    ds_read_b64_tr_b16 v[78:79], v2 offset:12800
    s_waitcnt vmcnt(6)
    s_barrier
    s_waitcnt lgkmcnt(7)
    v_mfma_f32_16x16x32_bf16 v[80:83], v[64:67], v[160:163], v[80:83]
    v_mfma_f32_16x16x32_bf16 v[88:91], v[64:67], v[164:167], v[88:91]
    ds_read_b64_tr_b16 v[64:65], v1 offset:16384
    s_add_u32 m0, s9, 0
    s_add_u32 s10, s15, 589952
    buffer_load_dwordx4 v3, s[52:55], s10 offen lds
    s_waitcnt lgkmcnt(6)
    v_mfma_f32_16x16x32_bf16 v[84:87], v[68:71], v[160:163], v[84:87]
    ds_read_b64_tr_b16 v[66:67], v1 offset:16896
    v_mfma_f32_16x16x32_bf16 v[92:95], v[68:71], v[164:167], v[92:95]
    ds_read_b64_tr_b16 v[68:69], v2 offset:16384
    s_waitcnt lgkmcnt(5)
    v_mfma_f32_16x16x32_bf16 v[80:83], v[72:75], v[168:171], v[80:83]
    ds_read_b64_tr_b16 v[70:71], v2 offset:16896
    v_mfma_f32_16x16x32_bf16 v[88:91], v[72:75], v[172:175], v[88:91]
    ds_read_b64_tr_b16 v[72:73], v1 offset:20480
    s_waitcnt lgkmcnt(5)
    v_mfma_f32_16x16x32_bf16 v[84:87], v[76:79], v[168:171], v[84:87]
    ds_read_b64_tr_b16 v[74:75], v1 offset:20992
    v_mfma_f32_16x16x32_bf16 v[92:95], v[76:79], v[172:175], v[92:95]
    ds_read_b64_tr_b16 v[76:77], v2 offset:20480
    ds_read_b64_tr_b16 v[78:79], v2 offset:20992
    s_waitcnt vmcnt(6)
    s_barrier
    s_waitcnt lgkmcnt(6)
    v_mfma_f32_16x16x32_bf16 v[80:83], v[64:67], v[176:179], v[80:83]
    v_mfma_f32_16x16x32_bf16 v[88:91], v[64:67], v[180:183], v[88:91]
    ds_read_b64_tr_b16 v[64:65], v1 offset:24576
    s_add_u32 m0, s9, 8192
    s_add_u32 s10, s15, 1179776
    buffer_load_dwordx4 v3, s[52:55], s10 offen lds
    s_waitcnt lgkmcnt(5)
    v_mfma_f32_16x16x32_bf16 v[84:87], v[68:71], v[176:179], v[84:87]
    ds_read_b64_tr_b16 v[66:67], v1 offset:25088
    v_mfma_f32_16x16x32_bf16 v[92:95], v[68:71], v[180:183], v[92:95]
    ds_read_b64_tr_b16 v[68:69], v2 offset:24576
    v_mul_f32 v60, 0x3fb8aa3b, v60
    v_mul_f32 v61, 0x3fb8aa3b, v61
    s_waitcnt lgkmcnt(5)
    v_mfma_f32_16x16x32_bf16 v[80:83], v[72:75], v[184:187], v[80:83]
    ds_read_b64_tr_b16 v[70:71], v2 offset:25088
    v_mfma_f32_16x16x32_bf16 v[88:91], v[72:75], v[188:191], v[88:91]
    ds_read_b64_tr_b16 v[72:73], v1 offset:28672
    s_waitcnt lgkmcnt(5)
    v_mfma_f32_16x16x32_bf16 v[84:87], v[76:79], v[184:187], v[84:87]
    ds_read_b64_tr_b16 v[74:75], v1 offset:29184
    v_mfma_f32_16x16x32_bf16 v[92:95], v[76:79], v[188:191], v[92:95]
    ds_read_b64_tr_b16 v[76:77], v2 offset:28672
    ds_read_b64_tr_b16 v[78:79], v2 offset:29184
    s_waitcnt vmcnt(6)
    s_barrier
    s_waitcnt lgkmcnt(6)
    v_mfma_f32_16x16x32_bf16 v[80:83], v[64:67], v[192:195], v[80:83]
    v_mfma_f32_16x16x32_bf16 v[88:91], v[64:67], v[196:199], v[88:91]
    ds_read_b64_tr_b16 v[64:65], v1 offset:32768
    s_add_u32 m0, s9, 16384
    s_add_u32 s10, s15, 1769600
    buffer_load_dwordx4 v3, s[52:55], s10 offen lds
    s_waitcnt lgkmcnt(5)
    v_mfma_f32_16x16x32_bf16 v[84:87], v[68:71], v[192:195], v[84:87]
    ds_read_b64_tr_b16 v[66:67], v1 offset:33280
    v_mfma_f32_16x16x32_bf16 v[92:95], v[68:71], v[196:199], v[92:95]
    ds_read_b64_tr_b16 v[68:69], v2 offset:32768
    s_waitcnt lgkmcnt(5)
    v_mfma_f32_16x16x32_bf16 v[80:83], v[72:75], v[200:203], v[80:83]
    ds_read_b64_tr_b16 v[70:71], v2 offset:33280
    v_mfma_f32_16x16x32_bf16 v[88:91], v[72:75], v[204:207], v[88:91]
    ds_read_b64_tr_b16 v[72:73], v1 offset:36864
    s_waitcnt lgkmcnt(5)
    v_mfma_f32_16x16x32_bf16 v[84:87], v[76:79], v[200:203], v[84:87]
    ds_read_b64_tr_b16 v[74:75], v1 offset:37376
    v_mfma_f32_16x16x32_bf16 v[92:95], v[76:79], v[204:207], v[92:95]
    ds_read_b64_tr_b16 v[76:77], v2 offset:36864
    ds_read_b64_tr_b16 v[78:79], v2 offset:37376
    s_waitcnt vmcnt(5)
    s_barrier
    s_waitcnt lgkmcnt(6)
    v_mfma_f32_16x16x32_bf16 v[80:83], v[64:67], v[208:211], v[80:83]
    v_mfma_f32_16x16x32_bf16 v[88:91], v[64:67], v[212:215], v[88:91]
    ds_read_b64_tr_b16 v[64:65], v1 offset:40960
    s_add_u32 m0, s9, 24576
    s_add_u32 s10, s15, 2359424
    buffer_load_dwordx4 v3, s[52:55], s10 offen lds
    s_waitcnt lgkmcnt(5)
    v_mfma_f32_16x16x32_bf16 v[84:87], v[68:71], v[208:211], v[84:87]
    ds_read_b64_tr_b16 v[66:67], v1 offset:41472
    v_mfma_f32_16x16x32_bf16 v[92:95], v[68:71], v[212:215], v[92:95]
    ds_read_b64_tr_b16 v[68:69], v2 offset:40960
    s_waitcnt lgkmcnt(5)
    v_mfma_f32_16x16x32_bf16 v[80:83], v[72:75], v[216:219], v[80:83]
    ds_read_b64_tr_b16 v[70:71], v2 offset:41472
    v_mfma_f32_16x16x32_bf16 v[88:91], v[72:75], v[220:223], v[88:91]
    ds_read_b64_tr_b16 v[72:73], v1 offset:45056
    s_waitcnt lgkmcnt(5)
    v_mfma_f32_16x16x32_bf16 v[84:87], v[76:79], v[216:219], v[84:87]
    ds_read_b64_tr_b16 v[74:75], v1 offset:45568
    v_mfma_f32_16x16x32_bf16 v[92:95], v[76:79], v[220:223], v[92:95]
    ds_read_b64_tr_b16 v[76:77], v2 offset:45056
    ds_read_b64_tr_b16 v[78:79], v2 offset:45568
    s_waitcnt vmcnt(5)
    s_barrier
    s_waitcnt lgkmcnt(6)
    v_mfma_f32_16x16x32_bf16 v[80:83], v[64:67], v[224:227], v[80:83]
    v_mfma_f32_16x16x32_bf16 v[88:91], v[64:67], v[228:231], v[88:91]
    ds_read_b64_tr_b16 v[64:65], v1 offset:49152
    s_add_u32 m0, s9, 32768
    s_add_u32 s10, s15, 2949248
    buffer_load_dwordx4 v3, s[52:55], s10 offen lds
    s_waitcnt lgkmcnt(5)
    v_mfma_f32_16x16x32_bf16 v[84:87], v[68:71], v[224:227], v[84:87]
    ds_read_b64_tr_b16 v[66:67], v1 offset:49664
    v_mfma_f32_16x16x32_bf16 v[92:95], v[68:71], v[228:231], v[92:95]
    ds_read_b64_tr_b16 v[68:69], v2 offset:49152
    s_waitcnt lgkmcnt(5)
    v_mfma_f32_16x16x32_bf16 v[80:83], v[72:75], v[232:235], v[80:83]
    ds_read_b64_tr_b16 v[70:71], v2 offset:49664
    v_mfma_f32_16x16x32_bf16 v[88:91], v[72:75], v[236:239], v[88:91]
    ds_read_b64_tr_b16 v[72:73], v1 offset:53248
    s_waitcnt lgkmcnt(5)
    v_mfma_f32_16x16x32_bf16 v[84:87], v[76:79], v[232:235], v[84:87]
    ds_read_b64_tr_b16 v[74:75], v1 offset:53760
    v_mfma_f32_16x16x32_bf16 v[92:95], v[76:79], v[236:239], v[92:95]
    ds_read_b64_tr_b16 v[76:77], v2 offset:53248
    ds_read_b64_tr_b16 v[78:79], v2 offset:53760
    s_waitcnt vmcnt(5)
    s_barrier
    s_waitcnt lgkmcnt(6)
    v_mfma_f32_16x16x32_bf16 v[80:83], v[64:67], v[240:243], v[80:83]
    v_mfma_f32_16x16x32_bf16 v[88:91], v[64:67], v[244:247], v[88:91]
    ds_read_b64_tr_b16 v[64:65], v1 offset:57344
    s_add_u32 m0, s9, 40960
    s_add_u32 s10, s15, 3539072
    buffer_load_dwordx4 v3, s[52:55], s10 offen lds
    s_waitcnt lgkmcnt(5)
    v_mfma_f32_16x16x32_bf16 v[84:87], v[68:71], v[240:243], v[84:87]
    ds_read_b64_tr_b16 v[66:67], v1 offset:57856
    v_mfma_f32_16x16x32_bf16 v[92:95], v[68:71], v[244:247], v[92:95]
    ds_read_b64_tr_b16 v[68:69], v2 offset:57344
    s_waitcnt lgkmcnt(5)
    v_mfma_f32_16x16x32_bf16 v[80:83], v[72:75], v[248:251], v[80:83]
    ds_read_b64_tr_b16 v[70:71], v2 offset:57856
    v_mfma_f32_16x16x32_bf16 v[88:91], v[72:75], v[252:255], v[88:91]
    ds_read_b64_tr_b16 v[72:73], v1 offset:61440
    s_waitcnt lgkmcnt(5)
    v_mfma_f32_16x16x32_bf16 v[84:87], v[76:79], v[248:251], v[84:87]
    ds_read_b64_tr_b16 v[74:75], v1 offset:61952
    v_mfma_f32_16x16x32_bf16 v[92:95], v[76:79], v[252:255], v[92:95]
    ds_read_b64_tr_b16 v[76:77], v2 offset:61440
    ds_read_b64_tr_b16 v[78:79], v2 offset:61952
    s_waitcnt vmcnt(5)
    s_barrier
    s_waitcnt lgkmcnt(6)
    v_mfma_f32_16x16x32_bf16 v[96:99], v[64:67], v[112:115], 0
    v_mfma_f32_16x16x32_bf16 v[104:107], v[64:67], v[116:119], 0
    ds_read_b64_tr_b16 v[64:65], v1 offset:0
    s_add_u32 m0, s9, 49152
    s_add_u32 s10, s15, 4128896
    buffer_load_dwordx4 v3, s[52:55], s10 offen lds
    s_waitcnt lgkmcnt(5)
    v_mfma_f32_16x16x32_bf16 v[100:103], v[68:71], v[112:115], 0
    ds_read_b64_tr_b16 v[66:67], v1 offset:512
    v_mfma_f32_16x16x32_bf16 v[108:111], v[68:71], v[116:119], 0
    ds_read_b64_tr_b16 v[68:69], v2 offset:0
    ds_read_b128 v[8:11], v59 offset:0
    ds_read_b128 v[12:15], v59 offset:32
    s_waitcnt lgkmcnt(1)
    v_mfma_f32_16x16x32_bf16 v[96:99], v[72:75], v[120:123], v[96:99]
    ds_read_b64_tr_b16 v[70:71], v2 offset:512
    v_fma_f32 v16, v80, v60, v8
    v_fma_f32 v17, v81, v60, v9
    v_mfma_f32_16x16x32_bf16 v[104:107], v[72:75], v[124:127], v[104:107]
    ds_read_b64_tr_b16 v[72:73], v1 offset:4096
    v_fma_f32 v18, v82, v60, v10
    v_mfma_f32_16x16x32_bf16 v[100:103], v[76:79], v[120:123], v[100:103]
    ds_read_b64_tr_b16 v[74:75], v1 offset:4608
    v_fma_f32 v19, v83, v60, v11
    v_exp_f32 v32, v16
    v_mfma_f32_16x16x32_bf16 v[108:111], v[76:79], v[124:127], v[108:111]
    ds_read_b64_tr_b16 v[76:77], v2 offset:4096
    ds_read_b64_tr_b16 v[78:79], v2 offset:4608
    v_exp_f32 v33, v17
    v_exp_f32 v34, v18
    s_waitcnt vmcnt(5)
    s_barrier
    v_mfma_f32_16x16x32_bf16 v[96:99], v[64:67], v[128:131], v[96:99]
    v_exp_f32 v35, v19
    v_fma_f32 v36, v32, -0.5, -1.0
    v_mfma_f32_16x16x32_bf16 v[104:107], v[64:67], v[132:135], v[104:107]
    ds_read_b64_tr_b16 v[64:65], v1 offset:8192
    s_add_u32 m0, s9, 57344
    s_add_u32 s10, s15, 4718720
    buffer_load_dwordx4 v3, s[52:55], s10 offen lds
    v_fma_f32 v37, v33, -0.5, -1.0
    s_waitcnt lgkmcnt(5)
    v_mfma_f32_16x16x32_bf16 v[100:103], v[68:71], v[128:131], v[100:103]
    ds_read_b64_tr_b16 v[66:67], v1 offset:8704
    v_fma_f32 v38, v34, -0.5, -1.0
    v_fma_f32 v39, v35, -0.5, -1.0
    v_mfma_f32_16x16x32_bf16 v[108:111], v[68:71], v[132:135], v[108:111]
    ds_read_b64_tr_b16 v[68:69], v2 offset:8192
    v_fma_f32 v36, v32, v36, -1.0
    s_waitcnt lgkmcnt(5)
    v_mfma_f32_16x16x32_bf16 v[96:99], v[72:75], v[136:139], v[96:99]
    ds_read_b64_tr_b16 v[70:71], v2 offset:8704
    v_fma_f32 v37, v33, v37, -1.0
    v_fma_f32 v38, v34, v38, -1.0
    v_mfma_f32_16x16x32_bf16 v[104:107], v[72:75], v[140:143], v[104:107]
    ds_read_b64_tr_b16 v[72:73], v1 offset:12288
    v_fma_f32 v39, v35, v39, -1.0
    v_rcp_f32 v36, v36
    s_waitcnt lgkmcnt(5)
    v_mfma_f32_16x16x32_bf16 v[100:103], v[76:79], v[136:139], v[100:103]
    ds_read_b64_tr_b16 v[74:75], v1 offset:12800
    v_rcp_f32 v37, v37
    v_rcp_f32 v38, v38
    v_mfma_f32_16x16x32_bf16 v[108:111], v[76:79], v[140:143], v[108:111]
    ds_read_b64_tr_b16 v[76:77], v2 offset:12288
    ds_read_b64_tr_b16 v[78:79], v2 offset:12800
    v_rcp_f32 v39, v39
    s_waitcnt vmcnt(5)
    s_barrier
    s_waitcnt lgkmcnt(6)
    v_mfma_f32_16x16x32_bf16 v[96:99], v[64:67], v[144:147], v[96:99]
    v_fmac_f32 v16, v16, v36
    v_fmac_f32 v17, v17, v37
    v_mfma_f32_16x16x32_bf16 v[104:107], v[64:67], v[148:151], v[104:107]
    ds_read_b64_tr_b16 v[64:65], v1 offset:16384
    s_add_u32 m0, s9, 0
    s_add_u32 s10, s15, 256
    buffer_load_dwordx4 v3, s[52:55], s10 offen lds
    v_fmac_f32 v18, v18, v38
    s_waitcnt lgkmcnt(5)
    v_mfma_f32_16x16x32_bf16 v[100:103], v[68:71], v[144:147], v[100:103]
    ds_read_b64_tr_b16 v[66:67], v1 offset:16896
    v_fmac_f32 v19, v19, v39
    v_cvt_pk_bf16_f32 v24, v16, v17
    v_mfma_f32_16x16x32_bf16 v[108:111], v[68:71], v[148:151], v[108:111]
    ds_read_b64_tr_b16 v[68:69], v2 offset:16384
    v_cvt_pk_bf16_f32 v25, v18, v19
    s_waitcnt lgkmcnt(5)
    v_mfma_f32_16x16x32_bf16 v[96:99], v[72:75], v[152:155], v[96:99]
    ds_read_b64_tr_b16 v[70:71], v2 offset:16896
    v_fma_f32 v20, v84, v60, v12
    v_fma_f32 v21, v85, v60, v13
    v_mfma_f32_16x16x32_bf16 v[104:107], v[72:75], v[156:159], v[104:107]
    ds_read_b64_tr_b16 v[72:73], v1 offset:20480
    v_fma_f32 v22, v86, v60, v14
    s_waitcnt lgkmcnt(5)
    v_mfma_f32_16x16x32_bf16 v[100:103], v[76:79], v[152:155], v[100:103]
    ds_read_b64_tr_b16 v[74:75], v1 offset:20992
    v_fma_f32 v23, v87, v60, v15
    v_exp_f32 v40, v20
    v_mfma_f32_16x16x32_bf16 v[108:111], v[76:79], v[156:159], v[108:111]
    ds_read_b64_tr_b16 v[76:77], v2 offset:20480
    ds_read_b64_tr_b16 v[78:79], v2 offset:20992
    v_exp_f32 v41, v21
    s_waitcnt vmcnt(5)
    s_barrier
    s_waitcnt lgkmcnt(6)
    v_mfma_f32_16x16x32_bf16 v[96:99], v[64:67], v[160:163], v[96:99]
    v_exp_f32 v42, v22
    v_exp_f32 v43, v23
    v_mfma_f32_16x16x32_bf16 v[104:107], v[64:67], v[164:167], v[104:107]
    ds_read_b64_tr_b16 v[64:65], v1 offset:24576
    s_add_u32 m0, s9, 8192
    s_add_u32 s10, s15, 590080
    buffer_load_dwordx4 v3, s[52:55], s10 offen lds
    v_fma_f32 v44, v40, -0.5, -1.0
    v_fma_f32 v45, v41, -0.5, -1.0
    s_waitcnt lgkmcnt(5)
    v_mfma_f32_16x16x32_bf16 v[100:103], v[68:71], v[160:163], v[100:103]
    ds_read_b64_tr_b16 v[66:67], v1 offset:25088
    v_fma_f32 v46, v42, -0.5, -1.0
    v_fma_f32 v47, v43, -0.5, -1.0
    v_mfma_f32_16x16x32_bf16 v[108:111], v[68:71], v[164:167], v[108:111]
    ds_read_b64_tr_b16 v[68:69], v2 offset:24576
    v_fma_f32 v44, v40, v44, -1.0
    s_waitcnt lgkmcnt(5)
    v_mfma_f32_16x16x32_bf16 v[96:99], v[72:75], v[168:171], v[96:99]
    ds_read_b64_tr_b16 v[70:71], v2 offset:25088
    v_fma_f32 v45, v41, v45, -1.0
    v_fma_f32 v46, v42, v46, -1.0
    v_mfma_f32_16x16x32_bf16 v[104:107], v[72:75], v[172:175], v[104:107]
    ds_read_b64_tr_b16 v[72:73], v1 offset:28672
    v_fma_f32 v47, v43, v47, -1.0
    v_rcp_f32 v44, v44
    s_waitcnt lgkmcnt(5)
    v_mfma_f32_16x16x32_bf16 v[100:103], v[76:79], v[168:171], v[100:103]
    ds_read_b64_tr_b16 v[74:75], v1 offset:29184
    v_rcp_f32 v45, v45
    v_rcp_f32 v46, v46
    v_mfma_f32_16x16x32_bf16 v[108:111], v[76:79], v[172:175], v[108:111]
    ds_read_b64_tr_b16 v[76:77], v2 offset:28672
    ds_read_b64_tr_b16 v[78:79], v2 offset:29184
    v_rcp_f32 v47, v47
    s_waitcnt vmcnt(5)
    s_barrier
    s_waitcnt lgkmcnt(6)
    v_mfma_f32_16x16x32_bf16 v[96:99], v[64:67], v[176:179], v[96:99]
    v_fmac_f32 v20, v20, v44
    v_fmac_f32 v21, v21, v45
    v_mfma_f32_16x16x32_bf16 v[104:107], v[64:67], v[180:183], v[104:107]
    ds_read_b64_tr_b16 v[64:65], v1 offset:32768
    s_add_u32 m0, s9, 16384
    s_add_u32 s10, s15, 1179904
    buffer_load_dwordx4 v3, s[52:55], s10 offen lds
    v_fmac_f32 v22, v22, v46
    s_waitcnt lgkmcnt(5)
    v_mfma_f32_16x16x32_bf16 v[100:103], v[68:71], v[176:179], v[100:103]
    ds_read_b64_tr_b16 v[66:67], v1 offset:33280
    v_fmac_f32 v23, v23, v47
    v_cvt_pk_bf16_f32 v26, v20, v21
    v_mfma_f32_16x16x32_bf16 v[108:111], v[68:71], v[180:183], v[108:111]
    ds_read_b64_tr_b16 v[68:69], v2 offset:32768
    v_cvt_pk_bf16_f32 v27, v22, v23
    ds_write_b128 v6, v[24:27] offset:0
    s_waitcnt lgkmcnt(6)
    v_mfma_f32_16x16x32_bf16 v[96:99], v[72:75], v[184:187], v[96:99]
    ds_read_b64_tr_b16 v[70:71], v2 offset:33280
    v_fma_f32 v16, v88, v61, v8
    v_fma_f32 v17, v89, v61, v9
    v_mfma_f32_16x16x32_bf16 v[104:107], v[72:75], v[188:191], v[104:107]
    ds_read_b64_tr_b16 v[72:73], v1 offset:36864
    v_fma_f32 v18, v90, v61, v10
    s_waitcnt lgkmcnt(6)
    v_mfma_f32_16x16x32_bf16 v[100:103], v[76:79], v[184:187], v[100:103]
    ds_read_b64_tr_b16 v[74:75], v1 offset:37376
    v_fma_f32 v19, v91, v61, v11
    v_exp_f32 v32, v16
    v_mfma_f32_16x16x32_bf16 v[108:111], v[76:79], v[188:191], v[108:111]
    ds_read_b64_tr_b16 v[76:77], v2 offset:36864
    ds_read_b64_tr_b16 v[78:79], v2 offset:37376
    v_exp_f32 v33, v17
    s_waitcnt vmcnt(5)
    s_barrier
    s_waitcnt lgkmcnt(7)
    v_mfma_f32_16x16x32_bf16 v[96:99], v[64:67], v[192:195], v[96:99]
    v_exp_f32 v34, v18
    v_exp_f32 v35, v19
    v_mfma_f32_16x16x32_bf16 v[104:107], v[64:67], v[196:199], v[104:107]
    ds_read_b64_tr_b16 v[64:65], v1 offset:40960
    s_add_u32 m0, s9, 24576
    s_add_u32 s10, s15, 1769728
    buffer_load_dwordx4 v3, s[52:55], s10 offen lds
    v_fma_f32 v36, v32, -0.5, -1.0
    v_fma_f32 v37, v33, -0.5, -1.0
    s_waitcnt lgkmcnt(5)
    v_mfma_f32_16x16x32_bf16 v[100:103], v[68:71], v[192:195], v[100:103]
    ds_read_b64_tr_b16 v[66:67], v1 offset:41472
    v_fma_f32 v38, v34, -0.5, -1.0
    v_fma_f32 v39, v35, -0.5, -1.0
    v_mfma_f32_16x16x32_bf16 v[108:111], v[68:71], v[196:199], v[108:111]
    ds_read_b64_tr_b16 v[68:69], v2 offset:40960
    v_fma_f32 v36, v32, v36, -1.0
    s_waitcnt lgkmcnt(5)
    v_mfma_f32_16x16x32_bf16 v[96:99], v[72:75], v[200:203], v[96:99]
    ds_read_b64_tr_b16 v[70:71], v2 offset:41472
    v_fma_f32 v37, v33, v37, -1.0
    v_fma_f32 v38, v34, v38, -1.0
    v_mfma_f32_16x16x32_bf16 v[104:107], v[72:75], v[204:207], v[104:107]
    ds_read_b64_tr_b16 v[72:73], v1 offset:45056
    v_fma_f32 v39, v35, v39, -1.0
    s_waitcnt lgkmcnt(5)
    v_mfma_f32_16x16x32_bf16 v[100:103], v[76:79], v[200:203], v[100:103]
    ds_read_b64_tr_b16 v[74:75], v1 offset:45568
    v_rcp_f32 v36, v36
    v_rcp_f32 v37, v37
    v_mfma_f32_16x16x32_bf16 v[108:111], v[76:79], v[204:207], v[108:111]
    ds_read_b64_tr_b16 v[76:77], v2 offset:45056
    ds_read_b64_tr_b16 v[78:79], v2 offset:45568
    v_rcp_f32 v38, v38
    v_rcp_f32 v39, v39
    s_waitcnt vmcnt(5)
    s_barrier
    s_waitcnt lgkmcnt(6)
    v_mfma_f32_16x16x32_bf16 v[96:99], v[64:67], v[208:211], v[96:99]
    v_fmac_f32 v16, v16, v36
    v_fmac_f32 v17, v17, v37
    v_mfma_f32_16x16x32_bf16 v[104:107], v[64:67], v[212:215], v[104:107]
    ds_read_b64_tr_b16 v[64:65], v1 offset:49152
    s_add_u32 m0, s9, 32768
    s_add_u32 s10, s15, 2359552
    buffer_load_dwordx4 v3, s[52:55], s10 offen lds
    v_fmac_f32 v18, v18, v38
    s_waitcnt lgkmcnt(5)
    v_mfma_f32_16x16x32_bf16 v[100:103], v[68:71], v[208:211], v[100:103]
    ds_read_b64_tr_b16 v[66:67], v1 offset:49664
    v_fmac_f32 v19, v19, v39
    v_cvt_pk_bf16_f32 v28, v16, v17
    v_mfma_f32_16x16x32_bf16 v[108:111], v[68:71], v[212:215], v[108:111]
    ds_read_b64_tr_b16 v[68:69], v2 offset:49152
    v_cvt_pk_bf16_f32 v29, v18, v19
    v_fma_f32 v20, v92, v61, v12
    s_waitcnt lgkmcnt(5)
    v_mfma_f32_16x16x32_bf16 v[96:99], v[72:75], v[216:219], v[96:99]
    ds_read_b64_tr_b16 v[70:71], v2 offset:49664
    v_fma_f32 v21, v93, v61, v13
    v_fma_f32 v22, v94, v61, v14
    v_mfma_f32_16x16x32_bf16 v[104:107], v[72:75], v[220:223], v[104:107]
    ds_read_b64_tr_b16 v[72:73], v1 offset:53248
    v_fma_f32 v23, v95, v61, v15
    s_waitcnt lgkmcnt(5)
    v_mfma_f32_16x16x32_bf16 v[100:103], v[76:79], v[216:219], v[100:103]
    ds_read_b64_tr_b16 v[74:75], v1 offset:53760
    v_exp_f32 v40, v20
    v_exp_f32 v41, v21
    v_mfma_f32_16x16x32_bf16 v[108:111], v[76:79], v[220:223], v[108:111]
    ds_read_b64_tr_b16 v[76:77], v2 offset:53248
    ds_read_b64_tr_b16 v[78:79], v2 offset:53760
    v_exp_f32 v42, v22
    s_waitcnt vmcnt(5)
    s_barrier
    s_waitcnt lgkmcnt(6)
    v_mfma_f32_16x16x32_bf16 v[96:99], v[64:67], v[224:227], v[96:99]
    v_exp_f32 v43, v23
    v_fma_f32 v44, v40, -0.5, -1.0
    v_mfma_f32_16x16x32_bf16 v[104:107], v[64:67], v[228:231], v[104:107]
    ds_read_b64_tr_b16 v[64:65], v1 offset:57344
    s_add_u32 m0, s9, 40960
    s_add_u32 s10, s15, 2949376
    buffer_load_dwordx4 v3, s[52:55], s10 offen lds
    v_fma_f32 v45, v41, -0.5, -1.0
    v_fma_f32 v46, v42, -0.5, -1.0
    s_waitcnt lgkmcnt(5)
    v_mfma_f32_16x16x32_bf16 v[100:103], v[68:71], v[224:227], v[100:103]
    ds_read_b64_tr_b16 v[66:67], v1 offset:57856
    v_fma_f32 v47, v43, -0.5, -1.0
    v_fma_f32 v44, v40, v44, -1.0
    v_mfma_f32_16x16x32_bf16 v[108:111], v[68:71], v[228:231], v[108:111]
    ds_read_b64_tr_b16 v[68:69], v2 offset:57344
    v_fma_f32 v45, v41, v45, -1.0
    s_waitcnt lgkmcnt(5)
    v_mfma_f32_16x16x32_bf16 v[96:99], v[72:75], v[232:235], v[96:99]
    ds_read_b64_tr_b16 v[70:71], v2 offset:57856
    v_fma_f32 v46, v42, v46, -1.0
    v_fma_f32 v47, v43, v47, -1.0
    v_mfma_f32_16x16x32_bf16 v[104:107], v[72:75], v[236:239], v[104:107]
    ds_read_b64_tr_b16 v[72:73], v1 offset:61440
    v_rcp_f32 v44, v44
    s_waitcnt lgkmcnt(5)
    v_mfma_f32_16x16x32_bf16 v[100:103], v[76:79], v[232:235], v[100:103]
    ds_read_b64_tr_b16 v[74:75], v1 offset:61952
    v_rcp_f32 v45, v45
    v_rcp_f32 v46, v46
    v_mfma_f32_16x16x32_bf16 v[108:111], v[76:79], v[236:239], v[108:111]
    ds_read_b64_tr_b16 v[76:77], v2 offset:61440
    ds_read_b64_tr_b16 v[78:79], v2 offset:61952
    v_rcp_f32 v47, v47
    v_fmac_f32 v20, v20, v44
    s_waitcnt vmcnt(5)
    s_barrier
    s_waitcnt lgkmcnt(6)
    v_mfma_f32_16x16x32_bf16 v[96:99], v[64:67], v[240:243], v[96:99]
    v_fmac_f32 v21, v21, v45
    v_fmac_f32 v22, v22, v46
    v_mfma_f32_16x16x32_bf16 v[104:107], v[64:67], v[244:247], v[104:107]
    ds_read_b64_tr_b16 v[64:65], v1 offset:0
    s_add_u32 m0, s9, 49152
    s_add_u32 s10, s15, 3539200
    buffer_load_dwordx4 v3, s[52:55], s10 offen lds
    v_fmac_f32 v23, v23, v47
    s_waitcnt lgkmcnt(5)
    v_mfma_f32_16x16x32_bf16 v[100:103], v[68:71], v[240:243], v[100:103]
    ds_read_b64_tr_b16 v[66:67], v1 offset:512
    v_cvt_pk_bf16_f32 v30, v20, v21
    v_cvt_pk_bf16_f32 v31, v22, v23
    v_mfma_f32_16x16x32_bf16 v[108:111], v[68:71], v[244:247], v[108:111]
    ds_read_b64_tr_b16 v[68:69], v2 offset:0
    ds_write_b128 v6, v[28:31] offset:1024
    s_waitcnt lgkmcnt(6)
    v_mfma_f32_16x16x32_bf16 v[96:99], v[72:75], v[248:251], v[96:99]
    ds_read_b64_tr_b16 v[70:71], v2 offset:512
    v_mfma_f32_16x16x32_bf16 v[104:107], v[72:75], v[252:255], v[104:107]
    ds_read_b64_tr_b16 v[72:73], v1 offset:4096
    s_waitcnt lgkmcnt(6)
    v_mfma_f32_16x16x32_bf16 v[100:103], v[76:79], v[248:251], v[100:103]
    ds_read_b64_tr_b16 v[74:75], v1 offset:4608
    v_mfma_f32_16x16x32_bf16 v[108:111], v[76:79], v[252:255], v[108:111]
    ds_read_b64_tr_b16 v[76:77], v2 offset:4096
    ds_read_b64_tr_b16 v[78:79], v2 offset:4608
    s_waitcnt vmcnt(5)
    s_barrier
    s_waitcnt lgkmcnt(7)
    v_mfma_f32_16x16x32_bf16 v[80:83], v[64:67], v[112:115], 0
    v_mfma_f32_16x16x32_bf16 v[88:91], v[64:67], v[116:119], 0
    ds_read_b64_tr_b16 v[64:65], v1 offset:8192
    s_add_u32 m0, s9, 57344
    s_add_u32 s10, s15, 4129024
    buffer_load_dwordx4 v3, s[52:55], s10 offen lds
    s_waitcnt lgkmcnt(5)
    v_mfma_f32_16x16x32_bf16 v[84:87], v[68:71], v[112:115], 0
    ds_read_b64_tr_b16 v[66:67], v1 offset:8704
    v_mfma_f32_16x16x32_bf16 v[92:95], v[68:71], v[116:119], 0
    ds_read_b64_tr_b16 v[68:69], v2 offset:8192
    ds_read_b128 v[8:11], v59 offset:128
    ds_read_b128 v[12:15], v59 offset:160
    s_waitcnt lgkmcnt(1)
    v_mfma_f32_16x16x32_bf16 v[80:83], v[72:75], v[120:123], v[80:83]
    ds_read_b64_tr_b16 v[70:71], v2 offset:8704
    v_fma_f32 v16, v96, v60, v8
    v_fma_f32 v17, v97, v60, v9
    v_mfma_f32_16x16x32_bf16 v[88:91], v[72:75], v[124:127], v[88:91]
    ds_read_b64_tr_b16 v[72:73], v1 offset:12288
    v_fma_f32 v18, v98, v60, v10
    v_mfma_f32_16x16x32_bf16 v[84:87], v[76:79], v[120:123], v[84:87]
    ds_read_b64_tr_b16 v[74:75], v1 offset:12800
    v_fma_f32 v19, v99, v60, v11
    v_exp_f32 v32, v16
    v_mfma_f32_16x16x32_bf16 v[92:95], v[76:79], v[124:127], v[92:95]
    ds_read_b64_tr_b16 v[76:77], v2 offset:12288
    ds_read_b64_tr_b16 v[78:79], v2 offset:12800
    v_exp_f32 v33, v17
    v_exp_f32 v34, v18
    s_waitcnt vmcnt(5)
    s_barrier
    v_mfma_f32_16x16x32_bf16 v[80:83], v[64:67], v[128:131], v[80:83]
    v_exp_f32 v35, v19
    v_fma_f32 v36, v32, -0.5, -1.0
    v_mfma_f32_16x16x32_bf16 v[88:91], v[64:67], v[132:135], v[88:91]
    ds_read_b64_tr_b16 v[64:65], v1 offset:16384
    s_add_u32 m0, s9, 0
    s_add_u32 s10, s15, 4718848
    buffer_load_dwordx4 v3, s[52:55], s10 offen lds
    v_fma_f32 v37, v33, -0.5, -1.0
    s_waitcnt lgkmcnt(5)
    v_mfma_f32_16x16x32_bf16 v[84:87], v[68:71], v[128:131], v[84:87]
    ds_read_b64_tr_b16 v[66:67], v1 offset:16896
    v_fma_f32 v38, v34, -0.5, -1.0
    v_fma_f32 v39, v35, -0.5, -1.0
    v_mfma_f32_16x16x32_bf16 v[92:95], v[68:71], v[132:135], v[92:95]
    ds_read_b64_tr_b16 v[68:69], v2 offset:16384
    v_fma_f32 v36, v32, v36, -1.0
    s_waitcnt lgkmcnt(5)
    v_mfma_f32_16x16x32_bf16 v[80:83], v[72:75], v[136:139], v[80:83]
    ds_read_b64_tr_b16 v[70:71], v2 offset:16896
    v_fma_f32 v37, v33, v37, -1.0
    v_fma_f32 v38, v34, v38, -1.0
    v_mfma_f32_16x16x32_bf16 v[88:91], v[72:75], v[140:143], v[88:91]
    ds_read_b64_tr_b16 v[72:73], v1 offset:20480
    v_fma_f32 v39, v35, v39, -1.0
    v_rcp_f32 v36, v36
    s_waitcnt lgkmcnt(5)
    v_mfma_f32_16x16x32_bf16 v[84:87], v[76:79], v[136:139], v[84:87]
    ds_read_b64_tr_b16 v[74:75], v1 offset:20992
    v_rcp_f32 v37, v37
    v_rcp_f32 v38, v38
    v_mfma_f32_16x16x32_bf16 v[92:95], v[76:79], v[140:143], v[92:95]
    ds_read_b64_tr_b16 v[76:77], v2 offset:20480
    ds_read_b64_tr_b16 v[78:79], v2 offset:20992
    v_rcp_f32 v39, v39
    s_waitcnt vmcnt(5)
    s_barrier
    s_waitcnt lgkmcnt(6)
    v_mfma_f32_16x16x32_bf16 v[80:83], v[64:67], v[144:147], v[80:83]
    v_fmac_f32 v16, v16, v36
    v_fmac_f32 v17, v17, v37
    v_mfma_f32_16x16x32_bf16 v[88:91], v[64:67], v[148:151], v[88:91]
    ds_read_b64_tr_b16 v[64:65], v1 offset:24576
    s_add_u32 m0, s9, 8192
    s_add_u32 s10, s15, 384
    buffer_load_dwordx4 v3, s[52:55], s10 offen lds
    v_fmac_f32 v18, v18, v38
    s_waitcnt lgkmcnt(5)
    v_mfma_f32_16x16x32_bf16 v[84:87], v[68:71], v[144:147], v[84:87]
    ds_read_b64_tr_b16 v[66:67], v1 offset:25088
    v_fmac_f32 v19, v19, v39
    v_cvt_pk_bf16_f32 v24, v16, v17
    v_mfma_f32_16x16x32_bf16 v[92:95], v[68:71], v[148:151], v[92:95]
    ds_read_b64_tr_b16 v[68:69], v2 offset:24576
    v_cvt_pk_bf16_f32 v25, v18, v19
    s_waitcnt lgkmcnt(5)
    v_mfma_f32_16x16x32_bf16 v[80:83], v[72:75], v[152:155], v[80:83]
    ds_read_b64_tr_b16 v[70:71], v2 offset:25088
    v_fma_f32 v20, v100, v60, v12
    v_fma_f32 v21, v101, v60, v13
    v_mfma_f32_16x16x32_bf16 v[88:91], v[72:75], v[156:159], v[88:91]
    ds_read_b64_tr_b16 v[72:73], v1 offset:28672
    v_fma_f32 v22, v102, v60, v14
    s_waitcnt lgkmcnt(5)
    v_mfma_f32_16x16x32_bf16 v[84:87], v[76:79], v[152:155], v[84:87]
    ds_read_b64_tr_b16 v[74:75], v1 offset:29184
    v_fma_f32 v23, v103, v60, v15
    v_exp_f32 v40, v20
    v_mfma_f32_16x16x32_bf16 v[92:95], v[76:79], v[156:159], v[92:95]
    ds_read_b64_tr_b16 v[76:77], v2 offset:28672
    ds_read_b64_tr_b16 v[78:79], v2 offset:29184
    v_exp_f32 v41, v21
    s_waitcnt vmcnt(5)
    s_barrier
    s_waitcnt lgkmcnt(6)
    v_mfma_f32_16x16x32_bf16 v[80:83], v[64:67], v[160:163], v[80:83]
    v_exp_f32 v42, v22
    v_exp_f32 v43, v23
    v_mfma_f32_16x16x32_bf16 v[88:91], v[64:67], v[164:167], v[88:91]
    ds_read_b64_tr_b16 v[64:65], v1 offset:32768
    s_add_u32 m0, s9, 16384
    s_add_u32 s10, s15, 590208
    buffer_load_dwordx4 v3, s[52:55], s10 offen lds
    v_fma_f32 v44, v40, -0.5, -1.0
    v_fma_f32 v45, v41, -0.5, -1.0
    s_waitcnt lgkmcnt(5)
    v_mfma_f32_16x16x32_bf16 v[84:87], v[68:71], v[160:163], v[84:87]
    ds_read_b64_tr_b16 v[66:67], v1 offset:33280
    v_fma_f32 v46, v42, -0.5, -1.0
    v_fma_f32 v47, v43, -0.5, -1.0
    v_mfma_f32_16x16x32_bf16 v[92:95], v[68:71], v[164:167], v[92:95]
    ds_read_b64_tr_b16 v[68:69], v2 offset:32768
    v_fma_f32 v44, v40, v44, -1.0
    s_waitcnt lgkmcnt(5)
    v_mfma_f32_16x16x32_bf16 v[80:83], v[72:75], v[168:171], v[80:83]
    ds_read_b64_tr_b16 v[70:71], v2 offset:33280
    v_fma_f32 v45, v41, v45, -1.0
    v_fma_f32 v46, v42, v46, -1.0
    v_mfma_f32_16x16x32_bf16 v[88:91], v[72:75], v[172:175], v[88:91]
    ds_read_b64_tr_b16 v[72:73], v1 offset:36864
    v_fma_f32 v47, v43, v47, -1.0
    v_rcp_f32 v44, v44
    s_waitcnt lgkmcnt(5)
    v_mfma_f32_16x16x32_bf16 v[84:87], v[76:79], v[168:171], v[84:87]
    ds_read_b64_tr_b16 v[74:75], v1 offset:37376
    v_rcp_f32 v45, v45
    v_rcp_f32 v46, v46
    v_mfma_f32_16x16x32_bf16 v[92:95], v[76:79], v[172:175], v[92:95]
    ds_read_b64_tr_b16 v[76:77], v2 offset:36864
    ds_read_b64_tr_b16 v[78:79], v2 offset:37376
    v_rcp_f32 v47, v47
    s_waitcnt vmcnt(5)
    s_barrier
    s_waitcnt lgkmcnt(6)
    v_mfma_f32_16x16x32_bf16 v[80:83], v[64:67], v[176:179], v[80:83]
    v_fmac_f32 v20, v20, v44
    v_fmac_f32 v21, v21, v45
    v_mfma_f32_16x16x32_bf16 v[88:91], v[64:67], v[180:183], v[88:91]
    ds_read_b64_tr_b16 v[64:65], v1 offset:40960
    s_add_u32 m0, s9, 24576
    s_add_u32 s10, s15, 1180032
    buffer_load_dwordx4 v3, s[52:55], s10 offen lds
    v_fmac_f32 v22, v22, v46
    s_waitcnt lgkmcnt(5)
    v_mfma_f32_16x16x32_bf16 v[84:87], v[68:71], v[176:179], v[84:87]
    ds_read_b64_tr_b16 v[66:67], v1 offset:41472
    v_fmac_f32 v23, v23, v47
    v_cvt_pk_bf16_f32 v26, v20, v21
    v_mfma_f32_16x16x32_bf16 v[92:95], v[68:71], v[180:183], v[92:95]
    ds_read_b64_tr_b16 v[68:69], v2 offset:40960
    v_cvt_pk_bf16_f32 v27, v22, v23
    ds_write_b128 v6, v[24:27] offset:4096
    s_waitcnt lgkmcnt(6)
    v_mfma_f32_16x16x32_bf16 v[80:83], v[72:75], v[184:187], v[80:83]
    ds_read_b64_tr_b16 v[70:71], v2 offset:41472
    v_fma_f32 v16, v104, v61, v8
    v_fma_f32 v17, v105, v61, v9
    v_mfma_f32_16x16x32_bf16 v[88:91], v[72:75], v[188:191], v[88:91]
    ds_read_b64_tr_b16 v[72:73], v1 offset:45056
    v_fma_f32 v18, v106, v61, v10
    s_waitcnt lgkmcnt(6)
    v_mfma_f32_16x16x32_bf16 v[84:87], v[76:79], v[184:187], v[84:87]
    ds_read_b64_tr_b16 v[74:75], v1 offset:45568
    v_fma_f32 v19, v107, v61, v11
    v_exp_f32 v32, v16
    v_mfma_f32_16x16x32_bf16 v[92:95], v[76:79], v[188:191], v[92:95]
    ds_read_b64_tr_b16 v[76:77], v2 offset:45056
    ds_read_b64_tr_b16 v[78:79], v2 offset:45568
    v_exp_f32 v33, v17
    s_waitcnt vmcnt(5)
    s_barrier
    s_waitcnt lgkmcnt(7)
    v_mfma_f32_16x16x32_bf16 v[80:83], v[64:67], v[192:195], v[80:83]
    v_exp_f32 v34, v18
    v_exp_f32 v35, v19
    v_mfma_f32_16x16x32_bf16 v[88:91], v[64:67], v[196:199], v[88:91]
    ds_read_b64_tr_b16 v[64:65], v1 offset:49152
    s_add_u32 m0, s9, 32768
    s_add_u32 s10, s15, 1769856
    buffer_load_dwordx4 v3, s[52:55], s10 offen lds
    v_fma_f32 v36, v32, -0.5, -1.0
    v_fma_f32 v37, v33, -0.5, -1.0
    s_waitcnt lgkmcnt(5)
    v_mfma_f32_16x16x32_bf16 v[84:87], v[68:71], v[192:195], v[84:87]
    ds_read_b64_tr_b16 v[66:67], v1 offset:49664
    v_fma_f32 v38, v34, -0.5, -1.0
    v_fma_f32 v39, v35, -0.5, -1.0
    v_mfma_f32_16x16x32_bf16 v[92:95], v[68:71], v[196:199], v[92:95]
    ds_read_b64_tr_b16 v[68:69], v2 offset:49152
    v_fma_f32 v36, v32, v36, -1.0
    s_waitcnt lgkmcnt(5)
    v_mfma_f32_16x16x32_bf16 v[80:83], v[72:75], v[200:203], v[80:83]
    ds_read_b64_tr_b16 v[70:71], v2 offset:49664
    v_fma_f32 v37, v33, v37, -1.0
    v_fma_f32 v38, v34, v38, -1.0
    v_mfma_f32_16x16x32_bf16 v[88:91], v[72:75], v[204:207], v[88:91]
    ds_read_b64_tr_b16 v[72:73], v1 offset:53248
    v_fma_f32 v39, v35, v39, -1.0
    s_waitcnt lgkmcnt(5)
    v_mfma_f32_16x16x32_bf16 v[84:87], v[76:79], v[200:203], v[84:87]
    ds_read_b64_tr_b16 v[74:75], v1 offset:53760
    v_rcp_f32 v36, v36
    v_rcp_f32 v37, v37
    v_mfma_f32_16x16x32_bf16 v[92:95], v[76:79], v[204:207], v[92:95]
    ds_read_b64_tr_b16 v[76:77], v2 offset:53248
    ds_read_b64_tr_b16 v[78:79], v2 offset:53760
    v_rcp_f32 v38, v38
    v_rcp_f32 v39, v39
    s_waitcnt vmcnt(5)
    s_barrier
    s_waitcnt lgkmcnt(6)
    v_mfma_f32_16x16x32_bf16 v[80:83], v[64:67], v[208:211], v[80:83]
    v_fmac_f32 v16, v16, v36
    v_fmac_f32 v17, v17, v37
    v_mfma_f32_16x16x32_bf16 v[88:91], v[64:67], v[212:215], v[88:91]
    ds_read_b64_tr_b16 v[64:65], v1 offset:57344
    s_add_u32 m0, s9, 40960
    s_add_u32 s10, s15, 2359680
    buffer_load_dwordx4 v3, s[52:55], s10 offen lds
    v_fmac_f32 v18, v18, v38
    s_waitcnt lgkmcnt(5)
    v_mfma_f32_16x16x32_bf16 v[84:87], v[68:71], v[208:211], v[84:87]
    ds_read_b64_tr_b16 v[66:67], v1 offset:57856
    v_fmac_f32 v19, v19, v39
    v_cvt_pk_bf16_f32 v28, v16, v17
    v_mfma_f32_16x16x32_bf16 v[92:95], v[68:71], v[212:215], v[92:95]
    ds_read_b64_tr_b16 v[68:69], v2 offset:57344
    v_cvt_pk_bf16_f32 v29, v18, v19
    v_fma_f32 v20, v108, v61, v12
    s_waitcnt lgkmcnt(5)
    v_mfma_f32_16x16x32_bf16 v[80:83], v[72:75], v[216:219], v[80:83]
    ds_read_b64_tr_b16 v[70:71], v2 offset:57856
    v_fma_f32 v21, v109, v61, v13
    v_fma_f32 v22, v110, v61, v14
    v_mfma_f32_16x16x32_bf16 v[88:91], v[72:75], v[220:223], v[88:91]
    ds_read_b64_tr_b16 v[72:73], v1 offset:61440
    v_fma_f32 v23, v111, v61, v15
    s_waitcnt lgkmcnt(5)
    v_mfma_f32_16x16x32_bf16 v[84:87], v[76:79], v[216:219], v[84:87]
    ds_read_b64_tr_b16 v[74:75], v1 offset:61952
    v_exp_f32 v40, v20
    v_exp_f32 v41, v21
    v_mfma_f32_16x16x32_bf16 v[92:95], v[76:79], v[220:223], v[92:95]
    ds_read_b64_tr_b16 v[76:77], v2 offset:61440
    ds_read_b64_tr_b16 v[78:79], v2 offset:61952
    v_exp_f32 v42, v22
    s_waitcnt vmcnt(5)
    s_barrier
    s_waitcnt lgkmcnt(6)
    v_mfma_f32_16x16x32_bf16 v[80:83], v[64:67], v[224:227], v[80:83]
    v_exp_f32 v43, v23
    v_fma_f32 v44, v40, -0.5, -1.0
    v_mfma_f32_16x16x32_bf16 v[88:91], v[64:67], v[228:231], v[88:91]
    ds_read_b64_tr_b16 v[64:65], v1 offset:0
    s_add_u32 m0, s9, 49152
    s_add_u32 s10, s15, 2949504
    buffer_load_dwordx4 v3, s[52:55], s10 offen lds
    v_fma_f32 v45, v41, -0.5, -1.0
    v_fma_f32 v46, v42, -0.5, -1.0
    s_waitcnt lgkmcnt(5)
    v_mfma_f32_16x16x32_bf16 v[84:87], v[68:71], v[224:227], v[84:87]
    ds_read_b64_tr_b16 v[66:67], v1 offset:512
    v_fma_f32 v47, v43, -0.5, -1.0
    v_fma_f32 v44, v40, v44, -1.0
    v_mfma_f32_16x16x32_bf16 v[92:95], v[68:71], v[228:231], v[92:95]
    ds_read_b64_tr_b16 v[68:69], v2 offset:0
    v_fma_f32 v45, v41, v45, -1.0
    s_waitcnt lgkmcnt(5)
    v_mfma_f32_16x16x32_bf16 v[80:83], v[72:75], v[232:235], v[80:83]
    ds_read_b64_tr_b16 v[70:71], v2 offset:512
    v_fma_f32 v46, v42, v46, -1.0
    v_fma_f32 v47, v43, v47, -1.0
    v_mfma_f32_16x16x32_bf16 v[88:91], v[72:75], v[236:239], v[88:91]
    ds_read_b64_tr_b16 v[72:73], v1 offset:4096
    v_rcp_f32 v44, v44
    s_waitcnt lgkmcnt(5)
    v_mfma_f32_16x16x32_bf16 v[84:87], v[76:79], v[232:235], v[84:87]
    ds_read_b64_tr_b16 v[74:75], v1 offset:4608
    v_rcp_f32 v45, v45
    v_rcp_f32 v46, v46
    v_mfma_f32_16x16x32_bf16 v[92:95], v[76:79], v[236:239], v[92:95]
    ds_read_b64_tr_b16 v[76:77], v2 offset:4096
    ds_read_b64_tr_b16 v[78:79], v2 offset:4608
    v_rcp_f32 v47, v47
    v_fmac_f32 v20, v20, v44
    s_waitcnt vmcnt(5)
    s_barrier
    s_waitcnt lgkmcnt(6)
    v_mfma_f32_16x16x32_bf16 v[80:83], v[64:67], v[240:243], v[80:83]
    v_fmac_f32 v21, v21, v45
    v_fmac_f32 v22, v22, v46
    v_mfma_f32_16x16x32_bf16 v[88:91], v[64:67], v[244:247], v[88:91]
    ds_read_b64_tr_b16 v[64:65], v1 offset:8192
    s_add_u32 m0, s9, 57344
    s_add_u32 s10, s15, 3539328
    buffer_load_dwordx4 v3, s[52:55], s10 offen lds
    v_fmac_f32 v23, v23, v47
    s_waitcnt lgkmcnt(5)
    v_mfma_f32_16x16x32_bf16 v[84:87], v[68:71], v[240:243], v[84:87]
    ds_read_b64_tr_b16 v[66:67], v1 offset:8704
    v_cvt_pk_bf16_f32 v30, v20, v21
    v_cvt_pk_bf16_f32 v31, v22, v23
    v_mfma_f32_16x16x32_bf16 v[92:95], v[68:71], v[244:247], v[92:95]
    ds_read_b64_tr_b16 v[68:69], v2 offset:8192
    ds_write_b128 v6, v[28:31] offset:5120
    s_waitcnt lgkmcnt(6)
    v_mfma_f32_16x16x32_bf16 v[80:83], v[72:75], v[248:251], v[80:83]
    ds_read_b64_tr_b16 v[70:71], v2 offset:8704
    v_mfma_f32_16x16x32_bf16 v[88:91], v[72:75], v[252:255], v[88:91]
    ds_read_b64_tr_b16 v[72:73], v1 offset:12288
    s_waitcnt lgkmcnt(6)
    v_mfma_f32_16x16x32_bf16 v[84:87], v[76:79], v[248:251], v[84:87]
    ds_read_b64_tr_b16 v[74:75], v1 offset:12800
    v_mfma_f32_16x16x32_bf16 v[92:95], v[76:79], v[252:255], v[92:95]
    ds_read_b64_tr_b16 v[76:77], v2 offset:12288
    ds_read_b64_tr_b16 v[78:79], v2 offset:12800
    s_waitcnt vmcnt(5)
    s_barrier
    s_waitcnt lgkmcnt(7)
    v_mfma_f32_16x16x32_bf16 v[96:99], v[64:67], v[112:115], 0
    v_mfma_f32_16x16x32_bf16 v[104:107], v[64:67], v[116:119], 0
    ds_read_b64_tr_b16 v[64:65], v1 offset:16384
    s_add_u32 m0, s9, 0
    s_add_u32 s10, s15, 4129152
    buffer_load_dwordx4 v3, s[52:55], s10 offen lds
    s_waitcnt lgkmcnt(5)
    v_mfma_f32_16x16x32_bf16 v[100:103], v[68:71], v[112:115], 0
    ds_read_b64_tr_b16 v[66:67], v1 offset:16896
    v_mfma_f32_16x16x32_bf16 v[108:111], v[68:71], v[116:119], 0
    ds_read_b64_tr_b16 v[68:69], v2 offset:16384
    ds_read_b128 v[8:11], v59 offset:256
    ds_read_b128 v[12:15], v59 offset:288
    s_waitcnt lgkmcnt(1)
    v_mfma_f32_16x16x32_bf16 v[96:99], v[72:75], v[120:123], v[96:99]
    ds_read_b64_tr_b16 v[70:71], v2 offset:16896
    v_fma_f32 v16, v80, v60, v8
    v_fma_f32 v17, v81, v60, v9
    v_mfma_f32_16x16x32_bf16 v[104:107], v[72:75], v[124:127], v[104:107]
    ds_read_b64_tr_b16 v[72:73], v1 offset:20480
    v_fma_f32 v18, v82, v60, v10
    v_mfma_f32_16x16x32_bf16 v[100:103], v[76:79], v[120:123], v[100:103]
    ds_read_b64_tr_b16 v[74:75], v1 offset:20992
    v_fma_f32 v19, v83, v60, v11
    v_exp_f32 v32, v16
    v_mfma_f32_16x16x32_bf16 v[108:111], v[76:79], v[124:127], v[108:111]
    ds_read_b64_tr_b16 v[76:77], v2 offset:20480
    ds_read_b64_tr_b16 v[78:79], v2 offset:20992
    v_exp_f32 v33, v17
    v_exp_f32 v34, v18
    s_waitcnt vmcnt(5)
    s_barrier
    v_mfma_f32_16x16x32_bf16 v[96:99], v[64:67], v[128:131], v[96:99]
    v_exp_f32 v35, v19
    v_fma_f32 v36, v32, -0.5, -1.0
    v_mfma_f32_16x16x32_bf16 v[104:107], v[64:67], v[132:135], v[104:107]
    ds_read_b64_tr_b16 v[64:65], v1 offset:24576
    s_add_u32 m0, s9, 8192
    s_add_u32 s10, s15, 4718976
    buffer_load_dwordx4 v3, s[52:55], s10 offen lds
    v_fma_f32 v37, v33, -0.5, -1.0
    s_waitcnt lgkmcnt(5)
    v_mfma_f32_16x16x32_bf16 v[100:103], v[68:71], v[128:131], v[100:103]
    ds_read_b64_tr_b16 v[66:67], v1 offset:25088
    v_fma_f32 v38, v34, -0.5, -1.0
    v_fma_f32 v39, v35, -0.5, -1.0
    v_mfma_f32_16x16x32_bf16 v[108:111], v[68:71], v[132:135], v[108:111]
    ds_read_b64_tr_b16 v[68:69], v2 offset:24576
    v_fma_f32 v36, v32, v36, -1.0
    s_waitcnt lgkmcnt(5)
    v_mfma_f32_16x16x32_bf16 v[96:99], v[72:75], v[136:139], v[96:99]
    ds_read_b64_tr_b16 v[70:71], v2 offset:25088
    v_fma_f32 v37, v33, v37, -1.0
    v_fma_f32 v38, v34, v38, -1.0
    v_mfma_f32_16x16x32_bf16 v[104:107], v[72:75], v[140:143], v[104:107]
    ds_read_b64_tr_b16 v[72:73], v1 offset:28672
    v_fma_f32 v39, v35, v39, -1.0
    v_rcp_f32 v36, v36
    s_waitcnt lgkmcnt(5)
    v_mfma_f32_16x16x32_bf16 v[100:103], v[76:79], v[136:139], v[100:103]
    ds_read_b64_tr_b16 v[74:75], v1 offset:29184
    v_rcp_f32 v37, v37
    v_rcp_f32 v38, v38
    v_mfma_f32_16x16x32_bf16 v[108:111], v[76:79], v[140:143], v[108:111]
    ds_read_b64_tr_b16 v[76:77], v2 offset:28672
    ds_read_b64_tr_b16 v[78:79], v2 offset:29184
    v_rcp_f32 v39, v39
    s_waitcnt vmcnt(5)
    s_barrier
    s_waitcnt lgkmcnt(6)
    v_mfma_f32_16x16x32_bf16 v[96:99], v[64:67], v[144:147], v[96:99]
    v_fmac_f32 v16, v16, v36
    v_fmac_f32 v17, v17, v37
    v_mfma_f32_16x16x32_bf16 v[104:107], v[64:67], v[148:151], v[104:107]
    ds_read_b64_tr_b16 v[64:65], v1 offset:32768
    s_add_u32 m0, s9, 16384
    s_add_u32 s10, s15, 512
    buffer_load_dwordx4 v3, s[52:55], s10 offen lds
    v_fmac_f32 v18, v18, v38
    s_waitcnt lgkmcnt(5)
    v_mfma_f32_16x16x32_bf16 v[100:103], v[68:71], v[144:147], v[100:103]
    ds_read_b64_tr_b16 v[66:67], v1 offset:33280
    v_fmac_f32 v19, v19, v39
    v_cvt_pk_bf16_f32 v24, v16, v17
    v_mfma_f32_16x16x32_bf16 v[108:111], v[68:71], v[148:151], v[108:111]
    ds_read_b64_tr_b16 v[68:69], v2 offset:32768
    v_cvt_pk_bf16_f32 v25, v18, v19
    s_waitcnt lgkmcnt(5)
    v_mfma_f32_16x16x32_bf16 v[96:99], v[72:75], v[152:155], v[96:99]
    ds_read_b64_tr_b16 v[70:71], v2 offset:33280
    v_fma_f32 v20, v84, v60, v12
    v_fma_f32 v21, v85, v60, v13
    v_mfma_f32_16x16x32_bf16 v[104:107], v[72:75], v[156:159], v[104:107]
    ds_read_b64_tr_b16 v[72:73], v1 offset:36864
    v_fma_f32 v22, v86, v60, v14
    s_waitcnt lgkmcnt(5)
    v_mfma_f32_16x16x32_bf16 v[100:103], v[76:79], v[152:155], v[100:103]
    ds_read_b64_tr_b16 v[74:75], v1 offset:37376
    v_fma_f32 v23, v87, v60, v15
    v_exp_f32 v40, v20
    v_mfma_f32_16x16x32_bf16 v[108:111], v[76:79], v[156:159], v[108:111]
    ds_read_b64_tr_b16 v[76:77], v2 offset:36864
    ds_read_b64_tr_b16 v[78:79], v2 offset:37376
    v_exp_f32 v41, v21
    s_waitcnt vmcnt(5)
    s_barrier
    s_waitcnt lgkmcnt(6)
    v_mfma_f32_16x16x32_bf16 v[96:99], v[64:67], v[160:163], v[96:99]
    v_exp_f32 v42, v22
    v_exp_f32 v43, v23
    v_mfma_f32_16x16x32_bf16 v[104:107], v[64:67], v[164:167], v[104:107]
    ds_read_b64_tr_b16 v[64:65], v1 offset:40960
    s_add_u32 m0, s9, 24576
    s_add_u32 s10, s15, 590336
    buffer_load_dwordx4 v3, s[52:55], s10 offen lds
    v_fma_f32 v44, v40, -0.5, -1.0
    v_fma_f32 v45, v41, -0.5, -1.0
    s_waitcnt lgkmcnt(5)
    v_mfma_f32_16x16x32_bf16 v[100:103], v[68:71], v[160:163], v[100:103]
    ds_read_b64_tr_b16 v[66:67], v1 offset:41472
    v_fma_f32 v46, v42, -0.5, -1.0
    v_fma_f32 v47, v43, -0.5, -1.0
    v_mfma_f32_16x16x32_bf16 v[108:111], v[68:71], v[164:167], v[108:111]
    ds_read_b64_tr_b16 v[68:69], v2 offset:40960
    v_fma_f32 v44, v40, v44, -1.0
    s_waitcnt lgkmcnt(5)
    v_mfma_f32_16x16x32_bf16 v[96:99], v[72:75], v[168:171], v[96:99]
    ds_read_b64_tr_b16 v[70:71], v2 offset:41472
    v_fma_f32 v45, v41, v45, -1.0
    v_fma_f32 v46, v42, v46, -1.0
    v_mfma_f32_16x16x32_bf16 v[104:107], v[72:75], v[172:175], v[104:107]
    ds_read_b64_tr_b16 v[72:73], v1 offset:45056
    v_fma_f32 v47, v43, v47, -1.0
    v_rcp_f32 v44, v44
    s_waitcnt lgkmcnt(5)
    v_mfma_f32_16x16x32_bf16 v[100:103], v[76:79], v[168:171], v[100:103]
    ds_read_b64_tr_b16 v[74:75], v1 offset:45568
    v_rcp_f32 v45, v45
    v_rcp_f32 v46, v46
    v_mfma_f32_16x16x32_bf16 v[108:111], v[76:79], v[172:175], v[108:111]
    ds_read_b64_tr_b16 v[76:77], v2 offset:45056
    ds_read_b64_tr_b16 v[78:79], v2 offset:45568
    v_rcp_f32 v47, v47
    s_waitcnt vmcnt(5)
    s_barrier
    s_waitcnt lgkmcnt(6)
    v_mfma_f32_16x16x32_bf16 v[96:99], v[64:67], v[176:179], v[96:99]
    v_fmac_f32 v20, v20, v44
    v_fmac_f32 v21, v21, v45
    v_mfma_f32_16x16x32_bf16 v[104:107], v[64:67], v[180:183], v[104:107]
    ds_read_b64_tr_b16 v[64:65], v1 offset:49152
    s_add_u32 m0, s9, 32768
    s_add_u32 s10, s15, 1180160
    buffer_load_dwordx4 v3, s[52:55], s10 offen lds
    v_fmac_f32 v22, v22, v46
    s_waitcnt lgkmcnt(5)
    v_mfma_f32_16x16x32_bf16 v[100:103], v[68:71], v[176:179], v[100:103]
    ds_read_b64_tr_b16 v[66:67], v1 offset:49664
    v_fmac_f32 v23, v23, v47
    v_cvt_pk_bf16_f32 v26, v20, v21
    v_mfma_f32_16x16x32_bf16 v[108:111], v[68:71], v[180:183], v[108:111]
    ds_read_b64_tr_b16 v[68:69], v2 offset:49152
    v_cvt_pk_bf16_f32 v27, v22, v23
    ds_write_b128 v6, v[24:27] offset:8192
    s_waitcnt lgkmcnt(6)
    v_mfma_f32_16x16x32_bf16 v[96:99], v[72:75], v[184:187], v[96:99]
    ds_read_b64_tr_b16 v[70:71], v2 offset:49664
    v_fma_f32 v16, v88, v61, v8
    v_fma_f32 v17, v89, v61, v9
    v_mfma_f32_16x16x32_bf16 v[104:107], v[72:75], v[188:191], v[104:107]
    ds_read_b64_tr_b16 v[72:73], v1 offset:53248
    v_fma_f32 v18, v90, v61, v10
    s_waitcnt lgkmcnt(6)
    v_mfma_f32_16x16x32_bf16 v[100:103], v[76:79], v[184:187], v[100:103]
    ds_read_b64_tr_b16 v[74:75], v1 offset:53760
    v_fma_f32 v19, v91, v61, v11
    v_exp_f32 v32, v16
    v_mfma_f32_16x16x32_bf16 v[108:111], v[76:79], v[188:191], v[108:111]
    ds_read_b64_tr_b16 v[76:77], v2 offset:53248
    ds_read_b64_tr_b16 v[78:79], v2 offset:53760
    v_exp_f32 v33, v17
    s_waitcnt vmcnt(5)
    s_barrier
    s_waitcnt lgkmcnt(7)
    v_mfma_f32_16x16x32_bf16 v[96:99], v[64:67], v[192:195], v[96:99]
    v_exp_f32 v34, v18
    v_exp_f32 v35, v19
    v_mfma_f32_16x16x32_bf16 v[104:107], v[64:67], v[196:199], v[104:107]
    ds_read_b64_tr_b16 v[64:65], v1 offset:57344
    s_add_u32 m0, s9, 40960
    s_add_u32 s10, s15, 1769984
    buffer_load_dwordx4 v3, s[52:55], s10 offen lds
    v_fma_f32 v36, v32, -0.5, -1.0
    v_fma_f32 v37, v33, -0.5, -1.0
    s_waitcnt lgkmcnt(5)
    v_mfma_f32_16x16x32_bf16 v[100:103], v[68:71], v[192:195], v[100:103]
    ds_read_b64_tr_b16 v[66:67], v1 offset:57856
    v_fma_f32 v38, v34, -0.5, -1.0
    v_fma_f32 v39, v35, -0.5, -1.0
    v_mfma_f32_16x16x32_bf16 v[108:111], v[68:71], v[196:199], v[108:111]
    ds_read_b64_tr_b16 v[68:69], v2 offset:57344
    v_fma_f32 v36, v32, v36, -1.0
    s_waitcnt lgkmcnt(5)
    v_mfma_f32_16x16x32_bf16 v[96:99], v[72:75], v[200:203], v[96:99]
    ds_read_b64_tr_b16 v[70:71], v2 offset:57856
    v_fma_f32 v37, v33, v37, -1.0
    v_fma_f32 v38, v34, v38, -1.0
    v_mfma_f32_16x16x32_bf16 v[104:107], v[72:75], v[204:207], v[104:107]
    ds_read_b64_tr_b16 v[72:73], v1 offset:61440
    v_fma_f32 v39, v35, v39, -1.0
    s_waitcnt lgkmcnt(5)
    v_mfma_f32_16x16x32_bf16 v[100:103], v[76:79], v[200:203], v[100:103]
    ds_read_b64_tr_b16 v[74:75], v1 offset:61952
    v_rcp_f32 v36, v36
    v_rcp_f32 v37, v37
    v_mfma_f32_16x16x32_bf16 v[108:111], v[76:79], v[204:207], v[108:111]
    ds_read_b64_tr_b16 v[76:77], v2 offset:61440
    ds_read_b64_tr_b16 v[78:79], v2 offset:61952
    v_rcp_f32 v38, v38
    v_rcp_f32 v39, v39
    s_waitcnt vmcnt(5)
    s_barrier
    s_waitcnt lgkmcnt(6)
    v_mfma_f32_16x16x32_bf16 v[96:99], v[64:67], v[208:211], v[96:99]
    v_fmac_f32 v16, v16, v36
    v_fmac_f32 v17, v17, v37
    v_mfma_f32_16x16x32_bf16 v[104:107], v[64:67], v[212:215], v[104:107]
    ds_read_b64_tr_b16 v[64:65], v1 offset:0
    s_add_u32 m0, s9, 49152
    s_add_u32 s10, s15, 2359808
    buffer_load_dwordx4 v3, s[52:55], s10 offen lds
    v_fmac_f32 v18, v18, v38
    s_waitcnt lgkmcnt(5)
    v_mfma_f32_16x16x32_bf16 v[100:103], v[68:71], v[208:211], v[100:103]
    ds_read_b64_tr_b16 v[66:67], v1 offset:512
    v_fmac_f32 v19, v19, v39
    v_cvt_pk_bf16_f32 v28, v16, v17
    v_mfma_f32_16x16x32_bf16 v[108:111], v[68:71], v[212:215], v[108:111]
    ds_read_b64_tr_b16 v[68:69], v2 offset:0
    v_cvt_pk_bf16_f32 v29, v18, v19
    v_fma_f32 v20, v92, v61, v12
    s_waitcnt lgkmcnt(5)
    v_mfma_f32_16x16x32_bf16 v[96:99], v[72:75], v[216:219], v[96:99]
    ds_read_b64_tr_b16 v[70:71], v2 offset:512
    v_fma_f32 v21, v93, v61, v13
    v_fma_f32 v22, v94, v61, v14
    v_mfma_f32_16x16x32_bf16 v[104:107], v[72:75], v[220:223], v[104:107]
    ds_read_b64_tr_b16 v[72:73], v1 offset:4096
    v_fma_f32 v23, v95, v61, v15
    s_waitcnt lgkmcnt(5)
    v_mfma_f32_16x16x32_bf16 v[100:103], v[76:79], v[216:219], v[100:103]
    ds_read_b64_tr_b16 v[74:75], v1 offset:4608
    v_exp_f32 v40, v20
    v_exp_f32 v41, v21
    v_mfma_f32_16x16x32_bf16 v[108:111], v[76:79], v[220:223], v[108:111]
    ds_read_b64_tr_b16 v[76:77], v2 offset:4096
    ds_read_b64_tr_b16 v[78:79], v2 offset:4608
    v_exp_f32 v42, v22
    s_waitcnt vmcnt(5)
    s_barrier
    s_waitcnt lgkmcnt(6)
    v_mfma_f32_16x16x32_bf16 v[96:99], v[64:67], v[224:227], v[96:99]
    v_exp_f32 v43, v23
    v_fma_f32 v44, v40, -0.5, -1.0
    v_mfma_f32_16x16x32_bf16 v[104:107], v[64:67], v[228:231], v[104:107]
    ds_read_b64_tr_b16 v[64:65], v1 offset:8192
    s_add_u32 m0, s9, 57344
    s_add_u32 s10, s15, 2949632
    buffer_load_dwordx4 v3, s[52:55], s10 offen lds
    v_fma_f32 v45, v41, -0.5, -1.0
    v_fma_f32 v46, v42, -0.5, -1.0
    s_waitcnt lgkmcnt(5)
    v_mfma_f32_16x16x32_bf16 v[100:103], v[68:71], v[224:227], v[100:103]
    ds_read_b64_tr_b16 v[66:67], v1 offset:8704
    v_fma_f32 v47, v43, -0.5, -1.0
    v_fma_f32 v44, v40, v44, -1.0
    v_mfma_f32_16x16x32_bf16 v[108:111], v[68:71], v[228:231], v[108:111]
    ds_read_b64_tr_b16 v[68:69], v2 offset:8192
    v_fma_f32 v45, v41, v45, -1.0
    s_waitcnt lgkmcnt(5)
    v_mfma_f32_16x16x32_bf16 v[96:99], v[72:75], v[232:235], v[96:99]
    ds_read_b64_tr_b16 v[70:71], v2 offset:8704
    v_fma_f32 v46, v42, v46, -1.0
    v_fma_f32 v47, v43, v47, -1.0
    v_mfma_f32_16x16x32_bf16 v[104:107], v[72:75], v[236:239], v[104:107]
    ds_read_b64_tr_b16 v[72:73], v1 offset:12288
    v_rcp_f32 v44, v44
    s_waitcnt lgkmcnt(5)
    v_mfma_f32_16x16x32_bf16 v[100:103], v[76:79], v[232:235], v[100:103]
    ds_read_b64_tr_b16 v[74:75], v1 offset:12800
    v_rcp_f32 v45, v45
    v_rcp_f32 v46, v46
    v_mfma_f32_16x16x32_bf16 v[108:111], v[76:79], v[236:239], v[108:111]
    ds_read_b64_tr_b16 v[76:77], v2 offset:12288
    ds_read_b64_tr_b16 v[78:79], v2 offset:12800
    v_rcp_f32 v47, v47
    v_fmac_f32 v20, v20, v44
    s_waitcnt vmcnt(5)
    s_barrier
    s_waitcnt lgkmcnt(6)
    v_mfma_f32_16x16x32_bf16 v[96:99], v[64:67], v[240:243], v[96:99]
    v_fmac_f32 v21, v21, v45
    v_fmac_f32 v22, v22, v46
    v_mfma_f32_16x16x32_bf16 v[104:107], v[64:67], v[244:247], v[104:107]
    ds_read_b64_tr_b16 v[64:65], v1 offset:16384
    s_add_u32 m0, s9, 0
    s_add_u32 s10, s15, 3539456
    buffer_load_dwordx4 v3, s[52:55], s10 offen lds
    v_fmac_f32 v23, v23, v47
    s_waitcnt lgkmcnt(5)
    v_mfma_f32_16x16x32_bf16 v[100:103], v[68:71], v[240:243], v[100:103]
    ds_read_b64_tr_b16 v[66:67], v1 offset:16896
    v_cvt_pk_bf16_f32 v30, v20, v21
    v_cvt_pk_bf16_f32 v31, v22, v23
    v_mfma_f32_16x16x32_bf16 v[108:111], v[68:71], v[244:247], v[108:111]
    ds_read_b64_tr_b16 v[68:69], v2 offset:16384
    ds_write_b128 v6, v[28:31] offset:9216
    s_waitcnt lgkmcnt(6)
    v_mfma_f32_16x16x32_bf16 v[96:99], v[72:75], v[248:251], v[96:99]
    ds_read_b64_tr_b16 v[70:71], v2 offset:16896
    v_mfma_f32_16x16x32_bf16 v[104:107], v[72:75], v[252:255], v[104:107]
    ds_read_b64_tr_b16 v[72:73], v1 offset:20480
    s_waitcnt lgkmcnt(6)
    v_mfma_f32_16x16x32_bf16 v[100:103], v[76:79], v[248:251], v[100:103]
    ds_read_b64_tr_b16 v[74:75], v1 offset:20992
    v_mfma_f32_16x16x32_bf16 v[108:111], v[76:79], v[252:255], v[108:111]
    ds_read_b64_tr_b16 v[76:77], v2 offset:20480
    ds_read_b64_tr_b16 v[78:79], v2 offset:20992
    s_waitcnt vmcnt(5)
    s_barrier
    s_waitcnt lgkmcnt(7)
    v_mfma_f32_16x16x32_bf16 v[80:83], v[64:67], v[112:115], 0
    v_mfma_f32_16x16x32_bf16 v[88:91], v[64:67], v[116:119], 0
    ds_read_b64_tr_b16 v[64:65], v1 offset:24576
    s_add_u32 m0, s9, 8192
    s_add_u32 s10, s15, 4129280
    buffer_load_dwordx4 v3, s[52:55], s10 offen lds
    s_waitcnt lgkmcnt(5)
    v_mfma_f32_16x16x32_bf16 v[84:87], v[68:71], v[112:115], 0
    ds_read_b64_tr_b16 v[66:67], v1 offset:25088
    v_mfma_f32_16x16x32_bf16 v[92:95], v[68:71], v[116:119], 0
    ds_read_b64_tr_b16 v[68:69], v2 offset:24576
    ds_read_b128 v[8:11], v59 offset:384
    ds_read_b128 v[12:15], v59 offset:416
    s_waitcnt lgkmcnt(1)
    v_mfma_f32_16x16x32_bf16 v[80:83], v[72:75], v[120:123], v[80:83]
    ds_read_b64_tr_b16 v[70:71], v2 offset:25088
    v_fma_f32 v16, v96, v60, v8
    v_fma_f32 v17, v97, v60, v9
    v_mfma_f32_16x16x32_bf16 v[88:91], v[72:75], v[124:127], v[88:91]
    ds_read_b64_tr_b16 v[72:73], v1 offset:28672
    v_fma_f32 v18, v98, v60, v10
    v_mfma_f32_16x16x32_bf16 v[84:87], v[76:79], v[120:123], v[84:87]
    ds_read_b64_tr_b16 v[74:75], v1 offset:29184
    v_fma_f32 v19, v99, v60, v11
    v_exp_f32 v32, v16
    v_mfma_f32_16x16x32_bf16 v[92:95], v[76:79], v[124:127], v[92:95]
    ds_read_b64_tr_b16 v[76:77], v2 offset:28672
    ds_read_b64_tr_b16 v[78:79], v2 offset:29184
    v_exp_f32 v33, v17
    v_exp_f32 v34, v18
    s_waitcnt vmcnt(5)
    s_barrier
    v_mfma_f32_16x16x32_bf16 v[80:83], v[64:67], v[128:131], v[80:83]
    v_exp_f32 v35, v19
    v_fma_f32 v36, v32, -0.5, -1.0
    v_mfma_f32_16x16x32_bf16 v[88:91], v[64:67], v[132:135], v[88:91]
    ds_read_b64_tr_b16 v[64:65], v1 offset:32768
    s_add_u32 m0, s9, 16384
    s_add_u32 s10, s15, 4719104
    buffer_load_dwordx4 v3, s[52:55], s10 offen lds
    v_fma_f32 v37, v33, -0.5, -1.0
    s_waitcnt lgkmcnt(5)
    v_mfma_f32_16x16x32_bf16 v[84:87], v[68:71], v[128:131], v[84:87]
    ds_read_b64_tr_b16 v[66:67], v1 offset:33280
    v_fma_f32 v38, v34, -0.5, -1.0
    v_fma_f32 v39, v35, -0.5, -1.0
    v_mfma_f32_16x16x32_bf16 v[92:95], v[68:71], v[132:135], v[92:95]
    ds_read_b64_tr_b16 v[68:69], v2 offset:32768
    v_fma_f32 v36, v32, v36, -1.0
    s_waitcnt lgkmcnt(5)
    v_mfma_f32_16x16x32_bf16 v[80:83], v[72:75], v[136:139], v[80:83]
    ds_read_b64_tr_b16 v[70:71], v2 offset:33280
    v_fma_f32 v37, v33, v37, -1.0
    v_fma_f32 v38, v34, v38, -1.0
    v_mfma_f32_16x16x32_bf16 v[88:91], v[72:75], v[140:143], v[88:91]
    ds_read_b64_tr_b16 v[72:73], v1 offset:36864
    v_fma_f32 v39, v35, v39, -1.0
    v_rcp_f32 v36, v36
    s_waitcnt lgkmcnt(5)
    v_mfma_f32_16x16x32_bf16 v[84:87], v[76:79], v[136:139], v[84:87]
    ds_read_b64_tr_b16 v[74:75], v1 offset:37376
    v_rcp_f32 v37, v37
    v_rcp_f32 v38, v38
    v_mfma_f32_16x16x32_bf16 v[92:95], v[76:79], v[140:143], v[92:95]
    ds_read_b64_tr_b16 v[76:77], v2 offset:36864
    ds_read_b64_tr_b16 v[78:79], v2 offset:37376
    v_rcp_f32 v39, v39
    s_waitcnt vmcnt(5)
    s_barrier
    s_waitcnt lgkmcnt(6)
    v_mfma_f32_16x16x32_bf16 v[80:83], v[64:67], v[144:147], v[80:83]
    v_fmac_f32 v16, v16, v36
    v_fmac_f32 v17, v17, v37
    v_mfma_f32_16x16x32_bf16 v[88:91], v[64:67], v[148:151], v[88:91]
    ds_read_b64_tr_b16 v[64:65], v1 offset:40960
    s_add_u32 m0, s9, 24576
    s_add_u32 s10, s15, 640
    buffer_load_dwordx4 v3, s[52:55], s10 offen lds
    v_fmac_f32 v18, v18, v38
    s_waitcnt lgkmcnt(5)
    v_mfma_f32_16x16x32_bf16 v[84:87], v[68:71], v[144:147], v[84:87]
    ds_read_b64_tr_b16 v[66:67], v1 offset:41472
    v_fmac_f32 v19, v19, v39
    v_cvt_pk_bf16_f32 v24, v16, v17
    v_mfma_f32_16x16x32_bf16 v[92:95], v[68:71], v[148:151], v[92:95]
    ds_read_b64_tr_b16 v[68:69], v2 offset:40960
    v_cvt_pk_bf16_f32 v25, v18, v19
    s_waitcnt lgkmcnt(5)
    v_mfma_f32_16x16x32_bf16 v[80:83], v[72:75], v[152:155], v[80:83]
    ds_read_b64_tr_b16 v[70:71], v2 offset:41472
    v_fma_f32 v20, v100, v60, v12
    v_fma_f32 v21, v101, v60, v13
    v_mfma_f32_16x16x32_bf16 v[88:91], v[72:75], v[156:159], v[88:91]
    ds_read_b64_tr_b16 v[72:73], v1 offset:45056
    v_fma_f32 v22, v102, v60, v14
    s_waitcnt lgkmcnt(5)
    v_mfma_f32_16x16x32_bf16 v[84:87], v[76:79], v[152:155], v[84:87]
    ds_read_b64_tr_b16 v[74:75], v1 offset:45568
    v_fma_f32 v23, v103, v60, v15
    v_exp_f32 v40, v20
    v_mfma_f32_16x16x32_bf16 v[92:95], v[76:79], v[156:159], v[92:95]
    ds_read_b64_tr_b16 v[76:77], v2 offset:45056
    ds_read_b64_tr_b16 v[78:79], v2 offset:45568
    v_exp_f32 v41, v21
    s_waitcnt vmcnt(5)
    s_barrier
    s_waitcnt lgkmcnt(6)
    v_mfma_f32_16x16x32_bf16 v[80:83], v[64:67], v[160:163], v[80:83]
    v_exp_f32 v42, v22
    v_exp_f32 v43, v23
    v_mfma_f32_16x16x32_bf16 v[88:91], v[64:67], v[164:167], v[88:91]
    ds_read_b64_tr_b16 v[64:65], v1 offset:49152
    s_add_u32 m0, s9, 32768
    s_add_u32 s10, s15, 590464
    buffer_load_dwordx4 v3, s[52:55], s10 offen lds
    v_fma_f32 v44, v40, -0.5, -1.0
    v_fma_f32 v45, v41, -0.5, -1.0
    s_waitcnt lgkmcnt(5)
    v_mfma_f32_16x16x32_bf16 v[84:87], v[68:71], v[160:163], v[84:87]
    ds_read_b64_tr_b16 v[66:67], v1 offset:49664
    v_fma_f32 v46, v42, -0.5, -1.0
    v_fma_f32 v47, v43, -0.5, -1.0
    v_mfma_f32_16x16x32_bf16 v[92:95], v[68:71], v[164:167], v[92:95]
    ds_read_b64_tr_b16 v[68:69], v2 offset:49152
    v_fma_f32 v44, v40, v44, -1.0
    s_waitcnt lgkmcnt(5)
    v_mfma_f32_16x16x32_bf16 v[80:83], v[72:75], v[168:171], v[80:83]
    ds_read_b64_tr_b16 v[70:71], v2 offset:49664
    v_fma_f32 v45, v41, v45, -1.0
    v_fma_f32 v46, v42, v46, -1.0
    v_mfma_f32_16x16x32_bf16 v[88:91], v[72:75], v[172:175], v[88:91]
    ds_read_b64_tr_b16 v[72:73], v1 offset:53248
    v_fma_f32 v47, v43, v47, -1.0
    v_rcp_f32 v44, v44
    s_waitcnt lgkmcnt(5)
    v_mfma_f32_16x16x32_bf16 v[84:87], v[76:79], v[168:171], v[84:87]
    ds_read_b64_tr_b16 v[74:75], v1 offset:53760
    v_rcp_f32 v45, v45
    v_rcp_f32 v46, v46
    v_mfma_f32_16x16x32_bf16 v[92:95], v[76:79], v[172:175], v[92:95]
    ds_read_b64_tr_b16 v[76:77], v2 offset:53248
    ds_read_b64_tr_b16 v[78:79], v2 offset:53760
    v_rcp_f32 v47, v47
    s_waitcnt vmcnt(5)
    s_barrier
    s_waitcnt lgkmcnt(6)
    v_mfma_f32_16x16x32_bf16 v[80:83], v[64:67], v[176:179], v[80:83]
    v_fmac_f32 v20, v20, v44
    v_fmac_f32 v21, v21, v45
    v_mfma_f32_16x16x32_bf16 v[88:91], v[64:67], v[180:183], v[88:91]
    ds_read_b64_tr_b16 v[64:65], v1 offset:57344
    s_add_u32 m0, s9, 40960
    s_add_u32 s10, s15, 1180288
    buffer_load_dwordx4 v3, s[52:55], s10 offen lds
    v_fmac_f32 v22, v22, v46
    s_waitcnt lgkmcnt(5)
    v_mfma_f32_16x16x32_bf16 v[84:87], v[68:71], v[176:179], v[84:87]
    ds_read_b64_tr_b16 v[66:67], v1 offset:57856
    v_fmac_f32 v23, v23, v47
    v_cvt_pk_bf16_f32 v26, v20, v21
    v_mfma_f32_16x16x32_bf16 v[92:95], v[68:71], v[180:183], v[92:95]
    ds_read_b64_tr_b16 v[68:69], v2 offset:57344
    v_cvt_pk_bf16_f32 v27, v22, v23
    ds_write_b128 v6, v[24:27] offset:12288
    s_waitcnt lgkmcnt(6)
    v_mfma_f32_16x16x32_bf16 v[80:83], v[72:75], v[184:187], v[80:83]
    ds_read_b64_tr_b16 v[70:71], v2 offset:57856
    v_fma_f32 v16, v104, v61, v8
    v_fma_f32 v17, v105, v61, v9
    v_mfma_f32_16x16x32_bf16 v[88:91], v[72:75], v[188:191], v[88:91]
    ds_read_b64_tr_b16 v[72:73], v1 offset:61440
    v_fma_f32 v18, v106, v61, v10
    s_waitcnt lgkmcnt(6)
    v_mfma_f32_16x16x32_bf16 v[84:87], v[76:79], v[184:187], v[84:87]
    ds_read_b64_tr_b16 v[74:75], v1 offset:61952
    v_fma_f32 v19, v107, v61, v11
    v_exp_f32 v32, v16
    v_mfma_f32_16x16x32_bf16 v[92:95], v[76:79], v[188:191], v[92:95]
    ds_read_b64_tr_b16 v[76:77], v2 offset:61440
    ds_read_b64_tr_b16 v[78:79], v2 offset:61952
    v_exp_f32 v33, v17
    s_waitcnt vmcnt(5)
    s_barrier
    s_waitcnt lgkmcnt(7)
    v_mfma_f32_16x16x32_bf16 v[80:83], v[64:67], v[192:195], v[80:83]
    v_exp_f32 v34, v18
    v_exp_f32 v35, v19
    v_mfma_f32_16x16x32_bf16 v[88:91], v[64:67], v[196:199], v[88:91]
    ds_read_b64_tr_b16 v[64:65], v1 offset:0
    s_add_u32 m0, s9, 49152
    s_add_u32 s10, s15, 1770112
    buffer_load_dwordx4 v3, s[52:55], s10 offen lds
    v_fma_f32 v36, v32, -0.5, -1.0
    v_fma_f32 v37, v33, -0.5, -1.0
    s_waitcnt lgkmcnt(5)
    v_mfma_f32_16x16x32_bf16 v[84:87], v[68:71], v[192:195], v[84:87]
    ds_read_b64_tr_b16 v[66:67], v1 offset:512
    v_fma_f32 v38, v34, -0.5, -1.0
    v_fma_f32 v39, v35, -0.5, -1.0
    v_mfma_f32_16x16x32_bf16 v[92:95], v[68:71], v[196:199], v[92:95]
    ds_read_b64_tr_b16 v[68:69], v2 offset:0
    v_fma_f32 v36, v32, v36, -1.0
    s_waitcnt lgkmcnt(5)
    v_mfma_f32_16x16x32_bf16 v[80:83], v[72:75], v[200:203], v[80:83]
    ds_read_b64_tr_b16 v[70:71], v2 offset:512
    v_fma_f32 v37, v33, v37, -1.0
    v_fma_f32 v38, v34, v38, -1.0
    v_mfma_f32_16x16x32_bf16 v[88:91], v[72:75], v[204:207], v[88:91]
    ds_read_b64_tr_b16 v[72:73], v1 offset:4096
    v_fma_f32 v39, v35, v39, -1.0
    s_waitcnt lgkmcnt(5)
    v_mfma_f32_16x16x32_bf16 v[84:87], v[76:79], v[200:203], v[84:87]
    ds_read_b64_tr_b16 v[74:75], v1 offset:4608
    v_rcp_f32 v36, v36
    v_rcp_f32 v37, v37
    v_mfma_f32_16x16x32_bf16 v[92:95], v[76:79], v[204:207], v[92:95]
    ds_read_b64_tr_b16 v[76:77], v2 offset:4096
    ds_read_b64_tr_b16 v[78:79], v2 offset:4608
    v_rcp_f32 v38, v38
    v_rcp_f32 v39, v39
    s_waitcnt vmcnt(5)
    s_barrier
    s_waitcnt lgkmcnt(6)
    v_mfma_f32_16x16x32_bf16 v[80:83], v[64:67], v[208:211], v[80:83]
    v_fmac_f32 v16, v16, v36
    v_fmac_f32 v17, v17, v37
    v_mfma_f32_16x16x32_bf16 v[88:91], v[64:67], v[212:215], v[88:91]
    ds_read_b64_tr_b16 v[64:65], v1 offset:8192
    s_add_u32 m0, s9, 57344
    s_add_u32 s10, s15, 2359936
    buffer_load_dwordx4 v3, s[52:55], s10 offen lds
    v_fmac_f32 v18, v18, v38
    s_waitcnt lgkmcnt(5)
    v_mfma_f32_16x16x32_bf16 v[84:87], v[68:71], v[208:211], v[84:87]
    ds_read_b64_tr_b16 v[66:67], v1 offset:8704
    v_fmac_f32 v19, v19, v39
    v_cvt_pk_bf16_f32 v28, v16, v17
    v_mfma_f32_16x16x32_bf16 v[92:95], v[68:71], v[212:215], v[92:95]
    ds_read_b64_tr_b16 v[68:69], v2 offset:8192
    v_cvt_pk_bf16_f32 v29, v18, v19
    v_fma_f32 v20, v108, v61, v12
    s_waitcnt lgkmcnt(5)
    v_mfma_f32_16x16x32_bf16 v[80:83], v[72:75], v[216:219], v[80:83]
    ds_read_b64_tr_b16 v[70:71], v2 offset:8704
    v_fma_f32 v21, v109, v61, v13
    v_fma_f32 v22, v110, v61, v14
    v_mfma_f32_16x16x32_bf16 v[88:91], v[72:75], v[220:223], v[88:91]
    ds_read_b64_tr_b16 v[72:73], v1 offset:12288
    v_fma_f32 v23, v111, v61, v15
    s_waitcnt lgkmcnt(5)
    v_mfma_f32_16x16x32_bf16 v[84:87], v[76:79], v[216:219], v[84:87]
    ds_read_b64_tr_b16 v[74:75], v1 offset:12800
    v_exp_f32 v40, v20
    v_exp_f32 v41, v21
    v_mfma_f32_16x16x32_bf16 v[92:95], v[76:79], v[220:223], v[92:95]
    ds_read_b64_tr_b16 v[76:77], v2 offset:12288
    ds_read_b64_tr_b16 v[78:79], v2 offset:12800
    v_exp_f32 v42, v22
    s_waitcnt vmcnt(5)
    s_barrier
    s_waitcnt lgkmcnt(6)
    v_mfma_f32_16x16x32_bf16 v[80:83], v[64:67], v[224:227], v[80:83]
    v_exp_f32 v43, v23
    v_fma_f32 v44, v40, -0.5, -1.0
    v_mfma_f32_16x16x32_bf16 v[88:91], v[64:67], v[228:231], v[88:91]
    ds_read_b64_tr_b16 v[64:65], v1 offset:16384
    s_add_u32 m0, s9, 0
    s_add_u32 s10, s15, 2949760
    buffer_load_dwordx4 v3, s[52:55], s10 offen lds
    v_fma_f32 v45, v41, -0.5, -1.0
    v_fma_f32 v46, v42, -0.5, -1.0
    s_waitcnt lgkmcnt(5)
    v_mfma_f32_16x16x32_bf16 v[84:87], v[68:71], v[224:227], v[84:87]
    ds_read_b64_tr_b16 v[66:67], v1 offset:16896
    v_fma_f32 v47, v43, -0.5, -1.0
    v_fma_f32 v44, v40, v44, -1.0
    v_mfma_f32_16x16x32_bf16 v[92:95], v[68:71], v[228:231], v[92:95]
    ds_read_b64_tr_b16 v[68:69], v2 offset:16384
    v_fma_f32 v45, v41, v45, -1.0
    s_waitcnt lgkmcnt(5)
    v_mfma_f32_16x16x32_bf16 v[80:83], v[72:75], v[232:235], v[80:83]
    ds_read_b64_tr_b16 v[70:71], v2 offset:16896
    v_fma_f32 v46, v42, v46, -1.0
    v_fma_f32 v47, v43, v47, -1.0
    v_mfma_f32_16x16x32_bf16 v[88:91], v[72:75], v[236:239], v[88:91]
    ds_read_b64_tr_b16 v[72:73], v1 offset:20480
    v_rcp_f32 v44, v44
    s_waitcnt lgkmcnt(5)
    v_mfma_f32_16x16x32_bf16 v[84:87], v[76:79], v[232:235], v[84:87]
    ds_read_b64_tr_b16 v[74:75], v1 offset:20992
    v_rcp_f32 v45, v45
    v_rcp_f32 v46, v46
    v_mfma_f32_16x16x32_bf16 v[92:95], v[76:79], v[236:239], v[92:95]
    ds_read_b64_tr_b16 v[76:77], v2 offset:20480
    ds_read_b64_tr_b16 v[78:79], v2 offset:20992
    v_rcp_f32 v47, v47
    v_fmac_f32 v20, v20, v44
    s_waitcnt vmcnt(5)
    s_barrier
    s_waitcnt lgkmcnt(6)
    v_mfma_f32_16x16x32_bf16 v[80:83], v[64:67], v[240:243], v[80:83]
    v_fmac_f32 v21, v21, v45
    v_fmac_f32 v22, v22, v46
    v_mfma_f32_16x16x32_bf16 v[88:91], v[64:67], v[244:247], v[88:91]
    ds_read_b64_tr_b16 v[64:65], v1 offset:24576
    s_add_u32 m0, s9, 8192
    s_add_u32 s10, s15, 3539584
    buffer_load_dwordx4 v3, s[52:55], s10 offen lds
    v_fmac_f32 v23, v23, v47
    s_waitcnt lgkmcnt(5)
    v_mfma_f32_16x16x32_bf16 v[84:87], v[68:71], v[240:243], v[84:87]
    ds_read_b64_tr_b16 v[66:67], v1 offset:25088
    v_cvt_pk_bf16_f32 v30, v20, v21
    v_cvt_pk_bf16_f32 v31, v22, v23
    v_mfma_f32_16x16x32_bf16 v[92:95], v[68:71], v[244:247], v[92:95]
    ds_read_b64_tr_b16 v[68:69], v2 offset:24576
    ds_write_b128 v6, v[28:31] offset:13312
    s_waitcnt lgkmcnt(6)
    v_mfma_f32_16x16x32_bf16 v[80:83], v[72:75], v[248:251], v[80:83]
    ds_read_b64_tr_b16 v[70:71], v2 offset:25088
    v_mfma_f32_16x16x32_bf16 v[88:91], v[72:75], v[252:255], v[88:91]
    ds_read_b64_tr_b16 v[72:73], v1 offset:28672
    s_waitcnt lgkmcnt(6)
    v_mfma_f32_16x16x32_bf16 v[84:87], v[76:79], v[248:251], v[84:87]
    ds_read_b64_tr_b16 v[74:75], v1 offset:29184
    v_mfma_f32_16x16x32_bf16 v[92:95], v[76:79], v[252:255], v[92:95]
    ds_read_b64_tr_b16 v[76:77], v2 offset:28672
    ds_read_b64_tr_b16 v[78:79], v2 offset:29184
    s_waitcnt vmcnt(5)
    s_barrier
    s_waitcnt lgkmcnt(7)
    v_mfma_f32_16x16x32_bf16 v[96:99], v[64:67], v[112:115], 0
    v_mfma_f32_16x16x32_bf16 v[104:107], v[64:67], v[116:119], 0
    ds_read_b64_tr_b16 v[64:65], v1 offset:32768
    s_add_u32 m0, s9, 16384
    s_add_u32 s10, s15, 4129408
    buffer_load_dwordx4 v3, s[52:55], s10 offen lds
    s_waitcnt lgkmcnt(5)
    v_mfma_f32_16x16x32_bf16 v[100:103], v[68:71], v[112:115], 0
    ds_read_b64_tr_b16 v[66:67], v1 offset:33280
    v_mfma_f32_16x16x32_bf16 v[108:111], v[68:71], v[116:119], 0
    ds_read_b64_tr_b16 v[68:69], v2 offset:32768
    ds_read_b128 v[8:11], v59 offset:512
    ds_read_b128 v[12:15], v59 offset:544
    s_waitcnt lgkmcnt(1)
    v_mfma_f32_16x16x32_bf16 v[96:99], v[72:75], v[120:123], v[96:99]
    ds_read_b64_tr_b16 v[70:71], v2 offset:33280
    v_fma_f32 v16, v80, v60, v8
    v_fma_f32 v17, v81, v60, v9
    v_mfma_f32_16x16x32_bf16 v[104:107], v[72:75], v[124:127], v[104:107]
    ds_read_b64_tr_b16 v[72:73], v1 offset:36864
    v_fma_f32 v18, v82, v60, v10
    v_mfma_f32_16x16x32_bf16 v[100:103], v[76:79], v[120:123], v[100:103]
    ds_read_b64_tr_b16 v[74:75], v1 offset:37376
    v_fma_f32 v19, v83, v60, v11
    v_exp_f32 v32, v16
    v_mfma_f32_16x16x32_bf16 v[108:111], v[76:79], v[124:127], v[108:111]
    ds_read_b64_tr_b16 v[76:77], v2 offset:36864
    ds_read_b64_tr_b16 v[78:79], v2 offset:37376
    v_exp_f32 v33, v17
    v_exp_f32 v34, v18
    s_waitcnt vmcnt(5)
    s_barrier
    v_mfma_f32_16x16x32_bf16 v[96:99], v[64:67], v[128:131], v[96:99]
    v_exp_f32 v35, v19
    v_fma_f32 v36, v32, -0.5, -1.0
    v_mfma_f32_16x16x32_bf16 v[104:107], v[64:67], v[132:135], v[104:107]
    ds_read_b64_tr_b16 v[64:65], v1 offset:40960
    s_add_u32 m0, s9, 24576
    s_add_u32 s10, s15, 4719232
    buffer_load_dwordx4 v3, s[52:55], s10 offen lds
    v_fma_f32 v37, v33, -0.5, -1.0
    s_waitcnt lgkmcnt(5)
    v_mfma_f32_16x16x32_bf16 v[100:103], v[68:71], v[128:131], v[100:103]
    ds_read_b64_tr_b16 v[66:67], v1 offset:41472
    v_fma_f32 v38, v34, -0.5, -1.0
    v_fma_f32 v39, v35, -0.5, -1.0
    v_mfma_f32_16x16x32_bf16 v[108:111], v[68:71], v[132:135], v[108:111]
    ds_read_b64_tr_b16 v[68:69], v2 offset:40960
    v_fma_f32 v36, v32, v36, -1.0
    s_waitcnt lgkmcnt(5)
    v_mfma_f32_16x16x32_bf16 v[96:99], v[72:75], v[136:139], v[96:99]
    ds_read_b64_tr_b16 v[70:71], v2 offset:41472
    v_fma_f32 v37, v33, v37, -1.0
    v_fma_f32 v38, v34, v38, -1.0
    v_mfma_f32_16x16x32_bf16 v[104:107], v[72:75], v[140:143], v[104:107]
    ds_read_b64_tr_b16 v[72:73], v1 offset:45056
    v_fma_f32 v39, v35, v39, -1.0
    v_rcp_f32 v36, v36
    s_waitcnt lgkmcnt(5)
    v_mfma_f32_16x16x32_bf16 v[100:103], v[76:79], v[136:139], v[100:103]
    ds_read_b64_tr_b16 v[74:75], v1 offset:45568
    v_rcp_f32 v37, v37
    v_rcp_f32 v38, v38
    v_mfma_f32_16x16x32_bf16 v[108:111], v[76:79], v[140:143], v[108:111]
    ds_read_b64_tr_b16 v[76:77], v2 offset:45056
    ds_read_b64_tr_b16 v[78:79], v2 offset:45568
    v_rcp_f32 v39, v39
    s_waitcnt vmcnt(5)
    s_barrier
    s_waitcnt lgkmcnt(6)
    v_mfma_f32_16x16x32_bf16 v[96:99], v[64:67], v[144:147], v[96:99]
    v_fmac_f32 v16, v16, v36
    v_fmac_f32 v17, v17, v37
    v_mfma_f32_16x16x32_bf16 v[104:107], v[64:67], v[148:151], v[104:107]
    ds_read_b64_tr_b16 v[64:65], v1 offset:49152
    s_add_u32 m0, s9, 32768
    s_add_u32 s10, s72, 0
    buffer_load_dwordx4 v4, s[56:59], s10 offen lds
    v_fmac_f32 v18, v18, v38
    s_waitcnt lgkmcnt(5)
    v_mfma_f32_16x16x32_bf16 v[100:103], v[68:71], v[144:147], v[100:103]
    ds_read_b64_tr_b16 v[66:67], v1 offset:49664
    v_fmac_f32 v19, v19, v39
    v_cvt_pk_bf16_f32 v24, v16, v17
    v_mfma_f32_16x16x32_bf16 v[108:111], v[68:71], v[148:151], v[108:111]
    ds_read_b64_tr_b16 v[68:69], v2 offset:49152
    v_cvt_pk_bf16_f32 v25, v18, v19
    s_waitcnt lgkmcnt(5)
    v_mfma_f32_16x16x32_bf16 v[96:99], v[72:75], v[152:155], v[96:99]
    ds_read_b64_tr_b16 v[70:71], v2 offset:49664
    v_fma_f32 v20, v84, v60, v12
    v_fma_f32 v21, v85, v60, v13
    v_mfma_f32_16x16x32_bf16 v[104:107], v[72:75], v[156:159], v[104:107]
    ds_read_b64_tr_b16 v[72:73], v1 offset:53248
    v_fma_f32 v22, v86, v60, v14
    s_waitcnt lgkmcnt(5)
    v_mfma_f32_16x16x32_bf16 v[100:103], v[76:79], v[152:155], v[100:103]
    ds_read_b64_tr_b16 v[74:75], v1 offset:53760
    v_fma_f32 v23, v87, v60, v15
    v_exp_f32 v40, v20
    v_mfma_f32_16x16x32_bf16 v[108:111], v[76:79], v[156:159], v[108:111]
    ds_read_b64_tr_b16 v[76:77], v2 offset:53248
    ds_read_b64_tr_b16 v[78:79], v2 offset:53760
    v_exp_f32 v41, v21
    s_waitcnt vmcnt(5)
    s_barrier
    s_waitcnt lgkmcnt(6)
    v_mfma_f32_16x16x32_bf16 v[96:99], v[64:67], v[160:163], v[96:99]
    v_exp_f32 v42, v22
    v_exp_f32 v43, v23
    v_mfma_f32_16x16x32_bf16 v[104:107], v[64:67], v[164:167], v[104:107]
    ds_read_b64_tr_b16 v[64:65], v1 offset:57344
    s_add_u32 m0, s9, 40960
    s_add_u32 s10, s72, 73728
    buffer_load_dwordx4 v4, s[56:59], s10 offen lds
    v_fma_f32 v44, v40, -0.5, -1.0
    v_fma_f32 v45, v41, -0.5, -1.0
    s_waitcnt lgkmcnt(5)
    v_mfma_f32_16x16x32_bf16 v[100:103], v[68:71], v[160:163], v[100:103]
    ds_read_b64_tr_b16 v[66:67], v1 offset:57856
    v_fma_f32 v46, v42, -0.5, -1.0
    v_fma_f32 v47, v43, -0.5, -1.0
    v_mfma_f32_16x16x32_bf16 v[108:111], v[68:71], v[164:167], v[108:111]
    ds_read_b64_tr_b16 v[68:69], v2 offset:57344
    v_fma_f32 v44, v40, v44, -1.0
    s_waitcnt lgkmcnt(5)
    v_mfma_f32_16x16x32_bf16 v[96:99], v[72:75], v[168:171], v[96:99]
    ds_read_b64_tr_b16 v[70:71], v2 offset:57856
    v_fma_f32 v45, v41, v45, -1.0
    v_fma_f32 v46, v42, v46, -1.0
    v_mfma_f32_16x16x32_bf16 v[104:107], v[72:75], v[172:175], v[104:107]
    ds_read_b64_tr_b16 v[72:73], v1 offset:61440
    v_fma_f32 v47, v43, v47, -1.0
    v_rcp_f32 v44, v44
    s_waitcnt lgkmcnt(5)
    v_mfma_f32_16x16x32_bf16 v[100:103], v[76:79], v[168:171], v[100:103]
    ds_read_b64_tr_b16 v[74:75], v1 offset:61952
    v_rcp_f32 v45, v45
    v_rcp_f32 v46, v46
    v_mfma_f32_16x16x32_bf16 v[108:111], v[76:79], v[172:175], v[108:111]
    ds_read_b64_tr_b16 v[76:77], v2 offset:61440
    ds_read_b64_tr_b16 v[78:79], v2 offset:61952
    v_rcp_f32 v47, v47
    s_waitcnt vmcnt(5)
    s_barrier
    s_waitcnt lgkmcnt(6)
    v_mfma_f32_16x16x32_bf16 v[96:99], v[64:67], v[176:179], v[96:99]
    v_fmac_f32 v20, v20, v44
    v_fmac_f32 v21, v21, v45
    v_mfma_f32_16x16x32_bf16 v[104:107], v[64:67], v[180:183], v[104:107]
    ds_read_b64_tr_b16 v[64:65], v1 offset:0
    s_add_u32 m0, s9, 49152
    s_add_u32 s10, s72, 147456
    buffer_load_dwordx4 v4, s[56:59], s10 offen lds
    v_fmac_f32 v22, v22, v46
    s_waitcnt lgkmcnt(5)
    v_mfma_f32_16x16x32_bf16 v[100:103], v[68:71], v[176:179], v[100:103]
    ds_read_b64_tr_b16 v[66:67], v1 offset:512
    v_fmac_f32 v23, v23, v47
    v_cvt_pk_bf16_f32 v26, v20, v21
    v_mfma_f32_16x16x32_bf16 v[108:111], v[68:71], v[180:183], v[108:111]
    ds_read_b64_tr_b16 v[68:69], v2 offset:0
    v_cvt_pk_bf16_f32 v27, v22, v23
    ds_write_b128 v6, v[24:27] offset:16384
    s_waitcnt lgkmcnt(6)
    v_mfma_f32_16x16x32_bf16 v[96:99], v[72:75], v[184:187], v[96:99]
    ds_read_b64_tr_b16 v[70:71], v2 offset:512
    v_fma_f32 v16, v88, v61, v8
    v_fma_f32 v17, v89, v61, v9
    v_mfma_f32_16x16x32_bf16 v[104:107], v[72:75], v[188:191], v[104:107]
    ds_read_b64_tr_b16 v[72:73], v1 offset:4096
    v_fma_f32 v18, v90, v61, v10
    ds_read_b128 v[112:115], v7 offset:0
    s_waitcnt lgkmcnt(7)
    v_mfma_f32_16x16x32_bf16 v[100:103], v[76:79], v[184:187], v[100:103]
    ds_read_b64_tr_b16 v[74:75], v1 offset:4608
    v_fma_f32 v19, v91, v61, v11
    v_exp_f32 v32, v16
    v_mfma_f32_16x16x32_bf16 v[108:111], v[76:79], v[188:191], v[108:111]
    ds_read_b64_tr_b16 v[76:77], v2 offset:4096
    ds_read_b64_tr_b16 v[78:79], v2 offset:4608
    v_exp_f32 v33, v17
    ds_read_b128 v[116:119], v7 offset:1024
    s_waitcnt vmcnt(5)
    s_barrier
    s_waitcnt lgkmcnt(9)
    v_mfma_f32_16x16x32_bf16 v[96:99], v[64:67], v[192:195], v[96:99]
    v_exp_f32 v34, v18
    v_exp_f32 v35, v19
    v_mfma_f32_16x16x32_bf16 v[104:107], v[64:67], v[196:199], v[104:107]
    ds_read_b64_tr_b16 v[64:65], v1 offset:8192
    s_add_u32 m0, s9, 57344
    s_add_u32 s10, s72, 221184
    buffer_load_dwordx4 v4, s[56:59], s10 offen lds
    v_fma_f32 v36, v32, -0.5, -1.0
    v_fma_f32 v37, v33, -0.5, -1.0
    ds_read_b128 v[120:123], v7 offset:2048
    s_waitcnt lgkmcnt(8)
    v_mfma_f32_16x16x32_bf16 v[100:103], v[68:71], v[192:195], v[100:103]
    ds_read_b64_tr_b16 v[66:67], v1 offset:8704
    v_fma_f32 v38, v34, -0.5, -1.0
    v_fma_f32 v39, v35, -0.5, -1.0
    v_mfma_f32_16x16x32_bf16 v[108:111], v[68:71], v[196:199], v[108:111]
    ds_read_b64_tr_b16 v[68:69], v2 offset:8192
    v_fma_f32 v36, v32, v36, -1.0
    ds_read_b128 v[124:127], v7 offset:3072
    s_waitcnt lgkmcnt(8)
    v_mfma_f32_16x16x32_bf16 v[96:99], v[72:75], v[200:203], v[96:99]
    ds_read_b64_tr_b16 v[70:71], v2 offset:8704
    v_fma_f32 v37, v33, v37, -1.0
    v_fma_f32 v38, v34, v38, -1.0
    v_mfma_f32_16x16x32_bf16 v[104:107], v[72:75], v[204:207], v[104:107]
    ds_read_b64_tr_b16 v[72:73], v1 offset:12288
    v_fma_f32 v39, v35, v39, -1.0
    ds_read_b128 v[128:131], v7 offset:4096
    s_waitcnt lgkmcnt(9)
    v_mfma_f32_16x16x32_bf16 v[100:103], v[76:79], v[200:203], v[100:103]
    ds_read_b64_tr_b16 v[74:75], v1 offset:12800
    v_rcp_f32 v36, v36
    v_rcp_f32 v37, v37
    v_mfma_f32_16x16x32_bf16 v[108:111], v[76:79], v[204:207], v[108:111]
    ds_read_b64_tr_b16 v[76:77], v2 offset:12288
    ds_read_b64_tr_b16 v[78:79], v2 offset:12800
    v_rcp_f32 v38, v38
    v_rcp_f32 v39, v39
    ds_read_b128 v[132:135], v7 offset:5120
    s_waitcnt vmcnt(5)
    s_barrier
    s_waitcnt lgkmcnt(9)
    v_mfma_f32_16x16x32_bf16 v[96:99], v[64:67], v[208:211], v[96:99]
    v_fmac_f32 v16, v16, v36
    v_fmac_f32 v17, v17, v37
    v_mfma_f32_16x16x32_bf16 v[104:107], v[64:67], v[212:215], v[104:107]
    ds_read_b64_tr_b16 v[64:65], v1 offset:16384
    s_add_u32 m0, s9, 0
    s_add_u32 s10, s72, 294912
    buffer_load_dwordx4 v4, s[56:59], s10 offen lds
    v_fmac_f32 v18, v18, v38
    ds_read_b128 v[136:139], v7 offset:6144
    s_waitcnt lgkmcnt(8)
    v_mfma_f32_16x16x32_bf16 v[100:103], v[68:71], v[208:211], v[100:103]
    ds_read_b64_tr_b16 v[66:67], v1 offset:16896
    v_fmac_f32 v19, v19, v39
    v_cvt_pk_bf16_f32 v28, v16, v17
    v_mfma_f32_16x16x32_bf16 v[108:111], v[68:71], v[212:215], v[108:111]
    ds_read_b64_tr_b16 v[68:69], v2 offset:16384
    v_cvt_pk_bf16_f32 v29, v18, v19
    v_fma_f32 v20, v92, v61, v12
    ds_read_b128 v[140:143], v7 offset:7168
    s_waitcnt lgkmcnt(8)
    v_mfma_f32_16x16x32_bf16 v[96:99], v[72:75], v[216:219], v[96:99]
    ds_read_b64_tr_b16 v[70:71], v2 offset:16896
    v_fma_f32 v21, v93, v61, v13
    v_fma_f32 v22, v94, v61, v14
    v_mfma_f32_16x16x32_bf16 v[104:107], v[72:75], v[220:223], v[104:107]
    ds_read_b64_tr_b16 v[72:73], v1 offset:20480
    v_fma_f32 v23, v95, v61, v15
    ds_read_b128 v[144:147], v7 offset:8192
    s_waitcnt lgkmcnt(9)
    v_mfma_f32_16x16x32_bf16 v[100:103], v[76:79], v[216:219], v[100:103]
    ds_read_b64_tr_b16 v[74:75], v1 offset:20992
    v_exp_f32 v40, v20
    v_exp_f32 v41, v21
    v_mfma_f32_16x16x32_bf16 v[108:111], v[76:79], v[220:223], v[108:111]
    ds_read_b64_tr_b16 v[76:77], v2 offset:20480
    ds_read_b64_tr_b16 v[78:79], v2 offset:20992
    v_exp_f32 v42, v22
    ds_read_b128 v[148:151], v7 offset:9216
    s_waitcnt vmcnt(5)
    s_barrier
    s_waitcnt lgkmcnt(9)
    v_mfma_f32_16x16x32_bf16 v[96:99], v[64:67], v[224:227], v[96:99]
    v_exp_f32 v43, v23
    v_fma_f32 v44, v40, -0.5, -1.0
    v_mfma_f32_16x16x32_bf16 v[104:107], v[64:67], v[228:231], v[104:107]
    ds_read_b64_tr_b16 v[64:65], v1 offset:24576
    s_add_u32 m0, s9, 8192
    s_add_u32 s10, s72, 368640
    buffer_load_dwordx4 v4, s[56:59], s10 offen lds
    v_fma_f32 v45, v41, -0.5, -1.0
    v_fma_f32 v46, v42, -0.5, -1.0
    ds_read_b128 v[152:155], v7 offset:10240
    s_waitcnt lgkmcnt(8)
    v_mfma_f32_16x16x32_bf16 v[100:103], v[68:71], v[224:227], v[100:103]
    ds_read_b64_tr_b16 v[66:67], v1 offset:25088
    v_fma_f32 v47, v43, -0.5, -1.0
    v_fma_f32 v44, v40, v44, -1.0
    v_mfma_f32_16x16x32_bf16 v[108:111], v[68:71], v[228:231], v[108:111]
    ds_read_b64_tr_b16 v[68:69], v2 offset:24576
    v_fma_f32 v45, v41, v45, -1.0
    ds_read_b128 v[156:159], v7 offset:11264
    s_waitcnt lgkmcnt(8)
    v_mfma_f32_16x16x32_bf16 v[96:99], v[72:75], v[232:235], v[96:99]
    ds_read_b64_tr_b16 v[70:71], v2 offset:25088
    v_fma_f32 v46, v42, v46, -1.0
    v_fma_f32 v47, v43, v47, -1.0
    v_mfma_f32_16x16x32_bf16 v[104:107], v[72:75], v[236:239], v[104:107]
    ds_read_b64_tr_b16 v[72:73], v1 offset:28672
    v_rcp_f32 v44, v44
    ds_read_b128 v[160:163], v7 offset:12288
    s_waitcnt lgkmcnt(9)
    v_mfma_f32_16x16x32_bf16 v[100:103], v[76:79], v[232:235], v[100:103]
    ds_read_b64_tr_b16 v[74:75], v1 offset:29184
    v_mfma_f32_16x16x32_bf16 v[108:111], v[76:79], v[236:239], v[108:111]
    ds_read_b64_tr_b16 v[76:77], v2 offset:28672
    ds_read_b64_tr_b16 v[78:79], v2 offset:29184
    v_bfe_u32 v58, v0, 4, 1
    v_lshlrev_b32 v58, 9, v58
    v_sub_u32 v1, v1, v58
    v_sub_u32 v2, v2, v58
    v_rcp_f32 v45, v45
    v_rcp_f32 v46, v46
    v_rcp_f32 v47, v47
    v_fmac_f32 v20, v20, v44
    ds_read_b128 v[164:167], v7 offset:13312
    s_waitcnt vmcnt(5)
    s_barrier
    s_waitcnt lgkmcnt(9)
    v_mfma_f32_16x16x32_bf16 v[96:99], v[64:67], v[240:243], v[96:99]
    v_fmac_f32 v21, v21, v45
    v_fmac_f32 v22, v22, v46
    v_mfma_f32_16x16x32_bf16 v[104:107], v[64:67], v[244:247], v[104:107]
    ds_read_b64_tr_b16 v[64:65], v1 offset:32768
    s_add_u32 m0, s9, 16384
    s_add_u32 s10, s72, 128
    buffer_load_dwordx4 v4, s[56:59], s10 offen lds
    v_fmac_f32 v23, v23, v47
    ds_read_b128 v[168:171], v7 offset:14336
    s_waitcnt lgkmcnt(8)
    v_mfma_f32_16x16x32_bf16 v[100:103], v[68:71], v[240:243], v[100:103]
    ds_read_b64_tr_b16 v[66:67], v1 offset:33792
    v_cvt_pk_bf16_f32 v30, v20, v21
    v_cvt_pk_bf16_f32 v31, v22, v23
    v_mfma_f32_16x16x32_bf16 v[108:111], v[68:71], v[244:247], v[108:111]
    ds_read_b64_tr_b16 v[68:69], v2 offset:32768
    ds_write_b128 v6, v[28:31] offset:17408
    ds_read_b128 v[172:175], v7 offset:15360
    s_waitcnt lgkmcnt(9)
    v_mfma_f32_16x16x32_bf16 v[96:99], v[72:75], v[248:251], v[96:99]
    ds_read_b64_tr_b16 v[70:71], v2 offset:33792
    v_mfma_f32_16x16x32_bf16 v[104:107], v[72:75], v[252:255], v[104:107]
    ds_read_b64_tr_b16 v[72:73], v1 offset:36864
    s_waitcnt lgkmcnt(9)
    v_mfma_f32_16x16x32_bf16 v[100:103], v[76:79], v[248:251], v[100:103]
    ds_read_b64_tr_b16 v[74:75], v1 offset:37888
    v_mfma_f32_16x16x32_bf16 v[108:111], v[76:79], v[252:255], v[108:111]
    ds_read_b64_tr_b16 v[76:77], v2 offset:36864
    ds_read_b64_tr_b16 v[78:79], v2 offset:37888
    s_waitcnt lgkmcnt(6)
    s_waitcnt vmcnt(5)
    s_barrier
    v_mfma_f32_16x16x32_bf16 v[80:83], v[64:67], v[112:115], 0
    v_mfma_f32_16x16x32_bf16 v[88:91], v[64:67], v[116:119], 0
    ds_read_b64_tr_b16 v[64:65], v1 offset:40960
    s_add_u32 m0, s9, 24576
    s_add_u32 s10, s72, 73856
    buffer_load_dwordx4 v4, s[56:59], s10 offen lds
    ds_read_b128 v[176:179], v7 offset:16384
    s_waitcnt lgkmcnt(6)
    v_mfma_f32_16x16x32_bf16 v[84:87], v[68:71], v[112:115], 0
    ds_read_b64_tr_b16 v[66:67], v1 offset:41984
    v_mfma_f32_16x16x32_bf16 v[92:95], v[68:71], v[116:119], 0
    ds_read_b64_tr_b16 v[68:69], v2 offset:40960
    ds_read_b128 v[8:11], v59 offset:640
    ds_read_b128 v[12:15], v59 offset:672
    s_waitcnt lgkmcnt(1)
    v_fma_f32 v16, v96, v60, v8
    v_fma_f32 v17, v97, v60, v9
    v_fma_f32 v18, v98, v60, v10
    v_fma_f32 v19, v99, v60, v11
    ds_read_b128 v[180:183], v7 offset:17408
    v_mfma_f32_16x16x32_bf16 v[80:83], v[72:75], v[120:123], v[80:83]
    ds_read_b64_tr_b16 v[70:71], v2 offset:41984
    v_exp_f32 v32, v16
    v_exp_f32 v33, v17
    v_mfma_f32_16x16x32_bf16 v[88:91], v[72:75], v[124:127], v[88:91]
    ds_read_b64_tr_b16 v[72:73], v1 offset:45056
    v_exp_f32 v34, v18
    v_exp_f32 v35, v19
    v_fma_f32 v36, v32, -0.5, -1.0
    v_fma_f32 v37, v33, -0.5, -1.0
    v_fma_f32 v38, v34, -0.5, -1.0
    v_fma_f32 v39, v35, -0.5, -1.0
    ds_read_b128 v[184:187], v7 offset:18432
    v_mfma_f32_16x16x32_bf16 v[84:87], v[76:79], v[120:123], v[84:87]
    ds_read_b64_tr_b16 v[74:75], v1 offset:46080
    v_fma_f32 v36, v32, v36, -1.0
    v_fma_f32 v37, v33, v37, -1.0
    v_mfma_f32_16x16x32_bf16 v[92:95], v[76:79], v[124:127], v[92:95]
    ds_read_b64_tr_b16 v[76:77], v2 offset:45056
    ds_read_b64_tr_b16 v[78:79], v2 offset:46080
    v_fma_f32 v38, v34, v38, -1.0
    v_fma_f32 v39, v35, v39, -1.0
    v_rcp_f32 v36, v36
    v_rcp_f32 v37, v37
    v_rcp_f32 v38, v38
    v_rcp_f32 v39, v39
    ds_read_b128 v[188:191], v7 offset:19456
    s_waitcnt vmcnt(5)
    s_barrier
    v_mfma_f32_16x16x32_bf16 v[80:83], v[64:67], v[128:131], v[80:83]
    v_fmac_f32 v16, v16, v36
    v_fmac_f32 v17, v17, v37
    v_mfma_f32_16x16x32_bf16 v[88:91], v[64:67], v[132:135], v[88:91]
    ds_read_b64_tr_b16 v[64:65], v1 offset:49152
    s_add_u32 m0, s9, 32768
    s_add_u32 s10, s72, 147584
    buffer_load_dwordx4 v4, s[56:59], s10 offen lds
    v_fmac_f32 v18, v18, v38
    v_fmac_f32 v19, v19, v39
    v_cvt_pk_bf16_f32 v24, v16, v17
    v_cvt_pk_bf16_f32 v25, v18, v19
    s_waitcnt lgkmcnt(9)
    v_fma_f32 v20, v100, v60, v12
    s_waitcnt lgkmcnt(7)
    v_mfma_f32_16x16x32_bf16 v[84:87], v[68:71], v[128:131], v[84:87]
    ds_read_b64_tr_b16 v[66:67], v1 offset:50176
    v_fma_f32 v21, v101, v60, v13
    v_fma_f32 v22, v102, v60, v14
    v_mfma_f32_16x16x32_bf16 v[92:95], v[68:71], v[132:135], v[92:95]
    ds_read_b64_tr_b16 v[68:69], v2 offset:49152
    v_fma_f32 v23, v103, v60, v15
    v_exp_f32 v40, v20
    v_exp_f32 v41, v21
    v_exp_f32 v42, v22
    v_exp_f32 v43, v23
    v_fma_f32 v44, v40, -0.5, -1.0
    s_waitcnt lgkmcnt(6)
    v_mfma_f32_16x16x32_bf16 v[80:83], v[72:75], v[136:139], v[80:83]
    ds_read_b64_tr_b16 v[70:71], v2 offset:50176
    v_fma_f32 v45, v41, -0.5, -1.0
    v_fma_f32 v46, v42, -0.5, -1.0
    v_mfma_f32_16x16x32_bf16 v[88:91], v[72:75], v[140:143], v[88:91]
    ds_read_b64_tr_b16 v[72:73], v1 offset:53248
    v_fma_f32 v47, v43, -0.5, -1.0
    v_fma_f32 v44, v40, v44, -1.0
    v_fma_f32 v45, v41, v45, -1.0
    v_fma_f32 v46, v42, v46, -1.0
    v_fma_f32 v47, v43, v47, -1.0
    v_rcp_f32 v44, v44
    s_waitcnt lgkmcnt(6)
    v_mfma_f32_16x16x32_bf16 v[84:87], v[76:79], v[136:139], v[84:87]
    ds_read_b64_tr_b16 v[74:75], v1 offset:54272
    v_rcp_f32 v45, v45
    v_rcp_f32 v46, v46
    v_mfma_f32_16x16x32_bf16 v[92:95], v[76:79], v[140:143], v[92:95]
    ds_read_b64_tr_b16 v[76:77], v2 offset:53248
    ds_read_b64_tr_b16 v[78:79], v2 offset:54272
    v_rcp_f32 v47, v47
    v_fmac_f32 v20, v20, v44
    v_fmac_f32 v21, v21, v45
    v_fmac_f32 v22, v22, v46
    v_fmac_f32 v23, v23, v47
    v_cvt_pk_bf16_f32 v26, v20, v21
    s_waitcnt vmcnt(5)
    s_barrier
    s_waitcnt lgkmcnt(6)
    v_mfma_f32_16x16x32_bf16 v[80:83], v[64:67], v[144:147], v[80:83]
    v_cvt_pk_bf16_f32 v27, v22, v23
    v_mfma_f32_16x16x32_bf16 v[88:91], v[64:67], v[148:151], v[88:91]
    ds_read_b64_tr_b16 v[64:65], v1 offset:57344
    s_add_u32 m0, s9, 40960
    s_add_u32 s10, s72, 221312
    buffer_load_dwordx4 v4, s[56:59], s10 offen lds
    ds_write_b128 v6, v[24:27] offset:20480
    v_fma_f32 v16, v104, v61, v8
    v_fma_f32 v17, v105, v61, v9
    v_fma_f32 v18, v106, v61, v10
    v_fma_f32 v19, v107, v61, v11
    v_exp_f32 v32, v16
    v_exp_f32 v33, v17
    s_waitcnt lgkmcnt(6)
    v_mfma_f32_16x16x32_bf16 v[84:87], v[68:71], v[144:147], v[84:87]
    ds_read_b64_tr_b16 v[66:67], v1 offset:58368
    v_exp_f32 v34, v18
    v_exp_f32 v35, v19
    v_mfma_f32_16x16x32_bf16 v[92:95], v[68:71], v[148:151], v[92:95]
    ds_read_b64_tr_b16 v[68:69], v2 offset:57344
    v_fma_f32 v36, v32, -0.5, -1.0
    v_fma_f32 v37, v33, -0.5, -1.0
    v_fma_f32 v38, v34, -0.5, -1.0
    v_fma_f32 v39, v35, -0.5, -1.0
    v_fma_f32 v36, v32, v36, -1.0
    v_fma_f32 v37, v33, v37, -1.0
    s_waitcnt lgkmcnt(6)
    v_mfma_f32_16x16x32_bf16 v[80:83], v[72:75], v[152:155], v[80:83]
    ds_read_b64_tr_b16 v[70:71], v2 offset:58368
    v_fma_f32 v38, v34, v38, -1.0
    v_fma_f32 v39, v35, v39, -1.0
    v_mfma_f32_16x16x32_bf16 v[88:91], v[72:75], v[156:159], v[88:91]
    ds_read_b64_tr_b16 v[72:73], v1 offset:61440
    v_rcp_f32 v36, v36
    v_rcp_f32 v37, v37
    v_rcp_f32 v38, v38
    v_rcp_f32 v39, v39
    v_fmac_f32 v16, v16, v36
    v_fmac_f32 v17, v17, v37
    s_waitcnt lgkmcnt(6)
    v_mfma_f32_16x16x32_bf16 v[84:87], v[76:79], v[152:155], v[84:87]
    ds_read_b64_tr_b16 v[74:75], v1 offset:62464
    v_fmac_f32 v18, v18, v38
    v_fmac_f32 v19, v19, v39
    v_mfma_f32_16x16x32_bf16 v[92:95], v[76:79], v[156:159], v[92:95]
    ds_read_b64_tr_b16 v[76:77], v2 offset:61440
    ds_read_b64_tr_b16 v[78:79], v2 offset:62464
    v_cvt_pk_bf16_f32 v28, v16, v17
    v_cvt_pk_bf16_f32 v29, v18, v19
    v_fma_f32 v20, v108, v61, v12
    v_fma_f32 v21, v109, v61, v13
    v_fma_f32 v22, v110, v61, v14
    v_fma_f32 v23, v111, v61, v15
    s_waitcnt vmcnt(5)
    s_barrier
    s_waitcnt lgkmcnt(6)
    v_mfma_f32_16x16x32_bf16 v[80:83], v[64:67], v[160:163], v[80:83]
    v_exp_f32 v40, v20
    v_exp_f32 v41, v21
    v_mfma_f32_16x16x32_bf16 v[88:91], v[64:67], v[164:167], v[88:91]
    ds_read_b64_tr_b16 v[64:65], v1 offset:0
    s_add_u32 m0, s9, 49152
    s_add_u32 s10, s72, 295040
    buffer_load_dwordx4 v4, s[56:59], s10 offen lds
    v_exp_f32 v42, v22
    v_exp_f32 v43, v23
    v_fma_f32 v44, v40, -0.5, -1.0
    v_fma_f32 v45, v41, -0.5, -1.0
    v_fma_f32 v46, v42, -0.5, -1.0
    v_fma_f32 v47, v43, -0.5, -1.0
    s_waitcnt lgkmcnt(5)
    v_mfma_f32_16x16x32_bf16 v[84:87], v[68:71], v[160:163], v[84:87]
    ds_read_b64_tr_b16 v[66:67], v1 offset:1024
    v_fma_f32 v44, v40, v44, -1.0
    v_fma_f32 v45, v41, v45, -1.0
    v_mfma_f32_16x16x32_bf16 v[92:95], v[68:71], v[164:167], v[92:95]
    ds_read_b64_tr_b16 v[68:69], v2 offset:0
    v_fma_f32 v46, v42, v46, -1.0
    v_fma_f32 v47, v43, v47, -1.0
    v_rcp_f32 v44, v44
    v_rcp_f32 v45, v45
    v_rcp_f32 v46, v46
    v_rcp_f32 v47, v47
    s_waitcnt lgkmcnt(5)
    v_mfma_f32_16x16x32_bf16 v[80:83], v[72:75], v[168:171], v[80:83]
    ds_read_b64_tr_b16 v[70:71], v2 offset:1024
    v_fmac_f32 v20, v20, v44
    v_fmac_f32 v21, v21, v45
    v_mfma_f32_16x16x32_bf16 v[88:91], v[72:75], v[172:175], v[88:91]
    ds_read_b64_tr_b16 v[72:73], v1 offset:4096
    v_fmac_f32 v22, v22, v46
    v_fmac_f32 v23, v23, v47
    v_cvt_pk_bf16_f32 v30, v20, v21
    v_cvt_pk_bf16_f32 v31, v22, v23
    ds_write_b128 v6, v[28:31] offset:21504
    s_waitcnt lgkmcnt(6)
    v_mfma_f32_16x16x32_bf16 v[84:87], v[76:79], v[168:171], v[84:87]
    ds_read_b64_tr_b16 v[74:75], v1 offset:5120
    v_mfma_f32_16x16x32_bf16 v[92:95], v[76:79], v[172:175], v[92:95]
    ds_read_b64_tr_b16 v[76:77], v2 offset:4096
    ds_read_b64_tr_b16 v[78:79], v2 offset:5120
    s_waitcnt lgkmcnt(3)
    s_waitcnt vmcnt(5)
    s_barrier
    v_mfma_f32_16x16x32_bf16 v[80:83], v[64:67], v[176:179], v[80:83]
    v_mfma_f32_16x16x32_bf16 v[88:91], v[64:67], v[180:183], v[88:91]
    ds_read_b64_tr_b16 v[64:65], v1 offset:8192
    s_add_u32 m0, s9, 57344
    s_add_u32 s10, s72, 368768
    buffer_load_dwordx4 v4, s[56:59], s10 offen lds
    ds_read_b128 v[192:195], v7 offset:20480
    ds_read_b128 v[196:199], v7 offset:21504
    v_mfma_f32_16x16x32_bf16 v[84:87], v[68:71], v[176:179], v[84:87]
    ds_read_b64_tr_b16 v[66:67], v1 offset:9216
    v_mfma_f32_16x16x32_bf16 v[92:95], v[68:71], v[180:183], v[92:95]
    ds_read_b64_tr_b16 v[68:69], v2 offset:8192
    ds_read_b128 v[200:203], v7 offset:22528
    ds_read_b128 v[204:207], v7 offset:23552
    s_waitcnt lgkmcnt(9)
    v_mfma_f32_16x16x32_bf16 v[80:83], v[72:75], v[184:187], v[80:83]
    ds_read_b64_tr_b16 v[70:71], v2 offset:9216
    v_mfma_f32_16x16x32_bf16 v[88:91], v[72:75], v[188:191], v[88:91]
    ds_read_b64_tr_b16 v[72:73], v1 offset:12288
    s_waitcnt lgkmcnt(9)
    v_mfma_f32_16x16x32_bf16 v[84:87], v[76:79], v[184:187], v[84:87]
    ds_read_b64_tr_b16 v[74:75], v1 offset:13312
    v_mfma_f32_16x16x32_bf16 v[92:95], v[76:79], v[188:191], v[92:95]
    ds_read_b64_tr_b16 v[76:77], v2 offset:12288
    ds_read_b64_tr_b16 v[78:79], v2 offset:13312
    s_waitcnt vmcnt(5)
    s_barrier
    s_waitcnt lgkmcnt(8)
    v_mfma_f32_16x16x32_bf16 v[80:83], v[64:67], v[192:195], v[80:83]
    v_mfma_f32_16x16x32_bf16 v[88:91], v[64:67], v[196:199], v[88:91]
    ds_read_b64_tr_b16 v[64:65], v1 offset:16384
    s_add_u32 m0, s9, 0
    s_add_u32 s10, s72, 256
    buffer_load_dwordx4 v4, s[56:59], s10 offen lds
    s_waitcnt lgkmcnt(5)
    v_mfma_f32_16x16x32_bf16 v[84:87], v[68:71], v[192:195], v[84:87]
    ds_read_b64_tr_b16 v[66:67], v1 offset:17408
    v_mfma_f32_16x16x32_bf16 v[92:95], v[68:71], v[196:199], v[92:95]
    ds_read_b64_tr_b16 v[68:69], v2 offset:16384
    s_waitcnt lgkmcnt(5)
    v_mfma_f32_16x16x32_bf16 v[80:83], v[72:75], v[200:203], v[80:83]
    ds_read_b64_tr_b16 v[70:71], v2 offset:17408
    v_mfma_f32_16x16x32_bf16 v[88:91], v[72:75], v[204:207], v[88:91]
    ds_read_b64_tr_b16 v[72:73], v1 offset:20480
    s_waitcnt lgkmcnt(5)
    v_mfma_f32_16x16x32_bf16 v[84:87], v[76:79], v[200:203], v[84:87]
    ds_read_b64_tr_b16 v[74:75], v1 offset:21504
    v_mfma_f32_16x16x32_bf16 v[92:95], v[76:79], v[204:207], v[92:95]
    ds_read_b64_tr_b16 v[76:77], v2 offset:20480
    ds_read_b64_tr_b16 v[78:79], v2 offset:21504
    s_waitcnt vmcnt(5)
    s_barrier
    s_waitcnt lgkmcnt(6)
    v_mfma_f32_16x16x32_bf16 v[96:99], v[64:67], v[112:115], 0
    v_mfma_f32_16x16x32_bf16 v[104:107], v[64:67], v[116:119], 0
    ds_read_b64_tr_b16 v[64:65], v1 offset:24576
    s_add_u32 m0, s9, 8192
    s_add_u32 s10, s72, 73984
    buffer_load_dwordx4 v4, s[56:59], s10 offen lds
    s_waitcnt lgkmcnt(5)
    v_mfma_f32_16x16x32_bf16 v[100:103], v[68:71], v[112:115], 0
    ds_read_b64_tr_b16 v[66:67], v1 offset:25600
    v_mfma_f32_16x16x32_bf16 v[108:111], v[68:71], v[116:119], 0
    ds_read_b64_tr_b16 v[68:69], v2 offset:24576
    s_waitcnt lgkmcnt(5)
    v_mfma_f32_16x16x32_bf16 v[96:99], v[72:75], v[120:123], v[96:99]
    ds_read_b64_tr_b16 v[70:71], v2 offset:25600
    v_mfma_f32_16x16x32_bf16 v[104:107], v[72:75], v[124:127], v[104:107]
    ds_read_b64_tr_b16 v[72:73], v1 offset:28672
    s_waitcnt lgkmcnt(5)
    v_mfma_f32_16x16x32_bf16 v[100:103], v[76:79], v[120:123], v[100:103]
    ds_read_b64_tr_b16 v[74:75], v1 offset:29696
    v_mfma_f32_16x16x32_bf16 v[108:111], v[76:79], v[124:127], v[108:111]
    ds_read_b64_tr_b16 v[76:77], v2 offset:28672
    ds_read_b64_tr_b16 v[78:79], v2 offset:29696
    v_cvt_pk_bf16_f32 v24, v80, v81
    s_waitcnt vmcnt(5)
    s_barrier
    s_waitcnt lgkmcnt(6)
    v_mfma_f32_16x16x32_bf16 v[96:99], v[64:67], v[128:131], v[96:99]
    v_cvt_pk_bf16_f32 v25, v82, v83
    v_cvt_pk_bf16_f32 v26, v84, v85
    v_mfma_f32_16x16x32_bf16 v[104:107], v[64:67], v[132:135], v[104:107]
    ds_read_b64_tr_b16 v[64:65], v1 offset:32768
    s_add_u32 m0, s9, 16384
    s_add_u32 s10, s72, 147712
    buffer_load_dwordx4 v4, s[56:59], s10 offen lds
    s_lshl_b32 s76, s5, 8
    s_waitcnt lgkmcnt(5)
    v_mfma_f32_16x16x32_bf16 v[100:103], v[68:71], v[128:131], v[100:103]
    ds_read_b64_tr_b16 v[66:67], v1 offset:33792
    v_cvt_pk_bf16_f32 v27, v86, v87
    v_mfma_f32_16x16x32_bf16 v[108:111], v[68:71], v[132:135], v[108:111]
    ds_read_b64_tr_b16 v[68:69], v2 offset:32768
    v_and_b32 v63, 31, v0
    s_waitcnt lgkmcnt(5)
    v_mfma_f32_16x16x32_bf16 v[96:99], v[72:75], v[136:139], v[96:99]
    ds_read_b64_tr_b16 v[70:71], v2 offset:33792
    s_mov_b32 s11, 0
    v_mfma_f32_16x16x32_bf16 v[104:107], v[72:75], v[140:143], v[104:107]
    ds_read_b64_tr_b16 v[72:73], v1 offset:36864
    buffer_store_dwordx4 v[24:27], v5, s[60:63], s11 offen sc1
    v_lshl_add_u32 v63, v63, 3, s76
    s_waitcnt lgkmcnt(5)
    v_mfma_f32_16x16x32_bf16 v[100:103], v[76:79], v[136:139], v[100:103]
    ds_read_b64_tr_b16 v[74:75], v1 offset:37888
    v_cvt_pk_bf16_f32 v28, v88, v89
    v_cvt_pk_bf16_f32 v29, v90, v91
    v_mfma_f32_16x16x32_bf16 v[108:111], v[76:79], v[140:143], v[108:111]
    ds_read_b64_tr_b16 v[76:77], v2 offset:36864
    ds_read_b64_tr_b16 v[78:79], v2 offset:37888
    ds_write_b64 v63, v[56:57]
    s_waitcnt vmcnt(6)
    s_barrier
    s_waitcnt lgkmcnt(7)
    v_mfma_f32_16x16x32_bf16 v[96:99], v[64:67], v[144:147], v[96:99]
    v_cvt_pk_bf16_f32 v30, v92, v93
    v_mfma_f32_16x16x32_bf16 v[104:107], v[64:67], v[148:151], v[104:107]
    ds_read_b64_tr_b16 v[64:65], v1 offset:40960
    s_add_u32 m0, s9, 24576
    s_add_u32 s10, s72, 221440
    buffer_load_dwordx4 v4, s[56:59], s10 offen lds
    s_waitcnt lgkmcnt(6)
    v_mfma_f32_16x16x32_bf16 v[100:103], v[68:71], v[144:147], v[100:103]
    ds_read_b64_tr_b16 v[66:67], v1 offset:41984
    v_cvt_pk_bf16_f32 v31, v94, v95
    s_mov_b32 s11, 512
    v_mfma_f32_16x16x32_bf16 v[108:111], v[68:71], v[148:151], v[108:111]
    ds_read_b64_tr_b16 v[68:69], v2 offset:40960
    s_waitcnt lgkmcnt(6)
    v_mfma_f32_16x16x32_bf16 v[96:99], v[72:75], v[152:155], v[96:99]
    ds_read_b64_tr_b16 v[70:71], v2 offset:41984
    v_mfma_f32_16x16x32_bf16 v[104:107], v[72:75], v[156:159], v[104:107]
    ds_read_b64_tr_b16 v[72:73], v1 offset:45056
    buffer_store_dwordx4 v[28:31], v5, s[60:63], s11 offen sc1
    s_waitcnt lgkmcnt(6)
    v_mfma_f32_16x16x32_bf16 v[100:103], v[76:79], v[152:155], v[100:103]
    ds_read_b64_tr_b16 v[74:75], v1 offset:46080
    v_mfma_f32_16x16x32_bf16 v[108:111], v[76:79], v[156:159], v[108:111]
    ds_read_b64_tr_b16 v[76:77], v2 offset:45056
    ds_read_b64_tr_b16 v[78:79], v2 offset:46080
    s_waitcnt lgkmcnt(8)
    s_waitcnt vmcnt(7)
    s_barrier
    s_waitcnt lgkmcnt(6)
    v_mfma_f32_16x16x32_bf16 v[96:99], v[64:67], v[160:163], v[96:99]
    v_mfma_f32_16x16x32_bf16 v[104:107], v[64:67], v[164:167], v[104:107]
    ds_read_b64_tr_b16 v[64:65], v1 offset:49152
    s_add_u32 m0, s9, 32768
    s_add_u32 s10, s72, 295168
    buffer_load_dwordx4 v4, s[56:59], s10 offen lds
    s_mov_b32 s84, s42
    s_and_b32 s85, s43, 0xffff
    s_mov_b32 s86, 4718592
    s_mov_b32 s87, 0x00020000
    s_mov_b32 s88, s32
    s_and_b32 s89, s33, 0xffff
    s_mov_b32 s90, 1152
    s_mov_b32 s91, 0x00020000
    s_mov_b32 s98, 0
    v_mov_b32 v58, 0x40000000
    s_mov_b32 s96, 0x0fff0fff
    s_mov_b32 s97, 0x0fff0fff
    s_add_u32 s73, s77, 1
    s_waitcnt lgkmcnt(5)
    v_mfma_f32_16x16x32_bf16 v[100:103], v[68:71], v[160:163], v[100:103]
    ds_read_b64_tr_b16 v[66:67], v1 offset:50176
    v_mfma_f32_16x16x32_bf16 v[108:111], v[68:71], v[164:167], v[108:111]
    ds_read_b64_tr_b16 v[68:69], v2 offset:49152
    s_add_u32 s74, s77, 4
    s_add_u32 s75, s77, 7
    s_and_b32 s11, s4, 1
    s_lshl_b32 s11, s11, 4
    s_lshl_b32 s76, s78, 5
    s_waitcnt lgkmcnt(5)
    v_mfma_f32_16x16x32_bf16 v[96:99], v[72:75], v[168:171], v[96:99]
    ds_read_b64_tr_b16 v[70:71], v2 offset:50176
    v_mfma_f32_16x16x32_bf16 v[104:107], v[72:75], v[172:175], v[104:107]
    ds_read_b64_tr_b16 v[72:73], v1 offset:53248
    s_add_u32 s11, s11, s76
    v_and_b32 v63, 15, v0
    v_add_u32 v63, s11, v63
    v_lshlrev_b32 v61, 3, v63
    ds_read_b64 v[22:23], v61
    s_lshl_b32 s11, s7, 7
    s_waitcnt lgkmcnt(6)
    v_mfma_f32_16x16x32_bf16 v[100:103], v[76:79], v[168:171], v[100:103]
    ds_read_b64_tr_b16 v[74:75], v1 offset:54272
    v_mfma_f32_16x16x32_bf16 v[108:111], v[76:79], v[172:175], v[108:111]
    ds_read_b64_tr_b16 v[76:77], v2 offset:53248
    ds_read_b64_tr_b16 v[78:79], v2 offset:54272
    v_add_u32 v63, s11, v63
    s_lshr_b32 s11, s4, 1
    s_lshl2_add_u32 s76, s77, s11
    s_lshl_b32 s11, s76, 4
    v_lshrrev_b32 v62, 4, v0
    s_waitcnt vmcnt(7)
    s_barrier
    s_waitcnt lgkmcnt(7)
    v_mfma_f32_16x16x32_bf16 v[96:99], v[64:67], v[176:179], v[96:99]
    v_mfma_f32_16x16x32_bf16 v[104:107], v[64:67], v[180:183], v[104:107]
    ds_read_b64_tr_b16 v[64:65], v1 offset:57344
    s_add_u32 m0, s9, 40960
    s_add_u32 s10, s72, 368896
    buffer_load_dwordx4 v4, s[56:59], s10 offen lds
    v_lshl_add_u32 v62, v62, 2, s11
    v_mul_u32_u24 v63, 576, v63
    v_add_u32 v63, v63, v62
    v_lshlrev_b32 v21, 2, v63
    v_lshlrev_b32 v63, 1, v63
    v_lshlrev_b32 v62, 1, v62
    s_waitcnt lgkmcnt(6)
    v_mfma_f32_16x16x32_bf16 v[100:103], v[68:71], v[176:179], v[100:103]
    ds_read_b64_tr_b16 v[66:67], v1 offset:58368
    v_mfma_f32_16x16x32_bf16 v[108:111], v[68:71], v[180:183], v[108:111]
    ds_read_b64_tr_b16 v[68:69], v2 offset:57344
    buffer_load_dwordx2 v[8:9], v63, s[48:51], 0 offen offset:0
    buffer_load_dwordx2 v[14:15], v62, s[88:91], 0 offen offset:0
    buffer_load_dwordx2 v[10:11], v63, s[48:51], 0 offen offset:384
    buffer_load_dwordx2 v[16:17], v62, s[88:91], 0 offen offset:384
    buffer_load_dwordx2 v[12:13], v63, s[48:51], 0 offen offset:768
    s_waitcnt lgkmcnt(5)
    v_mfma_f32_16x16x32_bf16 v[96:99], v[72:75], v[184:187], v[96:99]
    ds_read_b64_tr_b16 v[70:71], v2 offset:58368
    v_mfma_f32_16x16x32_bf16 v[104:107], v[72:75], v[188:191], v[104:107]
    ds_read_b64_tr_b16 v[72:73], v1 offset:61440
    buffer_load_dwordx2 v[18:19], v62, s[88:91], 0 offen offset:768
    s_lshl2_add_u32 s11, s7, s78
    s_mul_i32 s11, s11, 36
    s_add_u32 s11, s11, s76
    s_lshl_b32 s11, s11, 14
    s_and_b32 s76, s4, 1
    s_waitcnt lgkmcnt(5)
    v_mfma_f32_16x16x32_bf16 v[100:103], v[76:79], v[184:187], v[100:103]
    ds_read_b64_tr_b16 v[74:75], v1 offset:62464
    v_mfma_f32_16x16x32_bf16 v[108:111], v[76:79], v[188:191], v[108:111]
    ds_read_b64_tr_b16 v[76:77], v2 offset:61440
    ds_read_b64_tr_b16 v[78:79], v2 offset:62464
    s_lshl_b32 s76, s76, 9
    s_add_u32 s11, s11, s76
    s_add_u32 s11, s11, 1048576
    v_and_b32 v20, 31, v0
    v_lshl_add_u32 v20, v20, 4, s11
    s_waitcnt vmcnt(13)
    s_barrier
    s_waitcnt lgkmcnt(6)
    v_mfma_f32_16x16x32_bf16 v[96:99], v[64:67], v[192:195], v[96:99]
    v_mfma_f32_16x16x32_bf16 v[104:107], v[64:67], v[196:199], v[104:107]
    ds_read_b64_tr_b16 v[64:65], v1 offset:0
    s_add_u32 m0, s9, 49152
    s_add_u32 s10, s72, 384
    buffer_load_dwordx4 v4, s[56:59], s10 offen lds
    v_lshrrev_b32 v61, 5, v0
    v_lshl_add_u32 v20, v61, 10, v20
    s_mul_i32 s11, s7, 12
    s_add_u32 s11, s11, s8
    s_lshl_b32 s11, s11, 7
    s_add_u32 s11, s11, 262144
    s_waitcnt lgkmcnt(5)
    v_mfma_f32_16x16x32_bf16 v[100:103], v[68:71], v[192:195], v[100:103]
    ds_read_b64_tr_b16 v[66:67], v1 offset:1024
    v_mfma_f32_16x16x32_bf16 v[108:111], v[68:71], v[196:199], v[108:111]
    ds_read_b64_tr_b16 v[68:69], v2 offset:0
    v_and_b32 v61, 15, v0
    v_lshl_add_u32 v61, v61, 2, s11
    s_lshr_b32 s11, s7, 2
    s_lshl_b32 s11, s11, 6
    s_add_u32 s11, s11, 60
    s_waitcnt lgkmcnt(5)
    v_mfma_f32_16x16x32_bf16 v[96:99], v[72:75], v[200:203], v[96:99]
    ds_read_b64_tr_b16 v[70:71], v2 offset:1024
    v_mfma_f32_16x16x32_bf16 v[104:107], v[72:75], v[204:207], v[104:107]
    ds_read_b64_tr_b16 v[72:73], v1 offset:4096
    v_mov_b32 v63, s11
    buffer_load_dword v62, v63, s[68:71], 0 offen sc1
    s_mul_i32 s11, s7, 1536
    s_lshl2_add_u32 s11, s79, s11
    s_add_u32 s11, s11, 262144
    s_cmp_eq_u32 s4, 0
    s_waitcnt lgkmcnt(5)
    v_mfma_f32_16x16x32_bf16 v[100:103], v[76:79], v[200:203], v[100:103]
    ds_read_b64_tr_b16 v[74:75], v1 offset:5120
    v_mfma_f32_16x16x32_bf16 v[108:111], v[76:79], v[204:207], v[108:111]
    ds_read_b64_tr_b16 v[76:77], v2 offset:4096
    ds_read_b64_tr_b16 v[78:79], v2 offset:5120
    s_cselect_b32 s11, s11, 0x40000000
    v_lshl_add_u32 v59, v0, 7, s11
    v_cmp_gt_u32 vcc, 12, v0
    v_mov_b32 v60, 0x40000000
    v_cndmask_b32 v59, v60, v59, vcc
    s_waitcnt vmcnt(14)
    s_barrier
    s_waitcnt lgkmcnt(6)
    v_mfma_f32_16x16x32_bf16 v[80:83], v[64:67], v[112:115], 0
    v_mfma_f32_16x16x32_bf16 v[88:91], v[64:67], v[116:119], 0
    ds_read_b64_tr_b16 v[64:65], v1 offset:8192
    s_add_u32 m0, s9, 57344
    s_add_u32 s10, s72, 74112
    buffer_load_dwordx4 v4, s[56:59], s10 offen lds
    s_waitcnt lgkmcnt(5)
    v_mfma_f32_16x16x32_bf16 v[84:87], v[68:71], v[112:115], 0
    ds_read_b64_tr_b16 v[66:67], v1 offset:9216
    v_mfma_f32_16x16x32_bf16 v[92:95], v[68:71], v[116:119], 0
    ds_read_b64_tr_b16 v[68:69], v2 offset:8192
    s_waitcnt lgkmcnt(5)
    v_mfma_f32_16x16x32_bf16 v[80:83], v[72:75], v[120:123], v[80:83]
    ds_read_b64_tr_b16 v[70:71], v2 offset:9216
    v_mfma_f32_16x16x32_bf16 v[88:91], v[72:75], v[124:127], v[88:91]
    ds_read_b64_tr_b16 v[72:73], v1 offset:12288
    s_waitcnt lgkmcnt(5)
    v_mfma_f32_16x16x32_bf16 v[84:87], v[76:79], v[120:123], v[84:87]
    ds_read_b64_tr_b16 v[74:75], v1 offset:13312
    v_mfma_f32_16x16x32_bf16 v[92:95], v[76:79], v[124:127], v[92:95]
    ds_read_b64_tr_b16 v[76:77], v2 offset:12288
    ds_read_b64_tr_b16 v[78:79], v2 offset:13312
    v_cvt_pk_bf16_f32 v24, v96, v97
    s_waitcnt vmcnt(14)
    s_barrier
    s_waitcnt lgkmcnt(6)
    v_mfma_f32_16x16x32_bf16 v[80:83], v[64:67], v[128:131], v[80:83]
    v_cvt_pk_bf16_f32 v25, v98, v99
    v_cvt_pk_bf16_f32 v26, v100, v101
    v_mfma_f32_16x16x32_bf16 v[88:91], v[64:67], v[132:135], v[88:91]
    ds_read_b64_tr_b16 v[64:65], v1 offset:16384
    s_add_u32 m0, s9, 0
    s_add_u32 s10, s72, 147840
    buffer_load_dwordx4 v4, s[56:59], s10 offen lds
    s_waitcnt lgkmcnt(5)
    v_mfma_f32_16x16x32_bf16 v[84:87], v[68:71], v[128:131], v[84:87]
    ds_read_b64_tr_b16 v[66:67], v1 offset:17408
    v_cvt_pk_bf16_f32 v27, v102, v103
    v_mfma_f32_16x16x32_bf16 v[92:95], v[68:71], v[132:135], v[92:95]
    ds_read_b64_tr_b16 v[68:69], v2 offset:16384
    s_waitcnt lgkmcnt(5)
    v_mfma_f32_16x16x32_bf16 v[80:83], v[72:75], v[136:139], v[80:83]
    ds_read_b64_tr_b16 v[70:71], v2 offset:17408
    s_mov_b32 s11, 65536
    v_mfma_f32_16x16x32_bf16 v[88:91], v[72:75], v[140:143], v[88:91]
    ds_read_b64_tr_b16 v[72:73], v1 offset:20480
    buffer_store_dwordx4 v[24:27], v5, s[60:63], s11 offen sc1
    s_waitcnt lgkmcnt(5)
    v_mfma_f32_16x16x32_bf16 v[84:87], v[76:79], v[136:139], v[84:87]
    ds_read_b64_tr_b16 v[74:75], v1 offset:21504
    v_cvt_pk_bf16_f32 v28, v104, v105
    v_cvt_pk_bf16_f32 v29, v106, v107
    v_mfma_f32_16x16x32_bf16 v[92:95], v[76:79], v[140:143], v[92:95]
    ds_read_b64_tr_b16 v[76:77], v2 offset:20480
    ds_read_b64_tr_b16 v[78:79], v2 offset:21504
    s_waitcnt vmcnt(14)
    s_barrier
    s_waitcnt lgkmcnt(6)
    v_mfma_f32_16x16x32_bf16 v[80:83], v[64:67], v[144:147], v[80:83]
    v_cvt_pk_bf16_f32 v30, v108, v109
    v_mfma_f32_16x16x32_bf16 v[88:91], v[64:67], v[148:151], v[88:91]
    ds_read_b64_tr_b16 v[64:65], v1 offset:24576
    s_add_u32 m0, s9, 8192
    s_add_u32 s10, s72, 221568
    buffer_load_dwordx4 v4, s[56:59], s10 offen lds
    s_waitcnt lgkmcnt(5)
    v_mfma_f32_16x16x32_bf16 v[84:87], v[68:71], v[144:147], v[84:87]
    ds_read_b64_tr_b16 v[66:67], v1 offset:25600
    v_cvt_pk_bf16_f32 v31, v110, v111
    s_mov_b32 s11, 66048
    v_mfma_f32_16x16x32_bf16 v[92:95], v[68:71], v[148:151], v[92:95]
    ds_read_b64_tr_b16 v[68:69], v2 offset:24576
    s_waitcnt lgkmcnt(5)
    v_mfma_f32_16x16x32_bf16 v[80:83], v[72:75], v[152:155], v[80:83]
    ds_read_b64_tr_b16 v[70:71], v2 offset:25600
    v_mfma_f32_16x16x32_bf16 v[88:91], v[72:75], v[156:159], v[88:91]
    ds_read_b64_tr_b16 v[72:73], v1 offset:28672
    buffer_store_dwordx4 v[28:31], v5, s[60:63], s11 offen sc1
    s_waitcnt lgkmcnt(5)
    v_mfma_f32_16x16x32_bf16 v[84:87], v[76:79], v[152:155], v[84:87]
    ds_read_b64_tr_b16 v[74:75], v1 offset:29696
    v_mfma_f32_16x16x32_bf16 v[92:95], v[76:79], v[156:159], v[92:95]
    ds_read_b64_tr_b16 v[76:77], v2 offset:28672
    ds_read_b64_tr_b16 v[78:79], v2 offset:29696
    s_waitcnt vmcnt(15)
    s_waitcnt vmcnt(14)
    s_barrier
    s_waitcnt vmcnt(5)
    s_mov_b32 s83, 65536
.clp_2:
    s_and_b32 s11, s7, 3
    s_lshl_b32 s11, s11, 3
    v_lshrrev_b32 v62, s11, v62
    v_and_b32 v62, 0xff, v62
    v_cmp_gt_u32 vcc, 12, v62
    s_cbranch_vccz .cok_1
    buffer_load_dword v62, v63, s[68:71], 0 offen sc1
    s_waitcnt vmcnt(0)
    s_sub_u32 s83, s83, 1
    s_cmp_lg_u32 s83, 0
    s_cbranch_scc1 .clp_2
.cok_1:
    v_mov_b32 v60, 1
    buffer_store_dword v60, v59, s[60:63], 0 offen sc1
    s_waitcnt lgkmcnt(6)
    v_mfma_f32_16x16x32_bf16 v[80:83], v[64:67], v[160:163], v[80:83]
    v_mfma_f32_16x16x32_bf16 v[88:91], v[64:67], v[164:167], v[88:91]
    ds_read_b64_tr_b16 v[64:65], v1 offset:32768
    s_add_u32 m0, s9, 16384
    s_add_u32 s10, s72, 295296
    buffer_load_dwordx4 v4, s[56:59], s10 offen lds
    s_waitcnt lgkmcnt(5)
    v_mfma_f32_16x16x32_bf16 v[84:87], v[68:71], v[160:163], v[84:87]
    ds_read_b64_tr_b16 v[66:67], v1 offset:33792
    v_mfma_f32_16x16x32_bf16 v[92:95], v[68:71], v[164:167], v[92:95]
    ds_read_b64_tr_b16 v[68:69], v2 offset:32768
    s_waitcnt lgkmcnt(5)
    v_mfma_f32_16x16x32_bf16 v[80:83], v[72:75], v[168:171], v[80:83]
    ds_read_b64_tr_b16 v[70:71], v2 offset:33792
    v_mfma_f32_16x16x32_bf16 v[88:91], v[72:75], v[172:175], v[88:91]
    ds_read_b64_tr_b16 v[72:73], v1 offset:36864
    s_waitcnt lgkmcnt(5)
    v_mfma_f32_16x16x32_bf16 v[84:87], v[76:79], v[168:171], v[84:87]
    ds_read_b64_tr_b16 v[74:75], v1 offset:37888
    v_mfma_f32_16x16x32_bf16 v[92:95], v[76:79], v[172:175], v[92:95]
    ds_read_b64_tr_b16 v[76:77], v2 offset:36864
    ds_read_b64_tr_b16 v[78:79], v2 offset:37888
    s_barrier
    s_waitcnt lgkmcnt(6)
    v_mfma_f32_16x16x32_bf16 v[80:83], v[64:67], v[176:179], v[80:83]
    v_mfma_f32_16x16x32_bf16 v[88:91], v[64:67], v[180:183], v[88:91]
    ds_read_b64_tr_b16 v[64:65], v1 offset:40960
    s_add_u32 m0, s9, 24576
    s_add_u32 s10, s72, 369024
    buffer_load_dwordx4 v4, s[56:59], s10 offen lds
    s_waitcnt lgkmcnt(5)
    v_mfma_f32_16x16x32_bf16 v[84:87], v[68:71], v[176:179], v[84:87]
    ds_read_b64_tr_b16 v[66:67], v1 offset:41984
    v_mfma_f32_16x16x32_bf16 v[92:95], v[68:71], v[180:183], v[92:95]
    ds_read_b64_tr_b16 v[68:69], v2 offset:40960
    s_waitcnt lgkmcnt(5)
    v_mfma_f32_16x16x32_bf16 v[80:83], v[72:75], v[184:187], v[80:83]
    ds_read_b64_tr_b16 v[70:71], v2 offset:41984
    v_mfma_f32_16x16x32_bf16 v[88:91], v[72:75], v[188:191], v[88:91]
    ds_read_b64_tr_b16 v[72:73], v1 offset:45056
    s_waitcnt lgkmcnt(5)
    v_mfma_f32_16x16x32_bf16 v[84:87], v[76:79], v[184:187], v[84:87]
    ds_read_b64_tr_b16 v[74:75], v1 offset:46080
    v_mfma_f32_16x16x32_bf16 v[92:95], v[76:79], v[188:191], v[92:95]
    ds_read_b64_tr_b16 v[76:77], v2 offset:45056
    ds_read_b64_tr_b16 v[78:79], v2 offset:46080
    s_barrier
    s_waitcnt lgkmcnt(6)
    v_mfma_f32_16x16x32_bf16 v[80:83], v[64:67], v[192:195], v[80:83]
    v_mfma_f32_16x16x32_bf16 v[88:91], v[64:67], v[196:199], v[88:91]
    ds_read_b64_tr_b16 v[64:65], v1 offset:49152
    s_add_u32 m0, s9, 32768
    s_add_u32 s10, s72, 512
    buffer_load_dwordx4 v4, s[56:59], s10 offen lds
    s_waitcnt lgkmcnt(5)
    v_mfma_f32_16x16x32_bf16 v[84:87], v[68:71], v[192:195], v[84:87]
    ds_read_b64_tr_b16 v[66:67], v1 offset:50176
    v_mfma_f32_16x16x32_bf16 v[92:95], v[68:71], v[196:199], v[92:95]
    ds_read_b64_tr_b16 v[68:69], v2 offset:49152
    s_waitcnt lgkmcnt(5)
    v_mfma_f32_16x16x32_bf16 v[80:83], v[72:75], v[200:203], v[80:83]
    ds_read_b64_tr_b16 v[70:71], v2 offset:50176
    v_mfma_f32_16x16x32_bf16 v[88:91], v[72:75], v[204:207], v[88:91]
    ds_read_b64_tr_b16 v[72:73], v1 offset:53248
    s_waitcnt lgkmcnt(5)
    v_mfma_f32_16x16x32_bf16 v[84:87], v[76:79], v[200:203], v[84:87]
    ds_read_b64_tr_b16 v[74:75], v1 offset:54272
    v_mfma_f32_16x16x32_bf16 v[92:95], v[76:79], v[204:207], v[92:95]
    ds_read_b64_tr_b16 v[76:77], v2 offset:53248
    ds_read_b64_tr_b16 v[78:79], v2 offset:54272
    s_waitcnt vmcnt(8)
    s_barrier
    s_waitcnt lgkmcnt(6)
    v_mfma_f32_16x16x32_bf16 v[96:99], v[64:67], v[112:115], 0
    v_mfma_f32_16x16x32_bf16 v[104:107], v[64:67], v[116:119], 0
    ds_read_b64_tr_b16 v[64:65], v1 offset:57344
    s_add_u32 m0, s9, 40960
    s_add_u32 s10, s72, 74240
    buffer_load_dwordx4 v4, s[56:59], s10 offen lds
    v_lshlrev_b32 v32, 16, v8
    v_and_b32 v33, s13, v8
    s_waitcnt lgkmcnt(5)
    v_mfma_f32_16x16x32_bf16 v[100:103], v[68:71], v[112:115], 0
    ds_read_b64_tr_b16 v[66:67], v1 offset:58368
    v_mfma_f32_16x16x32_bf16 v[108:111], v[68:71], v[116:119], 0
    ds_read_b64_tr_b16 v[68:69], v2 offset:57344
    v_lshlrev_b32 v34, 16, v9
    v_and_b32 v35, s13, v9
    s_waitcnt lgkmcnt(5)
    v_mfma_f32_16x16x32_bf16 v[96:99], v[72:75], v[120:123], v[96:99]
    ds_read_b64_tr_b16 v[70:71], v2 offset:58368
    v_mfma_f32_16x16x32_bf16 v[104:107], v[72:75], v[124:127], v[104:107]
    ds_read_b64_tr_b16 v[72:73], v1 offset:61440
    v_sub_f32 v36, v32, v23
    v_sub_f32 v37, v33, v23
    s_waitcnt lgkmcnt(5)
    v_mfma_f32_16x16x32_bf16 v[100:103], v[76:79], v[120:123], v[100:103]
    ds_read_b64_tr_b16 v[74:75], v1 offset:62464
    v_mfma_f32_16x16x32_bf16 v[108:111], v[76:79], v[124:127], v[108:111]
    ds_read_b64_tr_b16 v[76:77], v2 offset:61440
    ds_read_b64_tr_b16 v[78:79], v2 offset:62464
    v_cvt_pk_bf16_f32 v24, v80, v81
    v_sub_f32 v38, v34, v23
    v_sub_f32 v39, v35, v23
    s_waitcnt vmcnt(8)
    s_barrier
    s_waitcnt lgkmcnt(6)
    v_mfma_f32_16x16x32_bf16 v[96:99], v[64:67], v[128:131], v[96:99]
    v_cvt_pk_bf16_f32 v25, v82, v83
    v_cvt_pk_bf16_f32 v26, v84, v85
    v_mfma_f32_16x16x32_bf16 v[104:107], v[64:67], v[132:135], v[104:107]
    ds_read_b64_tr_b16 v[64:65], v1 offset:0
    s_add_u32 m0, s9, 49152
    s_add_u32 s10, s72, 147968
    buffer_load_dwordx4 v4, s[56:59], s10 offen lds
    v_cvt_pk_bf16_f32 v8, v36, v37
    v_cvt_pk_bf16_f32 v9, v38, v39
    v_lshlrev_b32 v36, 16, v8
    s_waitcnt lgkmcnt(5)
    v_mfma_f32_16x16x32_bf16 v[100:103], v[68:71], v[128:131], v[100:103]
    ds_read_b64_tr_b16 v[66:67], v1 offset:1024
    v_cvt_pk_bf16_f32 v27, v86, v87
    v_mfma_f32_16x16x32_bf16 v[108:111], v[68:71], v[132:135], v[108:111]
    ds_read_b64_tr_b16 v[68:69], v2 offset:0
    v_and_b32 v37, s13, v8
    v_lshlrev_b32 v38, 16, v9
    s_waitcnt lgkmcnt(5)
    v_mfma_f32_16x16x32_bf16 v[96:99], v[72:75], v[136:139], v[96:99]
    ds_read_b64_tr_b16 v[70:71], v2 offset:1024
    s_mov_b32 s11, 131072
    v_mfma_f32_16x16x32_bf16 v[104:107], v[72:75], v[140:143], v[104:107]
    ds_read_b64_tr_b16 v[72:73], v1 offset:4096
    buffer_store_dwordx4 v[24:27], v5, s[60:63], s11 offen sc1
    v_and_b32 v39, s13, v9
    v_mul_f32 v36, v36, v22
    s_waitcnt lgkmcnt(5)
    v_mfma_f32_16x16x32_bf16 v[100:103], v[76:79], v[136:139], v[100:103]
    ds_read_b64_tr_b16 v[74:75], v1 offset:5120
    v_cvt_pk_bf16_f32 v28, v88, v89
    v_cvt_pk_bf16_f32 v29, v90, v91
    v_mfma_f32_16x16x32_bf16 v[108:111], v[76:79], v[140:143], v[108:111]
    ds_read_b64_tr_b16 v[76:77], v2 offset:4096
    ds_read_b64_tr_b16 v[78:79], v2 offset:5120
    v_mul_f32 v37, v37, v22
    v_mul_f32 v38, v38, v22
    s_waitcnt vmcnt(8)
    s_barrier
    s_waitcnt lgkmcnt(6)
    v_mfma_f32_16x16x32_bf16 v[96:99], v[64:67], v[144:147], v[96:99]
    v_cvt_pk_bf16_f32 v30, v92, v93
    v_mfma_f32_16x16x32_bf16 v[104:107], v[64:67], v[148:151], v[104:107]
    ds_read_b64_tr_b16 v[64:65], v1 offset:8192
    s_add_u32 m0, s9, 57344
    s_add_u32 s10, s72, 221696
    buffer_load_dwordx4 v4, s[56:59], s10 offen lds
    v_mul_f32 v39, v39, v22
    v_cvt_pk_bf16_f32 v8, v36, v37
    s_waitcnt lgkmcnt(5)
    v_mfma_f32_16x16x32_bf16 v[100:103], v[68:71], v[144:147], v[100:103]
    ds_read_b64_tr_b16 v[66:67], v1 offset:9216
    v_cvt_pk_bf16_f32 v31, v94, v95
    s_mov_b32 s11, 131584
    v_mfma_f32_16x16x32_bf16 v[108:111], v[68:71], v[148:151], v[108:111]
    ds_read_b64_tr_b16 v[68:69], v2 offset:8192
    v_cvt_pk_bf16_f32 v9, v38, v39
    v_lshlrev_b32 v36, 16, v8
    v_and_b32 v37, s13, v8
    s_waitcnt lgkmcnt(5)
    v_mfma_f32_16x16x32_bf16 v[96:99], v[72:75], v[152:155], v[96:99]
    ds_read_b64_tr_b16 v[70:71], v2 offset:9216
    v_mfma_f32_16x16x32_bf16 v[104:107], v[72:75], v[156:159], v[104:107]
    ds_read_b64_tr_b16 v[72:73], v1 offset:12288
    buffer_store_dwordx4 v[28:31], v5, s[60:63], s11 offen sc1
    v_lshlrev_b32 v38, 16, v9
    v_and_b32 v39, s13, v9
    s_waitcnt lgkmcnt(5)
    v_mfma_f32_16x16x32_bf16 v[100:103], v[76:79], v[152:155], v[100:103]
    ds_read_b64_tr_b16 v[74:75], v1 offset:13312
    v_mfma_f32_16x16x32_bf16 v[108:111], v[76:79], v[156:159], v[108:111]
    ds_read_b64_tr_b16 v[76:77], v2 offset:12288
    ds_read_b64_tr_b16 v[78:79], v2 offset:13312
    v_lshlrev_b32 v8, 16, v14
    v_and_b32 v9, s13, v14
    s_waitcnt vmcnt(9)
    s_waitcnt vmcnt(7)
    s_barrier
    v_mov_b32 v60, 2
    buffer_store_dword v60, v59, s[60:63], 0 offen sc1
    s_waitcnt lgkmcnt(6)
    v_mfma_f32_16x16x32_bf16 v[96:99], v[64:67], v[160:163], v[96:99]
    v_mfma_f32_16x16x32_bf16 v[104:107], v[64:67], v[164:167], v[104:107]
    ds_read_b64_tr_b16 v[64:65], v1 offset:16384
    s_add_u32 m0, s9, 0
    s_add_u32 s10, s72, 295424
    buffer_load_dwordx4 v4, s[56:59], s10 offen lds
    v_mul_f32 v36, v36, v8
    v_mul_f32 v37, v37, v9
    s_waitcnt lgkmcnt(5)
    v_mfma_f32_16x16x32_bf16 v[100:103], v[68:71], v[160:163], v[100:103]
    ds_read_b64_tr_b16 v[66:67], v1 offset:17408
    v_mfma_f32_16x16x32_bf16 v[108:111], v[68:71], v[164:167], v[108:111]
    ds_read_b64_tr_b16 v[68:69], v2 offset:16384
    v_lshlrev_b32 v8, 16, v15
    v_and_b32 v9, s13, v15
    s_waitcnt lgkmcnt(5)
    v_mfma_f32_16x16x32_bf16 v[96:99], v[72:75], v[168:171], v[96:99]
    ds_read_b64_tr_b16 v[70:71], v2 offset:17408
    v_mfma_f32_16x16x32_bf16 v[104:107], v[72:75], v[172:175], v[104:107]
    ds_read_b64_tr_b16 v[72:73], v1 offset:20480
    v_mul_f32 v38, v38, v8
    v_mul_f32 v39, v39, v9
    v_cvt_pk_bf16_f32 v8, v36, v37
    s_waitcnt lgkmcnt(5)
    v_mfma_f32_16x16x32_bf16 v[100:103], v[76:79], v[168:171], v[100:103]
    ds_read_b64_tr_b16 v[74:75], v1 offset:21504
    v_mfma_f32_16x16x32_bf16 v[108:111], v[76:79], v[172:175], v[108:111]
    ds_read_b64_tr_b16 v[76:77], v2 offset:20480
    ds_read_b64_tr_b16 v[78:79], v2 offset:21504
    v_cvt_pk_bf16_f32 v9, v38, v39
    v_lshlrev_b32 v36, 16, v8
    s_waitcnt vmcnt(8)
    s_barrier
    s_waitcnt lgkmcnt(6)
    v_mfma_f32_16x16x32_bf16 v[96:99], v[64:67], v[176:179], v[96:99]
    v_mfma_f32_16x16x32_bf16 v[104:107], v[64:67], v[180:183], v[104:107]
    ds_read_b64_tr_b16 v[64:65], v1 offset:24576
    s_add_u32 m0, s9, 8192
    s_add_u32 s10, s72, 369152
    buffer_load_dwordx4 v4, s[56:59], s10 offen lds
    v_and_b32 v37, s13, v8
    v_lshlrev_b32 v38, 16, v9
    s_waitcnt lgkmcnt(5)
    v_mfma_f32_16x16x32_bf16 v[100:103], v[68:71], v[176:179], v[100:103]
    ds_read_b64_tr_b16 v[66:67], v1 offset:25600
    v_mfma_f32_16x16x32_bf16 v[108:111], v[68:71], v[180:183], v[108:111]
    ds_read_b64_tr_b16 v[68:69], v2 offset:24576
    v_and_b32 v39, s13, v9
    v_lshlrev_b32 v40, 16, v10
    s_waitcnt lgkmcnt(5)
    v_mfma_f32_16x16x32_bf16 v[96:99], v[72:75], v[184:187], v[96:99]
    ds_read_b64_tr_b16 v[70:71], v2 offset:25600
    v_mfma_f32_16x16x32_bf16 v[104:107], v[72:75], v[188:191], v[104:107]
    ds_read_b64_tr_b16 v[72:73], v1 offset:28672
    v_and_b32 v41, s13, v10
    v_lshlrev_b32 v42, 16, v11
    v_and_b32 v43, s13, v11
    s_waitcnt lgkmcnt(5)
    v_mfma_f32_16x16x32_bf16 v[100:103], v[76:79], v[184:187], v[100:103]
    ds_read_b64_tr_b16 v[74:75], v1 offset:29696
    v_mfma_f32_16x16x32_bf16 v[108:111], v[76:79], v[188:191], v[108:111]
    ds_read_b64_tr_b16 v[76:77], v2 offset:28672
    ds_read_b64_tr_b16 v[78:79], v2 offset:29696
    v_sub_f32 v44, v40, v23
    v_sub_f32 v45, v41, v23
    s_waitcnt vmcnt(8)
    s_barrier
    s_waitcnt lgkmcnt(6)
    v_mfma_f32_16x16x32_bf16 v[96:99], v[64:67], v[192:195], v[96:99]
    v_mfma_f32_16x16x32_bf16 v[104:107], v[64:67], v[196:199], v[104:107]
    ds_read_b64_tr_b16 v[64:65], v1 offset:32768
    s_add_u32 m0, s9, 16384
    s_add_u32 s10, s72, 640
    buffer_load_dwordx4 v4, s[56:59], s10 offen lds
    v_sub_f32 v46, v42, v23
    v_sub_f32 v47, v43, v23
    s_waitcnt lgkmcnt(5)
    v_mfma_f32_16x16x32_bf16 v[100:103], v[68:71], v[192:195], v[100:103]
    ds_read_b64_tr_b16 v[66:67], v1 offset:33792
    v_mfma_f32_16x16x32_bf16 v[108:111], v[68:71], v[196:199], v[108:111]
    ds_read_b64_tr_b16 v[68:69], v2 offset:32768
    v_cvt_pk_bf16_f32 v10, v44, v45
    v_cvt_pk_bf16_f32 v11, v46, v47
    s_waitcnt lgkmcnt(5)
    v_mfma_f32_16x16x32_bf16 v[96:99], v[72:75], v[200:203], v[96:99]
    ds_read_b64_tr_b16 v[70:71], v2 offset:33792
    v_mfma_f32_16x16x32_bf16 v[104:107], v[72:75], v[204:207], v[104:107]
    ds_read_b64_tr_b16 v[72:73], v1 offset:36864
    v_lshlrev_b32 v44, 16, v10
    v_and_b32 v45, s13, v10
    s_waitcnt lgkmcnt(5)
    v_mfma_f32_16x16x32_bf16 v[100:103], v[76:79], v[200:203], v[100:103]
    ds_read_b64_tr_b16 v[74:75], v1 offset:37888
    v_mfma_f32_16x16x32_bf16 v[108:111], v[76:79], v[204:207], v[108:111]
    ds_read_b64_tr_b16 v[76:77], v2 offset:36864
    ds_read_b64_tr_b16 v[78:79], v2 offset:37888
    v_lshlrev_b32 v46, 16, v11
    v_and_b32 v47, s13, v11
    v_mul_f32 v44, v44, v22
    s_waitcnt vmcnt(8)
    s_barrier
    s_waitcnt lgkmcnt(6)
    v_mfma_f32_16x16x32_bf16 v[80:83], v[64:67], v[112:115], 0
    v_mfma_f32_16x16x32_bf16 v[88:91], v[64:67], v[116:119], 0
    ds_read_b64_tr_b16 v[64:65], v1 offset:40960
    s_add_u32 m0, s9, 24576
    s_add_u32 s10, s72, 74368
    buffer_load_dwordx4 v4, s[56:59], s10 offen lds
    v_mul_f32 v45, v45, v22
    v_mul_f32 v46, v46, v22
    s_waitcnt lgkmcnt(5)
    v_mfma_f32_16x16x32_bf16 v[84:87], v[68:71], v[112:115], 0
    ds_read_b64_tr_b16 v[66:67], v1 offset:41984
    v_mfma_f32_16x16x32_bf16 v[92:95], v[68:71], v[116:119], 0
    ds_read_b64_tr_b16 v[68:69], v2 offset:40960
    v_mul_f32 v47, v47, v22
    v_cvt_pk_bf16_f32 v10, v44, v45
    s_waitcnt lgkmcnt(5)
    v_mfma_f32_16x16x32_bf16 v[80:83], v[72:75], v[120:123], v[80:83]
    ds_read_b64_tr_b16 v[70:71], v2 offset:41984
    v_mfma_f32_16x16x32_bf16 v[88:91], v[72:75], v[124:127], v[88:91]
    ds_read_b64_tr_b16 v[72:73], v1 offset:45056
    v_cvt_pk_bf16_f32 v11, v46, v47
    v_lshlrev_b32 v44, 16, v10
    s_waitcnt lgkmcnt(5)
    v_mfma_f32_16x16x32_bf16 v[84:87], v[76:79], v[120:123], v[84:87]
    ds_read_b64_tr_b16 v[74:75], v1 offset:46080
    v_mfma_f32_16x16x32_bf16 v[92:95], v[76:79], v[124:127], v[92:95]
    ds_read_b64_tr_b16 v[76:77], v2 offset:45056
    ds_read_b64_tr_b16 v[78:79], v2 offset:46080
    v_cvt_pk_bf16_f32 v24, v96, v97
    v_and_b32 v45, s13, v10
    v_lshlrev_b32 v46, 16, v11
    s_waitcnt vmcnt(8)
    s_barrier
    s_waitcnt lgkmcnt(6)
    v_mfma_f32_16x16x32_bf16 v[80:83], v[64:67], v[128:131], v[80:83]
    v_cvt_pk_bf16_f32 v25, v98, v99
    v_cvt_pk_bf16_f32 v26, v100, v101
    v_mfma_f32_16x16x32_bf16 v[88:91], v[64:67], v[132:135], v[88:91]
    ds_read_b64_tr_b16 v[64:65], v1 offset:49152
    s_add_u32 m0, s9, 32768
    s_add_u32 s10, s72, 148096
    buffer_load_dwordx4 v4, s[56:59], s10 offen lds
    v_and_b32 v47, s13, v11
    v_lshlrev_b32 v10, 16, v16
    v_and_b32 v11, s13, v16
    s_waitcnt lgkmcnt(5)
    v_mfma_f32_16x16x32_bf16 v[84:87], v[68:71], v[128:131], v[84:87]
    ds_read_b64_tr_b16 v[66:67], v1 offset:50176
    v_cvt_pk_bf16_f32 v27, v102, v103
    v_mfma_f32_16x16x32_bf16 v[92:95], v[68:71], v[132:135], v[92:95]
    ds_read_b64_tr_b16 v[68:69], v2 offset:49152
    v_mul_f32 v44, v44, v10
    v_mul_f32 v45, v45, v11
    s_waitcnt lgkmcnt(5)
    v_mfma_f32_16x16x32_bf16 v[80:83], v[72:75], v[136:139], v[80:83]
    ds_read_b64_tr_b16 v[70:71], v2 offset:50176
    s_mov_b32 s11, 196608
    v_mfma_f32_16x16x32_bf16 v[88:91], v[72:75], v[140:143], v[88:91]
    ds_read_b64_tr_b16 v[72:73], v1 offset:53248
    buffer_store_dwordx4 v[24:27], v5, s[60:63], s11 offen sc1
    v_lshlrev_b32 v10, 16, v17
    v_and_b32 v11, s13, v17
    s_waitcnt lgkmcnt(5)
    v_mfma_f32_16x16x32_bf16 v[84:87], v[76:79], v[136:139], v[84:87]
    ds_read_b64_tr_b16 v[74:75], v1 offset:54272
    v_cvt_pk_bf16_f32 v28, v104, v105
    v_cvt_pk_bf16_f32 v29, v106, v107
    v_mfma_f32_16x16x32_bf16 v[92:95], v[76:79], v[140:143], v[92:95]
    ds_read_b64_tr_b16 v[76:77], v2 offset:53248
    ds_read_b64_tr_b16 v[78:79], v2 offset:54272
    v_mul_f32 v46, v46, v10
    v_mul_f32 v47, v47, v11
    s_waitcnt vmcnt(8)
    s_barrier
    s_waitcnt lgkmcnt(6)
    v_mfma_f32_16x16x32_bf16 v[80:83], v[64:67], v[144:147], v[80:83]
    v_cvt_pk_bf16_f32 v30, v108, v109
    v_mfma_f32_16x16x32_bf16 v[88:91], v[64:67], v[148:151], v[88:91]
    ds_read_b64_tr_b16 v[64:65], v1 offset:57344
    s_add_u32 m0, s9, 40960
    s_add_u32 s10, s72, 221824
    buffer_load_dwordx4 v4, s[56:59], s10 offen lds
    v_cvt_pk_bf16_f32 v10, v44, v45
    v_cvt_pk_bf16_f32 v11, v46, v47
    s_waitcnt lgkmcnt(5)
    v_mfma_f32_16x16x32_bf16 v[84:87], v[68:71], v[144:147], v[84:87]
    ds_read_b64_tr_b16 v[66:67], v1 offset:58368
    v_cvt_pk_bf16_f32 v31, v110, v111
    s_mov_b32 s11, 197120
    v_mfma_f32_16x16x32_bf16 v[92:95], v[68:71], v[148:151], v[92:95]
    ds_read_b64_tr_b16 v[68:69], v2 offset:57344
    v_lshlrev_b32 v44, 16, v10
    v_and_b32 v45, s13, v10
    v_lshlrev_b32 v46, 16, v11
    s_waitcnt lgkmcnt(5)
    v_mfma_f32_16x16x32_bf16 v[80:83], v[72:75], v[152:155], v[80:83]
    ds_read_b64_tr_b16 v[70:71], v2 offset:58368
    v_mfma_f32_16x16x32_bf16 v[88:91], v[72:75], v[156:159], v[88:91]
    ds_read_b64_tr_b16 v[72:73], v1 offset:61440
    buffer_store_dwordx4 v[28:31], v5, s[60:63], s11 offen sc1
    v_and_b32 v47, s13, v11
    v_lshlrev_b32 v48, 16, v12
    s_waitcnt lgkmcnt(5)
    v_mfma_f32_16x16x32_bf16 v[84:87], v[76:79], v[152:155], v[84:87]
    ds_read_b64_tr_b16 v[74:75], v1 offset:62464
    v_mfma_f32_16x16x32_bf16 v[92:95], v[76:79], v[156:159], v[92:95]
    ds_read_b64_tr_b16 v[76:77], v2 offset:61440
    ds_read_b64_tr_b16 v[78:79], v2 offset:62464
    v_and_b32 v49, s13, v12
    v_lshlrev_b32 v50, 16, v13
    s_waitcnt vmcnt(9)
    s_waitcnt vmcnt(7)
    s_barrier
    v_mov_b32 v60, 3
    buffer_store_dword v60, v59, s[60:63], 0 offen sc1
    s_waitcnt lgkmcnt(6)
    v_mfma_f32_16x16x32_bf16 v[80:83], v[64:67], v[160:163], v[80:83]
    v_mfma_f32_16x16x32_bf16 v[88:91], v[64:67], v[164:167], v[88:91]
    ds_read_b64_tr_b16 v[64:65], v1 offset:0
    s_add_u32 m0, s9, 49152
    s_add_u32 s10, s72, 295552
    buffer_load_dwordx4 v4, s[56:59], s10 offen lds
    v_and_b32 v51, s13, v13
    v_sub_f32 v52, v48, v23
    s_waitcnt lgkmcnt(5)
    v_mfma_f32_16x16x32_bf16 v[84:87], v[68:71], v[160:163], v[84:87]
    ds_read_b64_tr_b16 v[66:67], v1 offset:1024
    v_mfma_f32_16x16x32_bf16 v[92:95], v[68:71], v[164:167], v[92:95]
    ds_read_b64_tr_b16 v[68:69], v2 offset:0
    v_sub_f32 v53, v49, v23
    v_sub_f32 v54, v50, v23
    v_sub_f32 v55, v51, v23
    s_waitcnt lgkmcnt(5)
    v_mfma_f32_16x16x32_bf16 v[80:83], v[72:75], v[168:171], v[80:83]
    ds_read_b64_tr_b16 v[70:71], v2 offset:1024
    v_mfma_f32_16x16x32_bf16 v[88:91], v[72:75], v[172:175], v[88:91]
    ds_read_b64_tr_b16 v[72:73], v1 offset:4096
    v_cvt_pk_bf16_f32 v12, v52, v53
    v_cvt_pk_bf16_f32 v13, v54, v55
    s_waitcnt lgkmcnt(5)
    v_mfma_f32_16x16x32_bf16 v[84:87], v[76:79], v[168:171], v[84:87]
    ds_read_b64_tr_b16 v[74:75], v1 offset:5120
    v_mfma_f32_16x16x32_bf16 v[92:95], v[76:79], v[172:175], v[92:95]
    ds_read_b64_tr_b16 v[76:77], v2 offset:4096
    ds_read_b64_tr_b16 v[78:79], v2 offset:5120
    v_lshlrev_b32 v52, 16, v12
    v_and_b32 v53, s13, v12
    s_waitcnt vmcnt(8)
    s_barrier
    s_waitcnt lgkmcnt(6)
    v_mfma_f32_16x16x32_bf16 v[80:83], v[64:67], v[176:179], v[80:83]
    v_mfma_f32_16x16x32_bf16 v[88:91], v[64:67], v[180:183], v[88:91]
    ds_read_b64_tr_b16 v[64:65], v1 offset:8192
    s_add_u32 m0, s9, 57344
    s_add_u32 s10, s72, 369280
    buffer_load_dwordx4 v4, s[56:59], s10 offen lds
    v_lshlrev_b32 v54, 16, v13
    v_and_b32 v55, s13, v13
    s_waitcnt lgkmcnt(5)
    v_mfma_f32_16x16x32_bf16 v[84:87], v[68:71], v[176:179], v[84:87]
    ds_read_b64_tr_b16 v[66:67], v1 offset:9216
    v_mfma_f32_16x16x32_bf16 v[92:95], v[68:71], v[180:183], v[92:95]
    ds_read_b64_tr_b16 v[68:69], v2 offset:8192
    v_mul_f32 v52, v52, v22
    v_mul_f32 v53, v53, v22
    s_waitcnt lgkmcnt(5)
    v_mfma_f32_16x16x32_bf16 v[80:83], v[72:75], v[184:187], v[80:83]
    ds_read_b64_tr_b16 v[70:71], v2 offset:9216
    v_mfma_f32_16x16x32_bf16 v[88:91], v[72:75], v[188:191], v[88:91]
    ds_read_b64_tr_b16 v[72:73], v1 offset:12288
    v_mul_f32 v54, v54, v22
    v_mul_f32 v55, v55, v22
    v_cvt_pk_bf16_f32 v12, v52, v53
    s_waitcnt lgkmcnt(5)
    v_mfma_f32_16x16x32_bf16 v[84:87], v[76:79], v[184:187], v[84:87]
    ds_read_b64_tr_b16 v[74:75], v1 offset:13312
    v_mfma_f32_16x16x32_bf16 v[92:95], v[76:79], v[188:191], v[92:95]
    ds_read_b64_tr_b16 v[76:77], v2 offset:12288
    ds_read_b64_tr_b16 v[78:79], v2 offset:13312
    v_cvt_pk_bf16_f32 v13, v54, v55
    v_lshlrev_b32 v52, 16, v12
    s_waitcnt vmcnt(8)
    s_barrier
    s_waitcnt lgkmcnt(6)
    v_mfma_f32_16x16x32_bf16 v[80:83], v[64:67], v[192:195], v[80:83]
    v_mfma_f32_16x16x32_bf16 v[88:91], v[64:67], v[196:199], v[88:91]
    ds_read_b64_tr_b16 v[64:65], v1 offset:16384
    s_add_u32 m0, s9, 0
    s_add_u32 s10, s72, 768
    buffer_load_dwordx4 v4, s[56:59], s10 offen lds
    v_and_b32 v53, s13, v12
    v_lshlrev_b32 v54, 16, v13
    s_waitcnt lgkmcnt(5)
    v_mfma_f32_16x16x32_bf16 v[84:87], v[68:71], v[192:195], v[84:87]
    ds_read_b64_tr_b16 v[66:67], v1 offset:17408
    v_mfma_f32_16x16x32_bf16 v[92:95], v[68:71], v[196:199], v[92:95]
    ds_read_b64_tr_b16 v[68:69], v2 offset:16384
    v_and_b32 v55, s13, v13
    v_lshlrev_b32 v12, 16, v18
    s_waitcnt lgkmcnt(5)
    v_mfma_f32_16x16x32_bf16 v[80:83], v[72:75], v[200:203], v[80:83]
    ds_read_b64_tr_b16 v[70:71], v2 offset:17408
    v_mfma_f32_16x16x32_bf16 v[88:91], v[72:75], v[204:207], v[88:91]
    ds_read_b64_tr_b16 v[72:73], v1 offset:20480
    v_and_b32 v13, s13, v18
    v_mul_f32 v52, v52, v12
    s_waitcnt lgkmcnt(5)
    v_mfma_f32_16x16x32_bf16 v[84:87], v[76:79], v[200:203], v[84:87]
    ds_read_b64_tr_b16 v[74:75], v1 offset:21504
    v_mfma_f32_16x16x32_bf16 v[92:95], v[76:79], v[204:207], v[92:95]
    ds_read_b64_tr_b16 v[76:77], v2 offset:20480
    ds_read_b64_tr_b16 v[78:79], v2 offset:21504
    v_mul_f32 v53, v53, v13
    v_lshlrev_b32 v12, 16, v19
    v_and_b32 v13, s13, v19
    s_waitcnt vmcnt(8)
    s_barrier
    s_waitcnt lgkmcnt(6)
    v_mfma_f32_16x16x32_bf16 v[96:99], v[64:67], v[112:115], 0
    v_mfma_f32_16x16x32_bf16 v[104:107], v[64:67], v[116:119], 0
    ds_read_b64_tr_b16 v[64:65], v1 offset:24576
    s_add_u32 m0, s9, 8192
    s_add_u32 s10, s72, 74496
    buffer_load_dwordx4 v4, s[56:59], s10 offen lds
    v_mul_f32 v54, v54, v12
    v_mul_f32 v55, v55, v13
    s_waitcnt lgkmcnt(5)
    v_mfma_f32_16x16x32_bf16 v[100:103], v[68:71], v[112:115], 0
    ds_read_b64_tr_b16 v[66:67], v1 offset:25600
    v_mfma_f32_16x16x32_bf16 v[108:111], v[68:71], v[116:119], 0
    ds_read_b64_tr_b16 v[68:69], v2 offset:24576
    v_cvt_pk_bf16_f32 v12, v52, v53
    v_cvt_pk_bf16_f32 v13, v54, v55
    s_waitcnt lgkmcnt(5)
    v_mfma_f32_16x16x32_bf16 v[96:99], v[72:75], v[120:123], v[96:99]
    ds_read_b64_tr_b16 v[70:71], v2 offset:25600
    v_mfma_f32_16x16x32_bf16 v[104:107], v[72:75], v[124:127], v[104:107]
    ds_read_b64_tr_b16 v[72:73], v1 offset:28672
    v_lshlrev_b32 v52, 16, v12
    v_and_b32 v53, s13, v12
    s_waitcnt lgkmcnt(5)
    v_mfma_f32_16x16x32_bf16 v[100:103], v[76:79], v[120:123], v[100:103]
    ds_read_b64_tr_b16 v[74:75], v1 offset:29696
    v_mfma_f32_16x16x32_bf16 v[108:111], v[76:79], v[124:127], v[108:111]
    ds_read_b64_tr_b16 v[76:77], v2 offset:28672
    ds_read_b64_tr_b16 v[78:79], v2 offset:29696
    v_cvt_pk_bf16_f32 v24, v80, v81
    v_lshlrev_b32 v54, 16, v13
    v_and_b32 v55, s13, v13
    s_waitcnt vmcnt(8)
    s_barrier
    s_waitcnt lgkmcnt(6)
    v_mfma_f32_16x16x32_bf16 v[96:99], v[64:67], v[128:131], v[96:99]
    v_cvt_pk_bf16_f32 v25, v82, v83
    v_cvt_pk_bf16_f32 v26, v84, v85
    v_mfma_f32_16x16x32_bf16 v[104:107], v[64:67], v[132:135], v[104:107]
    ds_read_b64_tr_b16 v[64:65], v1 offset:32768
    s_add_u32 m0, s9, 16384
    s_add_u32 s10, s72, 148224
    buffer_load_dwordx4 v4, s[56:59], s10 offen lds
    s_waitcnt lgkmcnt(5)
    v_mfma_f32_16x16x32_bf16 v[100:103], v[68:71], v[128:131], v[100:103]
    ds_read_b64_tr_b16 v[66:67], v1 offset:33792
    v_cvt_pk_bf16_f32 v27, v86, v87
    v_mfma_f32_16x16x32_bf16 v[108:111], v[68:71], v[132:135], v[108:111]
    ds_read_b64_tr_b16 v[68:69], v2 offset:32768
    s_waitcnt lgkmcnt(5)
    v_mfma_f32_16x16x32_bf16 v[96:99], v[72:75], v[136:139], v[96:99]
    ds_read_b64_tr_b16 v[70:71], v2 offset:33792
    s_mov_b32 s11, 262144
    v_mfma_f32_16x16x32_bf16 v[104:107], v[72:75], v[140:143], v[104:107]
    ds_read_b64_tr_b16 v[72:73], v1 offset:36864
    buffer_store_dwordx4 v[24:27], v5, s[60:63], s11 offen sc1
    s_waitcnt lgkmcnt(5)
    v_mfma_f32_16x16x32_bf16 v[100:103], v[76:79], v[136:139], v[100:103]
    ds_read_b64_tr_b16 v[74:75], v1 offset:37888
    v_cvt_pk_bf16_f32 v28, v88, v89
    v_cvt_pk_bf16_f32 v29, v90, v91
    v_mfma_f32_16x16x32_bf16 v[108:111], v[76:79], v[140:143], v[108:111]
    ds_read_b64_tr_b16 v[76:77], v2 offset:36864
    ds_read_b64_tr_b16 v[78:79], v2 offset:37888
    s_waitcnt vmcnt(8)
    s_barrier
    s_waitcnt lgkmcnt(6)
    v_mfma_f32_16x16x32_bf16 v[96:99], v[64:67], v[144:147], v[96:99]
    v_cvt_pk_bf16_f32 v30, v92, v93
    v_mfma_f32_16x16x32_bf16 v[104:107], v[64:67], v[148:151], v[104:107]
    ds_read_b64_tr_b16 v[64:65], v1 offset:40960
    s_add_u32 m0, s9, 24576
    s_add_u32 s10, s72, 221952
    buffer_load_dwordx4 v4, s[56:59], s10 offen lds
    s_waitcnt lgkmcnt(5)
    v_mfma_f32_16x16x32_bf16 v[100:103], v[68:71], v[144:147], v[100:103]
    ds_read_b64_tr_b16 v[66:67], v1 offset:41984
    v_cvt_pk_bf16_f32 v31, v94, v95
    s_mov_b32 s11, 262656
    v_mfma_f32_16x16x32_bf16 v[108:111], v[68:71], v[148:151], v[108:111]
    ds_read_b64_tr_b16 v[68:69], v2 offset:40960
    s_waitcnt lgkmcnt(5)
    v_mfma_f32_16x16x32_bf16 v[96:99], v[72:75], v[152:155], v[96:99]
    ds_read_b64_tr_b16 v[70:71], v2 offset:41984
    v_mfma_f32_16x16x32_bf16 v[104:107], v[72:75], v[156:159], v[104:107]
    ds_read_b64_tr_b16 v[72:73], v1 offset:45056
    buffer_store_dwordx4 v[28:31], v5, s[60:63], s11 offen sc1
    s_waitcnt lgkmcnt(5)
    v_mfma_f32_16x16x32_bf16 v[100:103], v[76:79], v[152:155], v[100:103]
    ds_read_b64_tr_b16 v[74:75], v1 offset:46080
    v_mfma_f32_16x16x32_bf16 v[108:111], v[76:79], v[156:159], v[108:111]
    ds_read_b64_tr_b16 v[76:77], v2 offset:45056
    ds_read_b64_tr_b16 v[78:79], v2 offset:46080
    s_waitcnt vmcnt(9)
    s_waitcnt vmcnt(7)
    s_barrier
    v_mov_b32 v60, 4
    buffer_store_dword v60, v59, s[60:63], 0 offen sc1
    s_waitcnt lgkmcnt(6)
    v_mfma_f32_16x16x32_bf16 v[96:99], v[64:67], v[160:163], v[96:99]
    v_mfma_f32_16x16x32_bf16 v[104:107], v[64:67], v[164:167], v[104:107]
    ds_read_b64_tr_b16 v[64:65], v1 offset:49152
    s_add_u32 m0, s9, 32768
    s_add_u32 s10, s72, 295680
    buffer_load_dwordx4 v4, s[56:59], s10 offen lds
    s_waitcnt lgkmcnt(5)
    v_mfma_f32_16x16x32_bf16 v[100:103], v[68:71], v[160:163], v[100:103]
    ds_read_b64_tr_b16 v[66:67], v1 offset:50176
    v_mfma_f32_16x16x32_bf16 v[108:111], v[68:71], v[164:167], v[108:111]
    ds_read_b64_tr_b16 v[68:69], v2 offset:49152
    s_waitcnt lgkmcnt(5)
    v_mfma_f32_16x16x32_bf16 v[96:99], v[72:75], v[168:171], v[96:99]
    ds_read_b64_tr_b16 v[70:71], v2 offset:50176
    v_mfma_f32_16x16x32_bf16 v[104:107], v[72:75], v[172:175], v[104:107]
    ds_read_b64_tr_b16 v[72:73], v1 offset:53248
    s_waitcnt lgkmcnt(5)
    v_mfma_f32_16x16x32_bf16 v[100:103], v[76:79], v[168:171], v[100:103]
    ds_read_b64_tr_b16 v[74:75], v1 offset:54272
    v_mfma_f32_16x16x32_bf16 v[108:111], v[76:79], v[172:175], v[108:111]
    ds_read_b64_tr_b16 v[76:77], v2 offset:53248
    ds_read_b64_tr_b16 v[78:79], v2 offset:54272
    s_waitcnt vmcnt(8)
    s_barrier
    s_waitcnt lgkmcnt(6)
    v_mfma_f32_16x16x32_bf16 v[96:99], v[64:67], v[176:179], v[96:99]
    v_mfma_f32_16x16x32_bf16 v[104:107], v[64:67], v[180:183], v[104:107]
    ds_read_b64_tr_b16 v[64:65], v1 offset:57344
    s_add_u32 m0, s9, 40960
    s_add_u32 s10, s72, 369408
    buffer_load_dwordx4 v4, s[56:59], s10 offen lds
    s_waitcnt lgkmcnt(5)
    v_mfma_f32_16x16x32_bf16 v[100:103], v[68:71], v[176:179], v[100:103]
    ds_read_b64_tr_b16 v[66:67], v1 offset:58368
    v_mfma_f32_16x16x32_bf16 v[108:111], v[68:71], v[180:183], v[108:111]
    ds_read_b64_tr_b16 v[68:69], v2 offset:57344
    s_waitcnt lgkmcnt(5)
    v_mfma_f32_16x16x32_bf16 v[96:99], v[72:75], v[184:187], v[96:99]
    ds_read_b64_tr_b16 v[70:71], v2 offset:58368
    v_mfma_f32_16x16x32_bf16 v[104:107], v[72:75], v[188:191], v[104:107]
    ds_read_b64_tr_b16 v[72:73], v1 offset:61440
    s_waitcnt lgkmcnt(5)
    v_mfma_f32_16x16x32_bf16 v[100:103], v[76:79], v[184:187], v[100:103]
    ds_read_b64_tr_b16 v[74:75], v1 offset:62464
    v_mfma_f32_16x16x32_bf16 v[108:111], v[76:79], v[188:191], v[108:111]
    ds_read_b64_tr_b16 v[76:77], v2 offset:61440
    ds_read_b64_tr_b16 v[78:79], v2 offset:62464
    s_waitcnt vmcnt(8)
    s_barrier
    s_waitcnt lgkmcnt(6)
    v_mfma_f32_16x16x32_bf16 v[96:99], v[64:67], v[192:195], v[96:99]
    v_mfma_f32_16x16x32_bf16 v[104:107], v[64:67], v[196:199], v[104:107]
    ds_read_b64_tr_b16 v[64:65], v1 offset:0
    s_add_u32 m0, s9, 49152
    s_add_u32 s10, s72, 896
    buffer_load_dwordx4 v4, s[56:59], s10 offen lds
    s_waitcnt lgkmcnt(5)
    v_mfma_f32_16x16x32_bf16 v[100:103], v[68:71], v[192:195], v[100:103]
    ds_read_b64_tr_b16 v[66:67], v1 offset:1024
    v_mfma_f32_16x16x32_bf16 v[108:111], v[68:71], v[196:199], v[108:111]
    ds_read_b64_tr_b16 v[68:69], v2 offset:0
    s_waitcnt lgkmcnt(5)
    v_mfma_f32_16x16x32_bf16 v[96:99], v[72:75], v[200:203], v[96:99]
    ds_read_b64_tr_b16 v[70:71], v2 offset:1024
    v_mfma_f32_16x16x32_bf16 v[104:107], v[72:75], v[204:207], v[104:107]
    ds_read_b64_tr_b16 v[72:73], v1 offset:4096
    s_waitcnt lgkmcnt(5)
    v_mfma_f32_16x16x32_bf16 v[100:103], v[76:79], v[200:203], v[100:103]
    ds_read_b64_tr_b16 v[74:75], v1 offset:5120
    v_mfma_f32_16x16x32_bf16 v[108:111], v[76:79], v[204:207], v[108:111]
    ds_read_b64_tr_b16 v[76:77], v2 offset:4096
    ds_read_b64_tr_b16 v[78:79], v2 offset:5120
    s_waitcnt vmcnt(8)
    s_barrier
    s_waitcnt lgkmcnt(6)
    v_mfma_f32_16x16x32_bf16 v[80:83], v[64:67], v[112:115], 0
    v_mfma_f32_16x16x32_bf16 v[88:91], v[64:67], v[116:119], 0
    ds_read_b64_tr_b16 v[64:65], v1 offset:8192
    s_add_u32 m0, s9, 57344
    s_add_u32 s10, s72, 74624
    buffer_load_dwordx4 v4, s[56:59], s10 offen lds
    s_waitcnt lgkmcnt(5)
    v_mfma_f32_16x16x32_bf16 v[84:87], v[68:71], v[112:115], 0
    ds_read_b64_tr_b16 v[66:67], v1 offset:9216
    v_mfma_f32_16x16x32_bf16 v[92:95], v[68:71], v[116:119], 0
    ds_read_b64_tr_b16 v[68:69], v2 offset:8192
    s_waitcnt lgkmcnt(5)
    v_mfma_f32_16x16x32_bf16 v[80:83], v[72:75], v[120:123], v[80:83]
    ds_read_b64_tr_b16 v[70:71], v2 offset:9216
    v_mfma_f32_16x16x32_bf16 v[88:91], v[72:75], v[124:127], v[88:91]
    ds_read_b64_tr_b16 v[72:73], v1 offset:12288
    s_waitcnt lgkmcnt(5)
    v_mfma_f32_16x16x32_bf16 v[84:87], v[76:79], v[120:123], v[84:87]
    ds_read_b64_tr_b16 v[74:75], v1 offset:13312
    v_mfma_f32_16x16x32_bf16 v[92:95], v[76:79], v[124:127], v[92:95]
    ds_read_b64_tr_b16 v[76:77], v2 offset:12288
    ds_read_b64_tr_b16 v[78:79], v2 offset:13312
    v_cvt_pk_bf16_f32 v24, v96, v97
    s_waitcnt vmcnt(8)
    s_barrier
    s_waitcnt lgkmcnt(6)
    v_mfma_f32_16x16x32_bf16 v[80:83], v[64:67], v[128:131], v[80:83]
    v_cvt_pk_bf16_f32 v25, v98, v99
    v_cvt_pk_bf16_f32 v26, v100, v101
    v_mfma_f32_16x16x32_bf16 v[88:91], v[64:67], v[132:135], v[88:91]
    ds_read_b64_tr_b16 v[64:65], v1 offset:16384
    s_add_u32 m0, s9, 0
    s_add_u32 s10, s72, 148352
    buffer_load_dwordx4 v4, s[56:59], s10 offen lds
    s_waitcnt lgkmcnt(5)
    v_mfma_f32_16x16x32_bf16 v[84:87], v[68:71], v[128:131], v[84:87]
    ds_read_b64_tr_b16 v[66:67], v1 offset:17408
    v_cvt_pk_bf16_f32 v27, v102, v103
    v_mfma_f32_16x16x32_bf16 v[92:95], v[68:71], v[132:135], v[92:95]
    ds_read_b64_tr_b16 v[68:69], v2 offset:16384
    s_waitcnt lgkmcnt(5)
    v_mfma_f32_16x16x32_bf16 v[80:83], v[72:75], v[136:139], v[80:83]
    ds_read_b64_tr_b16 v[70:71], v2 offset:17408
    s_mov_b32 s11, 327680
    v_mfma_f32_16x16x32_bf16 v[88:91], v[72:75], v[140:143], v[88:91]
    ds_read_b64_tr_b16 v[72:73], v1 offset:20480
    buffer_store_dwordx4 v[24:27], v5, s[60:63], s11 offen sc1
    s_waitcnt lgkmcnt(5)
    v_mfma_f32_16x16x32_bf16 v[84:87], v[76:79], v[136:139], v[84:87]
    ds_read_b64_tr_b16 v[74:75], v1 offset:21504
    v_cvt_pk_bf16_f32 v28, v104, v105
    v_cvt_pk_bf16_f32 v29, v106, v107
    v_mfma_f32_16x16x32_bf16 v[92:95], v[76:79], v[140:143], v[92:95]
    ds_read_b64_tr_b16 v[76:77], v2 offset:20480
    ds_read_b64_tr_b16 v[78:79], v2 offset:21504
    s_waitcnt vmcnt(8)
    s_barrier
    s_waitcnt lgkmcnt(6)
    v_mfma_f32_16x16x32_bf16 v[80:83], v[64:67], v[144:147], v[80:83]
    v_cvt_pk_bf16_f32 v30, v108, v109
    v_mfma_f32_16x16x32_bf16 v[88:91], v[64:67], v[148:151], v[88:91]
    ds_read_b64_tr_b16 v[64:65], v1 offset:24576
    s_add_u32 m0, s9, 8192
    s_add_u32 s10, s72, 222080
    buffer_load_dwordx4 v4, s[56:59], s10 offen lds
    s_waitcnt lgkmcnt(5)
    v_mfma_f32_16x16x32_bf16 v[84:87], v[68:71], v[144:147], v[84:87]
    ds_read_b64_tr_b16 v[66:67], v1 offset:25600
    v_cvt_pk_bf16_f32 v31, v110, v111
    s_mov_b32 s11, 328192
    v_mfma_f32_16x16x32_bf16 v[92:95], v[68:71], v[148:151], v[92:95]
    ds_read_b64_tr_b16 v[68:69], v2 offset:24576
    s_waitcnt lgkmcnt(5)
    v_mfma_f32_16x16x32_bf16 v[80:83], v[72:75], v[152:155], v[80:83]
    ds_read_b64_tr_b16 v[70:71], v2 offset:25600
    v_mfma_f32_16x16x32_bf16 v[88:91], v[72:75], v[156:159], v[88:91]
    ds_read_b64_tr_b16 v[72:73], v1 offset:28672
    buffer_store_dwordx4 v[28:31], v5, s[60:63], s11 offen sc1
    s_waitcnt lgkmcnt(5)
    v_mfma_f32_16x16x32_bf16 v[84:87], v[76:79], v[152:155], v[84:87]
    ds_read_b64_tr_b16 v[74:75], v1 offset:29696
    v_mfma_f32_16x16x32_bf16 v[92:95], v[76:79], v[156:159], v[92:95]
    ds_read_b64_tr_b16 v[76:77], v2 offset:28672
    ds_read_b64_tr_b16 v[78:79], v2 offset:29696
    s_waitcnt vmcnt(9)
    s_waitcnt vmcnt(7)
    s_barrier
    v_mov_b32 v60, 5
    buffer_store_dword v60, v59, s[60:63], 0 offen sc1
    s_waitcnt lgkmcnt(6)
    v_mfma_f32_16x16x32_bf16 v[80:83], v[64:67], v[160:163], v[80:83]
    v_mfma_f32_16x16x32_bf16 v[88:91], v[64:67], v[164:167], v[88:91]
    ds_read_b64_tr_b16 v[64:65], v1 offset:32768
    s_add_u32 m0, s9, 16384
    s_add_u32 s10, s72, 295808
    buffer_load_dwordx4 v4, s[56:59], s10 offen lds
    s_waitcnt lgkmcnt(5)
    v_mfma_f32_16x16x32_bf16 v[84:87], v[68:71], v[160:163], v[84:87]
    ds_read_b64_tr_b16 v[66:67], v1 offset:33792
    v_mfma_f32_16x16x32_bf16 v[92:95], v[68:71], v[164:167], v[92:95]
    ds_read_b64_tr_b16 v[68:69], v2 offset:32768
    s_waitcnt lgkmcnt(5)
    v_mfma_f32_16x16x32_bf16 v[80:83], v[72:75], v[168:171], v[80:83]
    ds_read_b64_tr_b16 v[70:71], v2 offset:33792
    v_mfma_f32_16x16x32_bf16 v[88:91], v[72:75], v[172:175], v[88:91]
    ds_read_b64_tr_b16 v[72:73], v1 offset:36864
    s_waitcnt lgkmcnt(5)
    v_mfma_f32_16x16x32_bf16 v[84:87], v[76:79], v[168:171], v[84:87]
    ds_read_b64_tr_b16 v[74:75], v1 offset:37888
    v_mfma_f32_16x16x32_bf16 v[92:95], v[76:79], v[172:175], v[92:95]
    ds_read_b64_tr_b16 v[76:77], v2 offset:36864
    ds_read_b64_tr_b16 v[78:79], v2 offset:37888
    s_waitcnt vmcnt(8)
    s_barrier
    s_waitcnt lgkmcnt(6)
    v_mfma_f32_16x16x32_bf16 v[80:83], v[64:67], v[176:179], v[80:83]
    v_mfma_f32_16x16x32_bf16 v[88:91], v[64:67], v[180:183], v[88:91]
    ds_read_b64_tr_b16 v[64:65], v1 offset:40960
    s_add_u32 m0, s9, 24576
    s_add_u32 s10, s72, 369536
    buffer_load_dwordx4 v4, s[56:59], s10 offen lds
    s_waitcnt lgkmcnt(5)
    v_mfma_f32_16x16x32_bf16 v[84:87], v[68:71], v[176:179], v[84:87]
    ds_read_b64_tr_b16 v[66:67], v1 offset:41984
    v_mfma_f32_16x16x32_bf16 v[92:95], v[68:71], v[180:183], v[92:95]
    ds_read_b64_tr_b16 v[68:69], v2 offset:40960
    s_waitcnt lgkmcnt(5)
    v_mfma_f32_16x16x32_bf16 v[80:83], v[72:75], v[184:187], v[80:83]
    ds_read_b64_tr_b16 v[70:71], v2 offset:41984
    v_mfma_f32_16x16x32_bf16 v[88:91], v[72:75], v[188:191], v[88:91]
    ds_read_b64_tr_b16 v[72:73], v1 offset:45056
    s_waitcnt lgkmcnt(5)
    v_mfma_f32_16x16x32_bf16 v[84:87], v[76:79], v[184:187], v[84:87]
    ds_read_b64_tr_b16 v[74:75], v1 offset:46080
    v_mfma_f32_16x16x32_bf16 v[92:95], v[76:79], v[188:191], v[92:95]
    ds_read_b64_tr_b16 v[76:77], v2 offset:45056
    ds_read_b64_tr_b16 v[78:79], v2 offset:46080
    s_waitcnt vmcnt(8)
    s_barrier
    s_waitcnt lgkmcnt(6)
    v_mfma_f32_16x16x32_bf16 v[80:83], v[64:67], v[192:195], v[80:83]
    v_mfma_f32_16x16x32_bf16 v[88:91], v[64:67], v[196:199], v[88:91]
    ds_read_b64_tr_b16 v[64:65], v1 offset:49152
    s_add_u32 m0, s9, 32768
    s_add_u32 s10, s72, 1024
    buffer_load_dwordx4 v4, s[56:59], s10 offen lds
    s_waitcnt lgkmcnt(5)
    v_mfma_f32_16x16x32_bf16 v[84:87], v[68:71], v[192:195], v[84:87]
    ds_read_b64_tr_b16 v[66:67], v1 offset:50176
    v_mfma_f32_16x16x32_bf16 v[92:95], v[68:71], v[196:199], v[92:95]
    ds_read_b64_tr_b16 v[68:69], v2 offset:49152
    s_waitcnt lgkmcnt(5)
    v_mfma_f32_16x16x32_bf16 v[80:83], v[72:75], v[200:203], v[80:83]
    ds_read_b64_tr_b16 v[70:71], v2 offset:50176
    v_mfma_f32_16x16x32_bf16 v[88:91], v[72:75], v[204:207], v[88:91]
    ds_read_b64_tr_b16 v[72:73], v1 offset:53248
    s_waitcnt lgkmcnt(5)
    v_mfma_f32_16x16x32_bf16 v[84:87], v[76:79], v[200:203], v[84:87]
    ds_read_b64_tr_b16 v[74:75], v1 offset:54272
    v_mfma_f32_16x16x32_bf16 v[92:95], v[76:79], v[204:207], v[92:95]
    ds_read_b64_tr_b16 v[76:77], v2 offset:53248
    ds_read_b64_tr_b16 v[78:79], v2 offset:54272
    s_waitcnt vmcnt(8)
    s_barrier
    s_waitcnt lgkmcnt(6)
    v_mfma_f32_16x16x32_bf16 v[96:99], v[64:67], v[112:115], 0
    v_mfma_f32_16x16x32_bf16 v[104:107], v[64:67], v[116:119], 0
    ds_read_b64_tr_b16 v[64:65], v1 offset:57344
    s_add_u32 m0, s9, 40960
    s_add_u32 s10, s72, 74752
    buffer_load_dwordx4 v4, s[56:59], s10 offen lds
    s_waitcnt lgkmcnt(5)
    v_mfma_f32_16x16x32_bf16 v[100:103], v[68:71], v[112:115], 0
    ds_read_b64_tr_b16 v[66:67], v1 offset:58368
    v_mfma_f32_16x16x32_bf16 v[108:111], v[68:71], v[116:119], 0
    ds_read_b64_tr_b16 v[68:69], v2 offset:57344
    s_waitcnt lgkmcnt(5)
    v_mfma_f32_16x16x32_bf16 v[96:99], v[72:75], v[120:123], v[96:99]
    ds_read_b64_tr_b16 v[70:71], v2 offset:58368
    v_mfma_f32_16x16x32_bf16 v[104:107], v[72:75], v[124:127], v[104:107]
    ds_read_b64_tr_b16 v[72:73], v1 offset:61440
    s_waitcnt lgkmcnt(5)
    v_mfma_f32_16x16x32_bf16 v[100:103], v[76:79], v[120:123], v[100:103]
    ds_read_b64_tr_b16 v[74:75], v1 offset:62464
    v_mfma_f32_16x16x32_bf16 v[108:111], v[76:79], v[124:127], v[108:111]
    ds_read_b64_tr_b16 v[76:77], v2 offset:61440
    ds_read_b64_tr_b16 v[78:79], v2 offset:62464
    v_cvt_pk_bf16_f32 v24, v80, v81
    s_waitcnt vmcnt(8)
    s_barrier
    s_waitcnt lgkmcnt(6)
    v_mfma_f32_16x16x32_bf16 v[96:99], v[64:67], v[128:131], v[96:99]
    v_cvt_pk_bf16_f32 v25, v82, v83
    v_cvt_pk_bf16_f32 v26, v84, v85
    v_mfma_f32_16x16x32_bf16 v[104:107], v[64:67], v[132:135], v[104:107]
    ds_read_b64_tr_b16 v[64:65], v1 offset:0
    s_add_u32 m0, s9, 49152
    s_add_u32 s10, s72, 148480
    buffer_load_dwordx4 v4, s[56:59], s10 offen lds
    s_waitcnt lgkmcnt(5)
    v_mfma_f32_16x16x32_bf16 v[100:103], v[68:71], v[128:131], v[100:103]
    ds_read_b64_tr_b16 v[66:67], v1 offset:1024
    v_cvt_pk_bf16_f32 v27, v86, v87
    v_mfma_f32_16x16x32_bf16 v[108:111], v[68:71], v[132:135], v[108:111]
    ds_read_b64_tr_b16 v[68:69], v2 offset:0
    s_waitcnt lgkmcnt(5)
    v_mfma_f32_16x16x32_bf16 v[96:99], v[72:75], v[136:139], v[96:99]
    ds_read_b64_tr_b16 v[70:71], v2 offset:1024
    s_mov_b32 s11, 393216
    v_mfma_f32_16x16x32_bf16 v[104:107], v[72:75], v[140:143], v[104:107]
    ds_read_b64_tr_b16 v[72:73], v1 offset:4096
    buffer_store_dwordx4 v[24:27], v5, s[60:63], s11 offen sc1
    s_waitcnt lgkmcnt(5)
    v_mfma_f32_16x16x32_bf16 v[100:103], v[76:79], v[136:139], v[100:103]
    ds_read_b64_tr_b16 v[74:75], v1 offset:5120
    v_cvt_pk_bf16_f32 v28, v88, v89
    v_cvt_pk_bf16_f32 v29, v90, v91
    v_mfma_f32_16x16x32_bf16 v[108:111], v[76:79], v[140:143], v[108:111]
    ds_read_b64_tr_b16 v[76:77], v2 offset:4096
    ds_read_b64_tr_b16 v[78:79], v2 offset:5120
    s_waitcnt vmcnt(8)
    s_barrier
    s_waitcnt lgkmcnt(6)
    v_mfma_f32_16x16x32_bf16 v[96:99], v[64:67], v[144:147], v[96:99]
    v_cvt_pk_bf16_f32 v30, v92, v93
    v_mfma_f32_16x16x32_bf16 v[104:107], v[64:67], v[148:151], v[104:107]
    ds_read_b64_tr_b16 v[64:65], v1 offset:8192
    s_add_u32 m0, s9, 57344
    s_add_u32 s10, s72, 222208
    buffer_load_dwordx4 v4, s[56:59], s10 offen lds
    s_waitcnt lgkmcnt(5)
    v_mfma_f32_16x16x32_bf16 v[100:103], v[68:71], v[144:147], v[100:103]
    ds_read_b64_tr_b16 v[66:67], v1 offset:9216
    v_cvt_pk_bf16_f32 v31, v94, v95
    s_mov_b32 s11, 393728
    v_mfma_f32_16x16x32_bf16 v[108:111], v[68:71], v[148:151], v[108:111]
    ds_read_b64_tr_b16 v[68:69], v2 offset:8192
    s_waitcnt lgkmcnt(5)
    v_mfma_f32_16x16x32_bf16 v[96:99], v[72:75], v[152:155], v[96:99]
    ds_read_b64_tr_b16 v[70:71], v2 offset:9216
    v_mfma_f32_16x16x32_bf16 v[104:107], v[72:75], v[156:159], v[104:107]
    ds_read_b64_tr_b16 v[72:73], v1 offset:12288
    buffer_store_dwordx4 v[28:31], v5, s[60:63], s11 offen sc1
    s_waitcnt lgkmcnt(5)
    v_mfma_f32_16x16x32_bf16 v[100:103], v[76:79], v[152:155], v[100:103]
    ds_read_b64_tr_b16 v[74:75], v1 offset:13312
    v_mfma_f32_16x16x32_bf16 v[108:111], v[76:79], v[156:159], v[108:111]
    ds_read_b64_tr_b16 v[76:77], v2 offset:12288
    ds_read_b64_tr_b16 v[78:79], v2 offset:13312
    s_waitcnt vmcnt(9)
    s_waitcnt vmcnt(7)
    s_barrier
    v_mov_b32 v60, 6
    buffer_store_dword v60, v59, s[60:63], 0 offen sc1
    s_waitcnt lgkmcnt(6)
    v_mfma_f32_16x16x32_bf16 v[96:99], v[64:67], v[160:163], v[96:99]
    v_mfma_f32_16x16x32_bf16 v[104:107], v[64:67], v[164:167], v[104:107]
    ds_read_b64_tr_b16 v[64:65], v1 offset:16384
    s_add_u32 m0, s9, 0
    s_add_u32 s10, s72, 295936
    buffer_load_dwordx4 v4, s[56:59], s10 offen lds
    s_waitcnt lgkmcnt(5)
    v_mfma_f32_16x16x32_bf16 v[100:103], v[68:71], v[160:163], v[100:103]
    ds_read_b64_tr_b16 v[66:67], v1 offset:17408
    v_mfma_f32_16x16x32_bf16 v[108:111], v[68:71], v[164:167], v[108:111]
    ds_read_b64_tr_b16 v[68:69], v2 offset:16384
    s_waitcnt lgkmcnt(5)
    v_mfma_f32_16x16x32_bf16 v[96:99], v[72:75], v[168:171], v[96:99]
    ds_read_b64_tr_b16 v[70:71], v2 offset:17408
    v_mfma_f32_16x16x32_bf16 v[104:107], v[72:75], v[172:175], v[104:107]
    ds_read_b64_tr_b16 v[72:73], v1 offset:20480
    s_waitcnt lgkmcnt(5)
    v_mfma_f32_16x16x32_bf16 v[100:103], v[76:79], v[168:171], v[100:103]
    ds_read_b64_tr_b16 v[74:75], v1 offset:21504
    v_mfma_f32_16x16x32_bf16 v[108:111], v[76:79], v[172:175], v[108:111]
    ds_read_b64_tr_b16 v[76:77], v2 offset:20480
    ds_read_b64_tr_b16 v[78:79], v2 offset:21504
    s_waitcnt vmcnt(8)
    s_barrier
    s_waitcnt lgkmcnt(6)
    v_mfma_f32_16x16x32_bf16 v[96:99], v[64:67], v[176:179], v[96:99]
    v_mfma_f32_16x16x32_bf16 v[104:107], v[64:67], v[180:183], v[104:107]
    ds_read_b64_tr_b16 v[64:65], v1 offset:24576
    s_add_u32 m0, s9, 8192
    s_add_u32 s10, s72, 369664
    buffer_load_dwordx4 v4, s[56:59], s10 offen lds
    s_waitcnt lgkmcnt(5)
    v_mfma_f32_16x16x32_bf16 v[100:103], v[68:71], v[176:179], v[100:103]
    ds_read_b64_tr_b16 v[66:67], v1 offset:25600
    v_mfma_f32_16x16x32_bf16 v[108:111], v[68:71], v[180:183], v[108:111]
    ds_read_b64_tr_b16 v[68:69], v2 offset:24576
    s_waitcnt lgkmcnt(5)
    v_mfma_f32_16x16x32_bf16 v[96:99], v[72:75], v[184:187], v[96:99]
    ds_read_b64_tr_b16 v[70:71], v2 offset:25600
    v_mfma_f32_16x16x32_bf16 v[104:107], v[72:75], v[188:191], v[104:107]
    ds_read_b64_tr_b16 v[72:73], v1 offset:28672
    s_waitcnt lgkmcnt(5)
    v_mfma_f32_16x16x32_bf16 v[100:103], v[76:79], v[184:187], v[100:103]
    ds_read_b64_tr_b16 v[74:75], v1 offset:29696
    v_mfma_f32_16x16x32_bf16 v[108:111], v[76:79], v[188:191], v[108:111]
    ds_read_b64_tr_b16 v[76:77], v2 offset:28672
    ds_read_b64_tr_b16 v[78:79], v2 offset:29696
    s_waitcnt vmcnt(8)
    s_barrier
    s_waitcnt lgkmcnt(6)
    v_mfma_f32_16x16x32_bf16 v[96:99], v[64:67], v[192:195], v[96:99]
    v_mfma_f32_16x16x32_bf16 v[104:107], v[64:67], v[196:199], v[104:107]
    ds_read_b64_tr_b16 v[64:65], v1 offset:32768
    s_waitcnt lgkmcnt(5)
    v_mfma_f32_16x16x32_bf16 v[100:103], v[68:71], v[192:195], v[100:103]
    ds_read_b64_tr_b16 v[66:67], v1 offset:33792
    v_mfma_f32_16x16x32_bf16 v[108:111], v[68:71], v[196:199], v[108:111]
    ds_read_b64_tr_b16 v[68:69], v2 offset:32768
    s_waitcnt lgkmcnt(5)
    v_mfma_f32_16x16x32_bf16 v[96:99], v[72:75], v[200:203], v[96:99]
    ds_read_b64_tr_b16 v[70:71], v2 offset:33792
    v_mfma_f32_16x16x32_bf16 v[104:107], v[72:75], v[204:207], v[104:107]
    ds_read_b64_tr_b16 v[72:73], v1 offset:36864
    s_waitcnt lgkmcnt(5)
    v_mfma_f32_16x16x32_bf16 v[100:103], v[76:79], v[200:203], v[100:103]
    ds_read_b64_tr_b16 v[74:75], v1 offset:37888
    v_mfma_f32_16x16x32_bf16 v[108:111], v[76:79], v[204:207], v[108:111]
    ds_read_b64_tr_b16 v[76:77], v2 offset:36864
    ds_read_b64_tr_b16 v[78:79], v2 offset:37888
    s_waitcnt vmcnt(7)
    s_barrier
    s_waitcnt lgkmcnt(6)
    v_mfma_f32_16x16x32_bf16 v[80:83], v[64:67], v[112:115], 0
    v_mfma_f32_16x16x32_bf16 v[88:91], v[64:67], v[116:119], 0
    ds_read_b64_tr_b16 v[64:65], v1 offset:40960
    s_waitcnt lgkmcnt(5)
    v_mfma_f32_16x16x32_bf16 v[84:87], v[68:71], v[112:115], 0
    ds_read_b64_tr_b16 v[66:67], v1 offset:41984
    v_mfma_f32_16x16x32_bf16 v[92:95], v[68:71], v[116:119], 0
    ds_read_b64_tr_b16 v[68:69], v2 offset:40960
    s_waitcnt lgkmcnt(5)
    v_mfma_f32_16x16x32_bf16 v[80:83], v[72:75], v[120:123], v[80:83]
    ds_read_b64_tr_b16 v[70:71], v2 offset:41984
    v_mfma_f32_16x16x32_bf16 v[88:91], v[72:75], v[124:127], v[88:91]
    ds_read_b64_tr_b16 v[72:73], v1 offset:45056
    s_waitcnt lgkmcnt(5)
    v_mfma_f32_16x16x32_bf16 v[84:87], v[76:79], v[120:123], v[84:87]
    ds_read_b64_tr_b16 v[74:75], v1 offset:46080
    v_mfma_f32_16x16x32_bf16 v[92:95], v[76:79], v[124:127], v[92:95]
    ds_read_b64_tr_b16 v[76:77], v2 offset:45056
    ds_read_b64_tr_b16 v[78:79], v2 offset:46080
    v_cvt_pk_bf16_f32 v24, v96, v97
    s_waitcnt vmcnt(6)
    s_barrier
    s_waitcnt lgkmcnt(6)
    v_mfma_f32_16x16x32_bf16 v[80:83], v[64:67], v[128:131], v[80:83]
    v_cvt_pk_bf16_f32 v25, v98, v99
    v_cvt_pk_bf16_f32 v26, v100, v101
    v_mfma_f32_16x16x32_bf16 v[88:91], v[64:67], v[132:135], v[88:91]
    ds_read_b64_tr_b16 v[64:65], v1 offset:49152
    s_waitcnt lgkmcnt(5)
    v_mfma_f32_16x16x32_bf16 v[84:87], v[68:71], v[128:131], v[84:87]
    ds_read_b64_tr_b16 v[66:67], v1 offset:50176
    v_cvt_pk_bf16_f32 v27, v102, v103
    v_mfma_f32_16x16x32_bf16 v[92:95], v[68:71], v[132:135], v[92:95]
    ds_read_b64_tr_b16 v[68:69], v2 offset:49152
    s_waitcnt lgkmcnt(5)
    v_mfma_f32_16x16x32_bf16 v[80:83], v[72:75], v[136:139], v[80:83]
    ds_read_b64_tr_b16 v[70:71], v2 offset:50176
    s_mov_b32 s11, 458752
    v_mfma_f32_16x16x32_bf16 v[88:91], v[72:75], v[140:143], v[88:91]
    ds_read_b64_tr_b16 v[72:73], v1 offset:53248
    buffer_store_dwordx4 v[24:27], v5, s[60:63], s11 offen sc1
    s_waitcnt lgkmcnt(5)
    v_mfma_f32_16x16x32_bf16 v[84:87], v[76:79], v[136:139], v[84:87]
    ds_read_b64_tr_b16 v[74:75], v1 offset:54272
    v_cvt_pk_bf16_f32 v28, v104, v105
    v_cvt_pk_bf16_f32 v29, v106, v107
    v_mfma_f32_16x16x32_bf16 v[92:95], v[76:79], v[140:143], v[92:95]
    ds_read_b64_tr_b16 v[76:77], v2 offset:53248
    ds_read_b64_tr_b16 v[78:79], v2 offset:54272
    s_waitcnt vmcnt(5)
    s_barrier
    s_waitcnt lgkmcnt(6)
    v_mfma_f32_16x16x32_bf16 v[80:83], v[64:67], v[144:147], v[80:83]
    v_cvt_pk_bf16_f32 v30, v108, v109
    v_mfma_f32_16x16x32_bf16 v[88:91], v[64:67], v[148:151], v[88:91]
    ds_read_b64_tr_b16 v[64:65], v1 offset:57344
    s_waitcnt lgkmcnt(5)
    v_mfma_f32_16x16x32_bf16 v[84:87], v[68:71], v[144:147], v[84:87]
    ds_read_b64_tr_b16 v[66:67], v1 offset:58368
    v_cvt_pk_bf16_f32 v31, v110, v111
    s_mov_b32 s11, 459264
    v_mfma_f32_16x16x32_bf16 v[92:95], v[68:71], v[148:151], v[92:95]
    ds_read_b64_tr_b16 v[68:69], v2 offset:57344
    s_waitcnt lgkmcnt(5)
    v_mfma_f32_16x16x32_bf16 v[80:83], v[72:75], v[152:155], v[80:83]
    ds_read_b64_tr_b16 v[70:71], v2 offset:58368
    v_mfma_f32_16x16x32_bf16 v[88:91], v[72:75], v[156:159], v[88:91]
    ds_read_b64_tr_b16 v[72:73], v1 offset:61440
    buffer_store_dwordx4 v[28:31], v5, s[60:63], s11 offen sc1
    s_waitcnt lgkmcnt(5)
    v_mfma_f32_16x16x32_bf16 v[84:87], v[76:79], v[152:155], v[84:87]
    ds_read_b64_tr_b16 v[74:75], v1 offset:62464
    v_mfma_f32_16x16x32_bf16 v[92:95], v[76:79], v[156:159], v[92:95]
    ds_read_b64_tr_b16 v[76:77], v2 offset:61440
    ds_read_b64_tr_b16 v[78:79], v2 offset:62464
    s_waitcnt vmcnt(5)
    s_waitcnt vmcnt(3)
    s_barrier
    v_mov_b32 v60, 7
    buffer_store_dword v60, v59, s[60:63], 0 offen sc1
    s_waitcnt lgkmcnt(6)
    v_mfma_f32_16x16x32_bf16 v[80:83], v[64:67], v[160:163], v[80:83]
    v_mfma_f32_16x16x32_bf16 v[88:91], v[64:67], v[164:167], v[88:91]
    ds_read_b64_tr_b16 v[64:65], v1 offset:0
    s_waitcnt lgkmcnt(5)
    v_mfma_f32_16x16x32_bf16 v[84:87], v[68:71], v[160:163], v[84:87]
    ds_read_b64_tr_b16 v[66:67], v1 offset:1024
    v_mfma_f32_16x16x32_bf16 v[92:95], v[68:71], v[164:167], v[92:95]
    ds_read_b64_tr_b16 v[68:69], v2 offset:0
    buffer_load_dword v62, v61, s[60:63], 0 offen sc1
    s_waitcnt lgkmcnt(5)
    v_mfma_f32_16x16x32_bf16 v[80:83], v[72:75], v[168:171], v[80:83]
    ds_read_b64_tr_b16 v[70:71], v2 offset:1024
    v_mfma_f32_16x16x32_bf16 v[88:91], v[72:75], v[172:175], v[88:91]
    ds_read_b64_tr_b16 v[72:73], v1 offset:4096
    s_waitcnt lgkmcnt(5)
    v_mfma_f32_16x16x32_bf16 v[84:87], v[76:79], v[168:171], v[84:87]
    ds_read_b64_tr_b16 v[74:75], v1 offset:5120
    v_mfma_f32_16x16x32_bf16 v[92:95], v[76:79], v[172:175], v[92:95]
    ds_read_b64_tr_b16 v[76:77], v2 offset:4096
    ds_read_b64_tr_b16 v[78:79], v2 offset:5120
    s_waitcnt vmcnt(4)
    s_barrier
    s_waitcnt lgkmcnt(6)
    v_mfma_f32_16x16x32_bf16 v[80:83], v[64:67], v[176:179], v[80:83]
    v_mfma_f32_16x16x32_bf16 v[88:91], v[64:67], v[180:183], v[88:91]
    ds_read_b64_tr_b16 v[64:65], v1 offset:8192
    s_waitcnt lgkmcnt(5)
    v_mfma_f32_16x16x32_bf16 v[84:87], v[68:71], v[176:179], v[84:87]
    ds_read_b64_tr_b16 v[66:67], v1 offset:9216
    v_mfma_f32_16x16x32_bf16 v[92:95], v[68:71], v[180:183], v[92:95]
    ds_read_b64_tr_b16 v[68:69], v2 offset:8192
    s_waitcnt lgkmcnt(5)
    v_mfma_f32_16x16x32_bf16 v[80:83], v[72:75], v[184:187], v[80:83]
    ds_read_b64_tr_b16 v[70:71], v2 offset:9216
    v_mfma_f32_16x16x32_bf16 v[88:91], v[72:75], v[188:191], v[88:91]
    ds_read_b64_tr_b16 v[72:73], v1 offset:12288
    s_waitcnt lgkmcnt(5)
    v_mfma_f32_16x16x32_bf16 v[84:87], v[76:79], v[184:187], v[84:87]
    ds_read_b64_tr_b16 v[74:75], v1 offset:13312
    v_mfma_f32_16x16x32_bf16 v[92:95], v[76:79], v[188:191], v[92:95]
    ds_read_b64_tr_b16 v[76:77], v2 offset:12288
    ds_read_b64_tr_b16 v[78:79], v2 offset:13312
    s_waitcnt lgkmcnt(6)
    v_mfma_f32_16x16x32_bf16 v[80:83], v[64:67], v[192:195], v[80:83]
    v_mfma_f32_16x16x32_bf16 v[88:91], v[64:67], v[196:199], v[88:91]
    s_waitcnt lgkmcnt(4)
    v_mfma_f32_16x16x32_bf16 v[84:87], v[68:71], v[192:195], v[84:87]
    v_mfma_f32_16x16x32_bf16 v[92:95], v[68:71], v[196:199], v[92:95]
    s_waitcnt lgkmcnt(2)
    v_mfma_f32_16x16x32_bf16 v[80:83], v[72:75], v[200:203], v[80:83]
    v_mfma_f32_16x16x32_bf16 v[88:91], v[72:75], v[204:207], v[88:91]
    s_waitcnt lgkmcnt(0)
    v_mfma_f32_16x16x32_bf16 v[84:87], v[76:79], v[200:203], v[84:87]
    v_mfma_f32_16x16x32_bf16 v[92:95], v[76:79], v[204:207], v[92:95]
    s_nop 7
    s_nop 5
    v_cvt_pk_bf16_f32 v24, v80, v81
    v_cvt_pk_bf16_f32 v25, v82, v83
    v_cvt_pk_bf16_f32 v26, v84, v85
    v_cvt_pk_bf16_f32 v27, v86, v87
    s_mov_b32 s11, 524288
    buffer_store_dwordx4 v[24:27], v5, s[60:63], s11 offen sc1
    v_cvt_pk_bf16_f32 v28, v88, v89
    v_cvt_pk_bf16_f32 v29, v90, v91
    v_cvt_pk_bf16_f32 v30, v92, v93
    v_cvt_pk_bf16_f32 v31, v94, v95
    s_mov_b32 s11, 524800
    buffer_store_dwordx4 v[28:31], v5, s[60:63], s11 offen sc1
    s_waitcnt vmcnt(2)
    s_mov_b32 s101, s98
    s_waitcnt vmcnt(0)
    s_barrier
    v_mov_b32 v60, 9
    buffer_store_dword v60, v59, s[60:63], 0 offen sc1
    s_bitcmp1_b32 s98, 0
    s_cbranch_scc1 .cpn_4
    v_cmp_gt_u32 s[94:95], s73, v62
    s_and_b64 s[94:95], s[94:95], s[96:97]
    s_cbranch_scc1 .cpn_4
    s_mov_b32 s76, 0
    buffer_load_dwordx4 v[208:211], v20, s[60:63], s76 offen offset:0 sc1
    buffer_load_dwordx4 v[212:215], v20, s[60:63], s76 offen offset:2048 sc1
    s_mov_b32 s76, 4096
    buffer_load_dwordx4 v[216:219], v20, s[60:63], s76 offen offset:0 sc1
    buffer_load_dwordx4 v[220:223], v20, s[60:63], s76 offen offset:2048 sc1
    s_mov_b32 s76, 8192
    buffer_load_dwordx4 v[224:227], v20, s[60:63], s76 offen offset:0 sc1
    buffer_load_dwordx4 v[228:231], v20, s[60:63], s76 offen offset:2048 sc1
    s_bitset1_b32 s98, 0
    s_branch .cpe_3
.cpn_4:
    s_bitcmp1_b32 s98, 1
    s_cbranch_scc1 .cpn_5
    v_cmp_gt_u32 s[94:95], s74, v62
    s_and_b64 s[94:95], s[94:95], s[96:97]
    s_cbranch_scc1 .cpn_5
    s_mov_b32 s76, 196608
    buffer_load_dwordx4 v[232:235], v20, s[60:63], s76 offen offset:0 sc1
    buffer_load_dwordx4 v[236:239], v20, s[60:63], s76 offen offset:2048 sc1
    s_mov_b32 s76, 200704
    buffer_load_dwordx4 v[240:243], v20, s[60:63], s76 offen offset:0 sc1
    buffer_load_dwordx4 v[244:247], v20, s[60:63], s76 offen offset:2048 sc1
    s_mov_b32 s76, 204800
    buffer_load_dwordx4 v[248:251], v20, s[60:63], s76 offen offset:0 sc1
    buffer_load_dwordx4 v[252:255], v20, s[60:63], s76 offen offset:2048 sc1
    s_bitset1_b32 s98, 1
    s_branch .cpe_3
.cpn_5:
    s_bitcmp1_b32 s98, 2
    s_cbranch_scc1 .cpn_6
    v_cmp_gt_u32 s[94:95], s75, v62
    s_and_b64 s[94:95], s[94:95], s[96:97]
    s_cbranch_scc1 .cpn_6
    s_mov_b32 s76, 393216
    buffer_load_dwordx4 v[112:115], v20, s[60:63], s76 offen offset:0 sc1
    buffer_load_dwordx4 v[116:119], v20, s[60:63], s76 offen offset:2048 sc1
    s_mov_b32 s76, 397312
    buffer_load_dwordx4 v[120:123], v20, s[60:63], s76 offen offset:0 sc1
    buffer_load_dwordx4 v[124:127], v20, s[60:63], s76 offen offset:2048 sc1
    s_mov_b32 s76, 401408
    buffer_load_dwordx4 v[128:131], v20, s[60:63], s76 offen offset:0 sc1
    buffer_load_dwordx4 v[132:135], v20, s[60:63], s76 offen offset:2048 sc1
    s_bitset1_b32 s98, 2
    s_branch .cpe_3
.cpn_6:
    buffer_load_dword v63, v58, s[60:63], 0 offen
    buffer_load_dword v63, v58, s[60:63], 0 offen
    buffer_load_dword v63, v58, s[60:63], 0 offen
    buffer_load_dword v63, v58, s[60:63], 0 offen
    buffer_load_dword v63, v58, s[60:63], 0 offen
    buffer_load_dword v63, v58, s[60:63], 0 offen
.cpe_3:
    s_bitcmp1_b32 s98, 1
    s_cbranch_scc1 .cpn_8
    v_cmp_gt_u32 s[94:95], s74, v62
    s_and_b64 s[94:95], s[94:95], s[96:97]
    s_cbranch_scc1 .cpn_8
    s_mov_b32 s76, 196608
    buffer_load_dwordx4 v[232:235], v20, s[60:63], s76 offen offset:0 sc1
    buffer_load_dwordx4 v[236:239], v20, s[60:63], s76 offen offset:2048 sc1
    s_mov_b32 s76, 200704
    buffer_load_dwordx4 v[240:243], v20, s[60:63], s76 offen offset:0 sc1
    buffer_load_dwordx4 v[244:247], v20, s[60:63], s76 offen offset:2048 sc1
    s_mov_b32 s76, 204800
    buffer_load_dwordx4 v[248:251], v20, s[60:63], s76 offen offset:0 sc1
    buffer_load_dwordx4 v[252:255], v20, s[60:63], s76 offen offset:2048 sc1
    s_bitset1_b32 s98, 1
    s_branch .cpe_7
.cpn_8:
    s_bitcmp1_b32 s98, 2
    s_cbranch_scc1 .cpn_9
    v_cmp_gt_u32 s[94:95], s75, v62
    s_and_b64 s[94:95], s[94:95], s[96:97]
    s_cbranch_scc1 .cpn_9
    s_mov_b32 s76, 393216
    buffer_load_dwordx4 v[112:115], v20, s[60:63], s76 offen offset:0 sc1
    buffer_load_dwordx4 v[116:119], v20, s[60:63], s76 offen offset:2048 sc1
    s_mov_b32 s76, 397312
    buffer_load_dwordx4 v[120:123], v20, s[60:63], s76 offen offset:0 sc1
    buffer_load_dwordx4 v[124:127], v20, s[60:63], s76 offen offset:2048 sc1
    s_mov_b32 s76, 401408
    buffer_load_dwordx4 v[128:131], v20, s[60:63], s76 offen offset:0 sc1
    buffer_load_dwordx4 v[132:135], v20, s[60:63], s76 offen offset:2048 sc1
    s_bitset1_b32 s98, 2
    s_branch .cpe_7
.cpn_9:
    buffer_load_dword v63, v58, s[60:63], 0 offen
    buffer_load_dword v63, v58, s[60:63], 0 offen
    buffer_load_dword v63, v58, s[60:63], 0 offen
    buffer_load_dword v63, v58, s[60:63], 0 offen
    buffer_load_dword v63, v58, s[60:63], 0 offen
    buffer_load_dword v63, v58, s[60:63], 0 offen
.cpe_7:
    buffer_load_dword v62, v61, s[60:63], 0 offen sc1
    s_mov_b32 s99, 0
    s_mov_b32 s83, 65536
    s_branch .Lt_np
.Lt_loop:
    s_cmp_lt_u32 s100, 1
    s_cbranch_scc1 .Lt_w0
    s_cmp_lt_u32 s100, 2
    s_cbranch_scc1 .Lt_w1
    s_waitcnt vmcnt(2)
    s_branch .Lt_wd
.Lt_w1:
    s_waitcnt vmcnt(1)
    s_branch .Lt_wd
.Lt_w0:
    s_waitcnt vmcnt(0)
.Lt_wd:
    s_andn2_b32 s101, s98, s99
    s_bitcmp1_b32 s98, 0
    s_cbranch_scc1 .Lt_i0
    v_cmp_gt_u32 s[94:95], s73, v62
    s_and_b64 s[94:95], s[94:95], s[96:97]
    s_cbranch_scc1 .Lt_i0
    s_mov_b32 s76, 0
    buffer_load_dwordx4 v[208:211], v20, s[60:63], s76 offen offset:0 sc1
    buffer_load_dwordx4 v[212:215], v20, s[60:63], s76 offen offset:2048 sc1
    s_mov_b32 s76, 4096
    buffer_load_dwordx4 v[216:219], v20, s[60:63], s76 offen offset:0 sc1
    buffer_load_dwordx4 v[220:223], v20, s[60:63], s76 offen offset:2048 sc1
    s_mov_b32 s76, 8192
    buffer_load_dwordx4 v[224:227], v20, s[60:63], s76 offen offset:0 sc1
    buffer_load_dwordx4 v[228:231], v20, s[60:63], s76 offen offset:2048 sc1
    s_bitset1_b32 s98, 0
.Lt_i0:
    s_bitcmp1_b32 s98, 1
    s_cbranch_scc1 .Lt_i1
    v_cmp_gt_u32 s[94:95], s74, v62
    s_and_b64 s[94:95], s[94:95], s[96:97]
    s_cbranch_scc1 .Lt_i1
    s_mov_b32 s76, 196608
    buffer_load_dwordx4 v[232:235], v20, s[60:63], s76 offen offset:0 sc1
    buffer_load_dwordx4 v[236:239], v20, s[60:63], s76 offen offset:2048 sc1
    s_mov_b32 s76, 200704
    buffer_load_dwordx4 v[240:243], v20, s[60:63], s76 offen offset:0 sc1
    buffer_load_dwordx4 v[244:247], v20, s[60:63], s76 offen offset:2048 sc1
    s_mov_b32 s76, 204800
    buffer_load_dwordx4 v[248:251], v20, s[60:63], s76 offen offset:0 sc1
    buffer_load_dwordx4 v[252:255], v20, s[60:63], s76 offen offset:2048 sc1
    s_bitset1_b32 s98, 1
.Lt_i1:
    s_bitcmp1_b32 s98, 2
    s_cbranch_scc1 .Lt_i2
    v_cmp_gt_u32 s[94:95], s75, v62
    s_and_b64 s[94:95], s[94:95], s[96:97]
    s_cbranch_scc1 .Lt_i2
    s_mov_b32 s76, 393216
    buffer_load_dwordx4 v[112:115], v20, s[60:63], s76 offen offset:0 sc1
    buffer_load_dwordx4 v[116:119], v20, s[60:63], s76 offen offset:2048 sc1
    s_mov_b32 s76, 397312
    buffer_load_dwordx4 v[120:123], v20, s[60:63], s76 offen offset:0 sc1
    buffer_load_dwordx4 v[124:127], v20, s[60:63], s76 offen offset:2048 sc1
    s_mov_b32 s76, 401408
    buffer_load_dwordx4 v[128:131], v20, s[60:63], s76 offen offset:0 sc1
    buffer_load_dwordx4 v[132:135], v20, s[60:63], s76 offen offset:2048 sc1
    s_bitset1_b32 s98, 2
.Lt_i2:
    s_bitcmp1_b32 s98, 3
    s_cbranch_scc1 .Lt_i3
    v_cmp_gt_u32 s[94:95], s73, v62
    s_andn2_b64 s[94:95], s[94:95], s[96:97]
    s_cbranch_scc1 .Lt_i3
    s_mov_b32 s76, 12288
    buffer_load_dwordx4 v[136:139], v20, s[60:63], s76 offen offset:0 sc1
    buffer_load_dwordx4 v[140:143], v20, s[60:63], s76 offen offset:2048 sc1
    s_bitset1_b32 s98, 3
.Lt_i3:
    s_bitcmp1_b32 s98, 4
    s_cbranch_scc1 .Lt_i4
    v_cmp_gt_u32 s[94:95], s74, v62
    s_andn2_b64 s[94:95], s[94:95], s[96:97]
    s_cbranch_scc1 .Lt_i4
    s_mov_b32 s76, 208896
    buffer_load_dwordx4 v[144:147], v20, s[60:63], s76 offen offset:0 sc1
    buffer_load_dwordx4 v[148:151], v20, s[60:63], s76 offen offset:2048 sc1
    s_bitset1_b32 s98, 4
.Lt_i4:
    s_bitcmp1_b32 s98, 5
    s_cbranch_scc1 .Lt_i5
    v_cmp_gt_u32 s[94:95], s75, v62
    s_andn2_b64 s[94:95], s[94:95], s[96:97]
    s_cbranch_scc1 .Lt_i5
    s_mov_b32 s76, 405504
    buffer_load_dwordx4 v[152:155], v20, s[60:63], s76 offen offset:0 sc1
    buffer_load_dwordx4 v[156:159], v20, s[60:63], s76 offen offset:2048 sc1
    s_bitset1_b32 s98, 5
.Lt_i5:
    s_cmp_eq_u32 s98, 63
    s_cbranch_scc1 .Lt_np
    buffer_load_dword v62, v61, s[60:63], 0 offen sc1
.Lt_np:
    s_mov_b32 s100, 0
    s_bitcmp1_b32 s101, 0
    s_cbranch_scc0 .Lt_f0
    v_dot2_f32_bf16 v64, v208, s92, 0
    v_dot2_f32_bf16 v65, v208, s93, 0
    v_dot2_f32_bf16 v66, v209, s92, 0
    v_dot2_f32_bf16 v67, v209, s93, 0
    v_dot2_f32_bf16 v68, v210, s92, 0
    v_dot2_f32_bf16 v69, v210, s93, 0
    v_dot2_f32_bf16 v70, v211, s92, 0
    v_dot2_f32_bf16 v71, v211, s93, 0
    v_dot2_f32_bf16 v64, v212, s92, v64
    v_dot2_f32_bf16 v65, v212, s93, v65
    v_dot2_f32_bf16 v66, v213, s92, v66
    v_dot2_f32_bf16 v67, v213, s93, v67
    v_dot2_f32_bf16 v68, v214, s92, v68
    v_dot2_f32_bf16 v69, v214, s93, v69
    v_dot2_f32_bf16 v70, v215, s92, v70
    v_dot2_f32_bf16 v71, v215, s93, v71
    v_dot2_f32_bf16 v64, v216, s92, v64
    v_dot2_f32_bf16 v65, v216, s93, v65
    v_dot2_f32_bf16 v66, v217, s92, v66
    v_dot2_f32_bf16 v67, v217, s93, v67
    v_dot2_f32_bf16 v68, v218, s92, v68
    v_dot2_f32_bf16 v69, v218, s93, v69
    v_dot2_f32_bf16 v70, v219, s92, v70
    v_dot2_f32_bf16 v71, v219, s93, v71
    v_dot2_f32_bf16 v64, v220, s92, v64
    v_dot2_f32_bf16 v65, v220, s93, v65
    v_dot2_f32_bf16 v66, v221, s92, v66
    v_dot2_f32_bf16 v67, v221, s93, v67
    v_dot2_f32_bf16 v68, v222, s92, v68
    v_dot2_f32_bf16 v69, v222, s93, v69
    v_dot2_f32_bf16 v70, v223, s92, v70
    v_dot2_f32_bf16 v71, v223, s93, v71
    v_dot2_f32_bf16 v64, v224, s92, v64
    v_dot2_f32_bf16 v65, v224, s93, v65
    v_dot2_f32_bf16 v66, v225, s92, v66
    v_dot2_f32_bf16 v67, v225, s93, v67
    v_dot2_f32_bf16 v68, v226, s92, v68
    v_dot2_f32_bf16 v69, v226, s93, v69
    v_dot2_f32_bf16 v70, v227, s92, v70
    v_dot2_f32_bf16 v71, v227, s93, v71
    v_dot2_f32_bf16 v64, v228, s92, v64
    v_dot2_f32_bf16 v65, v228, s93, v65
    v_dot2_f32_bf16 v66, v229, s92, v66
    v_dot2_f32_bf16 v67, v229, s93, v67
    v_dot2_f32_bf16 v68, v230, s92, v68
    v_dot2_f32_bf16 v69, v230, s93, v69
    v_dot2_f32_bf16 v70, v231, s92, v70
    v_dot2_f32_bf16 v71, v231, s93, v71
    s_nop 3
    v_permlane32_swap_b32 v64, v68
    v_permlane32_swap_b32 v65, v69
    v_permlane32_swap_b32 v66, v70
    v_permlane32_swap_b32 v67, v71
    s_nop 1
    v_add_f32 v8, v64, v68
    v_add_f32 v9, v65, v69
    v_add_f32 v10, v66, v70
    v_add_f32 v11, v67, v71
    v_exp_f32 v64, -v8
    v_exp_f32 v65, -v9
    v_exp_f32 v66, -v10
    v_exp_f32 v67, -v11
    v_mul_f32 v8, 0x3f317218, v8
    v_mul_f32 v9, 0x3f317218, v9
    v_mul_f32 v10, 0x3f317218, v10
    v_mul_f32 v11, 0x3f317218, v11
    v_add_f32 v64, 1.0, v64
    v_add_f32 v65, 1.0, v65
    v_add_f32 v66, 1.0, v66
    v_add_f32 v67, 1.0, v67
    v_rcp_f32 v64, v64
    v_rcp_f32 v65, v65
    v_rcp_f32 v66, v66
    v_rcp_f32 v67, v67
    s_nop 0
    v_mul_f32 v8, v8, v64
    v_mul_f32 v9, v9, v65
    v_mul_f32 v10, v10, v66
    v_mul_f32 v11, v11, v67
    s_bitset1_b32 s99, 0
.Lt_f0:
    s_bitcmp1_b32 s101, 1
    s_cbranch_scc0 .Lt_f1
    v_dot2_f32_bf16 v64, v232, s92, 0
    v_dot2_f32_bf16 v65, v232, s93, 0
    v_dot2_f32_bf16 v66, v233, s92, 0
    v_dot2_f32_bf16 v67, v233, s93, 0
    v_dot2_f32_bf16 v68, v234, s92, 0
    v_dot2_f32_bf16 v69, v234, s93, 0
    v_dot2_f32_bf16 v70, v235, s92, 0
    v_dot2_f32_bf16 v71, v235, s93, 0
    v_dot2_f32_bf16 v64, v236, s92, v64
    v_dot2_f32_bf16 v65, v236, s93, v65
    v_dot2_f32_bf16 v66, v237, s92, v66
    v_dot2_f32_bf16 v67, v237, s93, v67
    v_dot2_f32_bf16 v68, v238, s92, v68
    v_dot2_f32_bf16 v69, v238, s93, v69
    v_dot2_f32_bf16 v70, v239, s92, v70
    v_dot2_f32_bf16 v71, v239, s93, v71
    v_dot2_f32_bf16 v64, v240, s92, v64
    v_dot2_f32_bf16 v65, v240, s93, v65
    v_dot2_f32_bf16 v66, v241, s92, v66
    v_dot2_f32_bf16 v67, v241, s93, v67
    v_dot2_f32_bf16 v68, v242, s92, v68
    v_dot2_f32_bf16 v69, v242, s93, v69
    v_dot2_f32_bf16 v70, v243, s92, v70
    v_dot2_f32_bf16 v71, v243, s93, v71
    v_dot2_f32_bf16 v64, v244, s92, v64
    v_dot2_f32_bf16 v65, v244, s93, v65
    v_dot2_f32_bf16 v66, v245, s92, v66
    v_dot2_f32_bf16 v67, v245, s93, v67
    v_dot2_f32_bf16 v68, v246, s92, v68
    v_dot2_f32_bf16 v69, v246, s93, v69
    v_dot2_f32_bf16 v70, v247, s92, v70
    v_dot2_f32_bf16 v71, v247, s93, v71
    v_dot2_f32_bf16 v64, v248, s92, v64
    v_dot2_f32_bf16 v65, v248, s93, v65
    v_dot2_f32_bf16 v66, v249, s92, v66
    v_dot2_f32_bf16 v67, v249, s93, v67
    v_dot2_f32_bf16 v68, v250, s92, v68
    v_dot2_f32_bf16 v69, v250, s93, v69
    v_dot2_f32_bf16 v70, v251, s92, v70
    v_dot2_f32_bf16 v71, v251, s93, v71
    v_dot2_f32_bf16 v64, v252, s92, v64
    v_dot2_f32_bf16 v65, v252, s93, v65
    v_dot2_f32_bf16 v66, v253, s92, v66
    v_dot2_f32_bf16 v67, v253, s93, v67
    v_dot2_f32_bf16 v68, v254, s92, v68
    v_dot2_f32_bf16 v69, v254, s93, v69
    v_dot2_f32_bf16 v70, v255, s92, v70
    v_dot2_f32_bf16 v71, v255, s93, v71
    s_nop 3
    v_permlane32_swap_b32 v64, v68
    v_permlane32_swap_b32 v65, v69
    v_permlane32_swap_b32 v66, v70
    v_permlane32_swap_b32 v67, v71
    s_nop 1
    v_add_f32 v12, v64, v68
    v_add_f32 v13, v65, v69
    v_add_f32 v14, v66, v70
    v_add_f32 v15, v67, v71
    v_exp_f32 v64, -v12
    v_exp_f32 v65, -v13
    v_exp_f32 v66, -v14
    v_exp_f32 v67, -v15
    v_mul_f32 v12, 0x3f317218, v12
    v_mul_f32 v13, 0x3f317218, v13
    v_mul_f32 v14, 0x3f317218, v14
    v_mul_f32 v15, 0x3f317218, v15
    v_add_f32 v64, 1.0, v64
    v_add_f32 v65, 1.0, v65
    v_add_f32 v66, 1.0, v66
    v_add_f32 v67, 1.0, v67
    v_rcp_f32 v64, v64
    v_rcp_f32 v65, v65
    v_rcp_f32 v66, v66
    v_rcp_f32 v67, v67
    s_nop 0
    v_mul_f32 v12, v12, v64
    v_mul_f32 v13, v13, v65
    v_mul_f32 v14, v14, v66
    v_mul_f32 v15, v15, v67
    s_bitset1_b32 s99, 1
.Lt_f1:
    s_bitcmp1_b32 s101, 2
    s_cbranch_scc0 .Lt_f2
    v_dot2_f32_bf16 v64, v112, s92, 0
    v_dot2_f32_bf16 v65, v112, s93, 0
    v_dot2_f32_bf16 v66, v113, s92, 0
    v_dot2_f32_bf16 v67, v113, s93, 0
    v_dot2_f32_bf16 v68, v114, s92, 0
    v_dot2_f32_bf16 v69, v114, s93, 0
    v_dot2_f32_bf16 v70, v115, s92, 0
    v_dot2_f32_bf16 v71, v115, s93, 0
    v_dot2_f32_bf16 v64, v116, s92, v64
    v_dot2_f32_bf16 v65, v116, s93, v65
    v_dot2_f32_bf16 v66, v117, s92, v66
    v_dot2_f32_bf16 v67, v117, s93, v67
    v_dot2_f32_bf16 v68, v118, s92, v68
    v_dot2_f32_bf16 v69, v118, s93, v69
    v_dot2_f32_bf16 v70, v119, s92, v70
    v_dot2_f32_bf16 v71, v119, s93, v71
    v_dot2_f32_bf16 v64, v120, s92, v64
    v_dot2_f32_bf16 v65, v120, s93, v65
    v_dot2_f32_bf16 v66, v121, s92, v66
    v_dot2_f32_bf16 v67, v121, s93, v67
    v_dot2_f32_bf16 v68, v122, s92, v68
    v_dot2_f32_bf16 v69, v122, s93, v69
    v_dot2_f32_bf16 v70, v123, s92, v70
    v_dot2_f32_bf16 v71, v123, s93, v71
    v_dot2_f32_bf16 v64, v124, s92, v64
    v_dot2_f32_bf16 v65, v124, s93, v65
    v_dot2_f32_bf16 v66, v125, s92, v66
    v_dot2_f32_bf16 v67, v125, s93, v67
    v_dot2_f32_bf16 v68, v126, s92, v68
    v_dot2_f32_bf16 v69, v126, s93, v69
    v_dot2_f32_bf16 v70, v127, s92, v70
    v_dot2_f32_bf16 v71, v127, s93, v71
    v_dot2_f32_bf16 v64, v128, s92, v64
    v_dot2_f32_bf16 v65, v128, s93, v65
    v_dot2_f32_bf16 v66, v129, s92, v66
    v_dot2_f32_bf16 v67, v129, s93, v67
    v_dot2_f32_bf16 v68, v130, s92, v68
    v_dot2_f32_bf16 v69, v130, s93, v69
    v_dot2_f32_bf16 v70, v131, s92, v70
    v_dot2_f32_bf16 v71, v131, s93, v71
    v_dot2_f32_bf16 v64, v132, s92, v64
    v_dot2_f32_bf16 v65, v132, s93, v65
    v_dot2_f32_bf16 v66, v133, s92, v66
    v_dot2_f32_bf16 v67, v133, s93, v67
    v_dot2_f32_bf16 v68, v134, s92, v68
    v_dot2_f32_bf16 v69, v134, s93, v69
    v_dot2_f32_bf16 v70, v135, s92, v70
    v_dot2_f32_bf16 v71, v135, s93, v71
    s_nop 3
    v_permlane32_swap_b32 v64, v68
    v_permlane32_swap_b32 v65, v69
    v_permlane32_swap_b32 v66, v70
    v_permlane32_swap_b32 v67, v71
    s_nop 1
    v_add_f32 v16, v64, v68
    v_add_f32 v17, v65, v69
    v_add_f32 v18, v66, v70
    v_add_f32 v19, v67, v71
    v_exp_f32 v64, -v16
    v_exp_f32 v65, -v17
    v_exp_f32 v66, -v18
    v_exp_f32 v67, -v19
    v_mul_f32 v16, 0x3f317218, v16
    v_mul_f32 v17, 0x3f317218, v17
    v_mul_f32 v18, 0x3f317218, v18
    v_mul_f32 v19, 0x3f317218, v19
    v_add_f32 v64, 1.0, v64
    v_add_f32 v65, 1.0, v65
    v_add_f32 v66, 1.0, v66
    v_add_f32 v67, 1.0, v67
    v_rcp_f32 v64, v64
    v_rcp_f32 v65, v65
    v_rcp_f32 v66, v66
    v_rcp_f32 v67, v67
    s_nop 0
    v_mul_f32 v16, v16, v64
    v_mul_f32 v17, v17, v65
    v_mul_f32 v18, v18, v66
    v_mul_f32 v19, v19, v67
    s_bitset1_b32 s99, 2
.Lt_f2:
    s_bitcmp1_b32 s101, 3
    s_cbranch_scc0 .Lt_f3
    s_bitcmp1_b32 s99, 0
    s_cbranch_scc0 .Lt_f3
    v_dot2_f32_bf16 v64, v136, s92, 0
    v_dot2_f32_bf16 v65, v136, s93, 0
    v_dot2_f32_bf16 v66, v137, s92, 0
    v_dot2_f32_bf16 v67, v137, s93, 0
    v_dot2_f32_bf16 v68, v138, s92, 0
    v_dot2_f32_bf16 v69, v138, s93, 0
    v_dot2_f32_bf16 v70, v139, s92, 0
    v_dot2_f32_bf16 v71, v139, s93, 0
    v_dot2_f32_bf16 v64, v140, s92, v64
    v_dot2_f32_bf16 v65, v140, s93, v65
    v_dot2_f32_bf16 v66, v141, s92, v66
    v_dot2_f32_bf16 v67, v141, s93, v67
    v_dot2_f32_bf16 v68, v142, s92, v68
    v_dot2_f32_bf16 v69, v142, s93, v69
    v_dot2_f32_bf16 v70, v143, s92, v70
    v_dot2_f32_bf16 v71, v143, s93, v71
    s_nop 3
    v_permlane32_swap_b32 v64, v68
    v_permlane32_swap_b32 v65, v69
    v_permlane32_swap_b32 v66, v70
    v_permlane32_swap_b32 v67, v71
    s_nop 1
    v_add_f32 v64, v64, v68
    v_add_f32 v65, v65, v69
    v_add_f32 v66, v66, v70
    v_add_f32 v67, v67, v71
    v_add_f32 v36, v36, v64
    v_add_f32 v37, v37, v65
    v_add_f32 v38, v38, v66
    v_add_f32 v39, v39, v67
    v_fma_f32 v32, v36, v8, v32
    v_fma_f32 v33, v37, v9, v33
    v_fma_f32 v34, v38, v10, v34
    v_fma_f32 v35, v39, v11, v35
    buffer_store_dwordx4 v[32:35], v21, s[84:87], 0 offen offset:0
    s_add_u32 s100, s100, 1
    s_bitset1_b32 s99, 3
.Lt_f3:
    s_bitcmp1_b32 s101, 4
    s_cbranch_scc0 .Lt_f4
    s_bitcmp1_b32 s99, 1
    s_cbranch_scc0 .Lt_f4
    v_dot2_f32_bf16 v64, v144, s92, 0
    v_dot2_f32_bf16 v65, v144, s93, 0
    v_dot2_f32_bf16 v66, v145, s92, 0
    v_dot2_f32_bf16 v67, v145, s93, 0
    v_dot2_f32_bf16 v68, v146, s92, 0
    v_dot2_f32_bf16 v69, v146, s93, 0
    v_dot2_f32_bf16 v70, v147, s92, 0
    v_dot2_f32_bf16 v71, v147, s93, 0
    v_dot2_f32_bf16 v64, v148, s92, v64
    v_dot2_f32_bf16 v65, v148, s93, v65
    v_dot2_f32_bf16 v66, v149, s92, v66
    v_dot2_f32_bf16 v67, v149, s93, v67
    v_dot2_f32_bf16 v68, v150, s92, v68
    v_dot2_f32_bf16 v69, v150, s93, v69
    v_dot2_f32_bf16 v70, v151, s92, v70
    v_dot2_f32_bf16 v71, v151, s93, v71
    s_nop 3
    v_permlane32_swap_b32 v64, v68
    v_permlane32_swap_b32 v65, v69
    v_permlane32_swap_b32 v66, v70
    v_permlane32_swap_b32 v67, v71
    s_nop 1
    v_add_f32 v64, v64, v68
    v_add_f32 v65, v65, v69
    v_add_f32 v66, v66, v70
    v_add_f32 v67, v67, v71
    v_add_f32 v44, v44, v64
    v_add_f32 v45, v45, v65
    v_add_f32 v46, v46, v66
    v_add_f32 v47, v47, v67
    v_fma_f32 v40, v44, v12, v40
    v_fma_f32 v41, v45, v13, v41
    v_fma_f32 v42, v46, v14, v42
    v_fma_f32 v43, v47, v15, v43
    buffer_store_dwordx4 v[40:43], v21, s[84:87], 0 offen offset:768
    s_add_u32 s100, s100, 1
    s_bitset1_b32 s99, 4
.Lt_f4:
    s_bitcmp1_b32 s101, 5
    s_cbranch_scc0 .Lt_f5
    s_bitcmp1_b32 s99, 2
    s_cbranch_scc0 .Lt_f5
    v_dot2_f32_bf16 v64, v152, s92, 0
    v_dot2_f32_bf16 v65, v152, s93, 0
    v_dot2_f32_bf16 v66, v153, s92, 0
    v_dot2_f32_bf16 v67, v153, s93, 0
    v_dot2_f32_bf16 v68, v154, s92, 0
    v_dot2_f32_bf16 v69, v154, s93, 0
    v_dot2_f32_bf16 v70, v155, s92, 0
    v_dot2_f32_bf16 v71, v155, s93, 0
    v_dot2_f32_bf16 v64, v156, s92, v64
    v_dot2_f32_bf16 v65, v156, s93, v65
    v_dot2_f32_bf16 v66, v157, s92, v66
    v_dot2_f32_bf16 v67, v157, s93, v67
    v_dot2_f32_bf16 v68, v158, s92, v68
    v_dot2_f32_bf16 v69, v158, s93, v69
    v_dot2_f32_bf16 v70, v159, s92, v70
    v_dot2_f32_bf16 v71, v159, s93, v71
    s_nop 3
    v_permlane32_swap_b32 v64, v68
    v_permlane32_swap_b32 v65, v69
    v_permlane32_swap_b32 v66, v70
    v_permlane32_swap_b32 v67, v71
    s_nop 1
    v_add_f32 v64, v64, v68
    v_add_f32 v65, v65, v69
    v_add_f32 v66, v66, v70
    v_add_f32 v67, v67, v71
    v_add_f32 v52, v52, v64
    v_add_f32 v53, v53, v65
    v_add_f32 v54, v54, v66
    v_add_f32 v55, v55, v67
    v_fma_f32 v48, v52, v16, v48
    v_fma_f32 v49, v53, v17, v49
    v_fma_f32 v50, v54, v18, v50
    v_fma_f32 v51, v55, v19, v51
    buffer_store_dwordx4 v[48:51], v21, s[84:87], 0 offen offset:1536
    s_add_u32 s100, s100, 1
    s_bitset1_b32 s99, 5
.Lt_f5:
    s_cmp_eq_u32 s99, 63
    s_cbranch_scc1 .Lt_end
    s_sub_u32 s83, s83, 1
    s_cmp_lg_u32 s83, 0
    s_cbranch_scc1 .Lt_loop
    s_mov_b32 s73, 0
    s_mov_b32 s74, 0
    s_mov_b32 s75, 0
    s_branch .Lt_loop
.Lt_end:
    s_endpgm
.Lk1_ssm:
    s_mov_b32 s8, s3
    s_mul_i32 s78, s3, 5
    s_cmp_eq_u32 s3, 3
    s_cselect_b32 s78, 14, s78
    s_add_u32 s79, s3, 12
    s_bitcmp1_b32 s4, 1
    s_cselect_b32 s52, s24, s22
    s_cselect_b32 s53, s25, s23
    s_and_b32 s53, s53, 0xffff
    s_mov_b32 s54, 663552
    s_mov_b32 s55, 0x00020000
    s_bitcmp1_b32 s4, 2
    s_cselect_b32 s56, s28, s26
    s_cselect_b32 s57, s29, s27
    s_and_b32 s57, s57, 0xffff
    s_mov_b32 s58, 663552
    s_mov_b32 s59, 0x00020000
    s_mov_b32 s64, s18
    s_and_b32 s65, s19, 0xffff
    s_mov_b32 s66, 1152
    s_mov_b32 s67, 0x00020000
    s_mov_b32 s84, s20
    s_and_b32 s85, s21, 0xffff
    s_mov_b32 s86, 1152
    s_mov_b32 s87, 0x00020000
    s_mov_b32 s88, s30
    s_and_b32 s89, s31, 0xffff
    s_mov_b32 s90, 1152
    s_mov_b32 s91, 0x00020000
    s_mov_b32 s68, s44
    s_and_b32 s69, s45, 0xffff
    s_mov_b32 s70, 256
    s_mov_b32 s71, 0x00020000
    s_mul_i32 s15, s78, 36864
    s_lshl_b32 s72, s78, 6
    s_lshl_b32 s74, s4, 11
    s_add_u32 s74, s74, 98304
    s_lshl_b32 s11, s6, 5
    s_and_b32 s73, s4, 1
    s_lshl_b32 s73, s73, 4
    s_add_u32 s11, s11, s73
    v_add_u32 v20, s11, v8
    v_mul_u32_u24 v20, 0x480, v20
    v_lshrrev_b32 v21, 4, v0
    v_xor_b32 v21, v21, v9
    v_lshl_add_u32 v6, v21, 4, v20
    v_xor_b32 v21, 4, v21
    v_add_u32 v20, 9216, v20
    v_lshl_add_u32 v7, v21, 4, v20
    s_add_u32 s10, s15, 0
    s_add_u32 m0, s74, 49152
    s_nop 0
    buffer_load_dwordx4 v6, s[52:55], s10 offen lds
    s_add_u32 m0, s74, 50176
    s_nop 0
    buffer_load_dwordx4 v7, s[52:55], s10 offen lds
    s_and_b32 s77, s4, 1
    s_lshl_b32 s73, s6, 1
    s_add_u32 s77, s77, s73
    v_and_b32 v20, 31, v0
    v_lshrrev_b32 v21, 5, v0
    v_bfe_u32 v22, v20, 1, 3
    v_xor_b32 v22, v22, v21
    s_lshl_b32 s11, s6, 13
    s_add_u32 s11, s11, 98304
    v_lshlrev_b32 v20, 7, v20
    v_add_u32 v20, s11, v20
    v_xor_b32 v21, 0, v22
    v_lshl_add_u32 v1, v21, 4, v20
    v_xor_b32 v21, 2, v22
    v_lshl_add_u32 v2, v21, 4, v20
    v_xor_b32 v21, 4, v22
    v_lshl_add_u32 v3, v21, 4, v20
    v_xor_b32 v21, 6, v22
    v_lshl_add_u32 v4, v21, 4, v20
    v_and_b32 v20, 15, v0
    v_cmp_gt_u32 s[94:95], s7, v20
    s_mov_b32 s96, 0
    s_mov_b32 s97, -1
    s_bitcmp1_b32 s5, 0
    s_cselect_b64 s[98:99], -1, 0
    s_bitcmp1_b32 s5, 1
    s_cselect_b64 s[100:101], -1, 0
    s_lshr_b32 s11, s4, 1
    s_mul_i32 s11, s11, 36864
    s_and_b32 s73, s4, 1
    s_lshl_b32 s73, s73, 4
    v_add_u32 v12, s73, v8
    v_lshlrev_b32 v13, 1, v9
    v_xor_b32 v12, v12, v13
    v_lshlrev_b32 v12, 4, v12
    v_lshrrev_b32 v13, 1, v9
    v_lshl_add_u32 v12, v13, 10, v12
    v_and_b32 v13, 1, v9
    v_lshl_add_u32 v12, v13, 9, v12
    v_add_u32 v12, s11, v12
    v_xor_b32 v13, 0x80, v12
    v_and_b32 v18, 31, v0
    v_lshrrev_b32 v19, 5, v0
    v_bfe_u32 v20, v18, 2, 1
    v_lshlrev_b32 v20, 4, v20
    v_lshrrev_b32 v21, 3, v18
    v_lshl_add_u32 v20, v21, 2, v20
    v_and_b32 v21, 3, v18
    v_add_u32 v20, v20, v21
    v_lshlrev_b32 v21, 1, v19
    v_xor_b32 v20, v20, v21
    s_mul_i32 s11, s5, 36864
    v_lshlrev_b32 v21, 9, v19
    v_add_u32 v21, s11, v21
    v_xor_b32 v22, 0, v20
    v_lshl_add_u32 v14, v22, 4, v21
    v_xor_b32 v22, 4, v20
    v_lshl_add_u32 v15, v22, 4, v21
    v_xor_b32 v22, 8, v20
    v_lshl_add_u32 v16, v22, 4, v21
    v_xor_b32 v22, 12, v20
    v_lshl_add_u32 v17, v22, 4, v21
    s_waitcnt vmcnt(20)
    v_dot2_f32_bf16 v32, v112, s12, 0
    v_dot2_f32_bf16 v34, v112, v112, 0
    v_dot2_f32_bf16 v33, v113, s12, 0
    v_dot2_f32_bf16 v35, v113, v113, 0
    v_dot2_f32_bf16 v32, v114, s12, v32
    v_dot2_f32_bf16 v34, v114, v114, v34
    v_dot2_f32_bf16 v33, v115, s12, v33
    v_dot2_f32_bf16 v35, v115, v115, v35
    s_waitcnt vmcnt(19)
    v_dot2_f32_bf16 v32, v116, s12, v32
    v_dot2_f32_bf16 v34, v116, v116, v34
    v_dot2_f32_bf16 v33, v117, s12, v33
    v_dot2_f32_bf16 v35, v117, v117, v35
    v_dot2_f32_bf16 v32, v118, s12, v32
    v_dot2_f32_bf16 v34, v118, v118, v34
    v_dot2_f32_bf16 v33, v119, s12, v33
    v_dot2_f32_bf16 v35, v119, v119, v35
    s_waitcnt vmcnt(18)
    v_dot2_f32_bf16 v32, v120, s12, v32
    v_dot2_f32_bf16 v34, v120, v120, v34
    v_dot2_f32_bf16 v33, v121, s12, v33
    v_dot2_f32_bf16 v35, v121, v121, v35
    v_dot2_f32_bf16 v32, v122, s12, v32
    v_dot2_f32_bf16 v34, v122, v122, v34
    v_dot2_f32_bf16 v33, v123, s12, v33
    v_dot2_f32_bf16 v35, v123, v123, v35
    s_waitcnt vmcnt(17)
    v_dot2_f32_bf16 v32, v124, s12, v32
    v_dot2_f32_bf16 v34, v124, v124, v34
    v_dot2_f32_bf16 v33, v125, s12, v33
    v_dot2_f32_bf16 v35, v125, v125, v35
    v_dot2_f32_bf16 v32, v126, s12, v32
    v_dot2_f32_bf16 v34, v126, v126, v34
    v_dot2_f32_bf16 v33, v127, s12, v33
    v_dot2_f32_bf16 v35, v127, v127, v35
    s_waitcnt vmcnt(16)
    v_dot2_f32_bf16 v32, v128, s12, v32
    v_dot2_f32_bf16 v34, v128, v128, v34
    v_dot2_f32_bf16 v33, v129, s12, v33
    v_dot2_f32_bf16 v35, v129, v129, v35
    v_dot2_f32_bf16 v32, v130, s12, v32
    v_dot2_f32_bf16 v34, v130, v130, v34
    v_dot2_f32_bf16 v33, v131, s12, v33
    v_dot2_f32_bf16 v35, v131, v131, v35
    s_waitcnt vmcnt(15)
    v_dot2_f32_bf16 v32, v132, s12, v32
    v_dot2_f32_bf16 v34, v132, v132, v34
    v_dot2_f32_bf16 v33, v133, s12, v33
    v_dot2_f32_bf16 v35, v133, v133, v35
    v_dot2_f32_bf16 v32, v134, s12, v32
    v_dot2_f32_bf16 v34, v134, v134, v34
    v_dot2_f32_bf16 v33, v135, s12, v33
    v_dot2_f32_bf16 v35, v135, v135, v35
    s_waitcnt vmcnt(14)
    v_dot2_f32_bf16 v32, v136, s12, v32
    v_dot2_f32_bf16 v34, v136, v136, v34
    v_dot2_f32_bf16 v33, v137, s12, v33
    v_dot2_f32_bf16 v35, v137, v137, v35
    v_dot2_f32_bf16 v32, v138, s12, v32
    v_dot2_f32_bf16 v34, v138, v138, v34
    v_dot2_f32_bf16 v33, v139, s12, v33
    v_dot2_f32_bf16 v35, v139, v139, v35
    s_waitcnt vmcnt(13)
    v_dot2_f32_bf16 v32, v140, s12, v32
    v_dot2_f32_bf16 v34, v140, v140, v34
    v_dot2_f32_bf16 v33, v141, s12, v33
    v_dot2_f32_bf16 v35, v141, v141, v35
    v_dot2_f32_bf16 v32, v142, s12, v32
    v_dot2_f32_bf16 v34, v142, v142, v34
    v_dot2_f32_bf16 v33, v143, s12, v33
    v_dot2_f32_bf16 v35, v143, v143, v35
    s_waitcnt vmcnt(12)
    v_dot2_f32_bf16 v32, v144, s12, v32
    v_dot2_f32_bf16 v34, v144, v144, v34
    v_dot2_f32_bf16 v33, v145, s12, v33
    v_dot2_f32_bf16 v35, v145, v145, v35
    v_dot2_f32_bf16 v32, v146, s12, v32
    v_dot2_f32_bf16 v34, v146, v146, v34
    v_dot2_f32_bf16 v33, v147, s12, v33
    v_dot2_f32_bf16 v35, v147, v147, v35
    s_nop 2
    v_add_f32 v32, v32, v33
    v_add_f32 v34, v34, v35
    s_waitcnt vmcnt(11)
    v_dot2_f32_bf16 v36, v148, s12, 0
    v_dot2_f32_bf16 v38, v148, v148, 0
    v_dot2_f32_bf16 v37, v149, s12, 0
    v_dot2_f32_bf16 v39, v149, v149, 0
    v_dot2_f32_bf16 v36, v150, s12, v36
    v_dot2_f32_bf16 v38, v150, v150, v38
    v_dot2_f32_bf16 v37, v151, s12, v37
    v_dot2_f32_bf16 v39, v151, v151, v39
    s_waitcnt vmcnt(10)
    v_dot2_f32_bf16 v36, v152, s12, v36
    v_dot2_f32_bf16 v38, v152, v152, v38
    v_dot2_f32_bf16 v37, v153, s12, v37
    v_dot2_f32_bf16 v39, v153, v153, v39
    v_dot2_f32_bf16 v36, v154, s12, v36
    v_dot2_f32_bf16 v38, v154, v154, v38
    v_dot2_f32_bf16 v37, v155, s12, v37
    v_dot2_f32_bf16 v39, v155, v155, v39
    s_waitcnt vmcnt(9)
    v_dot2_f32_bf16 v36, v156, s12, v36
    v_dot2_f32_bf16 v38, v156, v156, v38
    v_dot2_f32_bf16 v37, v157, s12, v37
    v_dot2_f32_bf16 v39, v157, v157, v39
    v_dot2_f32_bf16 v36, v158, s12, v36
    v_dot2_f32_bf16 v38, v158, v158, v38
    v_dot2_f32_bf16 v37, v159, s12, v37
    v_dot2_f32_bf16 v39, v159, v159, v39
    s_waitcnt vmcnt(8)
    v_dot2_f32_bf16 v36, v160, s12, v36
    v_dot2_f32_bf16 v38, v160, v160, v38
    v_dot2_f32_bf16 v37, v161, s12, v37
    v_dot2_f32_bf16 v39, v161, v161, v39
    v_dot2_f32_bf16 v36, v162, s12, v36
    v_dot2_f32_bf16 v38, v162, v162, v38
    v_dot2_f32_bf16 v37, v163, s12, v37
    v_dot2_f32_bf16 v39, v163, v163, v39
    s_waitcnt vmcnt(7)
    v_dot2_f32_bf16 v36, v164, s12, v36
    v_dot2_f32_bf16 v38, v164, v164, v38
    v_dot2_f32_bf16 v37, v165, s12, v37
    v_dot2_f32_bf16 v39, v165, v165, v39
    v_dot2_f32_bf16 v36, v166, s12, v36
    v_dot2_f32_bf16 v38, v166, v166, v38
    v_dot2_f32_bf16 v37, v167, s12, v37
    v_dot2_f32_bf16 v39, v167, v167, v39
    s_waitcnt vmcnt(6)
    v_dot2_f32_bf16 v36, v168, s12, v36
    v_dot2_f32_bf16 v38, v168, v168, v38
    v_dot2_f32_bf16 v37, v169, s12, v37
    v_dot2_f32_bf16 v39, v169, v169, v39
    v_dot2_f32_bf16 v36, v170, s12, v36
    v_dot2_f32_bf16 v38, v170, v170, v38
    v_dot2_f32_bf16 v37, v171, s12, v37
    v_dot2_f32_bf16 v39, v171, v171, v39
    s_waitcnt vmcnt(5)
    v_dot2_f32_bf16 v36, v172, s12, v36
    v_dot2_f32_bf16 v38, v172, v172, v38
    v_dot2_f32_bf16 v37, v173, s12, v37
    v_dot2_f32_bf16 v39, v173, v173, v39
    v_dot2_f32_bf16 v36, v174, s12, v36
    v_dot2_f32_bf16 v38, v174, v174, v38
    v_dot2_f32_bf16 v37, v175, s12, v37
    v_dot2_f32_bf16 v39, v175, v175, v39
    s_waitcnt vmcnt(4)
    v_dot2_f32_bf16 v36, v176, s12, v36
    v_dot2_f32_bf16 v38, v176, v176, v38
    v_dot2_f32_bf16 v37, v177, s12, v37
    v_dot2_f32_bf16 v39, v177, v177, v39
    v_dot2_f32_bf16 v36, v178, s12, v36
    v_dot2_f32_bf16 v38, v178, v178, v38
    v_dot2_f32_bf16 v37, v179, s12, v37
    v_dot2_f32_bf16 v39, v179, v179, v39
    s_waitcnt vmcnt(3)
    v_dot2_f32_bf16 v36, v180, s12, v36
    v_dot2_f32_bf16 v38, v180, v180, v38
    v_dot2_f32_bf16 v37, v181, s12, v37
    v_dot2_f32_bf16 v39, v181, v181, v39
    v_dot2_f32_bf16 v36, v182, s12, v36
    v_dot2_f32_bf16 v38, v182, v182, v38
    v_dot2_f32_bf16 v37, v183, s12, v37
    v_dot2_f32_bf16 v39, v183, v183, v39
    s_nop 2
    v_add_f32 v36, v36, v37
    v_add_f32 v38, v38, v39
    s_nop 0
    v_add_f32_dpp v32, v32, v32 quad_perm:[1,0,3,2] row_mask:0xf bank_mask:0xf
    v_add_f32_dpp v34, v34, v34 quad_perm:[1,0,3,2] row_mask:0xf bank_mask:0xf
    v_add_f32_dpp v36, v36, v36 quad_perm:[1,0,3,2] row_mask:0xf bank_mask:0xf
    v_add_f32_dpp v38, v38, v38 quad_perm:[1,0,3,2] row_mask:0xf bank_mask:0xf
    s_nop 0
    v_add_f32_dpp v32, v32, v32 quad_perm:[2,3,0,1] row_mask:0xf bank_mask:0xf
    v_add_f32_dpp v34, v34, v34 quad_perm:[2,3,0,1] row_mask:0xf bank_mask:0xf
    v_add_f32_dpp v36, v36, v36 quad_perm:[2,3,0,1] row_mask:0xf bank_mask:0xf
    v_add_f32_dpp v38, v38, v38 quad_perm:[2,3,0,1] row_mask:0xf bank_mask:0xf
    s_nop 0
    v_add_f32_dpp v32, v32, v32 row_half_mirror row_mask:0xf bank_mask:0xf
    v_add_f32_dpp v34, v34, v34 row_half_mirror row_mask:0xf bank_mask:0xf
    v_add_f32_dpp v36, v36, v36 row_half_mirror row_mask:0xf bank_mask:0xf
    v_add_f32_dpp v38, v38, v38 row_half_mirror row_mask:0xf bank_mask:0xf
    v_mul_f32 v32, 0x3ae38e39, v32
    v_mul_f32 v34, 0x3ae38e39, v34
    v_fma_f32 v34, -v32, v32, v34
    v_max_f32 v34, 0, v34
    v_cvt_pk_bf16_f32 v40, v32, v34
    v_and_b32 v34, s13, v40
    v_lshlrev_b32 v40, 16, v40
    v_add_f32 v34, 0x3727c5ac, v34
    v_cvt_pk_bf16_f32 v34, v34, v34
    v_and_b32 v34, s13, v34
    v_sqrt_f32 v34, v34
    s_nop 0
    v_cvt_pk_bf16_f32 v34, v34, v34
    v_and_b32 v34, s13, v34
    v_rcp_f32 v41, v34
    s_nop 0
    v_fma_f32 v44, -v34, v41, 1.0
    v_fma_f32 v41, v41, v44, v41
    v_mul_f32 v36, 0x3ae38e39, v36
    v_mul_f32 v38, 0x3ae38e39, v38
    v_fma_f32 v38, -v36, v36, v38
    v_max_f32 v38, 0, v38
    v_cvt_pk_bf16_f32 v42, v36, v38
    v_and_b32 v38, s13, v42
    v_lshlrev_b32 v42, 16, v42
    v_add_f32 v38, 0x3727c5ac, v38
    v_cvt_pk_bf16_f32 v38, v38, v38
    v_and_b32 v38, s13, v38
    v_sqrt_f32 v38, v38
    s_nop 0
    v_cvt_pk_bf16_f32 v38, v38, v38
    v_and_b32 v38, s13, v38
    v_rcp_f32 v43, v38
    s_nop 0
    v_fma_f32 v44, -v38, v43, 1.0
    v_fma_f32 v43, v43, v44, v43
    v_xor_b32 v44, 0x80000000, v40
    v_xor_b32 v45, 0x80000000, v42
    v_dot2_f32_bf16 v46, v112, s92, v44
    v_dot2_f32_bf16 v47, v112, s93, v44
    v_dot2_f32_bf16 v48, v113, s92, v44
    v_dot2_f32_bf16 v49, v113, s93, v44
    v_dot2_f32_bf16 v50, v114, s92, v44
    v_dot2_f32_bf16 v51, v114, s93, v44
    v_dot2_f32_bf16 v52, v115, s92, v44
    v_dot2_f32_bf16 v53, v115, s93, v44
    v_cvt_pk_bf16_f32 v112, v46, v47
    v_cvt_pk_bf16_f32 v113, v48, v49
    v_cvt_pk_bf16_f32 v114, v50, v51
    v_cvt_pk_bf16_f32 v115, v52, v53
    ds_write_b128 v12, v[112:115] offset:0
    v_dot2_f32_bf16 v46, v116, s92, v44
    v_dot2_f32_bf16 v47, v116, s93, v44
    v_dot2_f32_bf16 v48, v117, s92, v44
    v_dot2_f32_bf16 v49, v117, s93, v44
    v_dot2_f32_bf16 v50, v118, s92, v44
    v_dot2_f32_bf16 v51, v118, s93, v44
    v_dot2_f32_bf16 v52, v119, s92, v44
    v_dot2_f32_bf16 v53, v119, s93, v44
    v_cvt_pk_bf16_f32 v116, v46, v47
    v_cvt_pk_bf16_f32 v117, v48, v49
    v_cvt_pk_bf16_f32 v118, v50, v51
    v_cvt_pk_bf16_f32 v119, v52, v53
    ds_write_b128 v12, v[116:119] offset:4096
    v_dot2_f32_bf16 v46, v120, s92, v44
    v_dot2_f32_bf16 v47, v120, s93, v44
    v_dot2_f32_bf16 v48, v121, s92, v44
    v_dot2_f32_bf16 v49, v121, s93, v44
    v_dot2_f32_bf16 v50, v122, s92, v44
    v_dot2_f32_bf16 v51, v122, s93, v44
    v_dot2_f32_bf16 v52, v123, s92, v44
    v_dot2_f32_bf16 v53, v123, s93, v44
    v_cvt_pk_bf16_f32 v120, v46, v47
    v_cvt_pk_bf16_f32 v121, v48, v49
    v_cvt_pk_bf16_f32 v122, v50, v51
    v_cvt_pk_bf16_f32 v123, v52, v53
    ds_write_b128 v12, v[120:123] offset:8192
    v_dot2_f32_bf16 v46, v124, s92, v44
    v_dot2_f32_bf16 v47, v124, s93, v44
    v_dot2_f32_bf16 v48, v125, s92, v44
    v_dot2_f32_bf16 v49, v125, s93, v44
    v_dot2_f32_bf16 v50, v126, s92, v44
    v_dot2_f32_bf16 v51, v126, s93, v44
    v_dot2_f32_bf16 v52, v127, s92, v44
    v_dot2_f32_bf16 v53, v127, s93, v44
    v_cvt_pk_bf16_f32 v124, v46, v47
    v_cvt_pk_bf16_f32 v125, v48, v49
    v_cvt_pk_bf16_f32 v126, v50, v51
    v_cvt_pk_bf16_f32 v127, v52, v53
    ds_write_b128 v12, v[124:127] offset:12288
    v_dot2_f32_bf16 v46, v128, s92, v44
    v_dot2_f32_bf16 v47, v128, s93, v44
    v_dot2_f32_bf16 v48, v129, s92, v44
    v_dot2_f32_bf16 v49, v129, s93, v44
    v_dot2_f32_bf16 v50, v130, s92, v44
    v_dot2_f32_bf16 v51, v130, s93, v44
    v_dot2_f32_bf16 v52, v131, s92, v44
    v_dot2_f32_bf16 v53, v131, s93, v44
    v_cvt_pk_bf16_f32 v128, v46, v47
    v_cvt_pk_bf16_f32 v129, v48, v49
    v_cvt_pk_bf16_f32 v130, v50, v51
    v_cvt_pk_bf16_f32 v131, v52, v53
    ds_write_b128 v12, v[128:131] offset:16384
    v_dot2_f32_bf16 v46, v132, s92, v44
    v_dot2_f32_bf16 v47, v132, s93, v44
    v_dot2_f32_bf16 v48, v133, s92, v44
    v_dot2_f32_bf16 v49, v133, s93, v44
    v_dot2_f32_bf16 v50, v134, s92, v44
    v_dot2_f32_bf16 v51, v134, s93, v44
    v_dot2_f32_bf16 v52, v135, s92, v44
    v_dot2_f32_bf16 v53, v135, s93, v44
    v_cvt_pk_bf16_f32 v132, v46, v47
    v_cvt_pk_bf16_f32 v133, v48, v49
    v_cvt_pk_bf16_f32 v134, v50, v51
    v_cvt_pk_bf16_f32 v135, v52, v53
    ds_write_b128 v12, v[132:135] offset:20480
    v_dot2_f32_bf16 v46, v136, s92, v44
    v_dot2_f32_bf16 v47, v136, s93, v44
    v_dot2_f32_bf16 v48, v137, s92, v44
    v_dot2_f32_bf16 v49, v137, s93, v44
    v_dot2_f32_bf16 v50, v138, s92, v44
    v_dot2_f32_bf16 v51, v138, s93, v44
    v_dot2_f32_bf16 v52, v139, s92, v44
    v_dot2_f32_bf16 v53, v139, s93, v44
    v_cvt_pk_bf16_f32 v136, v46, v47
    v_cvt_pk_bf16_f32 v137, v48, v49
    v_cvt_pk_bf16_f32 v138, v50, v51
    v_cvt_pk_bf16_f32 v139, v52, v53
    ds_write_b128 v12, v[136:139] offset:24576
    v_dot2_f32_bf16 v46, v140, s92, v44
    v_dot2_f32_bf16 v47, v140, s93, v44
    v_dot2_f32_bf16 v48, v141, s92, v44
    v_dot2_f32_bf16 v49, v141, s93, v44
    v_dot2_f32_bf16 v50, v142, s92, v44
    v_dot2_f32_bf16 v51, v142, s93, v44
    v_dot2_f32_bf16 v52, v143, s92, v44
    v_dot2_f32_bf16 v53, v143, s93, v44
    v_cvt_pk_bf16_f32 v140, v46, v47
    v_cvt_pk_bf16_f32 v141, v48, v49
    v_cvt_pk_bf16_f32 v142, v50, v51
    v_cvt_pk_bf16_f32 v143, v52, v53
    ds_write_b128 v12, v[140:143] offset:28672
    v_dot2_f32_bf16 v46, v144, s92, v44
    v_dot2_f32_bf16 v47, v144, s93, v44
    v_dot2_f32_bf16 v48, v145, s92, v44
    v_dot2_f32_bf16 v49, v145, s93, v44
    v_dot2_f32_bf16 v50, v146, s92, v44
    v_dot2_f32_bf16 v51, v146, s93, v44
    v_dot2_f32_bf16 v52, v147, s92, v44
    v_dot2_f32_bf16 v53, v147, s93, v44
    v_cvt_pk_bf16_f32 v144, v46, v47
    v_cvt_pk_bf16_f32 v145, v48, v49
    v_cvt_pk_bf16_f32 v146, v50, v51
    v_cvt_pk_bf16_f32 v147, v52, v53
    ds_write_b128 v12, v[144:147] offset:32768
    v_dot2_f32_bf16 v46, v148, s92, v45
    v_dot2_f32_bf16 v47, v148, s93, v45
    v_dot2_f32_bf16 v48, v149, s92, v45
    v_dot2_f32_bf16 v49, v149, s93, v45
    v_dot2_f32_bf16 v50, v150, s92, v45
    v_dot2_f32_bf16 v51, v150, s93, v45
    v_dot2_f32_bf16 v52, v151, s92, v45
    v_dot2_f32_bf16 v53, v151, s93, v45
    v_cvt_pk_bf16_f32 v148, v46, v47
    v_cvt_pk_bf16_f32 v149, v48, v49
    v_cvt_pk_bf16_f32 v150, v50, v51
    v_cvt_pk_bf16_f32 v151, v52, v53
    ds_write_b128 v13, v[148:151] offset:0
    v_dot2_f32_bf16 v46, v152, s92, v45
    v_dot2_f32_bf16 v47, v152, s93, v45
    v_dot2_f32_bf16 v48, v153, s92, v45
    v_dot2_f32_bf16 v49, v153, s93, v45
    v_dot2_f32_bf16 v50, v154, s92, v45
    v_dot2_f32_bf16 v51, v154, s93, v45
    v_dot2_f32_bf16 v52, v155, s92, v45
    v_dot2_f32_bf16 v53, v155, s93, v45
    v_cvt_pk_bf16_f32 v152, v46, v47
    v_cvt_pk_bf16_f32 v153, v48, v49
    v_cvt_pk_bf16_f32 v154, v50, v51
    v_cvt_pk_bf16_f32 v155, v52, v53
    ds_write_b128 v13, v[152:155] offset:4096
    v_dot2_f32_bf16 v46, v156, s92, v45
    v_dot2_f32_bf16 v47, v156, s93, v45
    v_dot2_f32_bf16 v48, v157, s92, v45
    v_dot2_f32_bf16 v49, v157, s93, v45
    v_dot2_f32_bf16 v50, v158, s92, v45
    v_dot2_f32_bf16 v51, v158, s93, v45
    v_dot2_f32_bf16 v52, v159, s92, v45
    v_dot2_f32_bf16 v53, v159, s93, v45
    v_cvt_pk_bf16_f32 v156, v46, v47
    v_cvt_pk_bf16_f32 v157, v48, v49
    v_cvt_pk_bf16_f32 v158, v50, v51
    v_cvt_pk_bf16_f32 v159, v52, v53
    ds_write_b128 v13, v[156:159] offset:8192
    v_dot2_f32_bf16 v46, v160, s92, v45
    v_dot2_f32_bf16 v47, v160, s93, v45
    v_dot2_f32_bf16 v48, v161, s92, v45
    v_dot2_f32_bf16 v49, v161, s93, v45
    v_dot2_f32_bf16 v50, v162, s92, v45
    v_dot2_f32_bf16 v51, v162, s93, v45
    v_dot2_f32_bf16 v52, v163, s92, v45
    v_dot2_f32_bf16 v53, v163, s93, v45
    v_cvt_pk_bf16_f32 v160, v46, v47
    v_cvt_pk_bf16_f32 v161, v48, v49
    v_cvt_pk_bf16_f32 v162, v50, v51
    v_cvt_pk_bf16_f32 v163, v52, v53
    ds_write_b128 v13, v[160:163] offset:12288
    v_dot2_f32_bf16 v46, v164, s92, v45
    v_dot2_f32_bf16 v47, v164, s93, v45
    v_dot2_f32_bf16 v48, v165, s92, v45
    v_dot2_f32_bf16 v49, v165, s93, v45
    v_dot2_f32_bf16 v50, v166, s92, v45
    v_dot2_f32_bf16 v51, v166, s93, v45
    v_dot2_f32_bf16 v52, v167, s92, v45
    v_dot2_f32_bf16 v53, v167, s93, v45
    v_cvt_pk_bf16_f32 v164, v46, v47
    v_cvt_pk_bf16_f32 v165, v48, v49
    v_cvt_pk_bf16_f32 v166, v50, v51
    v_cvt_pk_bf16_f32 v167, v52, v53
    ds_write_b128 v13, v[164:167] offset:16384
    v_dot2_f32_bf16 v46, v168, s92, v45
    v_dot2_f32_bf16 v47, v168, s93, v45
    v_dot2_f32_bf16 v48, v169, s92, v45
    v_dot2_f32_bf16 v49, v169, s93, v45
    v_dot2_f32_bf16 v50, v170, s92, v45
    v_dot2_f32_bf16 v51, v170, s93, v45
    v_dot2_f32_bf16 v52, v171, s92, v45
    v_dot2_f32_bf16 v53, v171, s93, v45
    v_cvt_pk_bf16_f32 v168, v46, v47
    v_cvt_pk_bf16_f32 v169, v48, v49
    v_cvt_pk_bf16_f32 v170, v50, v51
    v_cvt_pk_bf16_f32 v171, v52, v53
    ds_write_b128 v13, v[168:171] offset:20480
    v_dot2_f32_bf16 v46, v172, s92, v45
    v_dot2_f32_bf16 v47, v172, s93, v45
    v_dot2_f32_bf16 v48, v173, s92, v45
    v_dot2_f32_bf16 v49, v173, s93, v45
    v_dot2_f32_bf16 v50, v174, s92, v45
    v_dot2_f32_bf16 v51, v174, s93, v45
    v_dot2_f32_bf16 v52, v175, s92, v45
    v_dot2_f32_bf16 v53, v175, s93, v45
    v_cvt_pk_bf16_f32 v172, v46, v47
    v_cvt_pk_bf16_f32 v173, v48, v49
    v_cvt_pk_bf16_f32 v174, v50, v51
    v_cvt_pk_bf16_f32 v175, v52, v53
    ds_write_b128 v13, v[172:175] offset:24576
    v_dot2_f32_bf16 v46, v176, s92, v45
    v_dot2_f32_bf16 v47, v176, s93, v45
    v_dot2_f32_bf16 v48, v177, s92, v45
    v_dot2_f32_bf16 v49, v177, s93, v45
    v_dot2_f32_bf16 v50, v178, s92, v45
    v_dot2_f32_bf16 v51, v178, s93, v45
    v_dot2_f32_bf16 v52, v179, s92, v45
    v_dot2_f32_bf16 v53, v179, s93, v45
    v_cvt_pk_bf16_f32 v176, v46, v47
    v_cvt_pk_bf16_f32 v177, v48, v49
    v_cvt_pk_bf16_f32 v178, v50, v51
    v_cvt_pk_bf16_f32 v179, v52, v53
    ds_write_b128 v13, v[176:179] offset:28672
    v_dot2_f32_bf16 v46, v180, s92, v45
    v_dot2_f32_bf16 v47, v180, s93, v45
    v_dot2_f32_bf16 v48, v181, s92, v45
    v_dot2_f32_bf16 v49, v181, s93, v45
    v_dot2_f32_bf16 v50, v182, s92, v45
    v_dot2_f32_bf16 v51, v182, s93, v45
    v_dot2_f32_bf16 v52, v183, s92, v45
    v_dot2_f32_bf16 v53, v183, s93, v45
    v_cvt_pk_bf16_f32 v180, v46, v47
    v_cvt_pk_bf16_f32 v181, v48, v49
    v_cvt_pk_bf16_f32 v182, v50, v51
    v_cvt_pk_bf16_f32 v183, v52, v53
    ds_write_b128 v13, v[180:183] offset:32768
    s_waitcnt lgkmcnt(0)
    s_barrier
    ds_read_b128 v[112:115], v14 offset:0
    ds_read_b128 v[116:119], v15 offset:1024
    ds_read_b128 v[120:123], v16 offset:2048
    ds_read_b128 v[124:127], v17 offset:3072
    ds_read_b128 v[128:131], v14 offset:4096
    ds_read_b128 v[132:135], v15 offset:5120
    ds_read_b128 v[136:139], v16 offset:6144
    ds_read_b128 v[140:143], v17 offset:7168
    ds_read_b128 v[144:147], v14 offset:8192
    ds_read_b128 v[148:151], v15 offset:9216
    ds_read_b128 v[152:155], v16 offset:10240
    ds_read_b128 v[156:159], v17 offset:11264
    ds_read_b128 v[160:163], v14 offset:12288
    ds_read_b128 v[164:167], v15 offset:13312
    ds_read_b128 v[168:171], v16 offset:14336
    ds_read_b128 v[172:175], v17 offset:15360
    ds_read_b128 v[176:179], v14 offset:16384
    ds_read_b128 v[180:183], v15 offset:17408
    ds_read_b128 v[184:187], v16 offset:18432
    ds_read_b128 v[188:191], v17 offset:19456
    ds_read_b128 v[192:195], v14 offset:20480
    ds_read_b128 v[196:199], v15 offset:21504
    ds_read_b128 v[200:203], v16 offset:22528
    ds_read_b128 v[204:207], v17 offset:23552
    ds_read_b128 v[208:211], v14 offset:24576
    ds_read_b128 v[212:215], v15 offset:25600
    ds_read_b128 v[216:219], v16 offset:26624
    ds_read_b128 v[220:223], v17 offset:27648
    ds_read_b128 v[224:227], v14 offset:28672
    ds_read_b128 v[228:231], v15 offset:29696
    ds_read_b128 v[232:235], v16 offset:30720
    ds_read_b128 v[236:239], v17 offset:31744
    ds_read_b128 v[240:243], v14 offset:32768
    ds_read_b128 v[244:247], v15 offset:33792
    ds_read_b128 v[248:251], v16 offset:34816
    ds_read_b128 v[252:255], v17 offset:35840
    s_add_u32 s11, s78, s6
    s_lshl_b32 s11, s11, 6
    v_and_b32 v20, 31, v0
    v_lshlrev_b32 v20, 1, v20
    buffer_load_ushort v48, v20, s[64:67], s11 offen offset:0
    buffer_load_ushort v49, v20, s[84:87], s11 offen offset:0
    buffer_load_ushort v50, v20, s[88:91], s11 offen offset:0
    buffer_load_ushort v51, v20, s[64:67], s11 offen offset:128
    buffer_load_ushort v52, v20, s[84:87], s11 offen offset:128
    buffer_load_ushort v53, v20, s[88:91], s11 offen offset:128
    buffer_load_ushort v54, v20, s[64:67], s11 offen offset:256
    buffer_load_ushort v55, v20, s[84:87], s11 offen offset:256
    buffer_load_ushort v56, v20, s[88:91], s11 offen offset:256
    s_waitcnt vmcnt(9)
    s_waitcnt lgkmcnt(0)
    s_barrier
    s_add_u32 s10, s15, 128
    s_add_u32 m0, s74, 0
    s_nop 0
    buffer_load_dwordx4 v6, s[52:55], s10 offen lds
    s_add_u32 m0, s74, 1024
    s_nop 0
    buffer_load_dwordx4 v7, s[52:55], s10 offen lds
    s_add_u32 s10, s15, 256
    s_add_u32 m0, s74, 16384
    s_nop 0
    buffer_load_dwordx4 v6, s[52:55], s10 offen lds
    s_add_u32 m0, s74, 17408
    s_nop 0
    buffer_load_dwordx4 v7, s[52:55], s10 offen lds
    s_lshl_b32 s11, s4, 6
    s_add_u32 s11, s11, 92160
    v_lshlrev_b32 v44, 2, v8
    v_add_u32 v44, s11, v44
    ds_write2_b32 v44, v41, v40 offset0:0 offset1:128
    ds_write2_b32 v44, v43, v42 offset0:8 offset1:136
    s_mov_b32 s48, s46
    s_and_b32 s49, s47, 0xffff
    s_mov_b32 s50, 73728
    s_mov_b32 s51, 0x00020000
    s_lshl_b32 s11, s6, 12
    s_lshl_b32 s73, s5, 9
    s_add_u32 s11, s11, s73
    s_add_u32 s11, s11, 81920
    v_lshlrev_b32 v20, 3, v0
    v_add_u32 v20, s11, v20
    v_mov_b32 v22, 0
    v_mov_b32 v23, 0
    ds_write_b64 v20, v[22:23]
    ds_read_b128 v[32:35], v1 offset:49152
    ds_read_b128 v[36:39], v1 offset:53248
    ds_read_b128 v[40:43], v2 offset:49152
    ds_read_b128 v[44:47], v2 offset:53248
    s_cmp_lt_u32 s8, 2
    s_cbranch_scc0 .Lssm_nt4
    s_waitcnt vmcnt(2)
    s_barrier
    s_add_u32 s10, s15, 384
    s_add_u32 m0, s74, 32768
    s_nop 0
    buffer_load_dwordx4 v6, s[52:55], s10 offen lds
    s_add_u32 m0, s74, 33792
    s_nop 0
    buffer_load_dwordx4 v7, s[52:55], s10 offen lds
    s_waitcnt lgkmcnt(3)
    v_mfma_f32_32x32x16_bf16 v[80:95], v[112:115], v[32:35], 0
    s_waitcnt lgkmcnt(2)
    v_mfma_f32_32x32x16_bf16 v[96:111], v[112:115], v[36:39], 0
    ds_read_b128 v[32:35], v3 offset:49152
    ds_read_b128 v[36:39], v3 offset:53248
    v_lshlrev_b32 v48, 16, v48
    s_waitcnt lgkmcnt(3)
    v_mfma_f32_32x32x16_bf16 v[80:95], v[116:119], v[40:43], v[80:95]
    v_lshlrev_b32 v49, 16, v49
    v_lshlrev_b32 v50, 16, v50
    s_waitcnt lgkmcnt(2)
    v_mfma_f32_32x32x16_bf16 v[96:111], v[116:119], v[44:47], v[96:111]
    ds_read_b128 v[40:43], v4 offset:49152
    ds_read_b128 v[44:47], v4 offset:53248
    v_mul_f32 v50, 0x3fb8aa3b, v50
    v_exp_f32 v50, v50
    s_waitcnt lgkmcnt(3)
    v_mfma_f32_32x32x16_bf16 v[80:95], v[120:123], v[32:35], v[80:95]
    v_mul_f32 v67, v48, v48
    v_cvt_pk_bf16_f32 v50, v50, v50
    s_waitcnt lgkmcnt(2)
    v_mfma_f32_32x32x16_bf16 v[96:111], v[120:123], v[36:39], v[96:111]
    ds_read_b128 v[32:35], v1 offset:0
    ds_read_b128 v[36:39], v1 offset:4096
    v_fma_f32 v67, v49, v49, v67
    v_lshlrev_b32 v50, 16, v50
    s_waitcnt lgkmcnt(3)
    v_mfma_f32_32x32x16_bf16 v[80:95], v[124:127], v[40:43], v[80:95]
    v_rcp_f32 v66, v67
    v_mul_f32 v60, v50, v48
    s_waitcnt lgkmcnt(2)
    v_mfma_f32_32x32x16_bf16 v[96:111], v[124:127], v[44:47], v[96:111]
    ds_read_b128 v[40:43], v2 offset:0
    ds_read_b128 v[44:47], v2 offset:4096
    v_mul_f32 v61, v50, v49
    v_mul_f32 v60, 0x3fb8aa3b, v60
    s_waitcnt vmcnt(2)
    s_barrier
    s_add_u32 s10, s15, 512
    s_add_u32 m0, s74, 49152
    s_nop 0
    buffer_load_dwordx4 v6, s[52:55], s10 offen lds
    s_add_u32 m0, s74, 50176
    s_nop 0
    buffer_load_dwordx4 v7, s[52:55], s10 offen lds
    s_waitcnt lgkmcnt(3)
    v_mfma_f32_32x32x16_bf16 v[80:95], v[128:131], v[32:35], v[80:95]
    v_mul_f32 v61, 0.15915494, v61
    v_exp_f32 v60, v60
    s_waitcnt lgkmcnt(2)
    v_mfma_f32_32x32x16_bf16 v[96:111], v[128:131], v[36:39], v[96:111]
    ds_read_b128 v[32:35], v3 offset:0
    ds_read_b128 v[36:39], v3 offset:4096
    v_rndne_f32 v62, v61
    v_sub_f32 v61, v61, v62
    s_waitcnt lgkmcnt(3)
    v_mfma_f32_32x32x16_bf16 v[80:95], v[132:135], v[40:43], v[80:95]
    v_fma_f32 v65, -v67, v66, 2.0
    v_sin_f32 v62, v61
    s_waitcnt lgkmcnt(2)
    v_mfma_f32_32x32x16_bf16 v[96:111], v[132:135], v[44:47], v[96:111]
    ds_read_b128 v[40:43], v4 offset:0
    ds_read_b128 v[44:47], v4 offset:4096
    v_cos_f32 v63, v61
    v_mul_f32 v66, v66, v65
    s_waitcnt lgkmcnt(3)
    v_mfma_f32_32x32x16_bf16 v[80:95], v[136:139], v[32:35], v[80:95]
    v_add_f32 v66, v66, v66
    v_mul_f32 v9, v60, v62
    s_waitcnt lgkmcnt(2)
    v_mfma_f32_32x32x16_bf16 v[96:111], v[136:139], v[36:39], v[96:111]
    ds_read_b128 v[32:35], v1 offset:16384
    ds_read_b128 v[36:39], v1 offset:20480
    v_mul_f32 v8, v60, v63
    v_add_f32 v60, -1.0, v8
    s_waitcnt lgkmcnt(3)
    v_mfma_f32_32x32x16_bf16 v[80:95], v[140:143], v[40:43], v[80:95]
    v_mul_f32 v61, v60, v48
    v_mul_f32 v62, v9, v48
    s_waitcnt lgkmcnt(2)
    v_mfma_f32_32x32x16_bf16 v[96:111], v[140:143], v[44:47], v[96:111]
    ds_read_b128 v[40:43], v2 offset:16384
    ds_read_b128 v[44:47], v2 offset:20480
    v_fma_f32 v61, v9, v49, v61
    v_fma_f32 v62, -v60, v49, v62
    s_waitcnt vmcnt(2)
    s_barrier
    s_add_u32 s10, s15, 640
    s_add_u32 m0, s74, 0
    s_nop 0
    buffer_load_dwordx4 v6, s[52:55], s10 offen lds
    s_add_u32 m0, s74, 1024
    s_nop 0
    buffer_load_dwordx4 v7, s[52:55], s10 offen lds
    s_waitcnt lgkmcnt(3)
    v_mfma_f32_32x32x16_bf16 v[80:95], v[144:147], v[32:35], v[80:95]
    v_mul_f32 v10, v61, v66
    v_mul_f32 v11, v62, v66
    s_waitcnt lgkmcnt(2)
    v_mfma_f32_32x32x16_bf16 v[96:111], v[144:147], v[36:39], v[96:111]
    ds_read_b128 v[32:35], v3 offset:16384
    ds_read_b128 v[36:39], v3 offset:20480
    v_lshlrev_b32 v51, 16, v51
    v_lshlrev_b32 v52, 16, v52
    s_waitcnt lgkmcnt(3)
    v_mfma_f32_32x32x16_bf16 v[80:95], v[148:151], v[40:43], v[80:95]
    v_lshlrev_b32 v53, 16, v53
    v_mul_f32 v53, 0x3fb8aa3b, v53
    s_waitcnt lgkmcnt(2)
    v_mfma_f32_32x32x16_bf16 v[96:111], v[148:151], v[44:47], v[96:111]
    ds_read_b128 v[40:43], v4 offset:16384
    ds_read_b128 v[44:47], v4 offset:20480
    v_exp_f32 v53, v53
    v_mul_f32 v67, v51, v51
    v_cvt_pk_bf16_f32 v53, v53, v53
    s_waitcnt lgkmcnt(3)
    v_mfma_f32_32x32x16_bf16 v[80:95], v[152:155], v[32:35], v[80:95]
    v_fma_f32 v67, v52, v52, v67
    v_lshlrev_b32 v53, 16, v53
    s_waitcnt lgkmcnt(2)
    v_mfma_f32_32x32x16_bf16 v[96:111], v[152:155], v[36:39], v[96:111]
    ds_read_b128 v[32:35], v1 offset:32768
    ds_read_b128 v[36:39], v1 offset:36864
    v_rcp_f32 v66, v67
    v_mul_f32 v60, v53, v51
    v_mul_f32 v61, v53, v52
    s_waitcnt lgkmcnt(3)
    v_mfma_f32_32x32x16_bf16 v[80:95], v[156:159], v[40:43], v[80:95]
    v_mul_f32 v60, 0x3fb8aa3b, v60
    v_mul_f32 v61, 0.15915494, v61
    s_waitcnt lgkmcnt(2)
    v_mfma_f32_32x32x16_bf16 v[96:111], v[156:159], v[44:47], v[96:111]
    ds_read_b128 v[40:43], v2 offset:32768
    ds_read_b128 v[44:47], v2 offset:36864
    v_exp_f32 v60, v60
    v_rndne_f32 v62, v61
    v_sub_f32 v61, v61, v62
    s_waitcnt vmcnt(2)
    s_barrier
    s_add_u32 s10, s15, 768
    s_add_u32 m0, s74, 16384
    s_nop 0
    buffer_load_dwordx4 v6, s[52:55], s10 offen lds
    s_add_u32 m0, s74, 17408
    s_nop 0
    buffer_load_dwordx4 v7, s[52:55], s10 offen lds
    s_waitcnt lgkmcnt(3)
    v_mfma_f32_32x32x16_bf16 v[80:95], v[160:163], v[32:35], v[80:95]
    v_fma_f32 v65, -v67, v66, 2.0
    v_sin_f32 v62, v61
    s_waitcnt lgkmcnt(2)
    v_mfma_f32_32x32x16_bf16 v[96:111], v[160:163], v[36:39], v[96:111]
    ds_read_b128 v[32:35], v3 offset:32768
    ds_read_b128 v[36:39], v3 offset:36864
    v_cos_f32 v63, v61
    v_mul_f32 v66, v66, v65
    s_waitcnt lgkmcnt(3)
    v_mfma_f32_32x32x16_bf16 v[80:95], v[164:167], v[40:43], v[80:95]
    v_add_f32 v66, v66, v66
    v_mul_f32 v69, v60, v62
    v_mul_f32 v68, v60, v63
    s_waitcnt lgkmcnt(2)
    v_mfma_f32_32x32x16_bf16 v[96:111], v[164:167], v[44:47], v[96:111]
    ds_read_b128 v[40:43], v4 offset:32768
    ds_read_b128 v[44:47], v4 offset:36864
    v_add_f32 v60, -1.0, v68
    v_mul_f32 v61, v60, v51
    s_waitcnt lgkmcnt(3)
    v_mfma_f32_32x32x16_bf16 v[80:95], v[168:171], v[32:35], v[80:95]
    v_mul_f32 v62, v69, v51
    v_fma_f32 v61, v69, v52, v61
    v_fma_f32 v62, -v60, v52, v62
    s_waitcnt lgkmcnt(2)
    v_mfma_f32_32x32x16_bf16 v[96:111], v[168:171], v[36:39], v[96:111]
    ds_read_b128 v[32:35], v1 offset:49152
    ds_read_b128 v[36:39], v1 offset:53248
    v_mul_f32 v70, v61, v66
    v_mul_f32 v71, v62, v66
    s_waitcnt lgkmcnt(3)
    v_mfma_f32_32x32x16_bf16 v[80:95], v[172:175], v[40:43], v[80:95]
    s_lshl_b32 s11, s6, 9
    s_add_u32 s11, s11, 90112
    v_and_b32 v60, 31, v0
    s_waitcnt lgkmcnt(2)
    v_mfma_f32_32x32x16_bf16 v[96:111], v[172:175], v[44:47], v[96:111]
    ds_read_b128 v[40:43], v2 offset:49152
    ds_read_b128 v[44:47], v2 offset:53248
    v_lshlrev_b32 v60, 4, v60
    v_add_u32 v60, s11, v60
    s_waitcnt vmcnt(2)
    s_barrier
    s_add_u32 s10, s15, 896
    s_add_u32 m0, s74, 32768
    s_nop 0
    buffer_load_dwordx4 v6, s[52:55], s10 offen lds
    s_add_u32 m0, s74, 33792
    s_nop 0
    buffer_load_dwordx4 v7, s[52:55], s10 offen lds
    s_waitcnt lgkmcnt(3)
    v_mfma_f32_32x32x16_bf16 v[80:95], v[176:179], v[32:35], v[80:95]
    ds_write_b128 v60, v[68:71] offset:0
    s_nop 1
    s_waitcnt lgkmcnt(3)
    v_mfma_f32_32x32x16_bf16 v[96:111], v[176:179], v[36:39], v[96:111]
    ds_read_b128 v[32:35], v3 offset:49152
    ds_read_b128 v[36:39], v3 offset:53248
    v_lshlrev_b32 v54, 16, v54
    v_lshlrev_b32 v55, 16, v55
    s_waitcnt lgkmcnt(4)
    v_mfma_f32_32x32x16_bf16 v[80:95], v[180:183], v[40:43], v[80:95]
    v_lshlrev_b32 v56, 16, v56
    v_mul_f32 v56, 0x3fb8aa3b, v56
    s_waitcnt lgkmcnt(3)
    v_mfma_f32_32x32x16_bf16 v[96:111], v[180:183], v[44:47], v[96:111]
    ds_read_b128 v[40:43], v4 offset:49152
    ds_read_b128 v[44:47], v4 offset:53248
    v_exp_f32 v56, v56
    v_mul_f32 v67, v54, v54
    v_cvt_pk_bf16_f32 v56, v56, v56
    s_waitcnt lgkmcnt(3)
    v_mfma_f32_32x32x16_bf16 v[80:95], v[184:187], v[32:35], v[80:95]
    v_fma_f32 v67, v55, v55, v67
    v_lshlrev_b32 v56, 16, v56
    s_waitcnt lgkmcnt(2)
    v_mfma_f32_32x32x16_bf16 v[96:111], v[184:187], v[36:39], v[96:111]
    ds_read_b128 v[32:35], v1 offset:0
    ds_read_b128 v[36:39], v1 offset:4096
    v_rcp_f32 v66, v67
    v_mul_f32 v60, v56, v54
    v_mul_f32 v61, v56, v55
    s_waitcnt lgkmcnt(3)
    v_mfma_f32_32x32x16_bf16 v[80:95], v[188:191], v[40:43], v[80:95]
    v_mul_f32 v60, 0x3fb8aa3b, v60
    v_mul_f32 v61, 0.15915494, v61
    s_waitcnt lgkmcnt(2)
    v_mfma_f32_32x32x16_bf16 v[96:111], v[188:191], v[44:47], v[96:111]
    ds_read_b128 v[40:43], v2 offset:0
    ds_read_b128 v[44:47], v2 offset:4096
    v_exp_f32 v60, v60
    v_rndne_f32 v62, v61
    v_sub_f32 v61, v61, v62
    s_waitcnt vmcnt(2)
    s_barrier
    s_add_u32 s10, s15, 1024
    s_add_u32 m0, s74, 49152
    s_nop 0
    buffer_load_dwordx4 v6, s[52:55], s10 offen lds
    s_add_u32 m0, s74, 50176
    s_nop 0
    buffer_load_dwordx4 v7, s[52:55], s10 offen lds
    s_waitcnt lgkmcnt(3)
    v_mfma_f32_32x32x16_bf16 v[80:95], v[192:195], v[32:35], v[80:95]
    v_fma_f32 v65, -v67, v66, 2.0
    v_sin_f32 v62, v61
    s_waitcnt lgkmcnt(2)
    v_mfma_f32_32x32x16_bf16 v[96:111], v[192:195], v[36:39], v[96:111]
    ds_read_b128 v[32:35], v3 offset:0
    ds_read_b128 v[36:39], v3 offset:4096
    v_cos_f32 v63, v61
    v_mul_f32 v66, v66, v65
    s_waitcnt lgkmcnt(3)
    v_mfma_f32_32x32x16_bf16 v[80:95], v[196:199], v[40:43], v[80:95]
    v_add_f32 v66, v66, v66
    v_mul_f32 v69, v60, v62
    v_mul_f32 v68, v60, v63
    s_waitcnt lgkmcnt(2)
    v_mfma_f32_32x32x16_bf16 v[96:111], v[196:199], v[44:47], v[96:111]
    ds_read_b128 v[40:43], v4 offset:0
    ds_read_b128 v[44:47], v4 offset:4096
    v_add_f32 v60, -1.0, v68
    v_mul_f32 v61, v60, v54
    s_waitcnt lgkmcnt(3)
    v_mfma_f32_32x32x16_bf16 v[80:95], v[200:203], v[32:35], v[80:95]
    v_mul_f32 v62, v69, v54
    v_fma_f32 v61, v69, v55, v61
    v_fma_f32 v62, -v60, v55, v62
    s_waitcnt lgkmcnt(2)
    v_mfma_f32_32x32x16_bf16 v[96:111], v[200:203], v[36:39], v[96:111]
    ds_read_b128 v[32:35], v1 offset:16384
    ds_read_b128 v[36:39], v1 offset:20480
    v_mul_f32 v70, v61, v66
    v_mul_f32 v71, v62, v66
    s_waitcnt lgkmcnt(3)
    v_mfma_f32_32x32x16_bf16 v[80:95], v[204:207], v[40:43], v[80:95]
    s_lshl_b32 s11, s6, 9
    s_add_u32 s11, s11, 90112
    v_and_b32 v60, 31, v0
    s_waitcnt lgkmcnt(2)
    v_mfma_f32_32x32x16_bf16 v[96:111], v[204:207], v[44:47], v[96:111]
    ds_read_b128 v[40:43], v2 offset:16384
    ds_read_b128 v[44:47], v2 offset:20480
    v_lshlrev_b32 v60, 4, v60
    v_add_u32 v60, s11, v60
    s_waitcnt vmcnt(2)
    s_barrier
    s_add_u32 s10, s15, 73728
    s_add_u32 m0, s74, 0
    s_nop 0
    buffer_load_dwordx4 v6, s[52:55], s10 offen lds
    s_add_u32 m0, s74, 1024
    s_nop 0
    buffer_load_dwordx4 v7, s[52:55], s10 offen lds
    s_waitcnt lgkmcnt(3)
    v_mfma_f32_32x32x16_bf16 v[80:95], v[208:211], v[32:35], v[80:95]
    ds_write_b128 v60, v[68:71] offset:1024
    s_nop 1
    s_waitcnt lgkmcnt(3)
    v_mfma_f32_32x32x16_bf16 v[96:111], v[208:211], v[36:39], v[96:111]
    ds_read_b128 v[32:35], v3 offset:16384
    ds_read_b128 v[36:39], v3 offset:20480
    s_waitcnt lgkmcnt(4)
    v_mfma_f32_32x32x16_bf16 v[80:95], v[212:215], v[40:43], v[80:95]
    s_waitcnt lgkmcnt(3)
    v_mfma_f32_32x32x16_bf16 v[96:111], v[212:215], v[44:47], v[96:111]
    ds_read_b128 v[40:43], v4 offset:16384
    ds_read_b128 v[44:47], v4 offset:20480
    s_waitcnt lgkmcnt(3)
    v_mfma_f32_32x32x16_bf16 v[80:95], v[216:219], v[32:35], v[80:95]
    s_waitcnt lgkmcnt(2)
    v_mfma_f32_32x32x16_bf16 v[96:111], v[216:219], v[36:39], v[96:111]
    ds_read_b128 v[32:35], v1 offset:32768
    ds_read_b128 v[36:39], v1 offset:36864
    s_waitcnt lgkmcnt(3)
    v_mfma_f32_32x32x16_bf16 v[80:95], v[220:223], v[40:43], v[80:95]
    s_waitcnt lgkmcnt(2)
    v_mfma_f32_32x32x16_bf16 v[96:111], v[220:223], v[44:47], v[96:111]
    ds_read_b128 v[40:43], v2 offset:32768
    ds_read_b128 v[44:47], v2 offset:36864
    s_waitcnt vmcnt(2)
    s_barrier
    s_add_u32 s10, s15, 73856
    s_add_u32 m0, s74, 16384
    s_nop 0
    buffer_load_dwordx4 v6, s[52:55], s10 offen lds
    s_add_u32 m0, s74, 17408
    s_nop 0
    buffer_load_dwordx4 v7, s[52:55], s10 offen lds
    s_waitcnt lgkmcnt(3)
    v_mfma_f32_32x32x16_bf16 v[80:95], v[224:227], v[32:35], v[80:95]
    s_waitcnt lgkmcnt(2)
    v_mfma_f32_32x32x16_bf16 v[96:111], v[224:227], v[36:39], v[96:111]
    ds_read_b128 v[32:35], v3 offset:32768
    ds_read_b128 v[36:39], v3 offset:36864
    s_waitcnt lgkmcnt(3)
    v_mfma_f32_32x32x16_bf16 v[80:95], v[228:231], v[40:43], v[80:95]
    s_waitcnt lgkmcnt(2)
    v_mfma_f32_32x32x16_bf16 v[96:111], v[228:231], v[44:47], v[96:111]
    ds_read_b128 v[40:43], v4 offset:32768
    ds_read_b128 v[44:47], v4 offset:36864
    s_waitcnt lgkmcnt(3)
    v_mfma_f32_32x32x16_bf16 v[80:95], v[232:235], v[32:35], v[80:95]
    s_waitcnt lgkmcnt(2)
    v_mfma_f32_32x32x16_bf16 v[96:111], v[232:235], v[36:39], v[96:111]
    ds_read_b128 v[32:35], v1 offset:49152
    ds_read_b128 v[36:39], v1 offset:53248
    s_waitcnt lgkmcnt(3)
    v_mfma_f32_32x32x16_bf16 v[80:95], v[236:239], v[40:43], v[80:95]
    s_waitcnt lgkmcnt(2)
    v_mfma_f32_32x32x16_bf16 v[96:111], v[236:239], v[44:47], v[96:111]
    ds_read_b128 v[40:43], v2 offset:49152
    ds_read_b128 v[44:47], v2 offset:53248
    s_waitcnt vmcnt(2)
    s_barrier
    s_add_u32 s10, s15, 73984
    s_add_u32 m0, s74, 32768
    s_nop 0
    buffer_load_dwordx4 v6, s[52:55], s10 offen lds
    s_add_u32 m0, s74, 33792
    s_nop 0
    buffer_load_dwordx4 v7, s[52:55], s10 offen lds
    s_waitcnt lgkmcnt(3)
    v_mfma_f32_32x32x16_bf16 v[80:95], v[240:243], v[32:35], v[80:95]
    s_waitcnt lgkmcnt(2)
    v_mfma_f32_32x32x16_bf16 v[96:111], v[240:243], v[36:39], v[96:111]
    ds_read_b128 v[32:35], v3 offset:49152
    ds_read_b128 v[36:39], v3 offset:53248
    s_waitcnt lgkmcnt(3)
    v_mfma_f32_32x32x16_bf16 v[80:95], v[244:247], v[40:43], v[80:95]
    s_waitcnt lgkmcnt(2)
    v_mfma_f32_32x32x16_bf16 v[96:111], v[244:247], v[44:47], v[96:111]
    ds_read_b128 v[40:43], v4 offset:49152
    ds_read_b128 v[44:47], v4 offset:53248
    s_waitcnt lgkmcnt(3)
    v_mfma_f32_32x32x16_bf16 v[80:95], v[248:251], v[32:35], v[80:95]
    s_waitcnt lgkmcnt(2)
    v_mfma_f32_32x32x16_bf16 v[96:111], v[248:251], v[36:39], v[96:111]
    ds_read_b128 v[32:35], v1 offset:0
    ds_read_b128 v[36:39], v1 offset:4096
    s_waitcnt lgkmcnt(3)
    v_mfma_f32_32x32x16_bf16 v[80:95], v[252:255], v[40:43], v[80:95]
    s_waitcnt lgkmcnt(2)
    v_mfma_f32_32x32x16_bf16 v[96:111], v[252:255], v[44:47], v[96:111]
    ds_read_b128 v[40:43], v2 offset:0
    ds_read_b128 v[44:47], v2 offset:4096
    s_waitcnt vmcnt(2)
    s_barrier
    s_add_u32 s10, s15, 74112
    s_add_u32 m0, s74, 49152
    s_nop 0
    buffer_load_dwordx4 v6, s[52:55], s10 offen lds
    s_add_u32 m0, s74, 50176
    s_nop 0
    buffer_load_dwordx4 v7, s[52:55], s10 offen lds
    s_waitcnt lgkmcnt(3)
    v_mfma_f32_32x32x16_bf16 v[48:63], v[112:115], v[32:35], 0
    s_waitcnt lgkmcnt(2)
    v_mfma_f32_32x32x16_bf16 v[64:79], v[112:115], v[36:39], 0
    ds_read_b128 v[32:35], v3 offset:0
    ds_read_b128 v[36:39], v3 offset:4096
    s_lshl_b32 s11, s5, 7
    s_add_u32 s11, s11, 92160
    v_lshrrev_b32 v30, 5, v0
    v_lshl_add_u32 v5, v30, 6, s11
    ds_read_b128 v[14:17], v5 offset:0
    ds_read_b128 v[18:21], v5 offset:16
    ds_read_b128 v[22:25], v5 offset:32
    s_lshl_b32 s11, s6, 12
    s_lshl_b32 s73, s5, 9
    s_add_u32 s11, s11, s73
    s_add_u32 s11, s11, 81920
    v_and_b32 v31, 31, v0
    v_lshlrev_b32 v31, 3, v31
    v_lshrrev_b32 v30, 5, v0
    v_lshl_add_u32 v31, v30, 8, v31
    v_add_u32 v31, s11, v31
    s_waitcnt lgkmcnt(6)
    v_mfma_f32_32x32x16_bf16 v[48:63], v[116:119], v[40:43], v[48:63]
    s_waitcnt lgkmcnt(2)
    v_mul_f32 v80, v14, v80
    v_mul_f32 v96, v14, v96
    v_mul_f32 v81, v15, v81
    v_mul_f32 v97, v15, v97
    v_mul_f32 v82, v16, v82
    v_mul_f32 v98, v16, v98
    v_mul_f32 v83, v17, v83
    v_mul_f32 v99, v17, v99
    ds_read_b128 v[14:17], v5 offset:48
    s_waitcnt lgkmcnt(2)
    v_mul_f32 v84, v18, v84
    v_mul_f32 v100, v18, v100
    v_mul_f32 v85, v19, v85
    v_mul_f32 v101, v19, v101
    v_mul_f32 v86, v20, v86
    v_mfma_f32_32x32x16_bf16 v[64:79], v[116:119], v[44:47], v[64:79]
    ds_read_b128 v[40:43], v4 offset:0
    ds_read_b128 v[44:47], v4 offset:4096
    v_mul_f32 v102, v20, v102
    v_mul_f32 v87, v21, v87
    v_mul_f32 v103, v21, v103
    s_waitcnt lgkmcnt(3)
    v_mul_f32 v88, v22, v88
    v_mul_f32 v104, v22, v104
    v_mul_f32 v89, v23, v89
    v_mul_f32 v105, v23, v105
    v_mul_f32 v90, v24, v90
    v_mul_f32 v106, v24, v106
    v_mul_f32 v91, v25, v91
    v_mul_f32 v107, v25, v107
    s_waitcnt lgkmcnt(2)
    v_mul_f32 v92, v14, v92
    v_mul_f32 v108, v14, v108
    v_mul_f32 v93, v15, v93
    v_mfma_f32_32x32x16_bf16 v[48:63], v[120:123], v[32:35], v[48:63]
    v_mul_f32 v109, v15, v109
    v_mul_f32 v94, v16, v94
    v_mul_f32 v110, v16, v110
    v_mul_f32 v95, v17, v95
    v_mul_f32 v111, v17, v111
    v_fma_f32 v28, v8, v80, v81
    v_fma_f32 v29, v8, v96, v97
    v_fma_f32 v28, -v9, v96, v28
    v_fma_f32 v29, v9, v80, v29
    v_fma_f32 v26, v8, v28, v82
    v_fma_f32 v27, v8, v29, v98
    v_fma_f32 v26, -v9, v29, v26
    v_fma_f32 v27, v9, v28, v27
    v_fma_f32 v28, v8, v26, v83
    v_fma_f32 v29, v8, v27, v99
    v_fma_f32 v28, -v9, v27, v28
    v_fma_f32 v29, v9, v26, v29
    v_mfma_f32_32x32x16_bf16 v[64:79], v[120:123], v[36:39], v[64:79]
    ds_read_b128 v[32:35], v1 offset:16384
    ds_read_b128 v[36:39], v1 offset:20480
    v_fma_f32 v26, v8, v28, v84
    v_fma_f32 v27, v8, v29, v100
    v_fma_f32 v26, -v9, v29, v26
    v_fma_f32 v27, v9, v28, v27
    v_fma_f32 v28, v8, v26, v85
    v_fma_f32 v29, v8, v27, v101
    v_fma_f32 v28, -v9, v27, v28
    v_fma_f32 v29, v9, v26, v29
    v_fma_f32 v26, v8, v28, v86
    v_fma_f32 v27, v8, v29, v102
    v_fma_f32 v26, -v9, v29, v26
    v_fma_f32 v27, v9, v28, v27
    v_fma_f32 v28, v8, v26, v87
    v_fma_f32 v29, v8, v27, v103
    v_fma_f32 v28, -v9, v27, v28
    v_fma_f32 v29, v9, v26, v29
    s_waitcnt lgkmcnt(3)
    v_mfma_f32_32x32x16_bf16 v[48:63], v[124:127], v[40:43], v[48:63]
    v_fma_f32 v26, v8, v28, v88
    v_fma_f32 v27, v8, v29, v104
    v_fma_f32 v26, -v9, v29, v26
    v_fma_f32 v27, v9, v28, v27
    v_fma_f32 v28, v8, v26, v89
    v_fma_f32 v29, v8, v27, v105
    v_fma_f32 v28, -v9, v27, v28
    v_fma_f32 v29, v9, v26, v29
    v_fma_f32 v26, v8, v28, v90
    v_fma_f32 v27, v8, v29, v106
    v_fma_f32 v26, -v9, v29, v26
    v_fma_f32 v27, v9, v28, v27
    v_fma_f32 v28, v8, v26, v91
    v_fma_f32 v29, v8, v27, v107
    v_fma_f32 v28, -v9, v27, v28
    v_fma_f32 v29, v9, v26, v29
    v_fma_f32 v26, v8, v28, v92
    s_waitcnt lgkmcnt(2)
    v_mfma_f32_32x32x16_bf16 v[64:79], v[124:127], v[44:47], v[64:79]
    ds_read_b128 v[40:43], v2 offset:16384
    ds_read_b128 v[44:47], v2 offset:20480
    v_fma_f32 v27, v8, v29, v108
    v_fma_f32 v26, -v9, v29, v26
    v_fma_f32 v27, v9, v28, v27
    v_fma_f32 v28, v8, v26, v93
    v_fma_f32 v29, v8, v27, v109
    v_fma_f32 v28, -v9, v27, v28
    v_fma_f32 v29, v9, v26, v29
    v_fma_f32 v26, v8, v28, v94
    v_fma_f32 v27, v8, v29, v110
    v_fma_f32 v26, -v9, v29, v26
    v_fma_f32 v27, v9, v28, v27
    v_fma_f32 v28, v8, v26, v95
    v_fma_f32 v29, v8, v27, v111
    v_fma_f32 v28, -v9, v27, v28
    v_fma_f32 v29, v9, v26, v29
    ds_write_b64 v31, v[28:29] offset:1792
    s_waitcnt lgkmcnt(0)
    s_waitcnt vmcnt(2)
    s_barrier
    s_add_u32 s10, s15, 74240
    s_add_u32 m0, s74, 0
    s_nop 0
    buffer_load_dwordx4 v6, s[52:55], s10 offen lds
    s_add_u32 m0, s74, 1024
    s_nop 0
    buffer_load_dwordx4 v7, s[52:55], s10 offen lds
    v_mfma_f32_32x32x16_bf16 v[48:63], v[128:131], v[32:35], v[48:63]
    ds_read_b64 v[14:15], v31 offset:0
    ds_read_b64 v[16:17], v31 offset:256
    ds_read_b64 v[18:19], v31 offset:512
    ds_read_b64 v[20:21], v31 offset:768
    ds_read_b64 v[22:23], v31 offset:1024
    ds_read_b64 v[24:25], v31 offset:1280
    ds_read_b64 v[26:27], v31 offset:1536
    v_mul_f32 v12, v9, v9
    v_mul_f32 v5, v8, v9
    v_mfma_f32_32x32x16_bf16 v[64:79], v[128:131], v[36:39], v[64:79]
    ds_read_b128 v[32:35], v3 offset:16384
    ds_read_b128 v[36:39], v3 offset:20480
    v_fma_f32 v30, v8, v8, -v12
    v_add_f32 v5, v5, v5
    v_mul_f32 v12, v5, v5
    v_mul_f32 v5, v30, v5
    v_fma_f32 v30, v30, v30, -v12
    v_add_f32 v5, v5, v5
    v_mul_f32 v12, v5, v5
    v_mul_f32 v5, v30, v5
    v_mfma_f32_32x32x16_bf16 v[48:63], v[132:135], v[40:43], v[48:63]
    v_fma_f32 v30, v30, v30, -v12
    v_add_f32 v5, v5, v5
    v_mul_f32 v12, v5, v5
    v_mul_f32 v5, v30, v5
    v_fma_f32 v30, v30, v30, -v12
    v_add_f32 v5, v5, v5
    s_waitcnt lgkmcnt(7)
    v_fma_f32 v16, v30, v14, v16
    v_fma_f32 v17, v30, v15, v17
    v_mfma_f32_32x32x16_bf16 v[64:79], v[132:135], v[44:47], v[64:79]
    ds_read_b128 v[40:43], v4 offset:16384
    ds_read_b128 v[44:47], v4 offset:20480
    v_fma_f32 v16, -v5, v15, v16
    v_fma_f32 v17, v5, v14, v17
    s_waitcnt lgkmcnt(8)
    v_fma_f32 v18, v30, v16, v18
    v_fma_f32 v19, v30, v17, v19
    v_fma_f32 v18, -v5, v17, v18
    v_fma_f32 v19, v5, v16, v19
    s_waitcnt lgkmcnt(7)
    s_waitcnt lgkmcnt(3)
    v_mfma_f32_32x32x16_bf16 v[48:63], v[136:139], v[32:35], v[48:63]
    v_fma_f32 v20, v30, v18, v20
    v_fma_f32 v21, v30, v19, v21
    v_fma_f32 v20, -v5, v19, v20
    v_fma_f32 v21, v5, v18, v21
    v_fma_f32 v22, v30, v20, v22
    v_fma_f32 v23, v30, v21, v23
    v_fma_f32 v22, -v5, v21, v22
    v_fma_f32 v23, v5, v20, v23
    s_waitcnt lgkmcnt(2)
    v_mfma_f32_32x32x16_bf16 v[64:79], v[136:139], v[36:39], v[64:79]
    ds_read_b128 v[32:35], v1 offset:32768
    ds_read_b128 v[36:39], v1 offset:36864
    v_fma_f32 v24, v30, v22, v24
    v_fma_f32 v25, v30, v23, v25
    v_fma_f32 v24, -v5, v23, v24
    v_fma_f32 v25, v5, v22, v25
    v_fma_f32 v12, v30, v24, v26
    v_fma_f32 v13, v30, v25, v27
    s_waitcnt lgkmcnt(3)
    v_mfma_f32_32x32x16_bf16 v[48:63], v[140:143], v[40:43], v[48:63]
    v_fma_f32 v12, -v5, v25, v12
    v_fma_f32 v13, v5, v24, v13
    v_fma_f32 v28, v30, v12, v28
    v_fma_f32 v29, v30, v13, v29
    v_fma_f32 v28, -v5, v13, v28
    v_fma_f32 v29, v5, v12, v29
    s_mul_i32 s11, s7, 4608
    s_add_u32 s73, s78, s6
    s_lshl_b32 s73, s73, 8
    s_waitcnt lgkmcnt(2)
    v_mfma_f32_32x32x16_bf16 v[64:79], v[140:143], v[44:47], v[64:79]
    ds_read_b128 v[40:43], v2 offset:32768
    ds_read_b128 v[44:47], v2 offset:36864
    s_add_u32 s11, s11, s73
    s_add_u32 s11, s11, -256
    s_cmp_eq_u32 s5, 3
    s_cselect_b32 s11, s11, 0x100000
    v_lshlrev_b32 v30, 3, v0
    v_add_u32 v30, s11, v30
    v_mov_b32 v5, 0x100000
    v_cndmask_b32 v30, v5, v30, s[96:97]
    s_waitcnt vmcnt(2)
    s_barrier
    buffer_store_dwordx2 v[28:29], v30, s[48:51], 0 offen sc1
    s_add_u32 s10, s15, 74368
    s_add_u32 m0, s74, 16384
    s_nop 0
    buffer_load_dwordx4 v6, s[52:55], s10 offen lds
    s_add_u32 m0, s74, 17408
    s_nop 0
    buffer_load_dwordx4 v7, s[52:55], s10 offen lds
    s_waitcnt lgkmcnt(3)
    v_mfma_f32_32x32x16_bf16 v[48:63], v[144:147], v[32:35], v[48:63]
    s_waitcnt lgkmcnt(2)
    v_mfma_f32_32x32x16_bf16 v[64:79], v[144:147], v[36:39], v[64:79]
    ds_read_b128 v[32:35], v3 offset:32768
    ds_read_b128 v[36:39], v3 offset:36864
    s_waitcnt lgkmcnt(3)
    v_mfma_f32_32x32x16_bf16 v[48:63], v[148:151], v[40:43], v[48:63]
    s_waitcnt lgkmcnt(2)
    v_mfma_f32_32x32x16_bf16 v[64:79], v[148:151], v[44:47], v[64:79]
    ds_read_b128 v[40:43], v4 offset:32768
    ds_read_b128 v[44:47], v4 offset:36864
    s_waitcnt lgkmcnt(3)
    v_mfma_f32_32x32x16_bf16 v[48:63], v[152:155], v[32:35], v[48:63]
    s_waitcnt lgkmcnt(2)
    v_mfma_f32_32x32x16_bf16 v[64:79], v[152:155], v[36:39], v[64:79]
    ds_read_b128 v[32:35], v1 offset:49152
    ds_read_b128 v[36:39], v1 offset:53248
    s_waitcnt lgkmcnt(3)
    v_mfma_f32_32x32x16_bf16 v[48:63], v[156:159], v[40:43], v[48:63]
    s_waitcnt lgkmcnt(2)
    v_mfma_f32_32x32x16_bf16 v[64:79], v[156:159], v[44:47], v[64:79]
    ds_read_b128 v[40:43], v2 offset:49152
    ds_read_b128 v[44:47], v2 offset:53248
    s_waitcnt vmcnt(3)
    s_barrier
    s_add_u32 s10, s15, 74496
    s_add_u32 m0, s74, 32768
    s_nop 0
    buffer_load_dwordx4 v6, s[52:55], s10 offen lds
    s_add_u32 m0, s74, 33792
    s_nop 0
    buffer_load_dwordx4 v7, s[52:55], s10 offen lds
    s_waitcnt lgkmcnt(3)
    v_mfma_f32_32x32x16_bf16 v[48:63], v[160:163], v[32:35], v[48:63]
    s_waitcnt lgkmcnt(2)
    v_mfma_f32_32x32x16_bf16 v[64:79], v[160:163], v[36:39], v[64:79]
    ds_read_b128 v[32:35], v3 offset:49152
    ds_read_b128 v[36:39], v3 offset:53248
    s_waitcnt lgkmcnt(3)
    v_mfma_f32_32x32x16_bf16 v[48:63], v[164:167], v[40:43], v[48:63]
    s_waitcnt lgkmcnt(2)
    v_mfma_f32_32x32x16_bf16 v[64:79], v[164:167], v[44:47], v[64:79]
    ds_read_b128 v[40:43], v4 offset:49152
    ds_read_b128 v[44:47], v4 offset:53248
    s_waitcnt lgkmcnt(3)
    v_mfma_f32_32x32x16_bf16 v[48:63], v[168:171], v[32:35], v[48:63]
    s_waitcnt lgkmcnt(2)
    v_mfma_f32_32x32x16_bf16 v[64:79], v[168:171], v[36:39], v[64:79]
    ds_read_b128 v[32:35], v1 offset:0
    ds_read_b128 v[36:39], v1 offset:4096
    s_waitcnt lgkmcnt(3)
    v_mfma_f32_32x32x16_bf16 v[48:63], v[172:175], v[40:43], v[48:63]
    s_waitcnt lgkmcnt(2)
    v_mfma_f32_32x32x16_bf16 v[64:79], v[172:175], v[44:47], v[64:79]
    ds_read_b128 v[40:43], v2 offset:0
    ds_read_b128 v[44:47], v2 offset:4096
    s_waitcnt vmcnt(2)
    s_barrier
    s_lshl_b32 s11, s8, 4
    s_add_u32 s11, s11, s7
    s_lshl_b32 s11, s11, 2
    s_cmp_eq_u32 s4, 3
    s_cselect_b32 s11, s11, 0x1000
    s_cmp_eq_u32 s7, 15
    s_cselect_b32 s11, 0x1000, s11
    v_lshlrev_b32 v30, 12, v0
    v_add_u32 v30, s11, v30
    v_mov_b32 v31, 1
    buffer_store_dword v31, v30, s[68:71], 0 offen sc1
    s_add_u32 s10, s15, 74624
    s_add_u32 m0, s74, 49152
    s_nop 0
    buffer_load_dwordx4 v6, s[52:55], s10 offen lds
    s_add_u32 m0, s74, 50176
    s_nop 0
    buffer_load_dwordx4 v7, s[52:55], s10 offen lds
    s_waitcnt lgkmcnt(3)
    v_mfma_f32_32x32x16_bf16 v[48:63], v[176:179], v[32:35], v[48:63]
    s_waitcnt lgkmcnt(2)
    v_mfma_f32_32x32x16_bf16 v[64:79], v[176:179], v[36:39], v[64:79]
    ds_read_b128 v[32:35], v3 offset:0
    ds_read_b128 v[36:39], v3 offset:4096
    s_waitcnt lgkmcnt(3)
    v_mfma_f32_32x32x16_bf16 v[48:63], v[180:183], v[40:43], v[48:63]
    s_waitcnt lgkmcnt(2)
    v_mfma_f32_32x32x16_bf16 v[64:79], v[180:183], v[44:47], v[64:79]
    ds_read_b128 v[40:43], v4 offset:0
    ds_read_b128 v[44:47], v4 offset:4096
    s_waitcnt lgkmcnt(3)
    v_mfma_f32_32x32x16_bf16 v[48:63], v[184:187], v[32:35], v[48:63]
    s_waitcnt lgkmcnt(2)
    v_mfma_f32_32x32x16_bf16 v[64:79], v[184:187], v[36:39], v[64:79]
    ds_read_b128 v[32:35], v1 offset:16384
    ds_read_b128 v[36:39], v1 offset:20480
    s_waitcnt lgkmcnt(3)
    v_mfma_f32_32x32x16_bf16 v[48:63], v[188:191], v[40:43], v[48:63]
    s_waitcnt lgkmcnt(2)
    v_mfma_f32_32x32x16_bf16 v[64:79], v[188:191], v[44:47], v[64:79]
    ds_read_b128 v[40:43], v2 offset:16384
    ds_read_b128 v[44:47], v2 offset:20480
    s_waitcnt vmcnt(3)
    s_barrier
    s_add_u32 s10, s15, 74752
    s_add_u32 m0, s74, 0
    s_nop 0
    buffer_load_dwordx4 v6, s[52:55], s10 offen lds
    s_add_u32 m0, s74, 1024
    s_nop 0
    buffer_load_dwordx4 v7, s[52:55], s10 offen lds
    s_waitcnt lgkmcnt(3)
    v_mfma_f32_32x32x16_bf16 v[48:63], v[192:195], v[32:35], v[48:63]
    s_waitcnt lgkmcnt(2)
    v_mfma_f32_32x32x16_bf16 v[64:79], v[192:195], v[36:39], v[64:79]
    ds_read_b128 v[32:35], v3 offset:16384
    ds_read_b128 v[36:39], v3 offset:20480
    s_waitcnt lgkmcnt(3)
    v_mfma_f32_32x32x16_bf16 v[48:63], v[196:199], v[40:43], v[48:63]
    s_waitcnt lgkmcnt(2)
    v_mfma_f32_32x32x16_bf16 v[64:79], v[196:199], v[44:47], v[64:79]
    ds_read_b128 v[40:43], v4 offset:16384
    ds_read_b128 v[44:47], v4 offset:20480
    s_waitcnt lgkmcnt(3)
    v_mfma_f32_32x32x16_bf16 v[48:63], v[200:203], v[32:35], v[48:63]
    s_waitcnt lgkmcnt(2)
    v_mfma_f32_32x32x16_bf16 v[64:79], v[200:203], v[36:39], v[64:79]
    ds_read_b128 v[32:35], v1 offset:32768
    ds_read_b128 v[36:39], v1 offset:36864
    s_waitcnt lgkmcnt(3)
    v_mfma_f32_32x32x16_bf16 v[48:63], v[204:207], v[40:43], v[48:63]
    s_waitcnt lgkmcnt(2)
    v_mfma_f32_32x32x16_bf16 v[64:79], v[204:207], v[44:47], v[64:79]
    ds_read_b128 v[40:43], v2 offset:32768
    ds_read_b128 v[44:47], v2 offset:36864
    s_waitcnt vmcnt(2)
    s_barrier
    v_and_b32 v31, 15, v0
    s_lshl_b32 s11, s8, 6
    v_lshlrev_b32 v31, 2, v31
    v_add_u32 v31, s11, v31
    buffer_load_dword v30, v31, s[68:71], 0 offen sc1
    s_add_u32 s10, s15, 147456
    s_add_u32 m0, s74, 16384
    s_nop 0
    buffer_load_dwordx4 v6, s[52:55], s10 offen lds
    s_add_u32 m0, s74, 17408
    s_nop 0
    buffer_load_dwordx4 v7, s[52:55], s10 offen lds
    s_waitcnt lgkmcnt(3)
    v_mfma_f32_32x32x16_bf16 v[48:63], v[208:211], v[32:35], v[48:63]
    s_waitcnt lgkmcnt(2)
    v_mfma_f32_32x32x16_bf16 v[64:79], v[208:211], v[36:39], v[64:79]
    ds_read_b128 v[32:35], v3 offset:32768
    ds_read_b128 v[36:39], v3 offset:36864
    s_waitcnt lgkmcnt(3)
    v_mfma_f32_32x32x16_bf16 v[48:63], v[212:215], v[40:43], v[48:63]
    s_waitcnt lgkmcnt(2)
    v_mfma_f32_32x32x16_bf16 v[64:79], v[212:215], v[44:47], v[64:79]
    ds_read_b128 v[40:43], v4 offset:32768
    ds_read_b128 v[44:47], v4 offset:36864
    s_waitcnt lgkmcnt(3)
    v_mfma_f32_32x32x16_bf16 v[48:63], v[216:219], v[32:35], v[48:63]
    s_waitcnt lgkmcnt(2)
    v_mfma_f32_32x32x16_bf16 v[64:79], v[216:219], v[36:39], v[64:79]
    ds_read_b128 v[32:35], v1 offset:49152
    ds_read_b128 v[36:39], v1 offset:53248
    s_waitcnt lgkmcnt(3)
    v_mfma_f32_32x32x16_bf16 v[48:63], v[220:223], v[40:43], v[48:63]
    s_waitcnt lgkmcnt(2)
    v_mfma_f32_32x32x16_bf16 v[64:79], v[220:223], v[44:47], v[64:79]
    ds_read_b128 v[40:43], v2 offset:49152
    ds_read_b128 v[44:47], v2 offset:53248
    s_waitcnt vmcnt(3)
    s_barrier
    s_waitcnt vmcnt(2)
    v_cmp_gt_u32 vcc, 1, v30
    s_and_b64 vcc, vcc, s[94:95]
    s_cbranch_scc0 .pok_10
    s_mov_b32 s83, 65536
.plp_11:
    buffer_load_dword v30, v31, s[68:71], 0 offen sc1
    s_waitcnt vmcnt(0)
    v_cmp_gt_u32 vcc, 1, v30
    s_and_b64 vcc, vcc, s[94:95]
    s_cbranch_scc0 .pok_10
    s_sub_u32 s83, s83, 1
    s_cmp_lg_u32 s83, 0
    s_cbranch_scc1 .plp_11
.pok_10:
    s_sub_u32 s11, s7, 1
    s_mul_i32 s11, s11, 4608
    s_add_u32 s73, s78, s6
    s_lshl_b32 s73, s73, 8
    s_add_u32 s11, s11, s73
    s_add_u32 s11, s11, 0
    v_and_b32 v30, 31, v0
    v_lshlrev_b32 v30, 3, v30
    v_lshrrev_b32 v31, 5, v0
    v_mul_u32_u24 v31, 4608, v31
    v_sub_u32 v30, v30, v31
    v_add_u32 v30, s11, v30
    v_subrev_u32 v28, 64512, v30
    buffer_load_dwordx2 v[28:29], v28, s[48:51], 0 offen sc1
    v_subrev_u32 v26, 55296, v30
    buffer_load_dwordx2 v[26:27], v26, s[48:51], 0 offen sc1
    v_subrev_u32 v24, 46080, v30
    buffer_load_dwordx2 v[24:25], v24, s[48:51], 0 offen sc1
    v_subrev_u32 v22, 36864, v30
    buffer_load_dwordx2 v[22:23], v22, s[48:51], 0 offen sc1
    v_subrev_u32 v20, 27648, v30
    buffer_load_dwordx2 v[20:21], v20, s[48:51], 0 offen sc1
    v_subrev_u32 v18, 18432, v30
    buffer_load_dwordx2 v[18:19], v18, s[48:51], 0 offen sc1
    v_subrev_u32 v16, 9216, v30
    buffer_load_dwordx2 v[16:17], v16, s[48:51], 0 offen sc1
    v_subrev_u32 v14, 0, v30
    buffer_load_dwordx2 v[14:15], v14, s[48:51], 0 offen sc1
    s_add_u32 s10, s15, 147584
    s_add_u32 m0, s74, 32768
    s_nop 0
    buffer_load_dwordx4 v6, s[52:55], s10 offen lds
    s_add_u32 m0, s74, 33792
    s_nop 0
    buffer_load_dwordx4 v7, s[52:55], s10 offen lds
    s_waitcnt lgkmcnt(3)
    v_mfma_f32_32x32x16_bf16 v[48:63], v[224:227], v[32:35], v[48:63]
    v_mul_f32 v5, v9, v9
    v_mul_f32 v31, v8, v9
    v_fma_f32 v30, v8, v8, -v5
    v_add_f32 v31, v31, v31
    v_mul_f32 v5, v31, v31
    s_waitcnt lgkmcnt(2)
    v_mfma_f32_32x32x16_bf16 v[64:79], v[224:227], v[36:39], v[64:79]
    ds_read_b128 v[32:35], v3 offset:49152
    ds_read_b128 v[36:39], v3 offset:53248
    v_mul_f32 v31, v30, v31
    v_fma_f32 v30, v30, v30, -v5
    v_add_f32 v31, v31, v31
    v_mul_f32 v5, v31, v31
    v_mul_f32 v31, v30, v31
    s_waitcnt lgkmcnt(3)
    v_mfma_f32_32x32x16_bf16 v[48:63], v[228:231], v[40:43], v[48:63]
    v_fma_f32 v30, v30, v30, -v5
    v_add_f32 v31, v31, v31
    v_mul_f32 v5, v31, v31
    v_mul_f32 v31, v30, v31
    s_waitcnt lgkmcnt(2)
    v_mfma_f32_32x32x16_bf16 v[64:79], v[228:231], v[44:47], v[64:79]
    ds_read_b128 v[40:43], v4 offset:49152
    ds_read_b128 v[44:47], v4 offset:53248
    v_fma_f32 v30, v30, v30, -v5
    v_add_f32 v31, v31, v31
    v_mul_f32 v5, v31, v31
    v_mul_f32 v31, v30, v31
    v_fma_f32 v30, v30, v30, -v5
    s_waitcnt lgkmcnt(3)
    v_mfma_f32_32x32x16_bf16 v[48:63], v[232:235], v[32:35], v[48:63]
    v_add_f32 v31, v31, v31
    v_mul_f32 v5, v31, v31
    v_mul_f32 v31, v30, v31
    v_fma_f32 v30, v30, v30, -v5
    s_waitcnt lgkmcnt(2)
    v_mfma_f32_32x32x16_bf16 v[64:79], v[232:235], v[36:39], v[64:79]
    ds_read_b128 v[32:35], v1 offset:0
    ds_read_b128 v[36:39], v1 offset:4096
    v_add_f32 v31, v31, v31
    v_mul_f32 v5, v31, v31
    v_mul_f32 v31, v30, v31
    v_fma_f32 v30, v30, v30, -v5
    v_add_f32 v31, v31, v31
    s_waitcnt lgkmcnt(3)
    v_mfma_f32_32x32x16_bf16 v[48:63], v[236:239], v[40:43], v[48:63]
    v_mul_f32 v5, v31, v31
    v_mul_f32 v31, v30, v31
    v_fma_f32 v30, v30, v30, -v5
    v_add_f32 v31, v31, v31
    s_waitcnt lgkmcnt(2)
    v_mfma_f32_32x32x16_bf16 v[64:79], v[236:239], v[44:47], v[64:79]
    ds_read_b128 v[40:43], v2 offset:0
    ds_read_b128 v[44:47], v2 offset:4096
    s_waitcnt vmcnt(10)
    s_barrier
    s_add_u32 s10, s15, 147712
    s_add_u32 m0, s74, 49152
    s_nop 0
    buffer_load_dwordx4 v6, s[52:55], s10 offen lds
    s_add_u32 m0, s74, 50176
    s_nop 0
    buffer_load_dwordx4 v7, s[52:55], s10 offen lds
    s_waitcnt lgkmcnt(3)
    v_mfma_f32_32x32x16_bf16 v[48:63], v[240:243], v[32:35], v[48:63]
    s_waitcnt vmcnt(10)
    v_fma_f32 v26, v30, v28, v26
    v_fma_f32 v27, v30, v29, v27
    v_fma_f32 v26, -v31, v29, v26
    v_fma_f32 v27, v31, v28, v27
    s_waitcnt vmcnt(9)
    v_fma_f32 v24, v30, v26, v24
    v_fma_f32 v25, v30, v27, v25
    v_fma_f32 v24, -v31, v27, v24
    v_fma_f32 v25, v31, v26, v25
    s_waitcnt vmcnt(8)
    v_fma_f32 v22, v30, v24, v22
    v_fma_f32 v23, v30, v25, v23
    v_fma_f32 v22, -v31, v25, v22
    v_fma_f32 v23, v31, v24, v23
    s_waitcnt vmcnt(7)
    v_fma_f32 v20, v30, v22, v20
    v_fma_f32 v21, v30, v23, v21
    v_fma_f32 v20, -v31, v23, v20
    v_fma_f32 v21, v31, v22, v21
    s_waitcnt vmcnt(6)
    v_fma_f32 v18, v30, v20, v18
    v_fma_f32 v19, v30, v21, v19
    v_fma_f32 v18, -v31, v21, v18
    v_fma_f32 v19, v31, v20, v19
    s_waitcnt vmcnt(5)
    v_fma_f32 v16, v30, v18, v16
    v_fma_f32 v17, v30, v19, v17
    v_fma_f32 v16, -v31, v19, v16
    v_fma_f32 v17, v31, v18, v17
    s_waitcnt vmcnt(4)
    v_fma_f32 v14, v30, v16, v14
    v_fma_f32 v15, v30, v17, v15
    s_waitcnt lgkmcnt(2)
    v_mfma_f32_32x32x16_bf16 v[64:79], v[240:243], v[36:39], v[64:79]
    ds_read_b128 v[32:35], v3 offset:0
    ds_read_b128 v[36:39], v3 offset:4096
    v_fma_f32 v14, -v31, v17, v14
    v_fma_f32 v15, v31, v16, v15
    v_mul_f32 v5, v9, v9
    v_mul_f32 v17, v8, v9
    v_fma_f32 v16, v8, v8, -v5
    v_add_f32 v17, v17, v17
    v_mul_f32 v5, v17, v17
    v_mul_f32 v17, v16, v17
    v_fma_f32 v16, v16, v16, -v5
    v_add_f32 v17, v17, v17
    v_mul_f32 v5, v17, v17
    v_mul_f32 v17, v16, v17
    v_fma_f32 v16, v16, v16, -v5
    v_add_f32 v17, v17, v17
    v_mul_f32 v5, v17, v17
    v_mul_f32 v17, v16, v17
    v_fma_f32 v16, v16, v16, -v5
    v_add_f32 v17, v17, v17
    v_mul_f32 v5, v17, v17
    v_mul_f32 v19, v16, v17
    v_fma_f32 v18, v16, v16, -v5
    v_add_f32 v19, v19, v19
    v_mul_f32 v5, v19, v19
    v_mul_f32 v21, v18, v19
    v_fma_f32 v20, v18, v18, -v5
    v_add_f32 v21, v21, v21
    v_mul_f32 v5, v21, v21
    v_mul_f32 v23, v20, v21
    v_fma_f32 v22, v20, v20, -v5
    v_add_f32 v23, v23, v23
    v_mul_f32 v24, v22, v14
    v_mul_f32 v25, v22, v15
    s_waitcnt lgkmcnt(3)
    v_mfma_f32_32x32x16_bf16 v[48:63], v[244:247], v[40:43], v[48:63]
    v_fma_f32 v24, -v23, v15, v24
    v_fma_f32 v25, v23, v14, v25
    v_cndmask_b32 v14, v14, v24, s[96:97]
    v_cndmask_b32 v15, v15, v25, s[96:97]
    v_mov_b32 v24, v14
    v_mov_b32 v25, v15
    v_cndmask_b32 v16, 1.0, v16, s[96:97]
    v_cndmask_b32 v17, 0, v17, s[96:97]
    v_permlane32_swap_b32 v14, v24
    v_permlane32_swap_b32 v15, v25
    v_cndmask_b32 v18, 1.0, v18, s[98:99]
    v_cndmask_b32 v19, 0, v19, s[98:99]
    v_cndmask_b32 v20, 1.0, v20, s[100:101]
    v_cndmask_b32 v21, 0, v21, s[100:101]
    v_add_f32 v14, v14, v24
    v_add_f32 v15, v15, v25
    v_mul_f32 v22, v16, v18
    v_mul_f32 v23, v16, v19
    v_fma_f32 v22, -v17, v19, v22
    v_fma_f32 v23, v17, v18, v23
    v_mul_f32 v16, v22, v20
    v_mul_f32 v17, v22, v21
    v_fma_f32 v16, -v23, v21, v16
    v_fma_f32 v17, v23, v20, v17
    v_fma_f32 v12, v16, v14, v12
    v_fma_f32 v13, v16, v15, v13
    v_fma_f32 v12, -v17, v15, v12
    v_fma_f32 v13, v17, v14, v13
    v_and_b32 v30, 3, v0
    v_xor_b32 v30, s5, v30
    v_lshlrev_b32 v30, 6, v30
    v_and_b32 v31, 31, v0
    s_waitcnt lgkmcnt(2)
    v_mfma_f32_32x32x16_bf16 v[64:79], v[244:247], v[44:47], v[64:79]
    ds_read_b128 v[40:43], v4 offset:0
    ds_read_b128 v[44:47], v4 offset:4096
    v_lshl_add_u32 v30, v31, 8, v30
    v_lshrrev_b32 v31, 5, v0
    v_lshl_add_u32 v30, v31, 5, v30
    s_lshl_b32 s11, s6, 14
    s_add_u32 s11, s11, 0
    v_add_u32 v31, s11, v30
    v_fma_f32 v80, v8, v12, v80
    v_fma_f32 v96, v8, v13, v96
    v_fma_f32 v80, -v9, v13, v80
    v_fma_f32 v96, v9, v12, v96
    v_mul_f32 v30, v10, v80
    v_mul_f32 v5, -v10, v96
    v_fma_f32 v30, -v11, v96, v30
    v_fma_f32 v5, -v11, v80, v5
    v_fma_f32 v81, v8, v80, v81
    v_fma_f32 v97, v8, v96, v97
    v_fma_f32 v81, -v9, v96, v81
    v_fma_f32 v97, v9, v80, v97
    v_mul_f32 v12, v10, v81
    v_mul_f32 v13, -v10, v97
    v_fma_f32 v12, -v11, v97, v12
    v_fma_f32 v13, -v11, v81, v13
    v_cvt_pk_bf16_f32 v14, v30, v12
    v_cvt_pk_bf16_f32 v18, v5, v13
    v_fma_f32 v82, v8, v81, v82
    v_fma_f32 v98, v8, v97, v98
    v_fma_f32 v82, -v9, v97, v82
    v_fma_f32 v98, v9, v81, v98
    v_mul_f32 v30, v10, v82
    v_mul_f32 v5, -v10, v98
    v_fma_f32 v30, -v11, v98, v30
    v_fma_f32 v5, -v11, v82, v5
    s_waitcnt lgkmcnt(3)
    v_mfma_f32_32x32x16_bf16 v[48:63], v[248:251], v[32:35], v[48:63]
    v_fma_f32 v83, v8, v82, v83
    v_fma_f32 v99, v8, v98, v99
    v_fma_f32 v83, -v9, v98, v83
    v_fma_f32 v99, v9, v82, v99
    v_mul_f32 v12, v10, v83
    v_mul_f32 v13, -v10, v99
    v_fma_f32 v12, -v11, v99, v12
    v_fma_f32 v13, -v11, v83, v13
    v_cvt_pk_bf16_f32 v15, v30, v12
    v_cvt_pk_bf16_f32 v19, v5, v13
    v_fma_f32 v84, v8, v83, v84
    v_fma_f32 v100, v8, v99, v100
    v_fma_f32 v84, -v9, v99, v84
    v_fma_f32 v100, v9, v83, v100
    v_mul_f32 v30, v10, v84
    v_mul_f32 v5, -v10, v100
    v_fma_f32 v30, -v11, v100, v30
    v_fma_f32 v5, -v11, v84, v5
    v_fma_f32 v85, v8, v84, v85
    v_fma_f32 v101, v8, v100, v101
    v_fma_f32 v85, -v9, v100, v85
    v_fma_f32 v101, v9, v84, v101
    v_mul_f32 v12, v10, v85
    v_mul_f32 v13, -v10, v101
    v_fma_f32 v12, -v11, v101, v12
    v_fma_f32 v13, -v11, v85, v13
    v_cvt_pk_bf16_f32 v16, v30, v12
    v_cvt_pk_bf16_f32 v20, v5, v13
    v_fma_f32 v86, v8, v85, v86
    v_fma_f32 v102, v8, v101, v102
    v_fma_f32 v86, -v9, v101, v86
    v_fma_f32 v102, v9, v85, v102
    s_waitcnt lgkmcnt(2)
    v_mfma_f32_32x32x16_bf16 v[64:79], v[248:251], v[36:39], v[64:79]
    ds_read_b128 v[32:35], v1 offset:16384
    ds_read_b128 v[36:39], v1 offset:20480
    v_mul_f32 v30, v10, v86
    v_mul_f32 v5, -v10, v102
    v_fma_f32 v30, -v11, v102, v30
    v_fma_f32 v5, -v11, v86, v5
    v_fma_f32 v87, v8, v86, v87
    v_fma_f32 v103, v8, v102, v103
    v_fma_f32 v87, -v9, v102, v87
    v_fma_f32 v103, v9, v86, v103
    v_mul_f32 v12, v10, v87
    v_mul_f32 v13, -v10, v103
    v_fma_f32 v12, -v11, v103, v12
    v_fma_f32 v13, -v11, v87, v13
    v_cvt_pk_bf16_f32 v17, v30, v12
    v_cvt_pk_bf16_f32 v21, v5, v13
    ds_write_b128 v31, v[14:17] offset:0
    ds_write_b128 v31, v[18:21] offset:8192
    v_fma_f32 v88, v8, v87, v88
    v_fma_f32 v104, v8, v103, v104
    v_fma_f32 v88, -v9, v103, v88
    v_fma_f32 v104, v9, v87, v104
    v_mul_f32 v30, v10, v88
    v_mul_f32 v5, -v10, v104
    v_fma_f32 v30, -v11, v104, v30
    v_fma_f32 v5, -v11, v88, v5
    v_fma_f32 v89, v8, v88, v89
    v_fma_f32 v105, v8, v104, v105
    v_fma_f32 v89, -v9, v104, v89
    v_fma_f32 v105, v9, v88, v105
    v_mul_f32 v12, v10, v89
    v_mul_f32 v13, -v10, v105
    v_fma_f32 v12, -v11, v105, v12
    v_fma_f32 v13, -v11, v89, v13
    s_waitcnt lgkmcnt(5)
    v_mfma_f32_32x32x16_bf16 v[48:63], v[252:255], v[40:43], v[48:63]
    v_cvt_pk_bf16_f32 v22, v30, v12
    v_cvt_pk_bf16_f32 v26, v5, v13
    v_fma_f32 v90, v8, v89, v90
    v_fma_f32 v106, v8, v105, v106
    v_fma_f32 v90, -v9, v105, v90
    v_fma_f32 v106, v9, v89, v106
    v_mul_f32 v30, v10, v90
    v_mul_f32 v5, -v10, v106
    v_fma_f32 v30, -v11, v106, v30
    v_fma_f32 v5, -v11, v90, v5
    v_fma_f32 v91, v8, v90, v91
    v_fma_f32 v107, v8, v106, v107
    v_fma_f32 v91, -v9, v106, v91
    v_fma_f32 v107, v9, v90, v107
    v_mul_f32 v12, v10, v91
    v_mul_f32 v13, -v10, v107
    v_fma_f32 v12, -v11, v107, v12
    v_fma_f32 v13, -v11, v91, v13
    v_cvt_pk_bf16_f32 v23, v30, v12
    v_cvt_pk_bf16_f32 v27, v5, v13
    v_fma_f32 v92, v8, v91, v92
    v_fma_f32 v108, v8, v107, v108
    v_fma_f32 v92, -v9, v107, v92
    v_fma_f32 v108, v9, v91, v108
    v_mul_f32 v30, v10, v92
    v_mul_f32 v5, -v10, v108
    v_fma_f32 v30, -v11, v108, v30
    v_fma_f32 v5, -v11, v92, v5
    v_fma_f32 v93, v8, v92, v93
    v_fma_f32 v109, v8, v108, v109
    v_fma_f32 v93, -v9, v108, v93
    v_fma_f32 v109, v9, v92, v109
    s_waitcnt lgkmcnt(4)
    v_mfma_f32_32x32x16_bf16 v[64:79], v[252:255], v[44:47], v[64:79]
    ds_read_b128 v[40:43], v2 offset:16384
    ds_read_b128 v[44:47], v2 offset:20480
    v_mul_f32 v12, v10, v93
    v_mul_f32 v13, -v10, v109
    v_fma_f32 v12, -v11, v109, v12
    v_fma_f32 v13, -v11, v93, v13
    v_cvt_pk_bf16_f32 v24, v30, v12
    v_cvt_pk_bf16_f32 v28, v5, v13
    v_fma_f32 v94, v8, v93, v94
    v_fma_f32 v110, v8, v109, v110
    v_fma_f32 v94, -v9, v109, v94
    v_fma_f32 v110, v9, v93, v110
    v_mul_f32 v30, v10, v94
    v_mul_f32 v5, -v10, v110
    v_fma_f32 v30, -v11, v110, v30
    v_fma_f32 v5, -v11, v94, v5
    v_fma_f32 v95, v8, v94, v95
    v_fma_f32 v111, v8, v110, v111
    v_fma_f32 v95, -v9, v110, v95
    v_fma_f32 v111, v9, v94, v111
    v_mul_f32 v12, v10, v95
    v_mul_f32 v13, -v10, v111
    v_fma_f32 v12, -v11, v111, v12
    v_fma_f32 v13, -v11, v95, v13
    v_cvt_pk_bf16_f32 v25, v30, v12
    v_cvt_pk_bf16_f32 v29, v5, v13
    ds_write_b128 v31, v[22:25] offset:16
    ds_write_b128 v31, v[26:29] offset:8208
    s_lshl_b32 s11, s6, 9
    s_add_u32 s11, s11, 90112
    v_and_b32 v30, 31, v0
    v_lshlrev_b32 v30, 4, v30
    v_add_u32 v30, s11, v30
    ds_read_b128 v[8:11], v30 offset:0
    s_cmp_eq_u32 s6, 0
    s_cbranch_scc0 .Lssm_h1
    s_waitcnt lgkmcnt(1)
    s_waitcnt vmcnt(2)
    s_barrier
    s_add_u32 s10, s15, 147840
    s_add_u32 m0, s74, 0
    s_nop 0
    buffer_load_dwordx4 v6, s[52:55], s10 offen lds
    s_add_u32 m0, s74, 1024
    s_nop 0
    buffer_load_dwordx4 v7, s[52:55], s10 offen lds
    v_mfma_f32_32x32x16_bf16 v[80:95], v[112:115], v[32:35], 0
    v_mfma_f32_32x32x16_bf16 v[96:111], v[112:115], v[36:39], 0
    ds_read_b128 v[32:35], v3 offset:16384
    ds_read_b128 v[36:39], v3 offset:20480
    s_lshl_b32 s11, s5, 7
    s_add_u32 s11, s11, 92160
    v_lshrrev_b32 v30, 5, v0
    v_lshl_add_u32 v5, v30, 6, s11
    ds_read_b128 v[14:17], v5 offset:0
    ds_read_b128 v[18:21], v5 offset:16
    ds_read_b128 v[22:25], v5 offset:32
    s_lshl_b32 s11, s6, 12
    s_lshl_b32 s73, s5, 9
    s_add_u32 s11, s11, s73
    s_add_u32 s11, s11, 81920
    v_and_b32 v31, 31, v0
    v_lshlrev_b32 v31, 3, v31
    v_lshrrev_b32 v30, 5, v0
    v_lshl_add_u32 v31, v30, 8, v31
    v_add_u32 v31, s11, v31
    s_waitcnt lgkmcnt(5)
    v_mfma_f32_32x32x16_bf16 v[80:95], v[116:119], v[40:43], v[80:95]
    s_waitcnt lgkmcnt(2)
    v_mul_f32 v48, v14, v48
    v_mul_f32 v64, v14, v64
    v_mul_f32 v49, v15, v49
    v_mul_f32 v65, v15, v65
    v_mul_f32 v50, v16, v50
    v_mul_f32 v66, v16, v66
    v_mul_f32 v51, v17, v51
    v_mul_f32 v67, v17, v67
    ds_read_b128 v[14:17], v5 offset:48
    s_waitcnt lgkmcnt(2)
    v_mul_f32 v52, v18, v52
    v_mul_f32 v68, v18, v68
    v_mul_f32 v53, v19, v53
    v_mul_f32 v69, v19, v69
    v_mfma_f32_32x32x16_bf16 v[96:111], v[116:119], v[44:47], v[96:111]
    ds_read_b128 v[40:43], v4 offset:16384
    ds_read_b128 v[44:47], v4 offset:20480
    v_mul_f32 v54, v20, v54
    v_mul_f32 v70, v20, v70
    v_mul_f32 v55, v21, v55
    v_mul_f32 v71, v21, v71
    s_waitcnt lgkmcnt(3)
    v_mul_f32 v56, v22, v56
    v_mul_f32 v72, v22, v72
    v_mul_f32 v57, v23, v57
    v_mul_f32 v73, v23, v73
    v_mul_f32 v58, v24, v58
    v_mul_f32 v74, v24, v74
    v_mul_f32 v59, v25, v59
    v_mul_f32 v75, v25, v75
    s_waitcnt lgkmcnt(2)
    v_mul_f32 v60, v14, v60
    v_mul_f32 v76, v14, v76
    v_mul_f32 v61, v15, v61
    v_mfma_f32_32x32x16_bf16 v[80:95], v[120:123], v[32:35], v[80:95]
    v_mul_f32 v77, v15, v77
    v_mul_f32 v62, v16, v62
    v_mul_f32 v78, v16, v78
    v_mul_f32 v63, v17, v63
    v_mul_f32 v79, v17, v79
    v_fma_f32 v28, v8, v48, v49
    v_fma_f32 v29, v8, v64, v65
    v_fma_f32 v28, -v9, v64, v28
    v_fma_f32 v29, v9, v48, v29
    v_fma_f32 v26, v8, v28, v50
    v_fma_f32 v27, v8, v29, v66
    v_fma_f32 v26, -v9, v29, v26
    v_fma_f32 v27, v9, v28, v27
    v_fma_f32 v28, v8, v26, v51
    v_fma_f32 v29, v8, v27, v67
    v_fma_f32 v28, -v9, v27, v28
    v_mfma_f32_32x32x16_bf16 v[96:111], v[120:123], v[36:39], v[96:111]
    ds_read_b128 v[32:35], v1 offset:32768
    ds_read_b128 v[36:39], v1 offset:36864
    v_fma_f32 v29, v9, v26, v29
    v_fma_f32 v26, v8, v28, v52
    v_fma_f32 v27, v8, v29, v68
    v_fma_f32 v26, -v9, v29, v26
    v_fma_f32 v27, v9, v28, v27
    v_fma_f32 v28, v8, v26, v53
    v_fma_f32 v29, v8, v27, v69
    v_fma_f32 v28, -v9, v27, v28
    v_fma_f32 v29, v9, v26, v29
    v_fma_f32 v26, v8, v28, v54
    v_fma_f32 v27, v8, v29, v70
    v_fma_f32 v26, -v9, v29, v26
    v_fma_f32 v27, v9, v28, v27
    v_fma_f32 v28, v8, v26, v55
    v_fma_f32 v29, v8, v27, v71
    v_fma_f32 v28, -v9, v27, v28
    v_fma_f32 v29, v9, v26, v29
    s_waitcnt lgkmcnt(3)
    v_mfma_f32_32x32x16_bf16 v[80:95], v[124:127], v[40:43], v[80:95]
    v_fma_f32 v26, v8, v28, v56
    v_fma_f32 v27, v8, v29, v72
    v_fma_f32 v26, -v9, v29, v26
    v_fma_f32 v27, v9, v28, v27
    v_fma_f32 v28, v8, v26, v57
    v_fma_f32 v29, v8, v27, v73
    v_fma_f32 v28, -v9, v27, v28
    v_fma_f32 v29, v9, v26, v29
    v_fma_f32 v26, v8, v28, v58
    v_fma_f32 v27, v8, v29, v74
    v_fma_f32 v26, -v9, v29, v26
    v_fma_f32 v27, v9, v28, v27
    v_fma_f32 v28, v8, v26, v59
    v_fma_f32 v29, v8, v27, v75
    v_fma_f32 v28, -v9, v27, v28
    v_fma_f32 v29, v9, v26, v29
    v_fma_f32 v26, v8, v28, v60
    s_waitcnt lgkmcnt(2)
    v_mfma_f32_32x32x16_bf16 v[96:111], v[124:127], v[44:47], v[96:111]
    ds_read_b128 v[40:43], v2 offset:32768
    ds_read_b128 v[44:47], v2 offset:36864
    v_fma_f32 v27, v8, v29, v76
    v_fma_f32 v26, -v9, v29, v26
    v_fma_f32 v27, v9, v28, v27
    v_fma_f32 v28, v8, v26, v61
    v_fma_f32 v29, v8, v27, v77
    v_fma_f32 v28, -v9, v27, v28
    v_fma_f32 v29, v9, v26, v29
    v_fma_f32 v26, v8, v28, v62
    v_fma_f32 v27, v8, v29, v78
    v_fma_f32 v26, -v9, v29, v26
    v_fma_f32 v27, v9, v28, v27
    v_fma_f32 v28, v8, v26, v63
    v_fma_f32 v29, v8, v27, v79
    v_fma_f32 v28, -v9, v27, v28
    v_fma_f32 v29, v9, v26, v29
    ds_write_b64 v31, v[28:29] offset:1792
    s_waitcnt lgkmcnt(0)
    s_waitcnt vmcnt(2)
    s_barrier
    s_add_u32 s10, s15, 147968
    s_add_u32 m0, s74, 16384
    s_nop 0
    buffer_load_dwordx4 v6, s[52:55], s10 offen lds
    s_add_u32 m0, s74, 17408
    s_nop 0
    buffer_load_dwordx4 v7, s[52:55], s10 offen lds
    v_mfma_f32_32x32x16_bf16 v[80:95], v[128:131], v[32:35], v[80:95]
    ds_read_b64 v[14:15], v31 offset:0
    ds_read_b64 v[16:17], v31 offset:256
    ds_read_b64 v[18:19], v31 offset:512
    ds_read_b64 v[20:21], v31 offset:768
    ds_read_b64 v[22:23], v31 offset:1024
    ds_read_b64 v[24:25], v31 offset:1280
    ds_read_b64 v[26:27], v31 offset:1536
    v_mul_f32 v12, v9, v9
    v_mul_f32 v5, v8, v9
    v_mfma_f32_32x32x16_bf16 v[96:111], v[128:131], v[36:39], v[96:111]
    ds_read_b128 v[32:35], v3 offset:32768
    ds_read_b128 v[36:39], v3 offset:36864
    v_fma_f32 v30, v8, v8, -v12
    v_add_f32 v5, v5, v5
    v_mul_f32 v12, v5, v5
    v_mul_f32 v5, v30, v5
    v_fma_f32 v30, v30, v30, -v12
    v_add_f32 v5, v5, v5
    v_mul_f32 v12, v5, v5
    v_mul_f32 v5, v30, v5
    v_mfma_f32_32x32x16_bf16 v[80:95], v[132:135], v[40:43], v[80:95]
    v_fma_f32 v30, v30, v30, -v12
    v_add_f32 v5, v5, v5
    v_mul_f32 v12, v5, v5
    v_mul_f32 v5, v30, v5
    v_fma_f32 v30, v30, v30, -v12
    v_add_f32 v5, v5, v5
    s_waitcnt lgkmcnt(7)
    v_fma_f32 v16, v30, v14, v16
    v_fma_f32 v17, v30, v15, v17
    v_mfma_f32_32x32x16_bf16 v[96:111], v[132:135], v[44:47], v[96:111]
    ds_read_b128 v[40:43], v4 offset:32768
    ds_read_b128 v[44:47], v4 offset:36864
    v_fma_f32 v16, -v5, v15, v16
    v_fma_f32 v17, v5, v14, v17
    s_waitcnt lgkmcnt(8)
    v_fma_f32 v18, v30, v16, v18
    v_fma_f32 v19, v30, v17, v19
    v_fma_f32 v18, -v5, v17, v18
    v_fma_f32 v19, v5, v16, v19
    s_waitcnt lgkmcnt(7)
    s_waitcnt lgkmcnt(3)
    v_mfma_f32_32x32x16_bf16 v[80:95], v[136:139], v[32:35], v[80:95]
    v_fma_f32 v20, v30, v18, v20
    v_fma_f32 v21, v30, v19, v21
    v_fma_f32 v20, -v5, v19, v20
    v_fma_f32 v21, v5, v18, v21
    v_fma_f32 v22, v30, v20, v22
    v_fma_f32 v23, v30, v21, v23
    v_fma_f32 v22, -v5, v21, v22
    v_fma_f32 v23, v5, v20, v23
    s_waitcnt lgkmcnt(2)
    v_mfma_f32_32x32x16_bf16 v[96:111], v[136:139], v[36:39], v[96:111]
    ds_read_b128 v[32:35], v1 offset:49152
    ds_read_b128 v[36:39], v1 offset:53248
    v_fma_f32 v24, v30, v22, v24
    v_fma_f32 v25, v30, v23, v25
    v_fma_f32 v24, -v5, v23, v24
    v_fma_f32 v25, v5, v22, v25
    v_fma_f32 v12, v30, v24, v26
    v_fma_f32 v13, v30, v25, v27
    s_waitcnt lgkmcnt(3)
    v_mfma_f32_32x32x16_bf16 v[80:95], v[140:143], v[40:43], v[80:95]
    v_fma_f32 v12, -v5, v25, v12
    v_fma_f32 v13, v5, v24, v13
    v_fma_f32 v28, v30, v12, v28
    v_fma_f32 v29, v30, v13, v29
    v_fma_f32 v28, -v5, v13, v28
    v_fma_f32 v29, v5, v12, v29
    s_mul_i32 s11, s7, 4608
    s_add_u32 s73, s78, s6
    s_lshl_b32 s73, s73, 8
    s_waitcnt lgkmcnt(2)
    v_mfma_f32_32x32x16_bf16 v[96:111], v[140:143], v[44:47], v[96:111]
    ds_read_b128 v[40:43], v2 offset:49152
    ds_read_b128 v[44:47], v2 offset:53248
    s_add_u32 s11, s11, s73
    s_add_u32 s11, s11, 256
    s_cmp_eq_u32 s5, 3
    s_cselect_b32 s11, s11, 0x100000
    v_lshlrev_b32 v30, 3, v0
    v_add_u32 v30, s11, v30
    v_mov_b32 v5, 0x100000
    v_cndmask_b32 v30, v5, v30, s[96:97]
    s_waitcnt vmcnt(2)
    s_barrier
    buffer_store_dwordx2 v[28:29], v30, s[48:51], 0 offen sc1
    s_add_u32 s10, s15, 148096
    s_add_u32 m0, s74, 32768
    s_nop 0
    buffer_load_dwordx4 v6, s[52:55], s10 offen lds
    s_add_u32 m0, s74, 33792
    s_nop 0
    buffer_load_dwordx4 v7, s[52:55], s10 offen lds
    s_waitcnt lgkmcnt(3)
    v_mfma_f32_32x32x16_bf16 v[80:95], v[144:147], v[32:35], v[80:95]
    s_waitcnt lgkmcnt(2)
    v_mfma_f32_32x32x16_bf16 v[96:111], v[144:147], v[36:39], v[96:111]
    ds_read_b128 v[32:35], v3 offset:49152
    ds_read_b128 v[36:39], v3 offset:53248
    s_waitcnt lgkmcnt(3)
    v_mfma_f32_32x32x16_bf16 v[80:95], v[148:151], v[40:43], v[80:95]
    s_waitcnt lgkmcnt(2)
    v_mfma_f32_32x32x16_bf16 v[96:111], v[148:151], v[44:47], v[96:111]
    ds_read_b128 v[40:43], v4 offset:49152
    ds_read_b128 v[44:47], v4 offset:53248
    s_waitcnt lgkmcnt(3)
    v_mfma_f32_32x32x16_bf16 v[80:95], v[152:155], v[32:35], v[80:95]
    s_waitcnt lgkmcnt(2)
    v_mfma_f32_32x32x16_bf16 v[96:111], v[152:155], v[36:39], v[96:111]
    ds_read_b128 v[32:35], v1 offset:0
    ds_read_b128 v[36:39], v1 offset:4096
    s_waitcnt lgkmcnt(3)
    v_mfma_f32_32x32x16_bf16 v[80:95], v[156:159], v[40:43], v[80:95]
    s_waitcnt lgkmcnt(2)
    v_mfma_f32_32x32x16_bf16 v[96:111], v[156:159], v[44:47], v[96:111]
    ds_read_b128 v[40:43], v2 offset:0
    ds_read_b128 v[44:47], v2 offset:4096
    s_waitcnt vmcnt(3)
    s_barrier
    s_add_u32 s10, s15, 148224
    s_add_u32 m0, s74, 49152
    s_nop 0
    buffer_load_dwordx4 v6, s[52:55], s10 offen lds
    s_add_u32 m0, s74, 50176
    s_nop 0
    buffer_load_dwordx4 v7, s[52:55], s10 offen lds
    s_waitcnt lgkmcnt(3)
    v_mfma_f32_32x32x16_bf16 v[80:95], v[160:163], v[32:35], v[80:95]
    s_waitcnt lgkmcnt(2)
    v_mfma_f32_32x32x16_bf16 v[96:111], v[160:163], v[36:39], v[96:111]
    ds_read_b128 v[32:35], v3 offset:0
    ds_read_b128 v[36:39], v3 offset:4096
    s_waitcnt lgkmcnt(3)
    v_mfma_f32_32x32x16_bf16 v[80:95], v[164:167], v[40:43], v[80:95]
    s_waitcnt lgkmcnt(2)
    v_mfma_f32_32x32x16_bf16 v[96:111], v[164:167], v[44:47], v[96:111]
    ds_read_b128 v[40:43], v4 offset:0
    ds_read_b128 v[44:47], v4 offset:4096
    s_waitcnt lgkmcnt(3)
    v_mfma_f32_32x32x16_bf16 v[80:95], v[168:171], v[32:35], v[80:95]
    s_waitcnt lgkmcnt(2)
    v_mfma_f32_32x32x16_bf16 v[96:111], v[168:171], v[36:39], v[96:111]
    ds_read_b128 v[32:35], v1 offset:16384
    ds_read_b128 v[36:39], v1 offset:20480
    s_waitcnt lgkmcnt(3)
    v_mfma_f32_32x32x16_bf16 v[80:95], v[172:175], v[40:43], v[80:95]
    s_waitcnt lgkmcnt(2)
    v_mfma_f32_32x32x16_bf16 v[96:111], v[172:175], v[44:47], v[96:111]
    ds_read_b128 v[40:43], v2 offset:16384
    ds_read_b128 v[44:47], v2 offset:20480
    s_waitcnt vmcnt(2)
    s_barrier
    s_lshl_b32 s11, s8, 4
    s_add_u32 s11, s11, s7
    s_lshl_b32 s11, s11, 2
    s_cmp_eq_u32 s4, 3
    s_cselect_b32 s11, s11, 0x1000
    s_cmp_eq_u32 s7, 15
    s_cselect_b32 s11, 0x1000, s11
    v_lshlrev_b32 v30, 12, v0
    v_add_u32 v30, s11, v30
    v_mov_b32 v31, 2
    buffer_store_dword v31, v30, s[68:71], 0 offen sc1
    s_add_u32 s10, s15, 148352
    s_add_u32 m0, s74, 0
    s_nop 0
    buffer_load_dwordx4 v6, s[52:55], s10 offen lds
    s_add_u32 m0, s74, 1024
    s_nop 0
    buffer_load_dwordx4 v7, s[52:55], s10 offen lds
    s_waitcnt lgkmcnt(3)
    v_mfma_f32_32x32x16_bf16 v[80:95], v[176:179], v[32:35], v[80:95]
    s_waitcnt lgkmcnt(2)
    v_mfma_f32_32x32x16_bf16 v[96:111], v[176:179], v[36:39], v[96:111]
    ds_read_b128 v[32:35], v3 offset:16384
    ds_read_b128 v[36:39], v3 offset:20480
    s_waitcnt lgkmcnt(3)
    v_mfma_f32_32x32x16_bf16 v[80:95], v[180:183], v[40:43], v[80:95]
    s_waitcnt lgkmcnt(2)
    v_mfma_f32_32x32x16_bf16 v[96:111], v[180:183], v[44:47], v[96:111]
    ds_read_b128 v[40:43], v4 offset:16384
    ds_read_b128 v[44:47], v4 offset:20480
    s_waitcnt lgkmcnt(3)
    v_mfma_f32_32x32x16_bf16 v[80:95], v[184:187], v[32:35], v[80:95]
    s_waitcnt lgkmcnt(2)
    v_mfma_f32_32x32x16_bf16 v[96:111], v[184:187], v[36:39], v[96:111]
    ds_read_b128 v[32:35], v1 offset:32768
    ds_read_b128 v[36:39], v1 offset:36864
    s_waitcnt lgkmcnt(3)
    v_mfma_f32_32x32x16_bf16 v[80:95], v[188:191], v[40:43], v[80:95]
    s_waitcnt lgkmcnt(2)
    v_mfma_f32_32x32x16_bf16 v[96:111], v[188:191], v[44:47], v[96:111]
    ds_read_b128 v[40:43], v2 offset:32768
    ds_read_b128 v[44:47], v2 offset:36864
    s_waitcnt vmcnt(3)
    s_barrier
    s_add_u32 s10, s15, 148480
    s_add_u32 m0, s74, 16384
    s_nop 0
    buffer_load_dwordx4 v6, s[52:55], s10 offen lds
    s_add_u32 m0, s74, 17408
    s_nop 0
    buffer_load_dwordx4 v7, s[52:55], s10 offen lds
    s_waitcnt lgkmcnt(3)
    v_mfma_f32_32x32x16_bf16 v[80:95], v[192:195], v[32:35], v[80:95]
    s_waitcnt lgkmcnt(2)
    v_mfma_f32_32x32x16_bf16 v[96:111], v[192:195], v[36:39], v[96:111]
    ds_read_b128 v[32:35], v3 offset:32768
    ds_read_b128 v[36:39], v3 offset:36864
    s_waitcnt lgkmcnt(3)
    v_mfma_f32_32x32x16_bf16 v[80:95], v[196:199], v[40:43], v[80:95]
    s_waitcnt lgkmcnt(2)
    v_mfma_f32_32x32x16_bf16 v[96:111], v[196:199], v[44:47], v[96:111]
    ds_read_b128 v[40:43], v4 offset:32768
    ds_read_b128 v[44:47], v4 offset:36864
    s_waitcnt lgkmcnt(3)
    v_mfma_f32_32x32x16_bf16 v[80:95], v[200:203], v[32:35], v[80:95]
    s_waitcnt lgkmcnt(2)
    v_mfma_f32_32x32x16_bf16 v[96:111], v[200:203], v[36:39], v[96:111]
    ds_read_b128 v[32:35], v1 offset:49152
    ds_read_b128 v[36:39], v1 offset:53248
    s_waitcnt lgkmcnt(3)
    v_mfma_f32_32x32x16_bf16 v[80:95], v[204:207], v[40:43], v[80:95]
    s_waitcnt lgkmcnt(2)
    v_mfma_f32_32x32x16_bf16 v[96:111], v[204:207], v[44:47], v[96:111]
    ds_read_b128 v[40:43], v2 offset:49152
    ds_read_b128 v[44:47], v2 offset:53248
    s_lshl_b32 s11, s5, 4
    v_lshrrev_b32 v6, 2, v0
    v_add_u32 v6, s11, v6
    v_mul_u32_u24 v6, 0x480, v6
    v_lshrrev_b32 v7, 4, v0
    v_xor_b32 v7, v7, v0
    v_and_b32 v7, 3, v7
    v_lshl_add_u32 v6, v7, 4, v6
    s_waitcnt vmcnt(2)
    s_barrier
    v_and_b32 v31, 15, v0
    s_lshl_b32 s11, s8, 6
    v_lshlrev_b32 v31, 2, v31
    v_add_u32 v31, s11, v31
    buffer_load_dword v30, v31, s[68:71], 0 offen sc1
    s_add_u32 m0, s9, 32768
    s_add_u32 s10, s72, 0
    buffer_load_dwordx4 v6, s[56:59], s10 offen lds
    s_add_u32 m0, s9, 40960
    s_add_u32 s10, s72, 73728
    buffer_load_dwordx4 v6, s[56:59], s10 offen lds
    s_waitcnt lgkmcnt(3)
    v_mfma_f32_32x32x16_bf16 v[80:95], v[208:211], v[32:35], v[80:95]
    s_waitcnt lgkmcnt(2)
    v_mfma_f32_32x32x16_bf16 v[96:111], v[208:211], v[36:39], v[96:111]
    ds_read_b128 v[32:35], v3 offset:49152
    ds_read_b128 v[36:39], v3 offset:53248
    s_waitcnt lgkmcnt(3)
    v_mfma_f32_32x32x16_bf16 v[80:95], v[212:215], v[40:43], v[80:95]
    s_waitcnt lgkmcnt(2)
    v_mfma_f32_32x32x16_bf16 v[96:111], v[212:215], v[44:47], v[96:111]
    ds_read_b128 v[40:43], v4 offset:49152
    ds_read_b128 v[44:47], v4 offset:53248
    s_waitcnt lgkmcnt(3)
    v_mfma_f32_32x32x16_bf16 v[80:95], v[216:219], v[32:35], v[80:95]
    s_waitcnt lgkmcnt(2)
    v_mfma_f32_32x32x16_bf16 v[96:111], v[216:219], v[36:39], v[96:111]
    ds_read_b128 v[32:35], v1 offset:0
    ds_read_b128 v[36:39], v1 offset:4096
    s_waitcnt lgkmcnt(3)
    v_mfma_f32_32x32x16_bf16 v[80:95], v[220:223], v[40:43], v[80:95]
    s_waitcnt lgkmcnt(2)
    v_mfma_f32_32x32x16_bf16 v[96:111], v[220:223], v[44:47], v[96:111]
    ds_read_b128 v[40:43], v2 offset:0
    ds_read_b128 v[44:47], v2 offset:4096
    s_waitcnt vmcnt(3)
    s_barrier
    s_waitcnt vmcnt(2)
    v_cmp_gt_u32 vcc, 2, v30
    s_and_b64 vcc, vcc, s[94:95]
    s_cbranch_scc0 .pok_12
    s_mov_b32 s83, 65536
.plp_13:
    buffer_load_dword v30, v31, s[68:71], 0 offen sc1
    s_waitcnt vmcnt(0)
    v_cmp_gt_u32 vcc, 2, v30
    s_and_b64 vcc, vcc, s[94:95]
    s_cbranch_scc0 .pok_12
    s_sub_u32 s83, s83, 1
    s_cmp_lg_u32 s83, 0
    s_cbranch_scc1 .plp_13
.pok_12:
    s_sub_u32 s11, s7, 1
    s_mul_i32 s11, s11, 4608
    s_add_u32 s73, s78, s6
    s_lshl_b32 s73, s73, 8
    s_add_u32 s11, s11, s73
    s_add_u32 s11, s11, 512
    v_and_b32 v30, 31, v0
    v_lshlrev_b32 v30, 3, v30
    v_lshrrev_b32 v31, 5, v0
    v_mul_u32_u24 v31, 4608, v31
    v_sub_u32 v30, v30, v31
    v_add_u32 v30, s11, v30
    v_subrev_u32 v28, 64512, v30
    buffer_load_dwordx2 v[28:29], v28, s[48:51], 0 offen sc1
    v_subrev_u32 v26, 55296, v30
    buffer_load_dwordx2 v[26:27], v26, s[48:51], 0 offen sc1
    v_subrev_u32 v24, 46080, v30
    buffer_load_dwordx2 v[24:25], v24, s[48:51], 0 offen sc1
    v_subrev_u32 v22, 36864, v30
    buffer_load_dwordx2 v[22:23], v22, s[48:51], 0 offen sc1
    v_subrev_u32 v20, 27648, v30
    buffer_load_dwordx2 v[20:21], v20, s[48:51], 0 offen sc1
    v_subrev_u32 v18, 18432, v30
    buffer_load_dwordx2 v[18:19], v18, s[48:51], 0 offen sc1
    v_subrev_u32 v16, 9216, v30
    buffer_load_dwordx2 v[16:17], v16, s[48:51], 0 offen sc1
    v_subrev_u32 v14, 0, v30
    buffer_load_dwordx2 v[14:15], v14, s[48:51], 0 offen sc1
    s_add_u32 m0, s9, 49152
    s_add_u32 s10, s72, 147456
    buffer_load_dwordx4 v6, s[56:59], s10 offen lds
    s_add_u32 m0, s9, 57344
    s_add_u32 s10, s72, 221184
    buffer_load_dwordx4 v6, s[56:59], s10 offen lds
    s_waitcnt lgkmcnt(3)
    v_mfma_f32_32x32x16_bf16 v[80:95], v[224:227], v[32:35], v[80:95]
    v_mul_f32 v5, v9, v9
    v_mul_f32 v31, v8, v9
    v_fma_f32 v30, v8, v8, -v5
    v_add_f32 v31, v31, v31
    v_mul_f32 v5, v31, v31
    s_waitcnt lgkmcnt(2)
    v_mfma_f32_32x32x16_bf16 v[96:111], v[224:227], v[36:39], v[96:111]
    ds_read_b128 v[32:35], v3 offset:0
    ds_read_b128 v[36:39], v3 offset:4096
    v_mul_f32 v31, v30, v31
    v_fma_f32 v30, v30, v30, -v5
    v_add_f32 v31, v31, v31
    v_mul_f32 v5, v31, v31
    v_mul_f32 v31, v30, v31
    s_waitcnt lgkmcnt(3)
    v_mfma_f32_32x32x16_bf16 v[80:95], v[228:231], v[40:43], v[80:95]
    v_fma_f32 v30, v30, v30, -v5
    v_add_f32 v31, v31, v31
    v_mul_f32 v5, v31, v31
    v_mul_f32 v31, v30, v31
    s_waitcnt lgkmcnt(2)
    v_mfma_f32_32x32x16_bf16 v[96:111], v[228:231], v[44:47], v[96:111]
    ds_read_b128 v[40:43], v4 offset:0
    ds_read_b128 v[44:47], v4 offset:4096
    v_fma_f32 v30, v30, v30, -v5
    v_add_f32 v31, v31, v31
    v_mul_f32 v5, v31, v31
    v_mul_f32 v31, v30, v31
    v_fma_f32 v30, v30, v30, -v5
    s_waitcnt lgkmcnt(3)
    v_mfma_f32_32x32x16_bf16 v[80:95], v[232:235], v[32:35], v[80:95]
    v_add_f32 v31, v31, v31
    v_mul_f32 v5, v31, v31
    v_mul_f32 v31, v30, v31
    v_fma_f32 v30, v30, v30, -v5
    s_waitcnt lgkmcnt(2)
    v_mfma_f32_32x32x16_bf16 v[96:111], v[232:235], v[36:39], v[96:111]
    ds_read_b128 v[32:35], v1 offset:16384
    ds_read_b128 v[36:39], v1 offset:20480
    v_add_f32 v31, v31, v31
    v_mul_f32 v5, v31, v31
    v_mul_f32 v31, v30, v31
    v_fma_f32 v30, v30, v30, -v5
    v_add_f32 v31, v31, v31
    s_waitcnt lgkmcnt(3)
    v_mfma_f32_32x32x16_bf16 v[80:95], v[236:239], v[40:43], v[80:95]
    v_mul_f32 v5, v31, v31
    v_mul_f32 v31, v30, v31
    v_fma_f32 v30, v30, v30, -v5
    v_add_f32 v31, v31, v31
    s_waitcnt lgkmcnt(2)
    v_mfma_f32_32x32x16_bf16 v[96:111], v[236:239], v[44:47], v[96:111]
    ds_read_b128 v[40:43], v2 offset:16384
    ds_read_b128 v[44:47], v2 offset:20480
    s_waitcnt vmcnt(10)
    s_barrier
    s_lshl_b32 s11, s6, 11
    s_add_u32 s11, s11, 98304
    v_bfe_u32 v1, v0, 2, 2
    v_lshrrev_b32 v2, 5, v0
    v_xor_b32 v1, v1, v2
    v_and_b32 v2, 31, v0
    v_lshlrev_b32 v2, 6, v2
    v_add_u32 v2, s11, v2
    v_lshl_add_u32 v1, v1, 4, v2
    v_xor_b32 v2, 32, v1
    s_add_u32 m0, s9, 0
    s_add_u32 s10, s72, 294912
    buffer_load_dwordx4 v6, s[56:59], s10 offen lds
    s_add_u32 m0, s9, 8192
    s_add_u32 s10, s72, 368640
    buffer_load_dwordx4 v6, s[56:59], s10 offen lds
    s_waitcnt lgkmcnt(3)
    v_mfma_f32_32x32x16_bf16 v[80:95], v[240:243], v[32:35], v[80:95]
    s_waitcnt vmcnt(10)
    v_fma_f32 v26, v30, v28, v26
    v_fma_f32 v27, v30, v29, v27
    v_fma_f32 v26, -v31, v29, v26
    v_fma_f32 v27, v31, v28, v27
    s_waitcnt vmcnt(9)
    v_fma_f32 v24, v30, v26, v24
    v_fma_f32 v25, v30, v27, v25
    v_fma_f32 v24, -v31, v27, v24
    v_fma_f32 v25, v31, v26, v25
    s_waitcnt vmcnt(8)
    v_fma_f32 v22, v30, v24, v22
    v_fma_f32 v23, v30, v25, v23
    v_fma_f32 v22, -v31, v25, v22
    v_fma_f32 v23, v31, v24, v23
    s_waitcnt vmcnt(7)
    v_fma_f32 v20, v30, v22, v20
    v_fma_f32 v21, v30, v23, v21
    v_fma_f32 v20, -v31, v23, v20
    v_fma_f32 v21, v31, v22, v21
    s_waitcnt vmcnt(6)
    v_fma_f32 v18, v30, v20, v18
    v_fma_f32 v19, v30, v21, v19
    v_fma_f32 v18, -v31, v21, v18
    v_fma_f32 v19, v31, v20, v19
    s_waitcnt vmcnt(5)
    v_fma_f32 v16, v30, v18, v16
    v_fma_f32 v17, v30, v19, v17
    v_fma_f32 v16, -v31, v19, v16
    v_fma_f32 v17, v31, v18, v17
    s_waitcnt vmcnt(4)
    v_fma_f32 v14, v30, v16, v14
    v_fma_f32 v15, v30, v17, v15
    s_waitcnt lgkmcnt(2)
    v_mfma_f32_32x32x16_bf16 v[96:111], v[240:243], v[36:39], v[96:111]
    ds_read_b128 v[32:35], v3 offset:16384
    ds_read_b128 v[36:39], v3 offset:20480
    v_fma_f32 v14, -v31, v17, v14
    v_fma_f32 v15, v31, v16, v15
    v_mul_f32 v5, v9, v9
    v_mul_f32 v17, v8, v9
    v_fma_f32 v16, v8, v8, -v5
    v_add_f32 v17, v17, v17
    v_mul_f32 v5, v17, v17
    v_mul_f32 v17, v16, v17
    v_fma_f32 v16, v16, v16, -v5
    v_add_f32 v17, v17, v17
    v_mul_f32 v5, v17, v17
    v_mul_f32 v17, v16, v17
    v_fma_f32 v16, v16, v16, -v5
    v_add_f32 v17, v17, v17
    v_mul_f32 v5, v17, v17
    v_mul_f32 v17, v16, v17
    v_fma_f32 v16, v16, v16, -v5
    v_add_f32 v17, v17, v17
    v_mul_f32 v5, v17, v17
    v_mul_f32 v19, v16, v17
    v_fma_f32 v18, v16, v16, -v5
    v_add_f32 v19, v19, v19
    v_mul_f32 v5, v19, v19
    v_mul_f32 v21, v18, v19
    v_fma_f32 v20, v18, v18, -v5
    v_add_f32 v21, v21, v21
    v_mul_f32 v5, v21, v21
    v_mul_f32 v23, v20, v21
    v_fma_f32 v22, v20, v20, -v5
    v_add_f32 v23, v23, v23
    v_mul_f32 v24, v22, v14
    v_mul_f32 v25, v22, v15
    s_waitcnt lgkmcnt(3)
    v_mfma_f32_32x32x16_bf16 v[80:95], v[244:247], v[40:43], v[80:95]
    v_fma_f32 v24, -v23, v15, v24
    v_fma_f32 v25, v23, v14, v25
    v_cndmask_b32 v14, v14, v24, s[96:97]
    v_cndmask_b32 v15, v15, v25, s[96:97]
    v_mov_b32 v24, v14
    v_mov_b32 v25, v15
    v_cndmask_b32 v16, 1.0, v16, s[96:97]
    v_cndmask_b32 v17, 0, v17, s[96:97]
    v_permlane32_swap_b32 v14, v24
    v_permlane32_swap_b32 v15, v25
    v_cndmask_b32 v18, 1.0, v18, s[98:99]
    v_cndmask_b32 v19, 0, v19, s[98:99]
    v_cndmask_b32 v20, 1.0, v20, s[100:101]
    v_cndmask_b32 v21, 0, v21, s[100:101]
    v_add_f32 v14, v14, v24
    v_add_f32 v15, v15, v25
    v_mul_f32 v22, v16, v18
    v_mul_f32 v23, v16, v19
    v_fma_f32 v22, -v17, v19, v22
    v_fma_f32 v23, v17, v18, v23
    v_mul_f32 v16, v22, v20
    v_mul_f32 v17, v22, v21
    v_fma_f32 v16, -v23, v21, v16
    v_fma_f32 v17, v23, v20, v17
    v_fma_f32 v12, v16, v14, v12
    v_fma_f32 v13, v16, v15, v13
    v_fma_f32 v12, -v17, v15, v12
    v_fma_f32 v13, v17, v14, v13
    v_and_b32 v30, 3, v0
    v_xor_b32 v30, s5, v30
    v_lshlrev_b32 v30, 6, v30
    v_and_b32 v31, 31, v0
    s_waitcnt lgkmcnt(2)
    v_mfma_f32_32x32x16_bf16 v[96:111], v[244:247], v[44:47], v[96:111]
    ds_read_b128 v[40:43], v4 offset:16384
    ds_read_b128 v[44:47], v4 offset:20480
    v_lshl_add_u32 v30, v31, 8, v30
    v_lshrrev_b32 v31, 5, v0
    v_lshl_add_u32 v30, v31, 5, v30
    s_lshl_b32 s11, s6, 14
    s_add_u32 s11, s11, 32768
    v_add_u32 v31, s11, v30
    v_fma_f32 v48, v8, v12, v48
    v_fma_f32 v64, v8, v13, v64
    v_fma_f32 v48, -v9, v13, v48
    v_fma_f32 v64, v9, v12, v64
    v_mul_f32 v30, v10, v48
    v_mul_f32 v5, -v10, v64
    v_fma_f32 v30, -v11, v64, v30
    v_fma_f32 v5, -v11, v48, v5
    v_fma_f32 v49, v8, v48, v49
    v_fma_f32 v65, v8, v64, v65
    v_fma_f32 v49, -v9, v64, v49
    v_fma_f32 v65, v9, v48, v65
    v_mul_f32 v12, v10, v49
    v_mul_f32 v13, -v10, v65
    v_fma_f32 v12, -v11, v65, v12
    v_fma_f32 v13, -v11, v49, v13
    v_cvt_pk_bf16_f32 v14, v30, v12
    v_cvt_pk_bf16_f32 v18, v5, v13
    v_fma_f32 v50, v8, v49, v50
    v_fma_f32 v66, v8, v65, v66
    v_fma_f32 v50, -v9, v65, v50
    v_fma_f32 v66, v9, v49, v66
    v_mul_f32 v30, v10, v50
    v_mul_f32 v5, -v10, v66
    v_fma_f32 v30, -v11, v66, v30
    v_fma_f32 v5, -v11, v50, v5
    s_waitcnt lgkmcnt(3)
    v_mfma_f32_32x32x16_bf16 v[80:95], v[248:251], v[32:35], v[80:95]
    v_fma_f32 v51, v8, v50, v51
    v_fma_f32 v67, v8, v66, v67
    v_fma_f32 v51, -v9, v66, v51
    v_fma_f32 v67, v9, v50, v67
    v_mul_f32 v12, v10, v51
    v_mul_f32 v13, -v10, v67
    v_fma_f32 v12, -v11, v67, v12
    v_fma_f32 v13, -v11, v51, v13
    v_cvt_pk_bf16_f32 v15, v30, v12
    v_cvt_pk_bf16_f32 v19, v5, v13
    v_fma_f32 v52, v8, v51, v52
    v_fma_f32 v68, v8, v67, v68
    v_fma_f32 v52, -v9, v67, v52
    v_fma_f32 v68, v9, v51, v68
    v_mul_f32 v30, v10, v52
    v_mul_f32 v5, -v10, v68
    v_fma_f32 v30, -v11, v68, v30
    v_fma_f32 v5, -v11, v52, v5
    v_fma_f32 v53, v8, v52, v53
    v_fma_f32 v69, v8, v68, v69
    v_fma_f32 v53, -v9, v68, v53
    v_fma_f32 v69, v9, v52, v69
    v_mul_f32 v12, v10, v53
    v_mul_f32 v13, -v10, v69
    v_fma_f32 v12, -v11, v69, v12
    v_fma_f32 v13, -v11, v53, v13
    v_cvt_pk_bf16_f32 v16, v30, v12
    v_cvt_pk_bf16_f32 v20, v5, v13
    v_fma_f32 v54, v8, v53, v54
    v_fma_f32 v70, v8, v69, v70
    v_fma_f32 v54, -v9, v69, v54
    v_fma_f32 v70, v9, v53, v70
    s_waitcnt lgkmcnt(2)
    v_mfma_f32_32x32x16_bf16 v[96:111], v[248:251], v[36:39], v[96:111]
    ds_read_b128 v[32:35], v1 offset:32768
    ds_read_b128 v[36:39], v2 offset:32768
    v_mul_f32 v30, v10, v54
    v_mul_f32 v5, -v10, v70
    v_fma_f32 v30, -v11, v70, v30
    v_fma_f32 v5, -v11, v54, v5
    v_fma_f32 v55, v8, v54, v55
    v_fma_f32 v71, v8, v70, v71
    v_fma_f32 v55, -v9, v70, v55
    v_fma_f32 v71, v9, v54, v71
    v_mul_f32 v12, v10, v55
    v_mul_f32 v13, -v10, v71
    v_fma_f32 v12, -v11, v71, v12
    v_fma_f32 v13, -v11, v55, v13
    v_cvt_pk_bf16_f32 v17, v30, v12
    v_cvt_pk_bf16_f32 v21, v5, v13
    ds_write_b128 v31, v[14:17] offset:0
    ds_write_b128 v31, v[18:21] offset:8192
    v_fma_f32 v56, v8, v55, v56
    v_fma_f32 v72, v8, v71, v72
    v_fma_f32 v56, -v9, v71, v56
    v_fma_f32 v72, v9, v55, v72
    v_mul_f32 v30, v10, v56
    v_mul_f32 v5, -v10, v72
    v_fma_f32 v30, -v11, v72, v30
    v_fma_f32 v5, -v11, v56, v5
    v_fma_f32 v57, v8, v56, v57
    v_fma_f32 v73, v8, v72, v73
    v_fma_f32 v57, -v9, v72, v57
    v_fma_f32 v73, v9, v56, v73
    v_mul_f32 v12, v10, v57
    v_mul_f32 v13, -v10, v73
    v_fma_f32 v12, -v11, v73, v12
    v_fma_f32 v13, -v11, v57, v13
    s_waitcnt lgkmcnt(5)
    v_mfma_f32_32x32x16_bf16 v[80:95], v[252:255], v[40:43], v[80:95]
    v_cvt_pk_bf16_f32 v22, v30, v12
    v_cvt_pk_bf16_f32 v26, v5, v13
    v_fma_f32 v58, v8, v57, v58
    v_fma_f32 v74, v8, v73, v74
    v_fma_f32 v58, -v9, v73, v58
    v_fma_f32 v74, v9, v57, v74
    v_mul_f32 v30, v10, v58
    v_mul_f32 v5, -v10, v74
    v_fma_f32 v30, -v11, v74, v30
    v_fma_f32 v5, -v11, v58, v5
    v_fma_f32 v59, v8, v58, v59
    v_fma_f32 v75, v8, v74, v75
    v_fma_f32 v59, -v9, v74, v59
    v_fma_f32 v75, v9, v58, v75
    v_mul_f32 v12, v10, v59
    v_mul_f32 v13, -v10, v75
    v_fma_f32 v12, -v11, v75, v12
    v_fma_f32 v13, -v11, v59, v13
    v_cvt_pk_bf16_f32 v23, v30, v12
    v_cvt_pk_bf16_f32 v27, v5, v13
    v_fma_f32 v60, v8, v59, v60
    v_fma_f32 v76, v8, v75, v76
    v_fma_f32 v60, -v9, v75, v60
    v_fma_f32 v76, v9, v59, v76
    v_mul_f32 v30, v10, v60
    v_mul_f32 v5, -v10, v76
    v_fma_f32 v30, -v11, v76, v30
    v_fma_f32 v5, -v11, v60, v5
    v_fma_f32 v61, v8, v60, v61
    v_fma_f32 v77, v8, v76, v77
    v_fma_f32 v61, -v9, v76, v61
    v_fma_f32 v77, v9, v60, v77
    s_waitcnt lgkmcnt(4)
    v_mfma_f32_32x32x16_bf16 v[96:111], v[252:255], v[44:47], v[96:111]
    ds_read_b128 v[40:43], v1 offset:36864
    ds_read_b128 v[44:47], v2 offset:36864
    v_mul_f32 v12, v10, v61
    v_mul_f32 v13, -v10, v77
    v_fma_f32 v12, -v11, v77, v12
    v_fma_f32 v13, -v11, v61, v13
    v_cvt_pk_bf16_f32 v24, v30, v12
    v_cvt_pk_bf16_f32 v28, v5, v13
    v_fma_f32 v62, v8, v61, v62
    v_fma_f32 v78, v8, v77, v78
    v_fma_f32 v62, -v9, v77, v62
    v_fma_f32 v78, v9, v61, v78
    v_mul_f32 v30, v10, v62
    v_mul_f32 v5, -v10, v78
    v_fma_f32 v30, -v11, v78, v30
    v_fma_f32 v5, -v11, v62, v5
    v_fma_f32 v63, v8, v62, v63
    v_fma_f32 v79, v8, v78, v79
    v_fma_f32 v63, -v9, v78, v63
    v_fma_f32 v79, v9, v62, v79
    v_mul_f32 v12, v10, v63
    v_mul_f32 v13, -v10, v79
    v_fma_f32 v12, -v11, v79, v12
    v_fma_f32 v13, -v11, v63, v13
    v_cvt_pk_bf16_f32 v25, v30, v12
    v_cvt_pk_bf16_f32 v29, v5, v13
    ds_write_b128 v31, v[22:25] offset:16
    ds_write_b128 v31, v[26:29] offset:8208
    s_lshl_b32 s11, s6, 9
    s_add_u32 s11, s11, 90112
    v_and_b32 v30, 31, v0
    v_lshlrev_b32 v30, 4, v30
    v_add_u32 v30, s11, v30
    ds_read_b128 v[8:11], v30 offset:1024
    s_waitcnt lgkmcnt(1)
    s_waitcnt vmcnt(2)
    s_barrier
    v_bfe_u32 v4, v0, 2, 2
    v_xor_b32 v3, s5, v4
    v_lshlrev_b32 v3, 6, v3
    v_lshl_add_u32 v3, v4, 8, v3
    v_lshrrev_b32 v4, 5, v0
    v_lshl_add_u32 v3, v4, 11, v3
    v_bfe_u32 v4, v0, 4, 1
    v_lshl_add_u32 v3, v4, 5, v3
    v_and_b32 v4, 3, v0
    v_lshl_add_u32 v3, v4, 3, v3
    v_add_u32 v4, 0x10000, v3
    ds_read_b64_tr_b16 v[48:49], v3 offset:0
    ds_read_b64_tr_b16 v[50:51], v3 offset:1024
    ds_read_b64_tr_b16 v[52:53], v3 offset:4096
    ds_read_b64_tr_b16 v[54:55], v3 offset:5120
    ds_read_b64_tr_b16 v[56:57], v3 offset:8192
    ds_read_b64_tr_b16 v[58:59], v3 offset:9216
    ds_read_b64_tr_b16 v[60:61], v3 offset:12288
    ds_read_b64_tr_b16 v[62:63], v3 offset:13312
    s_add_u32 m0, s9, 16384
    s_add_u32 s10, s72, 442368
    buffer_load_dwordx4 v6, s[56:59], s10 offen lds
    s_add_u32 m0, s9, 24576
    s_add_u32 s10, s72, 516096
    buffer_load_dwordx4 v6, s[56:59], s10 offen lds
    s_waitcnt lgkmcnt(6)
    v_mfma_f32_32x32x16_bf16 v[112:127], v[32:35], v[48:51], 0
    ds_read_b128 v[32:35], v1 offset:40960
    s_waitcnt lgkmcnt(5)
    v_mfma_f32_32x32x16_bf16 v[112:127], v[36:39], v[52:55], v[112:127]
    ds_read_b128 v[36:39], v2 offset:40960
    s_lshl_b32 s11, s5, 7
    s_add_u32 s11, s11, 92160
    v_lshrrev_b32 v30, 5, v0
    v_lshl_add_u32 v5, v30, 6, s11
    ds_read_b128 v[14:17], v5 offset:0
    ds_read_b128 v[18:21], v5 offset:16
    ds_read_b128 v[22:25], v5 offset:32
    s_lshl_b32 s11, s6, 12
    s_lshl_b32 s73, s5, 9
    s_add_u32 s11, s11, s73
    s_add_u32 s11, s11, 81920
    v_and_b32 v31, 31, v0
    v_lshlrev_b32 v31, 3, v31
    v_lshrrev_b32 v30, 5, v0
    v_lshl_add_u32 v31, v30, 8, v31
    v_add_u32 v31, s11, v31
    s_waitcnt lgkmcnt(7)
    v_mfma_f32_32x32x16_bf16 v[112:127], v[40:43], v[56:59], v[112:127]
    ds_read_b128 v[40:43], v1 offset:45056
    s_waitcnt lgkmcnt(3)
    v_mul_f32 v80, v14, v80
    v_mul_f32 v96, v14, v96
    v_mul_f32 v81, v15, v81
    v_mul_f32 v97, v15, v97
    v_mul_f32 v82, v16, v82
    v_mul_f32 v98, v16, v98
    v_mul_f32 v83, v17, v83
    v_mul_f32 v99, v17, v99
    ds_read_b128 v[14:17], v5 offset:48
    s_waitcnt lgkmcnt(3)
    v_mul_f32 v84, v18, v84
    v_mul_f32 v100, v18, v100
    v_mul_f32 v85, v19, v85
    v_mul_f32 v101, v19, v101
    v_mfma_f32_32x32x16_bf16 v[112:127], v[44:47], v[60:63], v[112:127]
    ds_read_b128 v[44:47], v2 offset:45056
    v_mul_f32 v86, v20, v86
    v_mul_f32 v102, v20, v102
    v_mul_f32 v87, v21, v87
    v_mul_f32 v103, v21, v103
    s_waitcnt lgkmcnt(3)
    v_mul_f32 v88, v22, v88
    v_mul_f32 v104, v22, v104
    v_mul_f32 v89, v23, v89
    v_mul_f32 v105, v23, v105
    v_mul_f32 v90, v24, v90
    v_mul_f32 v106, v24, v106
    v_mul_f32 v91, v25, v91
    v_mul_f32 v107, v25, v107
    s_waitcnt lgkmcnt(1)
    v_mul_f32 v92, v14, v92
    v_mul_f32 v108, v14, v108
    v_mul_f32 v93, v15, v93
    v_mfma_f32_32x32x16_bf16 v[128:143], v[32:35], v[48:51], 0
    ds_read_b128 v[32:35], v1 offset:49152
    v_mul_f32 v109, v15, v109
    v_mul_f32 v94, v16, v94
    v_mul_f32 v110, v16, v110
    v_mul_f32 v95, v17, v95
    v_mul_f32 v111, v17, v111
    v_fma_f32 v28, v8, v80, v81
    v_fma_f32 v29, v8, v96, v97
    v_fma_f32 v28, -v9, v96, v28
    v_fma_f32 v29, v9, v80, v29
    v_fma_f32 v26, v8, v28, v82
    v_fma_f32 v27, v8, v29, v98
    v_fma_f32 v26, -v9, v29, v26
    v_fma_f32 v27, v9, v28, v27
    v_fma_f32 v28, v8, v26, v83
    v_fma_f32 v29, v8, v27, v99
    v_fma_f32 v28, -v9, v27, v28
    v_mfma_f32_32x32x16_bf16 v[128:143], v[36:39], v[52:55], v[128:143]
    ds_read_b128 v[36:39], v2 offset:49152
    v_fma_f32 v29, v9, v26, v29
    v_fma_f32 v26, v8, v28, v84
    v_fma_f32 v27, v8, v29, v100
    v_fma_f32 v26, -v9, v29, v26
    v_fma_f32 v27, v9, v28, v27
    v_fma_f32 v28, v8, v26, v85
    v_fma_f32 v29, v8, v27, v101
    v_fma_f32 v28, -v9, v27, v28
    v_fma_f32 v29, v9, v26, v29
    v_fma_f32 v26, v8, v28, v86
    v_fma_f32 v27, v8, v29, v102
    v_fma_f32 v26, -v9, v29, v26
    v_fma_f32 v27, v9, v28, v27
    v_fma_f32 v28, v8, v26, v87
    v_fma_f32 v29, v8, v27, v103
    v_fma_f32 v28, -v9, v27, v28
    v_fma_f32 v29, v9, v26, v29
    v_mfma_f32_32x32x16_bf16 v[128:143], v[40:43], v[56:59], v[128:143]
    ds_read_b128 v[40:43], v1 offset:53248
    v_fma_f32 v26, v8, v28, v88
    v_fma_f32 v27, v8, v29, v104
    v_fma_f32 v26, -v9, v29, v26
    v_fma_f32 v27, v9, v28, v27
    v_fma_f32 v28, v8, v26, v89
    v_fma_f32 v29, v8, v27, v105
    v_fma_f32 v28, -v9, v27, v28
    v_fma_f32 v29, v9, v26, v29
    v_fma_f32 v26, v8, v28, v90
    v_fma_f32 v27, v8, v29, v106
    v_fma_f32 v26, -v9, v29, v26
    v_fma_f32 v27, v9, v28, v27
    v_fma_f32 v28, v8, v26, v91
    v_fma_f32 v29, v8, v27, v107
    v_fma_f32 v28, -v9, v27, v28
    v_fma_f32 v29, v9, v26, v29
    v_fma_f32 v26, v8, v28, v92
    s_waitcnt lgkmcnt(3)
    v_mfma_f32_32x32x16_bf16 v[128:143], v[44:47], v[60:63], v[128:143]
    ds_read_b128 v[44:47], v2 offset:53248
    v_fma_f32 v27, v8, v29, v108
    v_fma_f32 v26, -v9, v29, v26
    v_fma_f32 v27, v9, v28, v27
    v_fma_f32 v28, v8, v26, v93
    v_fma_f32 v29, v8, v27, v109
    v_fma_f32 v28, -v9, v27, v28
    v_fma_f32 v29, v9, v26, v29
    v_fma_f32 v26, v8, v28, v94
    v_fma_f32 v27, v8, v29, v110
    v_fma_f32 v26, -v9, v29, v26
    v_fma_f32 v27, v9, v28, v27
    v_fma_f32 v28, v8, v26, v95
    v_fma_f32 v29, v8, v27, v111
    v_fma_f32 v28, -v9, v27, v28
    v_fma_f32 v29, v9, v26, v29
    ds_write_b64 v31, v[28:29] offset:1792
    s_waitcnt lgkmcnt(0)
    s_waitcnt vmcnt(2)
    s_barrier
    s_add_u32 m0, s9, 32768
    s_add_u32 s10, s72, 589824
    buffer_load_dwordx4 v6, s[56:59], s10 offen lds
    s_add_u32 m0, s9, 40960
    s_add_u32 s10, s72, 64
    buffer_load_dwordx4 v6, s[56:59], s10 offen lds
    v_mfma_f32_32x32x16_bf16 v[144:159], v[32:35], v[48:51], 0
    ds_read_b128 v[32:35], v1 offset:57344
    ds_read_b64 v[14:15], v31 offset:0
    ds_read_b64 v[16:17], v31 offset:256
    ds_read_b64 v[18:19], v31 offset:512
    ds_read_b64 v[20:21], v31 offset:768
    ds_read_b64 v[22:23], v31 offset:1024
    ds_read_b64 v[24:25], v31 offset:1280
    ds_read_b64 v[26:27], v31 offset:1536
    v_mul_f32 v12, v9, v9
    v_mul_f32 v5, v8, v9
    v_mfma_f32_32x32x16_bf16 v[144:159], v[36:39], v[52:55], v[144:159]
    ds_read_b128 v[36:39], v2 offset:57344
    v_fma_f32 v30, v8, v8, -v12
    v_add_f32 v5, v5, v5
    v_mul_f32 v12, v5, v5
    v_mul_f32 v5, v30, v5
    v_fma_f32 v30, v30, v30, -v12
    v_add_f32 v5, v5, v5
    v_mul_f32 v12, v5, v5
    v_mul_f32 v5, v30, v5
    v_mfma_f32_32x32x16_bf16 v[144:159], v[40:43], v[56:59], v[144:159]
    ds_read_b128 v[40:43], v1 offset:61440
    v_fma_f32 v30, v30, v30, -v12
    v_add_f32 v5, v5, v5
    v_mul_f32 v12, v5, v5
    v_mul_f32 v5, v30, v5
    v_fma_f32 v30, v30, v30, -v12
    v_add_f32 v5, v5, v5
    s_waitcnt lgkmcnt(7)
    v_fma_f32 v16, v30, v14, v16
    v_fma_f32 v17, v30, v15, v17
    v_mfma_f32_32x32x16_bf16 v[144:159], v[44:47], v[60:63], v[144:159]
    ds_read_b128 v[44:47], v2 offset:61440
    v_fma_f32 v16, -v5, v15, v16
    v_fma_f32 v17, v5, v14, v17
    s_waitcnt lgkmcnt(7)
    v_fma_f32 v18, v30, v16, v18
    v_fma_f32 v19, v30, v17, v19
    v_fma_f32 v18, -v5, v17, v18
    v_fma_f32 v19, v5, v16, v19
    s_waitcnt lgkmcnt(6)
    v_mfma_f32_32x32x16_bf16 v[160:175], v[32:35], v[48:51], 0
    ds_read_b128 v[32:35], v1 offset:0
    v_fma_f32 v20, v30, v18, v20
    v_fma_f32 v21, v30, v19, v21
    v_fma_f32 v20, -v5, v19, v20
    v_fma_f32 v21, v5, v18, v21
    s_waitcnt lgkmcnt(6)
    v_fma_f32 v22, v30, v20, v22
    v_fma_f32 v23, v30, v21, v23
    v_fma_f32 v22, -v5, v21, v22
    v_fma_f32 v23, v5, v20, v23
    s_waitcnt lgkmcnt(3)
    v_mfma_f32_32x32x16_bf16 v[160:175], v[36:39], v[52:55], v[160:175]
    ds_read_b128 v[36:39], v2 offset:0
    v_fma_f32 v24, v30, v22, v24
    v_fma_f32 v25, v30, v23, v25
    v_fma_f32 v24, -v5, v23, v24
    v_fma_f32 v25, v5, v22, v25
    v_fma_f32 v12, v30, v24, v26
    v_fma_f32 v13, v30, v25, v27
    s_waitcnt lgkmcnt(3)
    v_mfma_f32_32x32x16_bf16 v[160:175], v[40:43], v[56:59], v[160:175]
    ds_read_b128 v[40:43], v1 offset:4096
    v_fma_f32 v12, -v5, v25, v12
    v_fma_f32 v13, v5, v24, v13
    v_fma_f32 v28, v30, v12, v28
    v_fma_f32 v29, v30, v13, v29
    v_fma_f32 v28, -v5, v13, v28
    v_fma_f32 v29, v5, v12, v29
    s_mul_i32 s11, s7, 4608
    s_add_u32 s73, s78, s6
    s_lshl_b32 s73, s73, 8
    s_waitcnt lgkmcnt(3)
    v_mfma_f32_32x32x16_bf16 v[160:175], v[44:47], v[60:63], v[160:175]
    ds_read_b128 v[44:47], v2 offset:4096
    s_add_u32 s11, s11, s73
    s_add_u32 s11, s11, 768
    s_cmp_eq_u32 s5, 3
    s_cselect_b32 s11, s11, 0x100000
    v_lshlrev_b32 v30, 3, v0
    v_add_u32 v30, s11, v30
    v_mov_b32 v5, 0x100000
    v_cndmask_b32 v30, v5, v30, s[96:97]
    s_waitcnt vmcnt(2)
    s_barrier
    buffer_store_dwordx2 v[28:29], v30, s[48:51], 0 offen sc1
    s_add_u32 m0, s9, 49152
    s_add_u32 s10, s72, 73792
    buffer_load_dwordx4 v6, s[56:59], s10 offen lds
    s_add_u32 m0, s9, 57344
    s_add_u32 s10, s72, 147520
    buffer_load_dwordx4 v6, s[56:59], s10 offen lds
    s_waitcnt lgkmcnt(3)
    v_mfma_f32_32x32x16_bf16 v[176:191], v[32:35], v[48:51], 0
    ds_read_b128 v[32:35], v1 offset:8192
    s_waitcnt lgkmcnt(3)
    v_mfma_f32_32x32x16_bf16 v[176:191], v[36:39], v[52:55], v[176:191]
    ds_read_b128 v[36:39], v2 offset:8192
    s_waitcnt lgkmcnt(3)
    v_mfma_f32_32x32x16_bf16 v[176:191], v[40:43], v[56:59], v[176:191]
    ds_read_b128 v[40:43], v1 offset:12288
    s_waitcnt lgkmcnt(3)
    v_mfma_f32_32x32x16_bf16 v[176:191], v[44:47], v[60:63], v[176:191]
    ds_read_b128 v[44:47], v2 offset:12288
    s_waitcnt lgkmcnt(3)
    v_mfma_f32_32x32x16_bf16 v[192:207], v[32:35], v[48:51], 0
    ds_read_b128 v[32:35], v1 offset:16384
    s_waitcnt lgkmcnt(3)
    v_mfma_f32_32x32x16_bf16 v[192:207], v[36:39], v[52:55], v[192:207]
    ds_read_b128 v[36:39], v2 offset:16384
    s_waitcnt lgkmcnt(3)
    v_mfma_f32_32x32x16_bf16 v[192:207], v[40:43], v[56:59], v[192:207]
    ds_read_b128 v[40:43], v1 offset:20480
    s_waitcnt lgkmcnt(3)
    v_mfma_f32_32x32x16_bf16 v[192:207], v[44:47], v[60:63], v[192:207]
    ds_read_b128 v[44:47], v2 offset:20480
    s_waitcnt vmcnt(3)
    s_barrier
    s_add_u32 m0, s9, 0
    s_add_u32 s10, s72, 221248
    buffer_load_dwordx4 v6, s[56:59], s10 offen lds
    s_add_u32 m0, s9, 8192
    s_add_u32 s10, s72, 294976
    buffer_load_dwordx4 v6, s[56:59], s10 offen lds
    s_waitcnt lgkmcnt(3)
    v_mfma_f32_32x32x16_bf16 v[208:223], v[32:35], v[48:51], 0
    ds_read_b128 v[32:35], v1 offset:24576
    s_waitcnt lgkmcnt(3)
    v_mfma_f32_32x32x16_bf16 v[208:223], v[36:39], v[52:55], v[208:223]
    ds_read_b128 v[36:39], v2 offset:24576
    s_waitcnt lgkmcnt(3)
    v_mfma_f32_32x32x16_bf16 v[208:223], v[40:43], v[56:59], v[208:223]
    ds_read_b128 v[40:43], v1 offset:28672
    s_waitcnt lgkmcnt(3)
    v_mfma_f32_32x32x16_bf16 v[208:223], v[44:47], v[60:63], v[208:223]
    ds_read_b128 v[44:47], v2 offset:28672
    s_waitcnt lgkmcnt(3)
    v_mfma_f32_32x32x16_bf16 v[224:239], v[32:35], v[48:51], 0
    ds_read_b128 v[32:35], v1 offset:32768
    ds_read_b64_tr_b16 v[64:65], v3 offset:16384
    ds_read_b64_tr_b16 v[66:67], v3 offset:17408
    s_waitcnt lgkmcnt(5)
    v_mfma_f32_32x32x16_bf16 v[224:239], v[36:39], v[52:55], v[224:239]
    ds_read_b128 v[36:39], v2 offset:32768
    ds_read_b64_tr_b16 v[68:69], v3 offset:20480
    ds_read_b64_tr_b16 v[70:71], v3 offset:21504
    s_waitcnt lgkmcnt(7)
    v_mfma_f32_32x32x16_bf16 v[224:239], v[40:43], v[56:59], v[224:239]
    ds_read_b128 v[40:43], v1 offset:36864
    ds_read_b64_tr_b16 v[72:73], v3 offset:24576
    ds_read_b64_tr_b16 v[74:75], v3 offset:25600
    s_waitcnt lgkmcnt(9)
    v_mfma_f32_32x32x16_bf16 v[224:239], v[44:47], v[60:63], v[224:239]
    ds_read_b128 v[44:47], v2 offset:36864
    ds_read_b64_tr_b16 v[76:77], v3 offset:28672
    ds_read_b64_tr_b16 v[78:79], v3 offset:29696
    s_waitcnt vmcnt(2)
    s_barrier
    s_lshl_b32 s11, s8, 4
    s_add_u32 s11, s11, s7
    s_lshl_b32 s11, s11, 2
    s_cmp_eq_u32 s4, 3
    s_cselect_b32 s11, s11, 0x1000
    s_cmp_eq_u32 s7, 15
    s_cselect_b32 s11, 0x1000, s11
    v_lshlrev_b32 v30, 12, v0
    v_add_u32 v30, s11, v30
    v_mov_b32 v31, 3
    buffer_store_dword v31, v30, s[68:71], 0 offen sc1
    s_add_u32 m0, s9, 16384
    s_add_u32 s10, s72, 368704
    buffer_load_dwordx4 v6, s[56:59], s10 offen lds
    s_add_u32 m0, s9, 24576
    s_add_u32 s10, s72, 442432
    buffer_load_dwordx4 v6, s[56:59], s10 offen lds
    s_waitcnt lgkmcnt(11)
    v_mfma_f32_32x32x16_bf16 v[240:255], v[32:35], v[48:51], 0
    ds_read_b128 v[32:35], v1 offset:40960
    s_waitcnt lgkmcnt(9)
    v_mfma_f32_32x32x16_bf16 v[240:255], v[36:39], v[52:55], v[240:255]
    ds_read_b128 v[36:39], v2 offset:40960
    s_waitcnt lgkmcnt(7)
    v_mfma_f32_32x32x16_bf16 v[240:255], v[40:43], v[56:59], v[240:255]
    ds_read_b128 v[40:43], v1 offset:45056
    s_waitcnt lgkmcnt(5)
    v_mfma_f32_32x32x16_bf16 v[240:255], v[44:47], v[60:63], v[240:255]
    ds_read_b128 v[44:47], v2 offset:45056
    s_waitcnt lgkmcnt(3)
    v_mfma_f32_32x32x16_bf16 v[112:127], v[32:35], v[64:67], v[112:127]
    ds_read_b128 v[32:35], v1 offset:49152
    s_waitcnt lgkmcnt(3)
    v_mfma_f32_32x32x16_bf16 v[112:127], v[36:39], v[68:71], v[112:127]
    ds_read_b128 v[36:39], v2 offset:49152
    s_waitcnt lgkmcnt(3)
    v_mfma_f32_32x32x16_bf16 v[112:127], v[40:43], v[72:75], v[112:127]
    ds_read_b128 v[40:43], v1 offset:53248
    s_waitcnt lgkmcnt(3)
    v_mfma_f32_32x32x16_bf16 v[112:127], v[44:47], v[76:79], v[112:127]
    ds_read_b128 v[44:47], v2 offset:53248
    s_waitcnt vmcnt(3)
    s_barrier
    s_add_u32 m0, s9, 32768
    s_add_u32 s10, s72, 516160
    buffer_load_dwordx4 v6, s[56:59], s10 offen lds
    s_add_u32 m0, s9, 40960
    s_add_u32 s10, s72, 589888
    buffer_load_dwordx4 v6, s[56:59], s10 offen lds
    s_waitcnt lgkmcnt(3)
    v_mfma_f32_32x32x16_bf16 v[128:143], v[32:35], v[64:67], v[128:143]
    ds_read_b128 v[32:35], v1 offset:57344
    s_waitcnt lgkmcnt(3)
    v_mfma_f32_32x32x16_bf16 v[128:143], v[36:39], v[68:71], v[128:143]
    ds_read_b128 v[36:39], v2 offset:57344
    s_waitcnt lgkmcnt(3)
    v_mfma_f32_32x32x16_bf16 v[128:143], v[40:43], v[72:75], v[128:143]
    ds_read_b128 v[40:43], v1 offset:61440
    s_waitcnt lgkmcnt(3)
    v_mfma_f32_32x32x16_bf16 v[128:143], v[44:47], v[76:79], v[128:143]
    ds_read_b128 v[44:47], v2 offset:61440
    s_waitcnt lgkmcnt(3)
    v_mfma_f32_32x32x16_bf16 v[144:159], v[32:35], v[64:67], v[144:159]
    ds_read_b128 v[32:35], v1 offset:0
    s_waitcnt lgkmcnt(3)
    v_mfma_f32_32x32x16_bf16 v[144:159], v[36:39], v[68:71], v[144:159]
    ds_read_b128 v[36:39], v2 offset:0
    s_waitcnt lgkmcnt(3)
    v_mfma_f32_32x32x16_bf16 v[144:159], v[40:43], v[72:75], v[144:159]
    ds_read_b128 v[40:43], v1 offset:4096
    s_waitcnt lgkmcnt(3)
    v_mfma_f32_32x32x16_bf16 v[144:159], v[44:47], v[76:79], v[144:159]
    ds_read_b128 v[44:47], v2 offset:4096
    s_waitcnt vmcnt(2)
    s_barrier
    s_add_u32 m0, s9, 49152
    s_add_u32 s10, s72, 128
    buffer_load_dwordx4 v6, s[56:59], s10 offen lds
    s_add_u32 m0, s9, 57344
    s_add_u32 s10, s72, 73856
    buffer_load_dwordx4 v6, s[56:59], s10 offen lds
    s_waitcnt lgkmcnt(3)
    v_mfma_f32_32x32x16_bf16 v[160:175], v[32:35], v[64:67], v[160:175]
    ds_read_b128 v[32:35], v1 offset:8192
    s_waitcnt lgkmcnt(3)
    v_mfma_f32_32x32x16_bf16 v[160:175], v[36:39], v[68:71], v[160:175]
    ds_read_b128 v[36:39], v2 offset:8192
    s_waitcnt lgkmcnt(3)
    v_mfma_f32_32x32x16_bf16 v[160:175], v[40:43], v[72:75], v[160:175]
    ds_read_b128 v[40:43], v1 offset:12288
    s_waitcnt lgkmcnt(3)
    v_mfma_f32_32x32x16_bf16 v[160:175], v[44:47], v[76:79], v[160:175]
    ds_read_b128 v[44:47], v2 offset:12288
    s_waitcnt lgkmcnt(3)
    v_mfma_f32_32x32x16_bf16 v[176:191], v[32:35], v[64:67], v[176:191]
    ds_read_b128 v[32:35], v1 offset:16384
    s_waitcnt lgkmcnt(3)
    v_mfma_f32_32x32x16_bf16 v[176:191], v[36:39], v[68:71], v[176:191]
    ds_read_b128 v[36:39], v2 offset:16384
    s_waitcnt lgkmcnt(3)
    v_mfma_f32_32x32x16_bf16 v[176:191], v[40:43], v[72:75], v[176:191]
    ds_read_b128 v[40:43], v1 offset:20480
    s_waitcnt lgkmcnt(3)
    v_mfma_f32_32x32x16_bf16 v[176:191], v[44:47], v[76:79], v[176:191]
    ds_read_b128 v[44:47], v2 offset:20480
    s_waitcnt vmcnt(2)
    s_barrier
    s_add_u32 m0, s9, 0
    s_add_u32 s10, s72, 147584
    buffer_load_dwordx4 v6, s[56:59], s10 offen lds
    s_add_u32 m0, s9, 8192
    s_add_u32 s10, s72, 221312
    buffer_load_dwordx4 v6, s[56:59], s10 offen lds
    s_waitcnt lgkmcnt(3)
    v_mfma_f32_32x32x16_bf16 v[192:207], v[32:35], v[64:67], v[192:207]
    ds_read_b128 v[32:35], v1 offset:24576
    s_waitcnt lgkmcnt(3)
    v_mfma_f32_32x32x16_bf16 v[192:207], v[36:39], v[68:71], v[192:207]
    ds_read_b128 v[36:39], v2 offset:24576
    s_waitcnt lgkmcnt(3)
    v_mfma_f32_32x32x16_bf16 v[192:207], v[40:43], v[72:75], v[192:207]
    ds_read_b128 v[40:43], v1 offset:28672
    s_waitcnt lgkmcnt(3)
    v_mfma_f32_32x32x16_bf16 v[192:207], v[44:47], v[76:79], v[192:207]
    ds_read_b128 v[44:47], v2 offset:28672
    s_waitcnt lgkmcnt(3)
    v_mfma_f32_32x32x16_bf16 v[208:223], v[32:35], v[64:67], v[208:223]
    ds_read_b128 v[32:35], v1 offset:32768
    s_waitcnt lgkmcnt(3)
    v_mfma_f32_32x32x16_bf16 v[208:223], v[36:39], v[68:71], v[208:223]
    ds_read_b128 v[36:39], v2 offset:32768
    s_waitcnt lgkmcnt(3)
    v_mfma_f32_32x32x16_bf16 v[208:223], v[40:43], v[72:75], v[208:223]
    ds_read_b128 v[40:43], v1 offset:36864
    s_waitcnt lgkmcnt(3)
    v_mfma_f32_32x32x16_bf16 v[208:223], v[44:47], v[76:79], v[208:223]
    ds_read_b128 v[44:47], v2 offset:36864
    s_waitcnt vmcnt(2)
    s_barrier
    s_add_u32 m0, s9, 16384
    s_add_u32 s10, s72, 295040
    buffer_load_dwordx4 v6, s[56:59], s10 offen lds
    s_add_u32 m0, s9, 24576
    s_add_u32 s10, s72, 368768
    buffer_load_dwordx4 v6, s[56:59], s10 offen lds
    s_waitcnt lgkmcnt(3)
    v_mfma_f32_32x32x16_bf16 v[224:239], v[32:35], v[64:67], v[224:239]
    ds_read_b128 v[32:35], v1 offset:40960
    ds_read_b64_tr_b16 v[48:49], v3 offset:32768
    ds_read_b64_tr_b16 v[50:51], v3 offset:33792
    s_waitcnt lgkmcnt(5)
    v_mfma_f32_32x32x16_bf16 v[224:239], v[36:39], v[68:71], v[224:239]
    ds_read_b128 v[36:39], v2 offset:40960
    ds_read_b64_tr_b16 v[52:53], v3 offset:36864
    ds_read_b64_tr_b16 v[54:55], v3 offset:37888
    s_waitcnt lgkmcnt(7)
    v_mfma_f32_32x32x16_bf16 v[224:239], v[40:43], v[72:75], v[224:239]
    ds_read_b128 v[40:43], v1 offset:45056
    ds_read_b64_tr_b16 v[56:57], v3 offset:40960
    ds_read_b64_tr_b16 v[58:59], v3 offset:41984
    s_waitcnt lgkmcnt(9)
    v_mfma_f32_32x32x16_bf16 v[224:239], v[44:47], v[76:79], v[224:239]
    ds_read_b128 v[44:47], v2 offset:45056
    ds_read_b64_tr_b16 v[60:61], v3 offset:45056
    ds_read_b64_tr_b16 v[62:63], v3 offset:46080
    s_waitcnt lgkmcnt(11)
    v_mfma_f32_32x32x16_bf16 v[240:255], v[32:35], v[64:67], v[240:255]
    ds_read_b128 v[32:35], v1 offset:49152
    s_waitcnt lgkmcnt(9)
    v_mfma_f32_32x32x16_bf16 v[240:255], v[36:39], v[68:71], v[240:255]
    ds_read_b128 v[36:39], v2 offset:49152
    s_waitcnt lgkmcnt(7)
    v_mfma_f32_32x32x16_bf16 v[240:255], v[40:43], v[72:75], v[240:255]
    ds_read_b128 v[40:43], v1 offset:53248
    s_waitcnt lgkmcnt(5)
    v_mfma_f32_32x32x16_bf16 v[240:255], v[44:47], v[76:79], v[240:255]
    ds_read_b128 v[44:47], v2 offset:53248
    s_waitcnt vmcnt(2)
    s_barrier
    s_add_u32 m0, s9, 32768
    s_add_u32 s10, s72, 442496
    buffer_load_dwordx4 v6, s[56:59], s10 offen lds
    s_add_u32 m0, s9, 40960
    s_add_u32 s10, s72, 516224
    buffer_load_dwordx4 v6, s[56:59], s10 offen lds
    s_waitcnt lgkmcnt(3)
    v_mfma_f32_32x32x16_bf16 v[112:127], v[32:35], v[48:51], v[112:127]
    ds_read_b128 v[32:35], v1 offset:57344
    s_waitcnt lgkmcnt(3)
    v_mfma_f32_32x32x16_bf16 v[112:127], v[36:39], v[52:55], v[112:127]
    ds_read_b128 v[36:39], v2 offset:57344
    s_waitcnt lgkmcnt(3)
    v_mfma_f32_32x32x16_bf16 v[112:127], v[40:43], v[56:59], v[112:127]
    ds_read_b128 v[40:43], v1 offset:61440
    s_waitcnt lgkmcnt(3)
    v_mfma_f32_32x32x16_bf16 v[112:127], v[44:47], v[60:63], v[112:127]
    ds_read_b128 v[44:47], v2 offset:61440
    s_waitcnt lgkmcnt(3)
    v_mfma_f32_32x32x16_bf16 v[128:143], v[32:35], v[48:51], v[128:143]
    ds_read_b128 v[32:35], v1 offset:0
    s_waitcnt lgkmcnt(3)
    v_mfma_f32_32x32x16_bf16 v[128:143], v[36:39], v[52:55], v[128:143]
    ds_read_b128 v[36:39], v2 offset:0
    s_waitcnt lgkmcnt(3)
    v_mfma_f32_32x32x16_bf16 v[128:143], v[40:43], v[56:59], v[128:143]
    ds_read_b128 v[40:43], v1 offset:4096
    s_waitcnt lgkmcnt(3)
    v_mfma_f32_32x32x16_bf16 v[128:143], v[44:47], v[60:63], v[128:143]
    ds_read_b128 v[44:47], v2 offset:4096
    s_waitcnt vmcnt(2)
    s_barrier
    v_and_b32 v31, 15, v0
    s_lshl_b32 s11, s8, 6
    v_lshlrev_b32 v31, 2, v31
    v_add_u32 v31, s11, v31
    buffer_load_dword v30, v31, s[68:71], 0 offen sc1
    s_add_u32 m0, s9, 49152
    s_add_u32 s10, s72, 589952
    buffer_load_dwordx4 v6, s[56:59], s10 offen lds
    s_add_u32 m0, s9, 57344
    s_add_u32 s10, s72, 192
    buffer_load_dwordx4 v6, s[56:59], s10 offen lds
    s_waitcnt lgkmcnt(3)
    v_mfma_f32_32x32x16_bf16 v[144:159], v[32:35], v[48:51], v[144:159]
    ds_read_b128 v[32:35], v1 offset:8192
    s_waitcnt lgkmcnt(3)
    v_mfma_f32_32x32x16_bf16 v[144:159], v[36:39], v[52:55], v[144:159]
    ds_read_b128 v[36:39], v2 offset:8192
    s_waitcnt lgkmcnt(3)
    v_mfma_f32_32x32x16_bf16 v[144:159], v[40:43], v[56:59], v[144:159]
    ds_read_b128 v[40:43], v1 offset:12288
    s_waitcnt lgkmcnt(3)
    v_mfma_f32_32x32x16_bf16 v[144:159], v[44:47], v[60:63], v[144:159]
    ds_read_b128 v[44:47], v2 offset:12288
    s_waitcnt lgkmcnt(3)
    v_mfma_f32_32x32x16_bf16 v[160:175], v[32:35], v[48:51], v[160:175]
    ds_read_b128 v[32:35], v1 offset:16384
    s_waitcnt lgkmcnt(3)
    v_mfma_f32_32x32x16_bf16 v[160:175], v[36:39], v[52:55], v[160:175]
    ds_read_b128 v[36:39], v2 offset:16384
    s_waitcnt lgkmcnt(3)
    v_mfma_f32_32x32x16_bf16 v[160:175], v[40:43], v[56:59], v[160:175]
    ds_read_b128 v[40:43], v1 offset:20480
    s_waitcnt lgkmcnt(3)
    v_mfma_f32_32x32x16_bf16 v[160:175], v[44:47], v[60:63], v[160:175]
    ds_read_b128 v[44:47], v2 offset:20480
    s_waitcnt vmcnt(3)
    s_barrier
    s_waitcnt vmcnt(2)
    v_cmp_gt_u32 vcc, 3, v30
    s_and_b64 vcc, vcc, s[94:95]
    s_cbranch_scc0 .pok_14
    s_mov_b32 s83, 65536
.plp_15:
    buffer_load_dword v30, v31, s[68:71], 0 offen sc1
    s_waitcnt vmcnt(0)
    v_cmp_gt_u32 vcc, 3, v30
    s_and_b64 vcc, vcc, s[94:95]
    s_cbranch_scc0 .pok_14
    s_sub_u32 s83, s83, 1
    s_cmp_lg_u32 s83, 0
    s_cbranch_scc1 .plp_15
.pok_14:
    s_sub_u32 s11, s7, 1
    s_mul_i32 s11, s11, 4608
    s_add_u32 s73, s78, s6
    s_lshl_b32 s73, s73, 8
    s_add_u32 s11, s11, s73
    s_add_u32 s11, s11, 1024
    v_and_b32 v30, 31, v0
    v_lshlrev_b32 v30, 3, v30
    v_lshrrev_b32 v31, 5, v0
    v_mul_u32_u24 v31, 4608, v31
    v_sub_u32 v30, v30, v31
    v_add_u32 v30, s11, v30
    v_subrev_u32 v28, 64512, v30
    buffer_load_dwordx2 v[28:29], v28, s[48:51], 0 offen sc1
    v_subrev_u32 v26, 55296, v30
    buffer_load_dwordx2 v[26:27], v26, s[48:51], 0 offen sc1
    v_subrev_u32 v24, 46080, v30
    buffer_load_dwordx2 v[24:25], v24, s[48:51], 0 offen sc1
    v_subrev_u32 v22, 36864, v30
    buffer_load_dwordx2 v[22:23], v22, s[48:51], 0 offen sc1
    v_subrev_u32 v20, 27648, v30
    buffer_load_dwordx2 v[20:21], v20, s[48:51], 0 offen sc1
    v_subrev_u32 v18, 18432, v30
    buffer_load_dwordx2 v[18:19], v18, s[48:51], 0 offen sc1
    v_subrev_u32 v16, 9216, v30
    buffer_load_dwordx2 v[16:17], v16, s[48:51], 0 offen sc1
    v_subrev_u32 v14, 0, v30
    buffer_load_dwordx2 v[14:15], v14, s[48:51], 0 offen sc1
    s_add_u32 m0, s9, 0
    s_add_u32 s10, s72, 256
    buffer_load_dwordx4 v6, s[56:59], s10 offen lds
    s_add_u32 m0, s9, 8192
    s_add_u32 s10, s72, 73920
    buffer_load_dwordx4 v6, s[56:59], s10 offen lds
    s_add_u32 m0, s9, -98304
    s_add_u32 s10, s72, 295168
    buffer_load_dwordx4 v6, s[56:59], s10 offen lds
    s_add_u32 m0, s9, -90112
    s_add_u32 s10, s72, 368832
    buffer_load_dwordx4 v6, s[56:59], s10 offen lds
    s_waitcnt lgkmcnt(3)
    v_mfma_f32_32x32x16_bf16 v[176:191], v[32:35], v[48:51], v[176:191]
    ds_read_b128 v[32:35], v1 offset:24576
    v_mul_f32 v5, v9, v9
    v_mul_f32 v31, v8, v9
    v_fma_f32 v30, v8, v8, -v5
    v_add_f32 v31, v31, v31
    v_mul_f32 v5, v31, v31
    s_waitcnt lgkmcnt(3)
    v_mfma_f32_32x32x16_bf16 v[176:191], v[36:39], v[52:55], v[176:191]
    ds_read_b128 v[36:39], v2 offset:24576
    v_mul_f32 v31, v30, v31
    v_fma_f32 v30, v30, v30, -v5
    v_add_f32 v31, v31, v31
    v_mul_f32 v5, v31, v31
    v_mul_f32 v31, v30, v31
    s_waitcnt lgkmcnt(3)
    v_mfma_f32_32x32x16_bf16 v[176:191], v[40:43], v[56:59], v[176:191]
    ds_read_b128 v[40:43], v1 offset:28672
    v_fma_f32 v30, v30, v30, -v5
    v_add_f32 v31, v31, v31
    v_mul_f32 v5, v31, v31
    v_mul_f32 v31, v30, v31
    s_waitcnt lgkmcnt(3)
    v_mfma_f32_32x32x16_bf16 v[176:191], v[44:47], v[60:63], v[176:191]
    ds_read_b128 v[44:47], v2 offset:28672
    v_fma_f32 v30, v30, v30, -v5
    v_add_f32 v31, v31, v31
    v_mul_f32 v5, v31, v31
    v_mul_f32 v31, v30, v31
    v_fma_f32 v30, v30, v30, -v5
    s_waitcnt lgkmcnt(3)
    v_mfma_f32_32x32x16_bf16 v[192:207], v[32:35], v[48:51], v[192:207]
    ds_read_b128 v[32:35], v1 offset:32768
    v_add_f32 v31, v31, v31
    v_mul_f32 v5, v31, v31
    v_mul_f32 v31, v30, v31
    v_fma_f32 v30, v30, v30, -v5
    s_waitcnt lgkmcnt(3)
    v_mfma_f32_32x32x16_bf16 v[192:207], v[36:39], v[52:55], v[192:207]
    ds_read_b128 v[36:39], v2 offset:32768
    v_add_f32 v31, v31, v31
    v_mul_f32 v5, v31, v31
    v_mul_f32 v31, v30, v31
    v_fma_f32 v30, v30, v30, -v5
    v_add_f32 v31, v31, v31
    s_waitcnt lgkmcnt(3)
    v_mfma_f32_32x32x16_bf16 v[192:207], v[40:43], v[56:59], v[192:207]
    ds_read_b128 v[40:43], v1 offset:36864
    v_mul_f32 v5, v31, v31
    v_mul_f32 v31, v30, v31
    v_fma_f32 v30, v30, v30, -v5
    v_add_f32 v31, v31, v31
    s_waitcnt lgkmcnt(3)
    v_mfma_f32_32x32x16_bf16 v[192:207], v[44:47], v[60:63], v[192:207]
    ds_read_b128 v[44:47], v2 offset:36864
    s_waitcnt vmcnt(12)
    s_barrier
    s_add_u32 m0, s9, 16384
    s_add_u32 s10, s72, 73984
    buffer_load_dwordx4 v6, s[56:59], s10 offen lds
    s_add_u32 m0, s9, 24576
    s_add_u32 s10, s72, 147648
    buffer_load_dwordx4 v6, s[56:59], s10 offen lds
    s_add_u32 m0, s9, -81920
    s_add_u32 s10, s72, 368896
    buffer_load_dwordx4 v6, s[56:59], s10 offen lds
    s_add_u32 m0, s9, -73728
    s_add_u32 s10, s72, 442560
    buffer_load_dwordx4 v6, s[56:59], s10 offen lds
    s_waitcnt lgkmcnt(3)
    v_mfma_f32_32x32x16_bf16 v[208:223], v[32:35], v[48:51], v[208:223]
    ds_read_b128 v[32:35], v1 offset:40960
    s_waitcnt vmcnt(14)
    v_fma_f32 v26, v30, v28, v26
    v_fma_f32 v27, v30, v29, v27
    v_fma_f32 v26, -v31, v29, v26
    v_fma_f32 v27, v31, v28, v27
    s_waitcnt vmcnt(13)
    v_fma_f32 v24, v30, v26, v24
    v_fma_f32 v25, v30, v27, v25
    v_fma_f32 v24, -v31, v27, v24
    v_fma_f32 v25, v31, v26, v25
    s_waitcnt vmcnt(12)
    v_fma_f32 v22, v30, v24, v22
    v_fma_f32 v23, v30, v25, v23
    v_fma_f32 v22, -v31, v25, v22
    v_fma_f32 v23, v31, v24, v23
    s_waitcnt vmcnt(11)
    s_waitcnt lgkmcnt(3)
    v_mfma_f32_32x32x16_bf16 v[208:223], v[36:39], v[52:55], v[208:223]
    ds_read_b128 v[36:39], v2 offset:40960
    v_fma_f32 v20, v30, v22, v20
    v_fma_f32 v21, v30, v23, v21
    v_fma_f32 v20, -v31, v23, v20
    v_fma_f32 v21, v31, v22, v21
    s_waitcnt vmcnt(10)
    v_fma_f32 v18, v30, v20, v18
    v_fma_f32 v19, v30, v21, v19
    v_fma_f32 v18, -v31, v21, v18
    v_fma_f32 v19, v31, v20, v19
    s_waitcnt vmcnt(9)
    v_fma_f32 v16, v30, v18, v16
    v_fma_f32 v17, v30, v19, v17
    v_fma_f32 v16, -v31, v19, v16
    v_fma_f32 v17, v31, v18, v17
    s_waitcnt vmcnt(8)
    v_fma_f32 v14, v30, v16, v14
    s_waitcnt lgkmcnt(3)
    v_mfma_f32_32x32x16_bf16 v[208:223], v[40:43], v[56:59], v[208:223]
    ds_read_b128 v[40:43], v1 offset:45056
    v_fma_f32 v15, v30, v17, v15
    v_fma_f32 v14, -v31, v17, v14
    v_fma_f32 v15, v31, v16, v15
    v_mul_f32 v5, v9, v9
    v_mul_f32 v17, v8, v9
    v_fma_f32 v16, v8, v8, -v5
    v_add_f32 v17, v17, v17
    v_mul_f32 v5, v17, v17
    v_mul_f32 v17, v16, v17
    v_fma_f32 v16, v16, v16, -v5
    v_add_f32 v17, v17, v17
    v_mul_f32 v5, v17, v17
    v_mul_f32 v17, v16, v17
    v_fma_f32 v16, v16, v16, -v5
    v_add_f32 v17, v17, v17
    v_mul_f32 v5, v17, v17
    s_waitcnt lgkmcnt(3)
    v_mfma_f32_32x32x16_bf16 v[208:223], v[44:47], v[60:63], v[208:223]
    ds_read_b128 v[44:47], v2 offset:45056
    v_mul_f32 v17, v16, v17
    v_fma_f32 v16, v16, v16, -v5
    v_add_f32 v17, v17, v17
    v_mul_f32 v5, v17, v17
    v_mul_f32 v19, v16, v17
    v_fma_f32 v18, v16, v16, -v5
    v_add_f32 v19, v19, v19
    v_mul_f32 v5, v19, v19
    v_mul_f32 v21, v18, v19
    v_fma_f32 v20, v18, v18, -v5
    v_add_f32 v21, v21, v21
    v_mul_f32 v5, v21, v21
    v_mul_f32 v23, v20, v21
    v_fma_f32 v22, v20, v20, -v5
    v_add_f32 v23, v23, v23
    s_waitcnt lgkmcnt(3)
    v_mfma_f32_32x32x16_bf16 v[224:239], v[32:35], v[48:51], v[224:239]
    ds_read_b128 v[32:35], v1 offset:49152
    v_mul_f32 v24, v22, v14
    v_mul_f32 v25, v22, v15
    v_fma_f32 v24, -v23, v15, v24
    v_fma_f32 v25, v23, v14, v25
    v_cndmask_b32 v14, v14, v24, s[96:97]
    v_cndmask_b32 v15, v15, v25, s[96:97]
    v_mov_b32 v24, v14
    v_mov_b32 v25, v15
    v_cndmask_b32 v16, 1.0, v16, s[96:97]
    v_cndmask_b32 v17, 0, v17, s[96:97]
    v_permlane32_swap_b32 v14, v24
    v_permlane32_swap_b32 v15, v25
    v_cndmask_b32 v18, 1.0, v18, s[98:99]
    v_cndmask_b32 v19, 0, v19, s[98:99]
    v_cndmask_b32 v20, 1.0, v20, s[100:101]
    v_cndmask_b32 v21, 0, v21, s[100:101]
    ds_read_b64_tr_b16 v[64:65], v3 offset:49152
    ds_read_b64_tr_b16 v[66:67], v3 offset:50176
    s_waitcnt lgkmcnt(5)
    v_mfma_f32_32x32x16_bf16 v[224:239], v[36:39], v[52:55], v[224:239]
    ds_read_b128 v[36:39], v2 offset:49152
    v_add_f32 v14, v14, v24
    v_add_f32 v15, v15, v25
    v_mul_f32 v22, v16, v18
    v_mul_f32 v23, v16, v19
    v_fma_f32 v22, -v17, v19, v22
    v_fma_f32 v23, v17, v18, v23
    v_mul_f32 v16, v22, v20
    v_mul_f32 v17, v22, v21
    v_fma_f32 v16, -v23, v21, v16
    v_fma_f32 v17, v23, v20, v17
    v_fma_f32 v12, v16, v14, v12
    v_fma_f32 v13, v16, v15, v13
    v_fma_f32 v12, -v17, v15, v12
    v_fma_f32 v13, v17, v14, v13
    v_and_b32 v30, 3, v0
    v_xor_b32 v30, s5, v30
    ds_read_b64_tr_b16 v[68:69], v3 offset:53248
    ds_read_b64_tr_b16 v[70:71], v3 offset:54272
    s_waitcnt lgkmcnt(7)
    v_mfma_f32_32x32x16_bf16 v[224:239], v[40:43], v[56:59], v[224:239]
    ds_read_b128 v[40:43], v1 offset:53248
    v_lshlrev_b32 v30, 6, v30
    v_and_b32 v31, 31, v0
    v_lshl_add_u32 v30, v31, 8, v30
    v_lshrrev_b32 v31, 5, v0
    v_lshl_add_u32 v30, v31, 5, v30
    s_lshl_b32 s11, s6, 14
    s_add_u32 s11, s11, 65536
    v_add_u32 v31, s11, v30
    v_fma_f32 v80, v8, v12, v80
    v_fma_f32 v96, v8, v13, v96
    v_fma_f32 v80, -v9, v13, v80
    v_fma_f32 v96, v9, v12, v96
    v_mul_f32 v30, v10, v80
    v_mul_f32 v5, -v10, v96
    v_fma_f32 v30, -v11, v96, v30
    ds_read_b64_tr_b16 v[72:73], v3 offset:57344
    ds_read_b64_tr_b16 v[74:75], v3 offset:58368
    s_waitcnt lgkmcnt(9)
    v_mfma_f32_32x32x16_bf16 v[224:239], v[44:47], v[60:63], v[224:239]
    ds_read_b128 v[44:47], v2 offset:53248
    v_fma_f32 v5, -v11, v80, v5
    v_fma_f32 v81, v8, v80, v81
    v_fma_f32 v97, v8, v96, v97
    v_fma_f32 v81, -v9, v96, v81
    v_fma_f32 v97, v9, v80, v97
    v_mul_f32 v12, v10, v81
    v_mul_f32 v13, -v10, v97
    v_fma_f32 v12, -v11, v97, v12
    v_fma_f32 v13, -v11, v81, v13
    v_cvt_pk_bf16_f32 v14, v30, v12
    v_cvt_pk_bf16_f32 v18, v5, v13
    v_fma_f32 v82, v8, v81, v82
    v_fma_f32 v98, v8, v97, v98
    v_fma_f32 v82, -v9, v97, v82
    v_fma_f32 v98, v9, v81, v98
    v_mul_f32 v30, v10, v82
    ds_read_b64_tr_b16 v[76:77], v3 offset:61440
    ds_read_b64_tr_b16 v[78:79], v3 offset:62464
    s_waitcnt vmcnt(6)
    s_barrier
    s_add_u32 m0, s9, 32768
    s_add_u32 s10, s72, 147712
    buffer_load_dwordx4 v6, s[56:59], s10 offen lds
    s_add_u32 m0, s9, 40960
    s_add_u32 s10, s72, 221376
    buffer_load_dwordx4 v6, s[56:59], s10 offen lds
    s_add_u32 m0, s9, -65536
    s_add_u32 s10, s72, 442624
    buffer_load_dwordx4 v6, s[56:59], s10 offen lds
    s_add_u32 m0, s9, -57344
    s_add_u32 s10, s72, 516288
    buffer_load_dwordx4 v6, s[56:59], s10 offen lds
    s_waitcnt lgkmcnt(11)
    v_mfma_f32_32x32x16_bf16 v[240:255], v[32:35], v[48:51], v[240:255]
    ds_read_b128 v[32:35], v1 offset:57344
    v_mul_f32 v5, -v10, v98
    v_fma_f32 v30, -v11, v98, v30
    v_fma_f32 v5, -v11, v82, v5
    v_fma_f32 v83, v8, v82, v83
    v_fma_f32 v99, v8, v98, v99
    v_fma_f32 v83, -v9, v98, v83
    v_fma_f32 v99, v9, v82, v99
    v_mul_f32 v12, v10, v83
    v_mul_f32 v13, -v10, v99
    v_fma_f32 v12, -v11, v99, v12
    v_fma_f32 v13, -v11, v83, v13
    v_cvt_pk_bf16_f32 v15, v30, v12
    v_cvt_pk_bf16_f32 v19, v5, v13
    v_fma_f32 v84, v8, v83, v84
    v_fma_f32 v100, v8, v99, v100
    v_fma_f32 v84, -v9, v99, v84
    s_waitcnt lgkmcnt(9)
    v_mfma_f32_32x32x16_bf16 v[240:255], v[36:39], v[52:55], v[240:255]
    ds_read_b128 v[36:39], v2 offset:57344
    v_fma_f32 v100, v9, v83, v100
    v_mul_f32 v30, v10, v84
    v_mul_f32 v5, -v10, v100
    v_fma_f32 v30, -v11, v100, v30
    v_fma_f32 v5, -v11, v84, v5
    v_fma_f32 v85, v8, v84, v85
    v_fma_f32 v101, v8, v100, v101
    v_fma_f32 v85, -v9, v100, v85
    v_fma_f32 v101, v9, v84, v101
    v_mul_f32 v12, v10, v85
    v_mul_f32 v13, -v10, v101
    v_fma_f32 v12, -v11, v101, v12
    v_fma_f32 v13, -v11, v85, v13
    v_cvt_pk_bf16_f32 v16, v30, v12
    v_cvt_pk_bf16_f32 v20, v5, v13
    s_waitcnt lgkmcnt(7)
    v_mfma_f32_32x32x16_bf16 v[240:255], v[40:43], v[56:59], v[240:255]
    ds_read_b128 v[40:43], v1 offset:61440
    v_fma_f32 v86, v8, v85, v86
    v_fma_f32 v102, v8, v101, v102
    v_fma_f32 v86, -v9, v101, v86
    v_fma_f32 v102, v9, v85, v102
    v_mul_f32 v30, v10, v86
    v_mul_f32 v5, -v10, v102
    v_fma_f32 v30, -v11, v102, v30
    v_fma_f32 v5, -v11, v86, v5
    v_fma_f32 v87, v8, v86, v87
    v_fma_f32 v103, v8, v102, v103
    v_fma_f32 v87, -v9, v102, v87
    v_fma_f32 v103, v9, v86, v103
    v_mul_f32 v12, v10, v87
    v_mul_f32 v13, -v10, v103
    v_fma_f32 v12, -v11, v103, v12
    v_fma_f32 v13, -v11, v87, v13
    s_waitcnt lgkmcnt(5)
    v_mfma_f32_32x32x16_bf16 v[240:255], v[44:47], v[60:63], v[240:255]
    ds_read_b128 v[44:47], v2 offset:61440
    v_cvt_pk_bf16_f32 v17, v30, v12
    v_cvt_pk_bf16_f32 v21, v5, v13
    ds_write_b128 v31, v[14:17] offset:0
    ds_write_b128 v31, v[18:21] offset:8192
    v_fma_f32 v88, v8, v87, v88
    v_fma_f32 v104, v8, v103, v104
    v_fma_f32 v88, -v9, v103, v88
    v_fma_f32 v104, v9, v87, v104
    v_mul_f32 v30, v10, v88
    v_mul_f32 v5, -v10, v104
    v_fma_f32 v30, -v11, v104, v30
    v_fma_f32 v5, -v11, v88, v5
    v_fma_f32 v89, v8, v88, v89
    v_fma_f32 v105, v8, v104, v105
    v_fma_f32 v89, -v9, v104, v89
    v_fma_f32 v105, v9, v88, v105
    s_waitcnt lgkmcnt(5)
    v_mfma_f32_32x32x16_bf16 v[112:127], v[32:35], v[64:67], v[112:127]
    ds_read_b128 v[32:35], v1 offset:0
    v_mul_f32 v12, v10, v89
    v_mul_f32 v13, -v10, v105
    v_fma_f32 v12, -v11, v105, v12
    v_fma_f32 v13, -v11, v89, v13
    v_cvt_pk_bf16_f32 v22, v30, v12
    v_cvt_pk_bf16_f32 v26, v5, v13
    v_fma_f32 v90, v8, v89, v90
    v_fma_f32 v106, v8, v105, v106
    v_fma_f32 v90, -v9, v105, v90
    v_fma_f32 v106, v9, v89, v106
    v_mul_f32 v30, v10, v90
    v_mul_f32 v5, -v10, v106
    v_fma_f32 v30, -v11, v106, v30
    v_fma_f32 v5, -v11, v90, v5
    v_fma_f32 v91, v8, v90, v91
    s_waitcnt lgkmcnt(5)
    v_mfma_f32_32x32x16_bf16 v[112:127], v[36:39], v[68:71], v[112:127]
    ds_read_b128 v[36:39], v2 offset:0
    v_fma_f32 v107, v8, v106, v107
    v_fma_f32 v91, -v9, v106, v91
    v_fma_f32 v107, v9, v90, v107
    v_mul_f32 v12, v10, v91
    v_mul_f32 v13, -v10, v107
    v_fma_f32 v12, -v11, v107, v12
    v_fma_f32 v13, -v11, v91, v13
    v_cvt_pk_bf16_f32 v23, v30, v12
    v_cvt_pk_bf16_f32 v27, v5, v13
    v_fma_f32 v92, v8, v91, v92
    v_fma_f32 v108, v8, v107, v108
    v_fma_f32 v92, -v9, v107, v92
    v_fma_f32 v108, v9, v91, v108
    v_mul_f32 v30, v10, v92
    v_mul_f32 v5, -v10, v108
    v_fma_f32 v30, -v11, v108, v30
    s_waitcnt lgkmcnt(5)
    v_mfma_f32_32x32x16_bf16 v[112:127], v[40:43], v[72:75], v[112:127]
    ds_read_b128 v[40:43], v1 offset:4096
    v_fma_f32 v5, -v11, v92, v5
    v_fma_f32 v93, v8, v92, v93
    v_fma_f32 v109, v8, v108, v109
    v_fma_f32 v93, -v9, v108, v93
    v_fma_f32 v109, v9, v92, v109
    v_mul_f32 v12, v10, v93
    v_mul_f32 v13, -v10, v109
    v_fma_f32 v12, -v11, v109, v12
    v_fma_f32 v13, -v11, v93, v13
    v_cvt_pk_bf16_f32 v24, v30, v12
    v_cvt_pk_bf16_f32 v28, v5, v13
    v_fma_f32 v94, v8, v93, v94
    v_fma_f32 v110, v8, v109, v110
    v_fma_f32 v94, -v9, v109, v94
    v_fma_f32 v110, v9, v93, v110
    v_mul_f32 v30, v10, v94
    s_waitcnt lgkmcnt(5)
    v_mfma_f32_32x32x16_bf16 v[112:127], v[44:47], v[76:79], v[112:127]
    ds_read_b128 v[44:47], v2 offset:4096
    v_mul_f32 v5, -v10, v110
    v_fma_f32 v30, -v11, v110, v30
    v_fma_f32 v5, -v11, v94, v5
    v_fma_f32 v95, v8, v94, v95
    v_fma_f32 v111, v8, v110, v111
    v_fma_f32 v95, -v9, v110, v95
    v_fma_f32 v111, v9, v94, v111
    v_mul_f32 v12, v10, v95
    v_mul_f32 v13, -v10, v111
    v_fma_f32 v12, -v11, v111, v12
    v_fma_f32 v13, -v11, v95, v13
    v_cvt_pk_bf16_f32 v25, v30, v12
    v_cvt_pk_bf16_f32 v29, v5, v13
    ds_write_b128 v31, v[22:25] offset:16
    ds_write_b128 v31, v[26:29] offset:8208
    s_waitcnt lgkmcnt(0)
    s_waitcnt vmcnt(6)
    s_barrier
    ds_read_b64_tr_b16 v[48:49], v4 offset:0
    ds_read_b64_tr_b16 v[50:51], v4 offset:1024
    ds_read_b64_tr_b16 v[52:53], v4 offset:4096
    ds_read_b64_tr_b16 v[54:55], v4 offset:5120
    ds_read_b64_tr_b16 v[56:57], v4 offset:8192
    ds_read_b64_tr_b16 v[58:59], v4 offset:9216
    ds_read_b64_tr_b16 v[60:61], v4 offset:12288
    ds_read_b64_tr_b16 v[62:63], v4 offset:13312
    s_add_u32 m0, s9, 49152
    s_add_u32 s10, s72, 221440
    buffer_load_dwordx4 v6, s[56:59], s10 offen lds
    s_add_u32 m0, s9, 57344
    s_add_u32 s10, s72, 295104
    buffer_load_dwordx4 v6, s[56:59], s10 offen lds
    s_waitcnt lgkmcnt(6)
    v_mfma_f32_32x32x16_bf16 v[112:127], v[32:35], v[48:51], v[112:127]
    ds_read_b128 v[32:35], v1 offset:8192
    s_lshl_b32 s11, s7, 2
    s_add_u32 s11, s11, s5
    s_mul_i32 s11, s11, 18
    s_add_u32 s11, s11, s6
    s_lshl_b32 s11, s11, 5
    s_add_u32 s11, s11, s79
    s_lshl_b32 s11, s11, 10
    s_add_u32 s11, s11, 1048576
    v_and_b32 v5, 15, v0
    v_lshl_add_u32 v5, v5, 4, s11
    v_bfe_u32 v24, v0, 4, 1
    v_lshl_add_u32 v5, v24, 9, v5
    v_lshrrev_b32 v24, 5, v0
    v_lshl_add_u32 v5, v24, 8, v5
    s_waitcnt lgkmcnt(5)
    v_mfma_f32_32x32x16_bf16 v[112:127], v[36:39], v[52:55], v[112:127]
    ds_read_b128 v[36:39], v2 offset:8192
    s_mul_i32 s11, s7, 1536
    s_lshl2_add_u32 s11, s79, s11
    s_add_u32 s11, s11, 262144
    s_cmp_eq_u32 s4, 0
    s_cselect_b32 s11, s11, 0x40000000
    s_waitcnt lgkmcnt(4)
    v_mfma_f32_32x32x16_bf16 v[112:127], v[40:43], v[56:59], v[112:127]
    ds_read_b128 v[40:43], v1 offset:12288
    v_lshl_add_u32 v12, v0, 7, s11
    v_cmp_gt_u32 vcc, 12, v0
    v_mov_b32 v13, 0x40000000
    v_cndmask_b32 v12, v13, v12, vcc
    s_lshr_b32 s11, s7, 2
    s_waitcnt lgkmcnt(3)
    v_mfma_f32_32x32x16_bf16 v[112:127], v[44:47], v[60:63], v[112:127]
    ds_read_b128 v[44:47], v2 offset:12288
    s_lshl_b32 s11, s11, 6
    s_add_u32 s11, s11, 60
    v_mov_b32 v15, s11
    buffer_load_dword v14, v15, s[68:71], 0 offen sc1
    s_waitcnt lgkmcnt(3)
    v_mfma_f32_32x32x16_bf16 v[128:143], v[32:35], v[64:67], v[128:143]
    ds_read_b128 v[32:35], v1 offset:16384
    s_waitcnt lgkmcnt(3)
    v_mfma_f32_32x32x16_bf16 v[128:143], v[36:39], v[68:71], v[128:143]
    ds_read_b128 v[36:39], v2 offset:16384
    s_nop 2
    v_cvt_pk_bf16_f32 v24, v112, v113
    v_cvt_pk_bf16_f32 v25, v114, v115
    s_waitcnt lgkmcnt(3)
    v_mfma_f32_32x32x16_bf16 v[128:143], v[40:43], v[72:75], v[128:143]
    ds_read_b128 v[40:43], v1 offset:20480
    v_cvt_pk_bf16_f32 v26, v116, v117
    v_cvt_pk_bf16_f32 v27, v118, v119
    s_waitcnt lgkmcnt(3)
    v_mfma_f32_32x32x16_bf16 v[128:143], v[44:47], v[76:79], v[128:143]
    ds_read_b128 v[44:47], v2 offset:20480
    s_mov_b32 s11, 0
    buffer_store_dwordx4 v[24:27], v5, s[60:63], s11 offen sc1
    s_waitcnt vmcnt(6)
    s_barrier
    s_add_u32 m0, s9, -49152
    s_add_u32 s10, s72, 516352
    buffer_load_dwordx4 v6, s[56:59], s10 offen lds
    s_add_u32 m0, s9, -40960
    s_add_u32 s10, s72, 590016
    buffer_load_dwordx4 v6, s[56:59], s10 offen lds
    s_add_u32 m0, s9, 0
    s_add_u32 s10, s72, 590080
    buffer_load_dwordx4 v6, s[56:59], s10 offen lds
    s_waitcnt lgkmcnt(3)
    v_mfma_f32_32x32x16_bf16 v[128:143], v[32:35], v[48:51], v[128:143]
    ds_read_b128 v[32:35], v1 offset:24576
    v_cvt_pk_bf16_f32 v28, v120, v121
    v_cvt_pk_bf16_f32 v29, v122, v123
    s_waitcnt lgkmcnt(3)
    v_mfma_f32_32x32x16_bf16 v[128:143], v[36:39], v[52:55], v[128:143]
    ds_read_b128 v[36:39], v2 offset:24576
    v_cvt_pk_bf16_f32 v30, v124, v125
    v_cvt_pk_bf16_f32 v31, v126, v127
    s_waitcnt lgkmcnt(3)
    v_mfma_f32_32x32x16_bf16 v[128:143], v[40:43], v[56:59], v[128:143]
    ds_read_b128 v[40:43], v1 offset:28672
    s_mov_b32 s11, 16384
    buffer_store_dwordx4 v[28:31], v5, s[60:63], s11 offen sc1
    s_waitcnt lgkmcnt(3)
    v_mfma_f32_32x32x16_bf16 v[128:143], v[44:47], v[60:63], v[128:143]
    ds_read_b128 v[44:47], v2 offset:28672
    s_waitcnt lgkmcnt(3)
    v_mfma_f32_32x32x16_bf16 v[144:159], v[32:35], v[64:67], v[144:159]
    ds_read_b128 v[32:35], v1 offset:32768
    s_waitcnt lgkmcnt(3)
    v_mfma_f32_32x32x16_bf16 v[144:159], v[36:39], v[68:71], v[144:159]
    ds_read_b128 v[36:39], v2 offset:32768
    s_nop 6
    v_cvt_pk_bf16_f32 v24, v128, v129
    v_cvt_pk_bf16_f32 v25, v130, v131
    s_waitcnt lgkmcnt(3)
    v_mfma_f32_32x32x16_bf16 v[144:159], v[40:43], v[72:75], v[144:159]
    ds_read_b128 v[40:43], v1 offset:36864
    v_cvt_pk_bf16_f32 v26, v132, v133
    v_cvt_pk_bf16_f32 v27, v134, v135
    s_waitcnt lgkmcnt(3)
    v_mfma_f32_32x32x16_bf16 v[144:159], v[44:47], v[76:79], v[144:159]
    ds_read_b128 v[44:47], v2 offset:36864
    s_mov_b32 s11, 65536
    buffer_store_dwordx4 v[24:27], v5, s[60:63], s11 offen sc1
    s_waitcnt vmcnt(7)
    s_barrier
    v_subrev_u32 v3, 98304, v1
    v_subrev_u32 v4, 98304, v2
    s_waitcnt lgkmcnt(3)
    v_mfma_f32_32x32x16_bf16 v[144:159], v[32:35], v[48:51], v[144:159]
    ds_read_b128 v[32:35], v1 offset:40960
    v_cvt_pk_bf16_f32 v28, v136, v137
    v_cvt_pk_bf16_f32 v29, v138, v139
    s_waitcnt lgkmcnt(3)
    v_mfma_f32_32x32x16_bf16 v[144:159], v[36:39], v[52:55], v[144:159]
    ds_read_b128 v[36:39], v2 offset:40960
    v_cvt_pk_bf16_f32 v30, v140, v141
    v_cvt_pk_bf16_f32 v31, v142, v143
    s_waitcnt lgkmcnt(3)
    v_mfma_f32_32x32x16_bf16 v[144:159], v[40:43], v[56:59], v[144:159]
    ds_read_b128 v[40:43], v1 offset:45056
    s_mov_b32 s11, 81920
    buffer_store_dwordx4 v[28:31], v5, s[60:63], s11 offen sc1
    s_waitcnt lgkmcnt(3)
    v_mfma_f32_32x32x16_bf16 v[144:159], v[44:47], v[60:63], v[144:159]
    ds_read_b128 v[44:47], v2 offset:45056
    s_waitcnt lgkmcnt(3)
    v_mfma_f32_32x32x16_bf16 v[160:175], v[32:35], v[64:67], v[160:175]
    ds_read_b128 v[32:35], v1 offset:49152
    s_waitcnt lgkmcnt(3)
    v_mfma_f32_32x32x16_bf16 v[160:175], v[36:39], v[68:71], v[160:175]
    ds_read_b128 v[36:39], v2 offset:49152
    s_nop 6
    v_cvt_pk_bf16_f32 v24, v144, v145
    v_cvt_pk_bf16_f32 v25, v146, v147
    s_waitcnt lgkmcnt(3)
    v_mfma_f32_32x32x16_bf16 v[160:175], v[40:43], v[72:75], v[160:175]
    ds_read_b128 v[40:43], v1 offset:53248
    v_cvt_pk_bf16_f32 v26, v148, v149
    v_cvt_pk_bf16_f32 v27, v150, v151
    s_waitcnt lgkmcnt(3)
    v_mfma_f32_32x32x16_bf16 v[160:175], v[44:47], v[76:79], v[160:175]
    ds_read_b128 v[44:47], v2 offset:53248
    s_mov_b32 s11, 131072
    buffer_store_dwordx4 v[24:27], v5, s[60:63], s11 offen sc1
    s_barrier
    s_waitcnt lgkmcnt(3)
    v_mfma_f32_32x32x16_bf16 v[160:175], v[32:35], v[48:51], v[160:175]
    ds_read_b128 v[32:35], v1 offset:57344
    v_cvt_pk_bf16_f32 v28, v152, v153
    v_cvt_pk_bf16_f32 v29, v154, v155
    s_waitcnt lgkmcnt(3)
    v_mfma_f32_32x32x16_bf16 v[160:175], v[36:39], v[52:55], v[160:175]
    ds_read_b128 v[36:39], v2 offset:57344
    v_cvt_pk_bf16_f32 v30, v156, v157
    v_cvt_pk_bf16_f32 v31, v158, v159
    s_waitcnt lgkmcnt(3)
    v_mfma_f32_32x32x16_bf16 v[160:175], v[40:43], v[56:59], v[160:175]
    ds_read_b128 v[40:43], v1 offset:61440
    s_mov_b32 s11, 147456
    buffer_store_dwordx4 v[28:31], v5, s[60:63], s11 offen sc1
    s_waitcnt lgkmcnt(3)
    v_mfma_f32_32x32x16_bf16 v[160:175], v[44:47], v[60:63], v[160:175]
    ds_read_b128 v[44:47], v2 offset:61440
    s_waitcnt lgkmcnt(3)
    v_mfma_f32_32x32x16_bf16 v[176:191], v[32:35], v[64:67], v[176:191]
    ds_read_b128 v[32:35], v3 offset:0
    s_waitcnt lgkmcnt(3)
    v_mfma_f32_32x32x16_bf16 v[176:191], v[36:39], v[68:71], v[176:191]
    ds_read_b128 v[36:39], v4 offset:0
    s_nop 6
    v_cvt_pk_bf16_f32 v24, v160, v161
    v_cvt_pk_bf16_f32 v25, v162, v163
    s_waitcnt lgkmcnt(3)
    v_mfma_f32_32x32x16_bf16 v[176:191], v[40:43], v[72:75], v[176:191]
    ds_read_b128 v[40:43], v3 offset:4096
    v_cvt_pk_bf16_f32 v26, v164, v165
    v_cvt_pk_bf16_f32 v27, v166, v167
    s_waitcnt lgkmcnt(3)
    v_mfma_f32_32x32x16_bf16 v[176:191], v[44:47], v[76:79], v[176:191]
    ds_read_b128 v[44:47], v4 offset:4096
    s_mov_b32 s11, 196608
    buffer_store_dwordx4 v[24:27], v5, s[60:63], s11 offen sc1
    s_waitcnt vmcnt(5)
    s_barrier
    s_mov_b32 s83, 65536
.clp_17:
    s_and_b32 s11, s7, 3
    s_lshl_b32 s11, s11, 3
    v_lshrrev_b32 v14, s11, v14
    v_and_b32 v14, 0xff, v14
    v_cmp_gt_u32 vcc, 12, v14
    s_cbranch_vccz .cok_16
    buffer_load_dword v14, v15, s[68:71], 0 offen sc1
    s_waitcnt vmcnt(0)
    s_sub_u32 s83, s83, 1
    s_cmp_lg_u32 s83, 0
    s_cbranch_scc1 .clp_17
.cok_16:
    v_mov_b32 v13, 1
    buffer_store_dword v13, v12, s[60:63], 0 offen sc1
    s_waitcnt lgkmcnt(3)
    v_mfma_f32_32x32x16_bf16 v[176:191], v[32:35], v[48:51], v[176:191]
    ds_read_b128 v[32:35], v3 offset:8192
    v_cvt_pk_bf16_f32 v28, v168, v169
    v_cvt_pk_bf16_f32 v29, v170, v171
    s_waitcnt lgkmcnt(3)
    v_mfma_f32_32x32x16_bf16 v[176:191], v[36:39], v[52:55], v[176:191]
    ds_read_b128 v[36:39], v4 offset:8192
    v_cvt_pk_bf16_f32 v30, v172, v173
    v_cvt_pk_bf16_f32 v31, v174, v175
    s_waitcnt lgkmcnt(3)
    v_mfma_f32_32x32x16_bf16 v[176:191], v[40:43], v[56:59], v[176:191]
    ds_read_b128 v[40:43], v3 offset:12288
    s_mov_b32 s11, 212992
    buffer_store_dwordx4 v[28:31], v5, s[60:63], s11 offen sc1
    s_waitcnt lgkmcnt(3)
    v_mfma_f32_32x32x16_bf16 v[176:191], v[44:47], v[60:63], v[176:191]
    ds_read_b128 v[44:47], v4 offset:12288
    s_waitcnt lgkmcnt(3)
    v_mfma_f32_32x32x16_bf16 v[192:207], v[32:35], v[64:67], v[192:207]
    ds_read_b128 v[32:35], v3 offset:16384
    s_waitcnt lgkmcnt(3)
    v_mfma_f32_32x32x16_bf16 v[192:207], v[36:39], v[68:71], v[192:207]
    ds_read_b128 v[36:39], v4 offset:16384
    s_nop 6
    v_cvt_pk_bf16_f32 v24, v176, v177
    v_cvt_pk_bf16_f32 v25, v178, v179
    s_waitcnt lgkmcnt(3)
    v_mfma_f32_32x32x16_bf16 v[192:207], v[40:43], v[72:75], v[192:207]
    ds_read_b128 v[40:43], v3 offset:20480
    v_cvt_pk_bf16_f32 v26, v180, v181
    v_cvt_pk_bf16_f32 v27, v182, v183
    s_waitcnt lgkmcnt(3)
    v_mfma_f32_32x32x16_bf16 v[192:207], v[44:47], v[76:79], v[192:207]
    ds_read_b128 v[44:47], v4 offset:20480
    s_mov_b32 s11, 262144
    buffer_store_dwordx4 v[24:27], v5, s[60:63], s11 offen sc1
    s_waitcnt vmcnt(6)
    s_barrier
    v_mov_b32 v13, 2
    buffer_store_dword v13, v12, s[60:63], 0 offen sc1
    s_waitcnt lgkmcnt(3)
    v_mfma_f32_32x32x16_bf16 v[192:207], v[32:35], v[48:51], v[192:207]
    ds_read_b128 v[32:35], v3 offset:24576
    v_cvt_pk_bf16_f32 v28, v184, v185
    v_cvt_pk_bf16_f32 v29, v186, v187
    s_waitcnt lgkmcnt(3)
    v_mfma_f32_32x32x16_bf16 v[192:207], v[36:39], v[52:55], v[192:207]
    ds_read_b128 v[36:39], v4 offset:24576
    v_cvt_pk_bf16_f32 v30, v188, v189
    v_cvt_pk_bf16_f32 v31, v190, v191
    s_waitcnt lgkmcnt(3)
    v_mfma_f32_32x32x16_bf16 v[192:207], v[40:43], v[56:59], v[192:207]
    ds_read_b128 v[40:43], v3 offset:28672
    s_mov_b32 s11, 278528
    buffer_store_dwordx4 v[28:31], v5, s[60:63], s11 offen sc1
    s_waitcnt lgkmcnt(3)
    v_mfma_f32_32x32x16_bf16 v[192:207], v[44:47], v[60:63], v[192:207]
    ds_read_b128 v[44:47], v4 offset:28672
    s_waitcnt lgkmcnt(3)
    v_mfma_f32_32x32x16_bf16 v[208:223], v[32:35], v[64:67], v[208:223]
    ds_read_b128 v[32:35], v3 offset:32768
    s_waitcnt lgkmcnt(3)
    v_mfma_f32_32x32x16_bf16 v[208:223], v[36:39], v[68:71], v[208:223]
    ds_read_b128 v[36:39], v4 offset:32768
    s_nop 6
    v_cvt_pk_bf16_f32 v24, v192, v193
    v_cvt_pk_bf16_f32 v25, v194, v195
    s_waitcnt lgkmcnt(3)
    v_mfma_f32_32x32x16_bf16 v[208:223], v[40:43], v[72:75], v[208:223]
    ds_read_b128 v[40:43], v3 offset:36864
    v_cvt_pk_bf16_f32 v26, v196, v197
    v_cvt_pk_bf16_f32 v27, v198, v199
    s_waitcnt lgkmcnt(3)
    v_mfma_f32_32x32x16_bf16 v[208:223], v[44:47], v[76:79], v[208:223]
    ds_read_b128 v[44:47], v4 offset:36864
    s_mov_b32 s11, 327680
    buffer_store_dwordx4 v[24:27], v5, s[60:63], s11 offen sc1
    s_waitcnt vmcnt(7)
    s_barrier
    v_mov_b32 v13, 3
    buffer_store_dword v13, v12, s[60:63], 0 offen sc1
    s_waitcnt lgkmcnt(3)
    v_mfma_f32_32x32x16_bf16 v[208:223], v[32:35], v[48:51], v[208:223]
    ds_read_b128 v[32:35], v3 offset:40960
    v_cvt_pk_bf16_f32 v28, v200, v201
    v_cvt_pk_bf16_f32 v29, v202, v203
    s_waitcnt lgkmcnt(3)
    v_mfma_f32_32x32x16_bf16 v[208:223], v[36:39], v[52:55], v[208:223]
    ds_read_b128 v[36:39], v4 offset:40960
    v_cvt_pk_bf16_f32 v30, v204, v205
    v_cvt_pk_bf16_f32 v31, v206, v207
    s_waitcnt lgkmcnt(3)
    v_mfma_f32_32x32x16_bf16 v[208:223], v[40:43], v[56:59], v[208:223]
    ds_read_b128 v[40:43], v3 offset:45056
    s_mov_b32 s11, 344064
    buffer_store_dwordx4 v[28:31], v5, s[60:63], s11 offen sc1
    s_waitcnt lgkmcnt(3)
    v_mfma_f32_32x32x16_bf16 v[208:223], v[44:47], v[60:63], v[208:223]
    ds_read_b128 v[44:47], v4 offset:45056
    s_waitcnt lgkmcnt(3)
    v_mfma_f32_32x32x16_bf16 v[224:239], v[32:35], v[64:67], v[224:239]
    ds_read_b128 v[32:35], v3 offset:49152
    s_waitcnt lgkmcnt(3)
    v_mfma_f32_32x32x16_bf16 v[224:239], v[36:39], v[68:71], v[224:239]
    ds_read_b128 v[36:39], v4 offset:49152
    s_nop 6
    v_cvt_pk_bf16_f32 v24, v208, v209
    v_cvt_pk_bf16_f32 v25, v210, v211
    s_waitcnt lgkmcnt(3)
    v_mfma_f32_32x32x16_bf16 v[224:239], v[40:43], v[72:75], v[224:239]
    ds_read_b128 v[40:43], v3 offset:53248
    v_cvt_pk_bf16_f32 v26, v212, v213
    v_cvt_pk_bf16_f32 v27, v214, v215
    s_waitcnt lgkmcnt(3)
    v_mfma_f32_32x32x16_bf16 v[224:239], v[44:47], v[76:79], v[224:239]
    ds_read_b128 v[44:47], v4 offset:53248
    s_mov_b32 s11, 393216
    buffer_store_dwordx4 v[24:27], v5, s[60:63], s11 offen sc1
    s_waitcnt vmcnt(7)
    s_barrier
    v_mov_b32 v13, 4
    buffer_store_dword v13, v12, s[60:63], 0 offen sc1
    s_waitcnt lgkmcnt(3)
    v_mfma_f32_32x32x16_bf16 v[224:239], v[32:35], v[48:51], v[224:239]
    ds_read_b128 v[32:35], v3 offset:57344
    v_cvt_pk_bf16_f32 v28, v216, v217
    v_cvt_pk_bf16_f32 v29, v218, v219
    s_waitcnt lgkmcnt(3)
    v_mfma_f32_32x32x16_bf16 v[224:239], v[36:39], v[52:55], v[224:239]
    ds_read_b128 v[36:39], v4 offset:57344
    v_cvt_pk_bf16_f32 v30, v220, v221
    v_cvt_pk_bf16_f32 v31, v222, v223
    s_waitcnt lgkmcnt(3)
    v_mfma_f32_32x32x16_bf16 v[224:239], v[40:43], v[56:59], v[224:239]
    ds_read_b128 v[40:43], v3 offset:61440
    s_mov_b32 s11, 409600
    buffer_store_dwordx4 v[28:31], v5, s[60:63], s11 offen sc1
    s_waitcnt lgkmcnt(3)
    v_mfma_f32_32x32x16_bf16 v[224:239], v[44:47], v[60:63], v[224:239]
    ds_read_b128 v[44:47], v4 offset:61440
    s_waitcnt lgkmcnt(3)
    v_mfma_f32_32x32x16_bf16 v[240:255], v[32:35], v[64:67], v[240:255]
    ds_read_b128 v[32:35], v1 offset:0
    s_waitcnt lgkmcnt(3)
    v_mfma_f32_32x32x16_bf16 v[240:255], v[36:39], v[68:71], v[240:255]
    ds_read_b128 v[36:39], v2 offset:0
    s_nop 6
    v_cvt_pk_bf16_f32 v24, v224, v225
    v_cvt_pk_bf16_f32 v25, v226, v227
    s_waitcnt lgkmcnt(3)
    v_mfma_f32_32x32x16_bf16 v[240:255], v[40:43], v[72:75], v[240:255]
    ds_read_b128 v[40:43], v1 offset:4096
    v_cvt_pk_bf16_f32 v26, v228, v229
    v_cvt_pk_bf16_f32 v27, v230, v231
    s_waitcnt lgkmcnt(3)
    v_mfma_f32_32x32x16_bf16 v[240:255], v[44:47], v[76:79], v[240:255]
    ds_read_b128 v[44:47], v2 offset:4096
    s_mov_b32 s11, 458752
    buffer_store_dwordx4 v[24:27], v5, s[60:63], s11 offen sc1
    s_waitcnt vmcnt(7)
    s_barrier
    v_mov_b32 v13, 5
    buffer_store_dword v13, v12, s[60:63], 0 offen sc1
    s_waitcnt lgkmcnt(3)
    v_mfma_f32_32x32x16_bf16 v[240:255], v[32:35], v[48:51], v[240:255]
    v_cvt_pk_bf16_f32 v28, v232, v233
    v_cvt_pk_bf16_f32 v29, v234, v235
    s_waitcnt lgkmcnt(2)
    v_mfma_f32_32x32x16_bf16 v[240:255], v[36:39], v[52:55], v[240:255]
    v_cvt_pk_bf16_f32 v30, v236, v237
    v_cvt_pk_bf16_f32 v31, v238, v239
    s_waitcnt lgkmcnt(1)
    v_mfma_f32_32x32x16_bf16 v[240:255], v[40:43], v[56:59], v[240:255]
    s_mov_b32 s11, 475136
    buffer_store_dwordx4 v[28:31], v5, s[60:63], s11 offen sc1
    s_waitcnt lgkmcnt(0)
    v_mfma_f32_32x32x16_bf16 v[240:255], v[44:47], v[60:63], v[240:255]
    s_nop 7
    s_nop 5
    v_cvt_pk_bf16_f32 v24, v240, v241
    v_cvt_pk_bf16_f32 v25, v242, v243
    v_cvt_pk_bf16_f32 v26, v244, v245
    v_cvt_pk_bf16_f32 v27, v246, v247
    s_mov_b32 s11, 524288
    buffer_store_dwordx4 v[24:27], v5, s[60:63], s11 offen sc1
    v_cvt_pk_bf16_f32 v28, v248, v249
    v_cvt_pk_bf16_f32 v29, v250, v251
    v_cvt_pk_bf16_f32 v30, v252, v253
    v_cvt_pk_bf16_f32 v31, v254, v255
    s_mov_b32 s11, 540672
    buffer_store_dwordx4 v[28:31], v5, s[60:63], s11 offen sc1
    s_waitcnt vmcnt(0)
    s_barrier
    v_mov_b32 v13, 9
    buffer_store_dword v13, v12, s[60:63], 0 offen sc1
    s_endpgm
.Lssm_h1:
    s_waitcnt lgkmcnt(1)
    s_waitcnt vmcnt(2)
    s_barrier
    s_lshl_b32 s11, s5, 7
    s_add_u32 s11, s11, 92160
    v_lshrrev_b32 v30, 5, v0
    v_lshl_add_u32 v5, v30, 6, s11
    ds_read_b128 v[14:17], v5 offset:0
    ds_read_b128 v[18:21], v5 offset:16
    ds_read_b128 v[22:25], v5 offset:32
    s_lshl_b32 s11, s6, 12
    s_lshl_b32 s73, s5, 9
    s_add_u32 s11, s11, s73
    s_add_u32 s11, s11, 81920
    v_and_b32 v31, 31, v0
    v_lshlrev_b32 v31, 3, v31
    v_lshrrev_b32 v30, 5, v0
    v_lshl_add_u32 v31, v30, 8, v31
    v_add_u32 v31, s11, v31
    s_waitcnt lgkmcnt(3)
    s_waitcnt lgkmcnt(2)
    v_mul_f32 v48, v14, v48
    v_mul_f32 v64, v14, v64
    v_mul_f32 v49, v15, v49
    v_mul_f32 v65, v15, v65
    v_mul_f32 v50, v16, v50
    v_mul_f32 v66, v16, v66
    v_mul_f32 v51, v17, v51
    v_mul_f32 v67, v17, v67
    ds_read_b128 v[14:17], v5 offset:48
    s_waitcnt lgkmcnt(2)
    v_mul_f32 v52, v18, v52
    v_mul_f32 v68, v18, v68
    v_mul_f32 v53, v19, v53
    v_mul_f32 v69, v19, v69
    v_mul_f32 v54, v20, v54
    v_mul_f32 v70, v20, v70
    v_mul_f32 v55, v21, v55
    v_mul_f32 v71, v21, v71
    s_waitcnt lgkmcnt(1)
    v_mul_f32 v56, v22, v56
    v_mul_f32 v72, v22, v72
    v_mul_f32 v57, v23, v57
    v_mul_f32 v73, v23, v73
    v_mul_f32 v58, v24, v58
    v_mul_f32 v74, v24, v74
    v_mul_f32 v59, v25, v59
    v_mul_f32 v75, v25, v75
    s_waitcnt lgkmcnt(0)
    v_mul_f32 v60, v14, v60
    v_mul_f32 v76, v14, v76
    v_mul_f32 v61, v15, v61
    v_mul_f32 v77, v15, v77
    v_mul_f32 v62, v16, v62
    v_mul_f32 v78, v16, v78
    v_mul_f32 v63, v17, v63
    v_mul_f32 v79, v17, v79
    v_fma_f32 v28, v8, v48, v49
    v_fma_f32 v29, v8, v64, v65
    v_fma_f32 v28, -v9, v64, v28
    v_fma_f32 v29, v9, v48, v29
    v_fma_f32 v26, v8, v28, v50
    v_fma_f32 v27, v8, v29, v66
    v_fma_f32 v26, -v9, v29, v26
    v_fma_f32 v27, v9, v28, v27
    v_fma_f32 v28, v8, v26, v51
    v_fma_f32 v29, v8, v27, v67
    v_fma_f32 v28, -v9, v27, v28
    v_fma_f32 v29, v9, v26, v29
    v_fma_f32 v26, v8, v28, v52
    v_fma_f32 v27, v8, v29, v68
    v_fma_f32 v26, -v9, v29, v26
    v_fma_f32 v27, v9, v28, v27
    v_fma_f32 v28, v8, v26, v53
    v_fma_f32 v29, v8, v27, v69
    v_fma_f32 v28, -v9, v27, v28
    v_fma_f32 v29, v9, v26, v29
    v_fma_f32 v26, v8, v28, v54
    v_fma_f32 v27, v8, v29, v70
    v_fma_f32 v26, -v9, v29, v26
    v_fma_f32 v27, v9, v28, v27
    v_fma_f32 v28, v8, v26, v55
    v_fma_f32 v29, v8, v27, v71
    v_fma_f32 v28, -v9, v27, v28
    v_fma_f32 v29, v9, v26, v29
    v_fma_f32 v26, v8, v28, v56
    v_fma_f32 v27, v8, v29, v72
    v_fma_f32 v26, -v9, v29, v26
    v_fma_f32 v27, v9, v28, v27
    v_fma_f32 v28, v8, v26, v57
    v_fma_f32 v29, v8, v27, v73
    v_fma_f32 v28, -v9, v27, v28
    v_fma_f32 v29, v9, v26, v29
    v_fma_f32 v26, v8, v28, v58
    v_fma_f32 v27, v8, v29, v74
    v_fma_f32 v26, -v9, v29, v26
    v_fma_f32 v27, v9, v28, v27
    v_fma_f32 v28, v8, v26, v59
    v_fma_f32 v29, v8, v27, v75
    v_fma_f32 v28, -v9, v27, v28
    v_fma_f32 v29, v9, v26, v29
    v_fma_f32 v26, v8, v28, v60
    v_fma_f32 v27, v8, v29, v76
    v_fma_f32 v26, -v9, v29, v26
    v_fma_f32 v27, v9, v28, v27
    v_fma_f32 v28, v8, v26, v61
    v_fma_f32 v29, v8, v27, v77
    v_fma_f32 v28, -v9, v27, v28
    v_fma_f32 v29, v9, v26, v29
    v_fma_f32 v26, v8, v28, v62
    v_fma_f32 v27, v8, v29, v78
    v_fma_f32 v26, -v9, v29, v26
    v_fma_f32 v27, v9, v28, v27
    v_fma_f32 v28, v8, v26, v63
    v_fma_f32 v29, v8, v27, v79
    v_fma_f32 v28, -v9, v27, v28
    v_fma_f32 v29, v9, v26, v29
    ds_write_b64 v31, v[28:29] offset:1792
    s_waitcnt lgkmcnt(0)
    s_waitcnt vmcnt(0)
    s_barrier
    ds_read_b64 v[14:15], v31 offset:0
    ds_read_b64 v[16:17], v31 offset:256
    ds_read_b64 v[18:19], v31 offset:512
    ds_read_b64 v[20:21], v31 offset:768
    ds_read_b64 v[22:23], v31 offset:1024
    ds_read_b64 v[24:25], v31 offset:1280
    ds_read_b64 v[26:27], v31 offset:1536
    v_mul_f32 v12, v9, v9
    v_mul_f32 v5, v8, v9
    v_fma_f32 v30, v8, v8, -v12
    v_add_f32 v5, v5, v5
    v_mul_f32 v12, v5, v5
    v_mul_f32 v5, v30, v5
    v_fma_f32 v30, v30, v30, -v12
    v_add_f32 v5, v5, v5
    v_mul_f32 v12, v5, v5
    v_mul_f32 v5, v30, v5
    v_fma_f32 v30, v30, v30, -v12
    v_add_f32 v5, v5, v5
    v_mul_f32 v12, v5, v5
    v_mul_f32 v5, v30, v5
    v_fma_f32 v30, v30, v30, -v12
    v_add_f32 v5, v5, v5
    s_waitcnt lgkmcnt(5)
    v_fma_f32 v16, v30, v14, v16
    v_fma_f32 v17, v30, v15, v17
    v_fma_f32 v16, -v5, v15, v16
    v_fma_f32 v17, v5, v14, v17
    s_waitcnt lgkmcnt(4)
    v_fma_f32 v18, v30, v16, v18
    v_fma_f32 v19, v30, v17, v19
    v_fma_f32 v18, -v5, v17, v18
    v_fma_f32 v19, v5, v16, v19
    s_waitcnt lgkmcnt(3)
    v_fma_f32 v20, v30, v18, v20
    v_fma_f32 v21, v30, v19, v21
    v_fma_f32 v20, -v5, v19, v20
    v_fma_f32 v21, v5, v18, v21
    s_waitcnt lgkmcnt(2)
    v_fma_f32 v22, v30, v20, v22
    v_fma_f32 v23, v30, v21, v23
    v_fma_f32 v22, -v5, v21, v22
    v_fma_f32 v23, v5, v20, v23
    s_waitcnt lgkmcnt(1)
    v_fma_f32 v24, v30, v22, v24
    v_fma_f32 v25, v30, v23, v25
    v_fma_f32 v24, -v5, v23, v24
    v_fma_f32 v25, v5, v22, v25
    s_waitcnt lgkmcnt(0)
    v_fma_f32 v12, v30, v24, v26
    v_fma_f32 v13, v30, v25, v27
    v_fma_f32 v12, -v5, v25, v12
    v_fma_f32 v13, v5, v24, v13
    v_fma_f32 v28, v30, v12, v28
    v_fma_f32 v29, v30, v13, v29
    v_fma_f32 v28, -v5, v13, v28
    v_fma_f32 v29, v5, v12, v29
    s_mul_i32 s11, s7, 4608
    s_add_u32 s73, s78, s6
    s_lshl_b32 s73, s73, 8
    s_add_u32 s11, s11, s73
    s_add_u32 s11, s11, 256
    s_cmp_eq_u32 s5, 3
    s_cselect_b32 s11, s11, 0x100000
    v_lshlrev_b32 v30, 3, v0
    v_add_u32 v30, s11, v30
    v_mov_b32 v5, 0x100000
    v_cndmask_b32 v30, v5, v30, s[96:97]
    s_barrier
    buffer_store_dwordx2 v[28:29], v30, s[48:51], 0 offen sc1
    s_barrier
    s_barrier
    s_lshl_b32 s11, s8, 4
    s_add_u32 s11, s11, s7
    s_lshl_b32 s11, s11, 2
    s_cmp_eq_u32 s4, 3
    s_cselect_b32 s11, s11, 0x1000
    s_cmp_eq_u32 s7, 15
    s_cselect_b32 s11, 0x1000, s11
    v_lshlrev_b32 v30, 12, v0
    v_add_u32 v30, s11, v30
    v_mov_b32 v31, 2
    buffer_store_dword v31, v30, s[68:71], 0 offen sc1
    s_barrier
    s_lshl_b32 s11, s5, 4
    v_lshrrev_b32 v6, 2, v0
    v_add_u32 v6, s11, v6
    v_mul_u32_u24 v6, 0x480, v6
    v_lshrrev_b32 v7, 4, v0
    v_xor_b32 v7, v7, v0
    v_and_b32 v7, 3, v7
    v_lshl_add_u32 v6, v7, 4, v6
    s_barrier
    v_and_b32 v31, 15, v0
    s_lshl_b32 s11, s8, 6
    v_lshlrev_b32 v31, 2, v31
    v_add_u32 v31, s11, v31
    buffer_load_dword v30, v31, s[68:71], 0 offen sc1
    s_add_u32 m0, s9, 32768
    s_add_u32 s10, s72, 0
    buffer_load_dwordx4 v6, s[56:59], s10 offen lds
    s_add_u32 m0, s9, 40960
    s_add_u32 s10, s72, 73728
    buffer_load_dwordx4 v6, s[56:59], s10 offen lds
    s_barrier
    s_waitcnt vmcnt(2)
    v_cmp_gt_u32 vcc, 2, v30
    s_and_b64 vcc, vcc, s[94:95]
    s_cbranch_scc0 .pok_18
    s_mov_b32 s83, 65536
.plp_19:
    buffer_load_dword v30, v31, s[68:71], 0 offen sc1
    s_waitcnt vmcnt(0)
    v_cmp_gt_u32 vcc, 2, v30
    s_and_b64 vcc, vcc, s[94:95]
    s_cbranch_scc0 .pok_18
    s_sub_u32 s83, s83, 1
    s_cmp_lg_u32 s83, 0
    s_cbranch_scc1 .plp_19
.pok_18:
    s_sub_u32 s11, s7, 1
    s_mul_i32 s11, s11, 4608
    s_add_u32 s73, s78, s6
    s_lshl_b32 s73, s73, 8
    s_add_u32 s11, s11, s73
    s_add_u32 s11, s11, 512
    v_and_b32 v30, 31, v0
    v_lshlrev_b32 v30, 3, v30
    v_lshrrev_b32 v31, 5, v0
    v_mul_u32_u24 v31, 4608, v31
    v_sub_u32 v30, v30, v31
    v_add_u32 v30, s11, v30
    v_subrev_u32 v28, 64512, v30
    buffer_load_dwordx2 v[28:29], v28, s[48:51], 0 offen sc1
    v_subrev_u32 v26, 55296, v30
    buffer_load_dwordx2 v[26:27], v26, s[48:51], 0 offen sc1
    v_subrev_u32 v24, 46080, v30
    buffer_load_dwordx2 v[24:25], v24, s[48:51], 0 offen sc1
    v_subrev_u32 v22, 36864, v30
    buffer_load_dwordx2 v[22:23], v22, s[48:51], 0 offen sc1
    v_subrev_u32 v20, 27648, v30
    buffer_load_dwordx2 v[20:21], v20, s[48:51], 0 offen sc1
    v_subrev_u32 v18, 18432, v30
    buffer_load_dwordx2 v[18:19], v18, s[48:51], 0 offen sc1
    v_subrev_u32 v16, 9216, v30
    buffer_load_dwordx2 v[16:17], v16, s[48:51], 0 offen sc1
    v_subrev_u32 v14, 0, v30
    buffer_load_dwordx2 v[14:15], v14, s[48:51], 0 offen sc1
    s_add_u32 m0, s9, 49152
    s_add_u32 s10, s72, 147456
    buffer_load_dwordx4 v6, s[56:59], s10 offen lds
    s_add_u32 m0, s9, 57344
    s_add_u32 s10, s72, 221184
    buffer_load_dwordx4 v6, s[56:59], s10 offen lds
    v_mul_f32 v5, v9, v9
    v_mul_f32 v31, v8, v9
    v_fma_f32 v30, v8, v8, -v5
    v_add_f32 v31, v31, v31
    v_mul_f32 v5, v31, v31
    v_mul_f32 v31, v30, v31
    v_fma_f32 v30, v30, v30, -v5
    v_add_f32 v31, v31, v31
    v_mul_f32 v5, v31, v31
    v_mul_f32 v31, v30, v31
    v_fma_f32 v30, v30, v30, -v5
    v_add_f32 v31, v31, v31
    v_mul_f32 v5, v31, v31
    v_mul_f32 v31, v30, v31
    v_fma_f32 v30, v30, v30, -v5
    v_add_f32 v31, v31, v31
    v_mul_f32 v5, v31, v31
    v_mul_f32 v31, v30, v31
    v_fma_f32 v30, v30, v30, -v5
    v_add_f32 v31, v31, v31
    v_mul_f32 v5, v31, v31
    v_mul_f32 v31, v30, v31
    v_fma_f32 v30, v30, v30, -v5
    v_add_f32 v31, v31, v31
    v_mul_f32 v5, v31, v31
    v_mul_f32 v31, v30, v31
    v_fma_f32 v30, v30, v30, -v5
    v_add_f32 v31, v31, v31
    v_mul_f32 v5, v31, v31
    v_mul_f32 v31, v30, v31
    v_fma_f32 v30, v30, v30, -v5
    v_add_f32 v31, v31, v31
    s_waitcnt vmcnt(10)
    s_barrier
    s_lshl_b32 s11, s6, 11
    s_add_u32 s11, s11, 98304
    v_bfe_u32 v1, v0, 2, 2
    v_lshrrev_b32 v2, 5, v0
    v_xor_b32 v1, v1, v2
    v_and_b32 v2, 31, v0
    v_lshlrev_b32 v2, 6, v2
    v_add_u32 v2, s11, v2
    v_lshl_add_u32 v1, v1, 4, v2
    v_xor_b32 v2, 32, v1
    s_add_u32 m0, s9, 0
    s_add_u32 s10, s72, 294912
    buffer_load_dwordx4 v6, s[56:59], s10 offen lds
    s_add_u32 m0, s9, 8192
    s_add_u32 s10, s72, 368640
    buffer_load_dwordx4 v6, s[56:59], s10 offen lds
    s_waitcnt vmcnt(10)
    v_fma_f32 v26, v30, v28, v26
    v_fma_f32 v27, v30, v29, v27
    v_fma_f32 v26, -v31, v29, v26
    v_fma_f32 v27, v31, v28, v27
    s_waitcnt vmcnt(9)
    v_fma_f32 v24, v30, v26, v24
    v_fma_f32 v25, v30, v27, v25
    v_fma_f32 v24, -v31, v27, v24
    v_fma_f32 v25, v31, v26, v25
    s_waitcnt vmcnt(8)
    v_fma_f32 v22, v30, v24, v22
    v_fma_f32 v23, v30, v25, v23
    v_fma_f32 v22, -v31, v25, v22
    v_fma_f32 v23, v31, v24, v23
    s_waitcnt vmcnt(7)
    v_fma_f32 v20, v30, v22, v20
    v_fma_f32 v21, v30, v23, v21
    v_fma_f32 v20, -v31, v23, v20
    v_fma_f32 v21, v31, v22, v21
    s_waitcnt vmcnt(6)
    v_fma_f32 v18, v30, v20, v18
    v_fma_f32 v19, v30, v21, v19
    v_fma_f32 v18, -v31, v21, v18
    v_fma_f32 v19, v31, v20, v19
    s_waitcnt vmcnt(5)
    v_fma_f32 v16, v30, v18, v16
    v_fma_f32 v17, v30, v19, v17
    v_fma_f32 v16, -v31, v19, v16
    v_fma_f32 v17, v31, v18, v17
    s_waitcnt vmcnt(4)
    v_fma_f32 v14, v30, v16, v14
    v_fma_f32 v15, v30, v17, v15
    v_fma_f32 v14, -v31, v17, v14
    v_fma_f32 v15, v31, v16, v15
    v_mul_f32 v5, v9, v9
    v_mul_f32 v17, v8, v9
    v_fma_f32 v16, v8, v8, -v5
    v_add_f32 v17, v17, v17
    v_mul_f32 v5, v17, v17
    v_mul_f32 v17, v16, v17
    v_fma_f32 v16, v16, v16, -v5
    v_add_f32 v17, v17, v17
    v_mul_f32 v5, v17, v17
    v_mul_f32 v17, v16, v17
    v_fma_f32 v16, v16, v16, -v5
    v_add_f32 v17, v17, v17
    v_mul_f32 v5, v17, v17
    v_mul_f32 v17, v16, v17
    v_fma_f32 v16, v16, v16, -v5
    v_add_f32 v17, v17, v17
    v_mul_f32 v5, v17, v17
    v_mul_f32 v19, v16, v17
    v_fma_f32 v18, v16, v16, -v5
    v_add_f32 v19, v19, v19
    v_mul_f32 v5, v19, v19
    v_mul_f32 v21, v18, v19
    v_fma_f32 v20, v18, v18, -v5
    v_add_f32 v21, v21, v21
    v_mul_f32 v5, v21, v21
    v_mul_f32 v23, v20, v21
    v_fma_f32 v22, v20, v20, -v5
    v_add_f32 v23, v23, v23
    v_mul_f32 v24, v22, v14
    v_mul_f32 v25, v22, v15
    v_fma_f32 v24, -v23, v15, v24
    v_fma_f32 v25, v23, v14, v25
    v_cndmask_b32 v14, v14, v24, s[96:97]
    v_cndmask_b32 v15, v15, v25, s[96:97]
    v_mov_b32 v24, v14
    v_mov_b32 v25, v15
    v_cndmask_b32 v16, 1.0, v16, s[96:97]
    v_cndmask_b32 v17, 0, v17, s[96:97]
    v_permlane32_swap_b32 v14, v24
    v_permlane32_swap_b32 v15, v25
    v_cndmask_b32 v18, 1.0, v18, s[98:99]
    v_cndmask_b32 v19, 0, v19, s[98:99]
    v_cndmask_b32 v20, 1.0, v20, s[100:101]
    v_cndmask_b32 v21, 0, v21, s[100:101]
    v_add_f32 v14, v14, v24
    v_add_f32 v15, v15, v25
    v_mul_f32 v22, v16, v18
    v_mul_f32 v23, v16, v19
    v_fma_f32 v22, -v17, v19, v22
    v_fma_f32 v23, v17, v18, v23
    v_mul_f32 v16, v22, v20
    v_mul_f32 v17, v22, v21
    v_fma_f32 v16, -v23, v21, v16
    v_fma_f32 v17, v23, v20, v17
    v_fma_f32 v12, v16, v14, v12
    v_fma_f32 v13, v16, v15, v13
    v_fma_f32 v12, -v17, v15, v12
    v_fma_f32 v13, v17, v14, v13
    v_and_b32 v30, 3, v0
    v_xor_b32 v30, s5, v30
    v_lshlrev_b32 v30, 6, v30
    v_and_b32 v31, 31, v0
    v_lshl_add_u32 v30, v31, 8, v30
    v_lshrrev_b32 v31, 5, v0
    v_lshl_add_u32 v30, v31, 5, v30
    s_lshl_b32 s11, s6, 14
    s_add_u32 s11, s11, 32768
    v_add_u32 v31, s11, v30
    v_fma_f32 v48, v8, v12, v48
    v_fma_f32 v64, v8, v13, v64
    v_fma_f32 v48, -v9, v13, v48
    v_fma_f32 v64, v9, v12, v64
    v_mul_f32 v30, v10, v48
    v_mul_f32 v5, -v10, v64
    v_fma_f32 v30, -v11, v64, v30
    v_fma_f32 v5, -v11, v48, v5
    v_fma_f32 v49, v8, v48, v49
    v_fma_f32 v65, v8, v64, v65
    v_fma_f32 v49, -v9, v64, v49
    v_fma_f32 v65, v9, v48, v65
    v_mul_f32 v12, v10, v49
    v_mul_f32 v13, -v10, v65
    v_fma_f32 v12, -v11, v65, v12
    v_fma_f32 v13, -v11, v49, v13
    v_cvt_pk_bf16_f32 v14, v30, v12
    v_cvt_pk_bf16_f32 v18, v5, v13
    v_fma_f32 v50, v8, v49, v50
    v_fma_f32 v66, v8, v65, v66
    v_fma_f32 v50, -v9, v65, v50
    v_fma_f32 v66, v9, v49, v66
    v_mul_f32 v30, v10, v50
    v_mul_f32 v5, -v10, v66
    v_fma_f32 v30, -v11, v66, v30
    v_fma_f32 v5, -v11, v50, v5
    v_fma_f32 v51, v8, v50, v51
    v_fma_f32 v67, v8, v66, v67
    v_fma_f32 v51, -v9, v66, v51
    v_fma_f32 v67, v9, v50, v67
    v_mul_f32 v12, v10, v51
    v_mul_f32 v13, -v10, v67
    v_fma_f32 v12, -v11, v67, v12
    v_fma_f32 v13, -v11, v51, v13
    v_cvt_pk_bf16_f32 v15, v30, v12
    v_cvt_pk_bf16_f32 v19, v5, v13
    v_fma_f32 v52, v8, v51, v52
    v_fma_f32 v68, v8, v67, v68
    v_fma_f32 v52, -v9, v67, v52
    v_fma_f32 v68, v9, v51, v68
    v_mul_f32 v30, v10, v52
    v_mul_f32 v5, -v10, v68
    v_fma_f32 v30, -v11, v68, v30
    v_fma_f32 v5, -v11, v52, v5
    v_fma_f32 v53, v8, v52, v53
    v_fma_f32 v69, v8, v68, v69
    v_fma_f32 v53, -v9, v68, v53
    v_fma_f32 v69, v9, v52, v69
    v_mul_f32 v12, v10, v53
    v_mul_f32 v13, -v10, v69
    v_fma_f32 v12, -v11, v69, v12
    v_fma_f32 v13, -v11, v53, v13
    v_cvt_pk_bf16_f32 v16, v30, v12
    v_cvt_pk_bf16_f32 v20, v5, v13
    ds_read_b128 v[32:35], v1 offset:32768
    ds_read_b128 v[36:39], v2 offset:32768
    v_fma_f32 v54, v8, v53, v54
    v_fma_f32 v70, v8, v69, v70
    v_fma_f32 v54, -v9, v69, v54
    v_fma_f32 v70, v9, v53, v70
    v_mul_f32 v30, v10, v54
    v_mul_f32 v5, -v10, v70
    v_fma_f32 v30, -v11, v70, v30
    v_fma_f32 v5, -v11, v54, v5
    v_fma_f32 v55, v8, v54, v55
    v_fma_f32 v71, v8, v70, v71
    v_fma_f32 v55, -v9, v70, v55
    v_fma_f32 v71, v9, v54, v71
    v_mul_f32 v12, v10, v55
    v_mul_f32 v13, -v10, v71
    v_fma_f32 v12, -v11, v71, v12
    v_fma_f32 v13, -v11, v55, v13
    v_cvt_pk_bf16_f32 v17, v30, v12
    v_cvt_pk_bf16_f32 v21, v5, v13
    ds_write_b128 v31, v[14:17] offset:0
    ds_write_b128 v31, v[18:21] offset:8192
    v_fma_f32 v56, v8, v55, v56
    v_fma_f32 v72, v8, v71, v72
    v_fma_f32 v56, -v9, v71, v56
    v_fma_f32 v72, v9, v55, v72
    v_mul_f32 v30, v10, v56
    v_mul_f32 v5, -v10, v72
    v_fma_f32 v30, -v11, v72, v30
    v_fma_f32 v5, -v11, v56, v5
    v_fma_f32 v57, v8, v56, v57
    v_fma_f32 v73, v8, v72, v73
    v_fma_f32 v57, -v9, v72, v57
    v_fma_f32 v73, v9, v56, v73
    v_mul_f32 v12, v10, v57
    v_mul_f32 v13, -v10, v73
    v_fma_f32 v12, -v11, v73, v12
    v_fma_f32 v13, -v11, v57, v13
    v_cvt_pk_bf16_f32 v22, v30, v12
    v_cvt_pk_bf16_f32 v26, v5, v13
    v_fma_f32 v58, v8, v57, v58
    v_fma_f32 v74, v8, v73, v74
    v_fma_f32 v58, -v9, v73, v58
    v_fma_f32 v74, v9, v57, v74
    v_mul_f32 v30, v10, v58
    v_mul_f32 v5, -v10, v74
    v_fma_f32 v30, -v11, v74, v30
    v_fma_f32 v5, -v11, v58, v5
    v_fma_f32 v59, v8, v58, v59
    v_fma_f32 v75, v8, v74, v75
    v_fma_f32 v59, -v9, v74, v59
    v_fma_f32 v75, v9, v58, v75
    v_mul_f32 v12, v10, v59
    v_mul_f32 v13, -v10, v75
    v_fma_f32 v12, -v11, v75, v12
    v_fma_f32 v13, -v11, v59, v13
    v_cvt_pk_bf16_f32 v23, v30, v12
    v_cvt_pk_bf16_f32 v27, v5, v13
    v_fma_f32 v60, v8, v59, v60
    v_fma_f32 v76, v8, v75, v76
    v_fma_f32 v60, -v9, v75, v60
    v_fma_f32 v76, v9, v59, v76
    v_mul_f32 v30, v10, v60
    v_mul_f32 v5, -v10, v76
    v_fma_f32 v30, -v11, v76, v30
    ds_read_b128 v[40:43], v1 offset:36864
    ds_read_b128 v[44:47], v2 offset:36864
    v_fma_f32 v5, -v11, v60, v5
    v_fma_f32 v61, v8, v60, v61
    v_fma_f32 v77, v8, v76, v77
    v_fma_f32 v61, -v9, v76, v61
    v_fma_f32 v77, v9, v60, v77
    v_mul_f32 v12, v10, v61
    v_mul_f32 v13, -v10, v77
    v_fma_f32 v12, -v11, v77, v12
    v_fma_f32 v13, -v11, v61, v13
    v_cvt_pk_bf16_f32 v24, v30, v12
    v_cvt_pk_bf16_f32 v28, v5, v13
    v_fma_f32 v62, v8, v61, v62
    v_fma_f32 v78, v8, v77, v78
    v_fma_f32 v62, -v9, v77, v62
    v_fma_f32 v78, v9, v61, v78
    v_mul_f32 v30, v10, v62
    v_mul_f32 v5, -v10, v78
    v_fma_f32 v30, -v11, v78, v30
    v_fma_f32 v5, -v11, v62, v5
    v_fma_f32 v63, v8, v62, v63
    v_fma_f32 v79, v8, v78, v79
    v_fma_f32 v63, -v9, v78, v63
    v_fma_f32 v79, v9, v62, v79
    v_mul_f32 v12, v10, v63
    v_mul_f32 v13, -v10, v79
    v_fma_f32 v12, -v11, v79, v12
    v_fma_f32 v13, -v11, v63, v13
    v_cvt_pk_bf16_f32 v25, v30, v12
    v_cvt_pk_bf16_f32 v29, v5, v13
    ds_write_b128 v31, v[22:25] offset:16
    ds_write_b128 v31, v[26:29] offset:8208
    s_waitcnt lgkmcnt(0)
    s_waitcnt vmcnt(2)
    s_barrier
    v_bfe_u32 v4, v0, 2, 2
    v_xor_b32 v3, s5, v4
    v_lshlrev_b32 v3, 6, v3
    v_lshl_add_u32 v3, v4, 8, v3
    v_lshrrev_b32 v4, 5, v0
    v_lshl_add_u32 v3, v4, 11, v3
    v_bfe_u32 v4, v0, 4, 1
    v_lshl_add_u32 v3, v4, 5, v3
    v_and_b32 v4, 3, v0
    v_lshl_add_u32 v3, v4, 3, v3
    v_add_u32 v4, 0x10000, v3
    ds_read_b64_tr_b16 v[48:49], v3 offset:0
    ds_read_b64_tr_b16 v[50:51], v3 offset:1024
    ds_read_b64_tr_b16 v[52:53], v3 offset:4096
    ds_read_b64_tr_b16 v[54:55], v3 offset:5120
    ds_read_b64_tr_b16 v[56:57], v3 offset:8192
    ds_read_b64_tr_b16 v[58:59], v3 offset:9216
    ds_read_b64_tr_b16 v[60:61], v3 offset:12288
    ds_read_b64_tr_b16 v[62:63], v3 offset:13312
    s_add_u32 m0, s9, 16384
    s_add_u32 s10, s72, 442368
    buffer_load_dwordx4 v6, s[56:59], s10 offen lds
    s_add_u32 m0, s9, 24576
    s_add_u32 s10, s72, 516096
    buffer_load_dwordx4 v6, s[56:59], s10 offen lds
    s_waitcnt lgkmcnt(6)
    v_mfma_f32_32x32x16_bf16 v[112:127], v[32:35], v[48:51], 0
    ds_read_b128 v[32:35], v1 offset:40960
    s_waitcnt lgkmcnt(5)
    v_mfma_f32_32x32x16_bf16 v[112:127], v[36:39], v[52:55], v[112:127]
    ds_read_b128 v[36:39], v2 offset:40960
    s_waitcnt lgkmcnt(4)
    v_mfma_f32_32x32x16_bf16 v[112:127], v[40:43], v[56:59], v[112:127]
    ds_read_b128 v[40:43], v1 offset:45056
    s_waitcnt lgkmcnt(3)
    v_mfma_f32_32x32x16_bf16 v[112:127], v[44:47], v[60:63], v[112:127]
    ds_read_b128 v[44:47], v2 offset:45056
    s_waitcnt lgkmcnt(3)
    v_mfma_f32_32x32x16_bf16 v[128:143], v[32:35], v[48:51], 0
    ds_read_b128 v[32:35], v1 offset:49152
    s_waitcnt lgkmcnt(3)
    v_mfma_f32_32x32x16_bf16 v[128:143], v[36:39], v[52:55], v[128:143]
    ds_read_b128 v[36:39], v2 offset:49152
    s_waitcnt lgkmcnt(3)
    v_mfma_f32_32x32x16_bf16 v[128:143], v[40:43], v[56:59], v[128:143]
    ds_read_b128 v[40:43], v1 offset:53248
    s_waitcnt lgkmcnt(3)
    v_mfma_f32_32x32x16_bf16 v[128:143], v[44:47], v[60:63], v[128:143]
    ds_read_b128 v[44:47], v2 offset:53248
    s_waitcnt vmcnt(2)
    s_barrier
    s_add_u32 m0, s9, 32768
    s_add_u32 s10, s72, 589824
    buffer_load_dwordx4 v6, s[56:59], s10 offen lds
    s_add_u32 m0, s9, 40960
    s_add_u32 s10, s72, 64
    buffer_load_dwordx4 v6, s[56:59], s10 offen lds
    s_waitcnt lgkmcnt(3)
    v_mfma_f32_32x32x16_bf16 v[144:159], v[32:35], v[48:51], 0
    ds_read_b128 v[32:35], v1 offset:57344
    s_waitcnt lgkmcnt(3)
    v_mfma_f32_32x32x16_bf16 v[144:159], v[36:39], v[52:55], v[144:159]
    ds_read_b128 v[36:39], v2 offset:57344
    s_waitcnt lgkmcnt(3)
    v_mfma_f32_32x32x16_bf16 v[144:159], v[40:43], v[56:59], v[144:159]
    ds_read_b128 v[40:43], v1 offset:61440
    s_waitcnt lgkmcnt(3)
    v_mfma_f32_32x32x16_bf16 v[144:159], v[44:47], v[60:63], v[144:159]
    ds_read_b128 v[44:47], v2 offset:61440
    s_waitcnt lgkmcnt(3)
    v_mfma_f32_32x32x16_bf16 v[160:175], v[32:35], v[48:51], 0
    ds_read_b128 v[32:35], v1 offset:0
    s_waitcnt lgkmcnt(3)
    v_mfma_f32_32x32x16_bf16 v[160:175], v[36:39], v[52:55], v[160:175]
    ds_read_b128 v[36:39], v2 offset:0
    s_waitcnt lgkmcnt(3)
    v_mfma_f32_32x32x16_bf16 v[160:175], v[40:43], v[56:59], v[160:175]
    ds_read_b128 v[40:43], v1 offset:4096
    s_waitcnt lgkmcnt(3)
    v_mfma_f32_32x32x16_bf16 v[160:175], v[44:47], v[60:63], v[160:175]
    ds_read_b128 v[44:47], v2 offset:4096
    s_waitcnt vmcnt(2)
    s_barrier
    s_add_u32 m0, s9, 49152
    s_add_u32 s10, s72, 73792
    buffer_load_dwordx4 v6, s[56:59], s10 offen lds
    s_add_u32 m0, s9, 57344
    s_add_u32 s10, s72, 147520
    buffer_load_dwordx4 v6, s[56:59], s10 offen lds
    s_waitcnt lgkmcnt(3)
    v_mfma_f32_32x32x16_bf16 v[176:191], v[32:35], v[48:51], 0
    ds_read_b128 v[32:35], v1 offset:8192
    s_waitcnt lgkmcnt(3)
    v_mfma_f32_32x32x16_bf16 v[176:191], v[36:39], v[52:55], v[176:191]
    ds_read_b128 v[36:39], v2 offset:8192
    s_waitcnt lgkmcnt(3)
    v_mfma_f32_32x32x16_bf16 v[176:191], v[40:43], v[56:59], v[176:191]
    ds_read_b128 v[40:43], v1 offset:12288
    s_waitcnt lgkmcnt(3)
    v_mfma_f32_32x32x16_bf16 v[176:191], v[44:47], v[60:63], v[176:191]
    ds_read_b128 v[44:47], v2 offset:12288
    s_waitcnt lgkmcnt(3)
    v_mfma_f32_32x32x16_bf16 v[192:207], v[32:35], v[48:51], 0
    ds_read_b128 v[32:35], v1 offset:16384
    s_waitcnt lgkmcnt(3)
    v_mfma_f32_32x32x16_bf16 v[192:207], v[36:39], v[52:55], v[192:207]
    ds_read_b128 v[36:39], v2 offset:16384
    s_waitcnt lgkmcnt(3)
    v_mfma_f32_32x32x16_bf16 v[192:207], v[40:43], v[56:59], v[192:207]
    ds_read_b128 v[40:43], v1 offset:20480
    s_waitcnt lgkmcnt(3)
    v_mfma_f32_32x32x16_bf16 v[192:207], v[44:47], v[60:63], v[192:207]
    ds_read_b128 v[44:47], v2 offset:20480
    s_waitcnt vmcnt(2)
    s_barrier
    s_add_u32 m0, s9, 0
    s_add_u32 s10, s72, 221248
    buffer_load_dwordx4 v6, s[56:59], s10 offen lds
    s_add_u32 m0, s9, 8192
    s_add_u32 s10, s72, 294976
    buffer_load_dwordx4 v6, s[56:59], s10 offen lds
    s_waitcnt lgkmcnt(3)
    v_mfma_f32_32x32x16_bf16 v[208:223], v[32:35], v[48:51], 0
    ds_read_b128 v[32:35], v1 offset:24576
    s_waitcnt lgkmcnt(3)
    v_mfma_f32_32x32x16_bf16 v[208:223], v[36:39], v[52:55], v[208:223]
    ds_read_b128 v[36:39], v2 offset:24576
    s_waitcnt lgkmcnt(3)
    v_mfma_f32_32x32x16_bf16 v[208:223], v[40:43], v[56:59], v[208:223]
    ds_read_b128 v[40:43], v1 offset:28672
    s_waitcnt lgkmcnt(3)
    v_mfma_f32_32x32x16_bf16 v[208:223], v[44:47], v[60:63], v[208:223]
    ds_read_b128 v[44:47], v2 offset:28672
    s_waitcnt lgkmcnt(3)
    v_mfma_f32_32x32x16_bf16 v[224:239], v[32:35], v[48:51], 0
    ds_read_b128 v[32:35], v1 offset:32768
    ds_read_b64_tr_b16 v[64:65], v3 offset:16384
    ds_read_b64_tr_b16 v[66:67], v3 offset:17408
    s_waitcnt lgkmcnt(5)
    v_mfma_f32_32x32x16_bf16 v[224:239], v[36:39], v[52:55], v[224:239]
    ds_read_b128 v[36:39], v2 offset:32768
    ds_read_b64_tr_b16 v[68:69], v3 offset:20480
    ds_read_b64_tr_b16 v[70:71], v3 offset:21504
    s_waitcnt lgkmcnt(7)
    v_mfma_f32_32x32x16_bf16 v[224:239], v[40:43], v[56:59], v[224:239]
    ds_read_b128 v[40:43], v1 offset:36864
    ds_read_b64_tr_b16 v[72:73], v3 offset:24576
    ds_read_b64_tr_b16 v[74:75], v3 offset:25600
    s_waitcnt lgkmcnt(9)
    v_mfma_f32_32x32x16_bf16 v[224:239], v[44:47], v[60:63], v[224:239]
    ds_read_b128 v[44:47], v2 offset:36864
    ds_read_b64_tr_b16 v[76:77], v3 offset:28672
    ds_read_b64_tr_b16 v[78:79], v3 offset:29696
    s_waitcnt vmcnt(2)
    s_barrier
    s_add_u32 m0, s9, 16384
    s_add_u32 s10, s72, 368704
    buffer_load_dwordx4 v6, s[56:59], s10 offen lds
    s_add_u32 m0, s9, 24576
    s_add_u32 s10, s72, 442432
    buffer_load_dwordx4 v6, s[56:59], s10 offen lds
    s_waitcnt lgkmcnt(11)
    v_mfma_f32_32x32x16_bf16 v[240:255], v[32:35], v[48:51], 0
    ds_read_b128 v[32:35], v1 offset:40960
    s_waitcnt lgkmcnt(9)
    v_mfma_f32_32x32x16_bf16 v[240:255], v[36:39], v[52:55], v[240:255]
    ds_read_b128 v[36:39], v2 offset:40960
    s_waitcnt lgkmcnt(7)
    v_mfma_f32_32x32x16_bf16 v[240:255], v[40:43], v[56:59], v[240:255]
    ds_read_b128 v[40:43], v1 offset:45056
    s_waitcnt lgkmcnt(5)
    v_mfma_f32_32x32x16_bf16 v[240:255], v[44:47], v[60:63], v[240:255]
    ds_read_b128 v[44:47], v2 offset:45056
    s_waitcnt lgkmcnt(3)
    v_mfma_f32_32x32x16_bf16 v[112:127], v[32:35], v[64:67], v[112:127]
    ds_read_b128 v[32:35], v1 offset:49152
    s_waitcnt lgkmcnt(3)
    v_mfma_f32_32x32x16_bf16 v[112:127], v[36:39], v[68:71], v[112:127]
    ds_read_b128 v[36:39], v2 offset:49152
    s_waitcnt lgkmcnt(3)
    v_mfma_f32_32x32x16_bf16 v[112:127], v[40:43], v[72:75], v[112:127]
    ds_read_b128 v[40:43], v1 offset:53248
    s_waitcnt lgkmcnt(3)
    v_mfma_f32_32x32x16_bf16 v[112:127], v[44:47], v[76:79], v[112:127]
    ds_read_b128 v[44:47], v2 offset:53248
    s_waitcnt vmcnt(2)
    s_barrier
    s_add_u32 m0, s9, 32768
    s_add_u32 s10, s72, 516160
    buffer_load_dwordx4 v6, s[56:59], s10 offen lds
    s_add_u32 m0, s9, 40960
    s_add_u32 s10, s72, 589888
    buffer_load_dwordx4 v6, s[56:59], s10 offen lds
    s_waitcnt lgkmcnt(3)
    v_mfma_f32_32x32x16_bf16 v[128:143], v[32:35], v[64:67], v[128:143]
    ds_read_b128 v[32:35], v1 offset:57344
    s_waitcnt lgkmcnt(3)
    v_mfma_f32_32x32x16_bf16 v[128:143], v[36:39], v[68:71], v[128:143]
    ds_read_b128 v[36:39], v2 offset:57344
    s_waitcnt lgkmcnt(3)
    v_mfma_f32_32x32x16_bf16 v[128:143], v[40:43], v[72:75], v[128:143]
    ds_read_b128 v[40:43], v1 offset:61440
    s_waitcnt lgkmcnt(3)
    v_mfma_f32_32x32x16_bf16 v[128:143], v[44:47], v[76:79], v[128:143]
    ds_read_b128 v[44:47], v2 offset:61440
    s_waitcnt lgkmcnt(3)
    v_mfma_f32_32x32x16_bf16 v[144:159], v[32:35], v[64:67], v[144:159]
    ds_read_b128 v[32:35], v1 offset:0
    s_waitcnt lgkmcnt(3)
    v_mfma_f32_32x32x16_bf16 v[144:159], v[36:39], v[68:71], v[144:159]
    ds_read_b128 v[36:39], v2 offset:0
    s_waitcnt lgkmcnt(3)
    v_mfma_f32_32x32x16_bf16 v[144:159], v[40:43], v[72:75], v[144:159]
    ds_read_b128 v[40:43], v1 offset:4096
    s_waitcnt lgkmcnt(3)
    v_mfma_f32_32x32x16_bf16 v[144:159], v[44:47], v[76:79], v[144:159]
    ds_read_b128 v[44:47], v2 offset:4096
    s_waitcnt vmcnt(2)
    s_barrier
    s_add_u32 m0, s9, 49152
    s_add_u32 s10, s72, 128
    buffer_load_dwordx4 v6, s[56:59], s10 offen lds
    s_add_u32 m0, s9, 57344
    s_add_u32 s10, s72, 73856
    buffer_load_dwordx4 v6, s[56:59], s10 offen lds
    s_waitcnt lgkmcnt(3)
    v_mfma_f32_32x32x16_bf16 v[160:175], v[32:35], v[64:67], v[160:175]
    ds_read_b128 v[32:35], v1 offset:8192
    s_waitcnt lgkmcnt(3)
    v_mfma_f32_32x32x16_bf16 v[160:175], v[36:39], v[68:71], v[160:175]
    ds_read_b128 v[36:39], v2 offset:8192
    s_waitcnt lgkmcnt(3)
    v_mfma_f32_32x32x16_bf16 v[160:175], v[40:43], v[72:75], v[160:175]
    ds_read_b128 v[40:43], v1 offset:12288
    s_waitcnt lgkmcnt(3)
    v_mfma_f32_32x32x16_bf16 v[160:175], v[44:47], v[76:79], v[160:175]
    ds_read_b128 v[44:47], v2 offset:12288
    s_waitcnt lgkmcnt(3)
    v_mfma_f32_32x32x16_bf16 v[176:191], v[32:35], v[64:67], v[176:191]
    ds_read_b128 v[32:35], v1 offset:16384
    s_waitcnt lgkmcnt(3)
    v_mfma_f32_32x32x16_bf16 v[176:191], v[36:39], v[68:71], v[176:191]
    ds_read_b128 v[36:39], v2 offset:16384
    s_waitcnt lgkmcnt(3)
    v_mfma_f32_32x32x16_bf16 v[176:191], v[40:43], v[72:75], v[176:191]
    ds_read_b128 v[40:43], v1 offset:20480
    s_waitcnt lgkmcnt(3)
    v_mfma_f32_32x32x16_bf16 v[176:191], v[44:47], v[76:79], v[176:191]
    ds_read_b128 v[44:47], v2 offset:20480
    s_waitcnt vmcnt(2)
    s_barrier
    s_add_u32 m0, s9, 0
    s_add_u32 s10, s72, 147584
    buffer_load_dwordx4 v6, s[56:59], s10 offen lds
    s_add_u32 m0, s9, 8192
    s_add_u32 s10, s72, 221312
    buffer_load_dwordx4 v6, s[56:59], s10 offen lds
    s_waitcnt lgkmcnt(3)
    v_mfma_f32_32x32x16_bf16 v[192:207], v[32:35], v[64:67], v[192:207]
    ds_read_b128 v[32:35], v1 offset:24576
    s_waitcnt lgkmcnt(3)
    v_mfma_f32_32x32x16_bf16 v[192:207], v[36:39], v[68:71], v[192:207]
    ds_read_b128 v[36:39], v2 offset:24576
    s_waitcnt lgkmcnt(3)
    v_mfma_f32_32x32x16_bf16 v[192:207], v[40:43], v[72:75], v[192:207]
    ds_read_b128 v[40:43], v1 offset:28672
    s_waitcnt lgkmcnt(3)
    v_mfma_f32_32x32x16_bf16 v[192:207], v[44:47], v[76:79], v[192:207]
    ds_read_b128 v[44:47], v2 offset:28672
    s_waitcnt lgkmcnt(3)
    v_mfma_f32_32x32x16_bf16 v[208:223], v[32:35], v[64:67], v[208:223]
    ds_read_b128 v[32:35], v1 offset:32768
    s_waitcnt lgkmcnt(3)
    v_mfma_f32_32x32x16_bf16 v[208:223], v[36:39], v[68:71], v[208:223]
    ds_read_b128 v[36:39], v2 offset:32768
    s_waitcnt lgkmcnt(3)
    v_mfma_f32_32x32x16_bf16 v[208:223], v[40:43], v[72:75], v[208:223]
    ds_read_b128 v[40:43], v1 offset:36864
    s_waitcnt lgkmcnt(3)
    v_mfma_f32_32x32x16_bf16 v[208:223], v[44:47], v[76:79], v[208:223]
    ds_read_b128 v[44:47], v2 offset:36864
    s_waitcnt vmcnt(2)
    s_barrier
    s_add_u32 m0, s9, 16384
    s_add_u32 s10, s72, 295040
    buffer_load_dwordx4 v6, s[56:59], s10 offen lds
    s_add_u32 m0, s9, 24576
    s_add_u32 s10, s72, 368768
    buffer_load_dwordx4 v6, s[56:59], s10 offen lds
    s_waitcnt lgkmcnt(3)
    v_mfma_f32_32x32x16_bf16 v[224:239], v[32:35], v[64:67], v[224:239]
    ds_read_b128 v[32:35], v1 offset:40960
    ds_read_b64_tr_b16 v[48:49], v3 offset:32768
    ds_read_b64_tr_b16 v[50:51], v3 offset:33792
    s_waitcnt lgkmcnt(5)
    v_mfma_f32_32x32x16_bf16 v[224:239], v[36:39], v[68:71], v[224:239]
    ds_read_b128 v[36:39], v2 offset:40960
    ds_read_b64_tr_b16 v[52:53], v3 offset:36864
    ds_read_b64_tr_b16 v[54:55], v3 offset:37888
    s_waitcnt lgkmcnt(7)
    v_mfma_f32_32x32x16_bf16 v[224:239], v[40:43], v[72:75], v[224:239]
    ds_read_b128 v[40:43], v1 offset:45056
    ds_read_b64_tr_b16 v[56:57], v3 offset:40960
    ds_read_b64_tr_b16 v[58:59], v3 offset:41984
    s_waitcnt lgkmcnt(9)
    v_mfma_f32_32x32x16_bf16 v[224:239], v[44:47], v[76:79], v[224:239]
    ds_read_b128 v[44:47], v2 offset:45056
    ds_read_b64_tr_b16 v[60:61], v3 offset:45056
    ds_read_b64_tr_b16 v[62:63], v3 offset:46080
    s_waitcnt lgkmcnt(11)
    v_mfma_f32_32x32x16_bf16 v[240:255], v[32:35], v[64:67], v[240:255]
    ds_read_b128 v[32:35], v1 offset:49152
    s_waitcnt lgkmcnt(9)
    v_mfma_f32_32x32x16_bf16 v[240:255], v[36:39], v[68:71], v[240:255]
    ds_read_b128 v[36:39], v2 offset:49152
    s_waitcnt lgkmcnt(7)
    v_mfma_f32_32x32x16_bf16 v[240:255], v[40:43], v[72:75], v[240:255]
    ds_read_b128 v[40:43], v1 offset:53248
    s_waitcnt lgkmcnt(5)
    v_mfma_f32_32x32x16_bf16 v[240:255], v[44:47], v[76:79], v[240:255]
    ds_read_b128 v[44:47], v2 offset:53248
    s_waitcnt vmcnt(2)
    s_barrier
    s_add_u32 m0, s9, 32768
    s_add_u32 s10, s72, 442496
    buffer_load_dwordx4 v6, s[56:59], s10 offen lds
    s_add_u32 m0, s9, 40960
    s_add_u32 s10, s72, 516224
    buffer_load_dwordx4 v6, s[56:59], s10 offen lds
    s_waitcnt lgkmcnt(3)
    v_mfma_f32_32x32x16_bf16 v[112:127], v[32:35], v[48:51], v[112:127]
    ds_read_b128 v[32:35], v1 offset:57344
    s_waitcnt lgkmcnt(3)
    v_mfma_f32_32x32x16_bf16 v[112:127], v[36:39], v[52:55], v[112:127]
    ds_read_b128 v[36:39], v2 offset:57344
    s_waitcnt lgkmcnt(3)
    v_mfma_f32_32x32x16_bf16 v[112:127], v[40:43], v[56:59], v[112:127]
    ds_read_b128 v[40:43], v1 offset:61440
    s_waitcnt lgkmcnt(3)
    v_mfma_f32_32x32x16_bf16 v[112:127], v[44:47], v[60:63], v[112:127]
    ds_read_b128 v[44:47], v2 offset:61440
    s_waitcnt lgkmcnt(3)
    v_mfma_f32_32x32x16_bf16 v[128:143], v[32:35], v[48:51], v[128:143]
    ds_read_b128 v[32:35], v1 offset:0
    s_waitcnt lgkmcnt(3)
    v_mfma_f32_32x32x16_bf16 v[128:143], v[36:39], v[52:55], v[128:143]
    ds_read_b128 v[36:39], v2 offset:0
    s_waitcnt lgkmcnt(3)
    v_mfma_f32_32x32x16_bf16 v[128:143], v[40:43], v[56:59], v[128:143]
    ds_read_b128 v[40:43], v1 offset:4096
    s_waitcnt lgkmcnt(3)
    v_mfma_f32_32x32x16_bf16 v[128:143], v[44:47], v[60:63], v[128:143]
    ds_read_b128 v[44:47], v2 offset:4096
    s_waitcnt vmcnt(2)
    s_barrier
    s_add_u32 m0, s9, 49152
    s_add_u32 s10, s72, 589952
    buffer_load_dwordx4 v6, s[56:59], s10 offen lds
    s_add_u32 m0, s9, 57344
    s_add_u32 s10, s72, 192
    buffer_load_dwordx4 v6, s[56:59], s10 offen lds
    s_waitcnt lgkmcnt(3)
    v_mfma_f32_32x32x16_bf16 v[144:159], v[32:35], v[48:51], v[144:159]
    ds_read_b128 v[32:35], v1 offset:8192
    s_waitcnt lgkmcnt(3)
    v_mfma_f32_32x32x16_bf16 v[144:159], v[36:39], v[52:55], v[144:159]
    ds_read_b128 v[36:39], v2 offset:8192
    s_waitcnt lgkmcnt(3)
    v_mfma_f32_32x32x16_bf16 v[144:159], v[40:43], v[56:59], v[144:159]
    ds_read_b128 v[40:43], v1 offset:12288
    s_waitcnt lgkmcnt(3)
    v_mfma_f32_32x32x16_bf16 v[144:159], v[44:47], v[60:63], v[144:159]
    ds_read_b128 v[44:47], v2 offset:12288
    s_waitcnt lgkmcnt(3)
    v_mfma_f32_32x32x16_bf16 v[160:175], v[32:35], v[48:51], v[160:175]
    ds_read_b128 v[32:35], v1 offset:16384
    s_waitcnt lgkmcnt(3)
    v_mfma_f32_32x32x16_bf16 v[160:175], v[36:39], v[52:55], v[160:175]
    ds_read_b128 v[36:39], v2 offset:16384
    s_waitcnt lgkmcnt(3)
    v_mfma_f32_32x32x16_bf16 v[160:175], v[40:43], v[56:59], v[160:175]
    ds_read_b128 v[40:43], v1 offset:20480
    s_waitcnt lgkmcnt(3)
    v_mfma_f32_32x32x16_bf16 v[160:175], v[44:47], v[60:63], v[160:175]
    ds_read_b128 v[44:47], v2 offset:20480
    s_waitcnt vmcnt(2)
    s_barrier
    s_add_u32 m0, s9, 0
    s_add_u32 s10, s72, 256
    buffer_load_dwordx4 v6, s[56:59], s10 offen lds
    s_add_u32 m0, s9, 8192
    s_add_u32 s10, s72, 73920
    buffer_load_dwordx4 v6, s[56:59], s10 offen lds
    s_add_u32 m0, s9, -98304
    s_add_u32 s10, s72, 295168
    buffer_load_dwordx4 v6, s[56:59], s10 offen lds
    s_add_u32 m0, s9, -90112
    s_add_u32 s10, s72, 368832
    buffer_load_dwordx4 v6, s[56:59], s10 offen lds
    s_waitcnt lgkmcnt(3)
    v_mfma_f32_32x32x16_bf16 v[176:191], v[32:35], v[48:51], v[176:191]
    ds_read_b128 v[32:35], v1 offset:24576
    s_waitcnt lgkmcnt(3)
    v_mfma_f32_32x32x16_bf16 v[176:191], v[36:39], v[52:55], v[176:191]
    ds_read_b128 v[36:39], v2 offset:24576
    s_waitcnt lgkmcnt(3)
    v_mfma_f32_32x32x16_bf16 v[176:191], v[40:43], v[56:59], v[176:191]
    ds_read_b128 v[40:43], v1 offset:28672
    s_waitcnt lgkmcnt(3)
    v_mfma_f32_32x32x16_bf16 v[176:191], v[44:47], v[60:63], v[176:191]
    ds_read_b128 v[44:47], v2 offset:28672
    s_waitcnt lgkmcnt(3)
    v_mfma_f32_32x32x16_bf16 v[192:207], v[32:35], v[48:51], v[192:207]
    ds_read_b128 v[32:35], v1 offset:32768
    s_waitcnt lgkmcnt(3)
    v_mfma_f32_32x32x16_bf16 v[192:207], v[36:39], v[52:55], v[192:207]
    ds_read_b128 v[36:39], v2 offset:32768
    s_waitcnt lgkmcnt(3)
    v_mfma_f32_32x32x16_bf16 v[192:207], v[40:43], v[56:59], v[192:207]
    ds_read_b128 v[40:43], v1 offset:36864
    s_waitcnt lgkmcnt(3)
    v_mfma_f32_32x32x16_bf16 v[192:207], v[44:47], v[60:63], v[192:207]
    ds_read_b128 v[44:47], v2 offset:36864
    s_waitcnt vmcnt(4)
    s_barrier
    s_add_u32 m0, s9, 16384
    s_add_u32 s10, s72, 73984
    buffer_load_dwordx4 v6, s[56:59], s10 offen lds
    s_add_u32 m0, s9, 24576
    s_add_u32 s10, s72, 147648
    buffer_load_dwordx4 v6, s[56:59], s10 offen lds
    s_add_u32 m0, s9, -81920
    s_add_u32 s10, s72, 368896
    buffer_load_dwordx4 v6, s[56:59], s10 offen lds
    s_add_u32 m0, s9, -73728
    s_add_u32 s10, s72, 442560
    buffer_load_dwordx4 v6, s[56:59], s10 offen lds
    s_waitcnt lgkmcnt(3)
    v_mfma_f32_32x32x16_bf16 v[208:223], v[32:35], v[48:51], v[208:223]
    ds_read_b128 v[32:35], v1 offset:40960
    s_waitcnt lgkmcnt(3)
    v_mfma_f32_32x32x16_bf16 v[208:223], v[36:39], v[52:55], v[208:223]
    ds_read_b128 v[36:39], v2 offset:40960
    s_waitcnt lgkmcnt(3)
    v_mfma_f32_32x32x16_bf16 v[208:223], v[40:43], v[56:59], v[208:223]
    ds_read_b128 v[40:43], v1 offset:45056
    s_waitcnt lgkmcnt(3)
    v_mfma_f32_32x32x16_bf16 v[208:223], v[44:47], v[60:63], v[208:223]
    ds_read_b128 v[44:47], v2 offset:45056
    s_waitcnt lgkmcnt(3)
    v_mfma_f32_32x32x16_bf16 v[224:239], v[32:35], v[48:51], v[224:239]
    ds_read_b128 v[32:35], v1 offset:49152
    ds_read_b64_tr_b16 v[64:65], v3 offset:49152
    ds_read_b64_tr_b16 v[66:67], v3 offset:50176
    s_waitcnt lgkmcnt(5)
    v_mfma_f32_32x32x16_bf16 v[224:239], v[36:39], v[52:55], v[224:239]
    ds_read_b128 v[36:39], v2 offset:49152
    ds_read_b64_tr_b16 v[68:69], v3 offset:53248
    ds_read_b64_tr_b16 v[70:71], v3 offset:54272
    s_waitcnt lgkmcnt(7)
    v_mfma_f32_32x32x16_bf16 v[224:239], v[40:43], v[56:59], v[224:239]
    ds_read_b128 v[40:43], v1 offset:53248
    ds_read_b64_tr_b16 v[72:73], v3 offset:57344
    ds_read_b64_tr_b16 v[74:75], v3 offset:58368
    s_waitcnt lgkmcnt(9)
    v_mfma_f32_32x32x16_bf16 v[224:239], v[44:47], v[60:63], v[224:239]
    ds_read_b128 v[44:47], v2 offset:53248
    ds_read_b64_tr_b16 v[76:77], v3 offset:61440
    ds_read_b64_tr_b16 v[78:79], v3 offset:62464
    s_waitcnt vmcnt(6)
    s_barrier
    s_add_u32 m0, s9, 32768
    s_add_u32 s10, s72, 147712
    buffer_load_dwordx4 v6, s[56:59], s10 offen lds
    s_add_u32 m0, s9, 40960
    s_add_u32 s10, s72, 221376
    buffer_load_dwordx4 v6, s[56:59], s10 offen lds
    s_add_u32 m0, s9, -65536
    s_add_u32 s10, s72, 442624
    buffer_load_dwordx4 v6, s[56:59], s10 offen lds
    s_add_u32 m0, s9, -57344
    s_add_u32 s10, s72, 516288
    buffer_load_dwordx4 v6, s[56:59], s10 offen lds
    s_waitcnt lgkmcnt(11)
    v_mfma_f32_32x32x16_bf16 v[240:255], v[32:35], v[48:51], v[240:255]
    ds_read_b128 v[32:35], v1 offset:57344
    s_waitcnt lgkmcnt(9)
    v_mfma_f32_32x32x16_bf16 v[240:255], v[36:39], v[52:55], v[240:255]
    ds_read_b128 v[36:39], v2 offset:57344
    s_waitcnt lgkmcnt(7)
    v_mfma_f32_32x32x16_bf16 v[240:255], v[40:43], v[56:59], v[240:255]
    ds_read_b128 v[40:43], v1 offset:61440
    s_waitcnt lgkmcnt(5)
    v_mfma_f32_32x32x16_bf16 v[240:255], v[44:47], v[60:63], v[240:255]
    ds_read_b128 v[44:47], v2 offset:61440
    s_waitcnt lgkmcnt(3)
    v_mfma_f32_32x32x16_bf16 v[112:127], v[32:35], v[64:67], v[112:127]
    ds_read_b128 v[32:35], v1 offset:0
    s_waitcnt lgkmcnt(3)
    v_mfma_f32_32x32x16_bf16 v[112:127], v[36:39], v[68:71], v[112:127]
    ds_read_b128 v[36:39], v2 offset:0
    s_waitcnt lgkmcnt(3)
    v_mfma_f32_32x32x16_bf16 v[112:127], v[40:43], v[72:75], v[112:127]
    ds_read_b128 v[40:43], v1 offset:4096
    s_waitcnt lgkmcnt(3)
    v_mfma_f32_32x32x16_bf16 v[112:127], v[44:47], v[76:79], v[112:127]
    ds_read_b128 v[44:47], v2 offset:4096
    s_waitcnt vmcnt(6)
    s_barrier
    ds_read_b64_tr_b16 v[48:49], v4 offset:0
    ds_read_b64_tr_b16 v[50:51], v4 offset:1024
    ds_read_b64_tr_b16 v[52:53], v4 offset:4096
    ds_read_b64_tr_b16 v[54:55], v4 offset:5120
    ds_read_b64_tr_b16 v[56:57], v4 offset:8192
    ds_read_b64_tr_b16 v[58:59], v4 offset:9216
    ds_read_b64_tr_b16 v[60:61], v4 offset:12288
    ds_read_b64_tr_b16 v[62:63], v4 offset:13312
    s_add_u32 m0, s9, 49152
    s_add_u32 s10, s72, 221440
    buffer_load_dwordx4 v6, s[56:59], s10 offen lds
    s_add_u32 m0, s9, 57344
    s_add_u32 s10, s72, 295104
    buffer_load_dwordx4 v6, s[56:59], s10 offen lds
    s_waitcnt lgkmcnt(11)
    s_waitcnt lgkmcnt(6)
    v_mfma_f32_32x32x16_bf16 v[112:127], v[32:35], v[48:51], v[112:127]
    ds_read_b128 v[32:35], v1 offset:8192
    s_lshl_b32 s11, s7, 2
    s_add_u32 s11, s11, s5
    s_mul_i32 s11, s11, 18
    s_add_u32 s11, s11, s6
    s_lshl_b32 s11, s11, 5
    s_add_u32 s11, s11, s79
    s_lshl_b32 s11, s11, 10
    s_add_u32 s11, s11, 1048576
    v_and_b32 v5, 15, v0
    v_lshl_add_u32 v5, v5, 4, s11
    v_bfe_u32 v24, v0, 4, 1
    v_lshl_add_u32 v5, v24, 9, v5
    v_lshrrev_b32 v24, 5, v0
    v_lshl_add_u32 v5, v24, 8, v5
    s_waitcnt lgkmcnt(5)
    v_mfma_f32_32x32x16_bf16 v[112:127], v[36:39], v[52:55], v[112:127]
    ds_read_b128 v[36:39], v2 offset:8192
    s_mul_i32 s11, s7, 1536
    s_lshl2_add_u32 s11, s79, s11
    s_add_u32 s11, s11, 262144
    s_cmp_eq_u32 s4, 0
    s_cselect_b32 s11, s11, 0x40000000
    s_waitcnt lgkmcnt(4)
    v_mfma_f32_32x32x16_bf16 v[112:127], v[40:43], v[56:59], v[112:127]
    ds_read_b128 v[40:43], v1 offset:12288
    v_lshl_add_u32 v12, v0, 7, s11
    v_cmp_gt_u32 vcc, 12, v0
    v_mov_b32 v13, 0x40000000
    v_cndmask_b32 v12, v13, v12, vcc
    s_lshr_b32 s11, s7, 2
    s_waitcnt lgkmcnt(3)
    v_mfma_f32_32x32x16_bf16 v[112:127], v[44:47], v[60:63], v[112:127]
    ds_read_b128 v[44:47], v2 offset:12288
    s_lshl_b32 s11, s11, 6
    s_add_u32 s11, s11, 60
    v_mov_b32 v15, s11
    buffer_load_dword v14, v15, s[68:71], 0 offen sc1
    s_waitcnt lgkmcnt(3)
    v_mfma_f32_32x32x16_bf16 v[128:143], v[32:35], v[64:67], v[128:143]
    ds_read_b128 v[32:35], v1 offset:16384
    s_waitcnt lgkmcnt(3)
    v_mfma_f32_32x32x16_bf16 v[128:143], v[36:39], v[68:71], v[128:143]
    ds_read_b128 v[36:39], v2 offset:16384
    s_nop 2
    v_cvt_pk_bf16_f32 v24, v112, v113
    v_cvt_pk_bf16_f32 v25, v114, v115
    s_waitcnt lgkmcnt(3)
    v_mfma_f32_32x32x16_bf16 v[128:143], v[40:43], v[72:75], v[128:143]
    ds_read_b128 v[40:43], v1 offset:20480
    v_cvt_pk_bf16_f32 v26, v116, v117
    v_cvt_pk_bf16_f32 v27, v118, v119
    s_waitcnt lgkmcnt(3)
    v_mfma_f32_32x32x16_bf16 v[128:143], v[44:47], v[76:79], v[128:143]
    ds_read_b128 v[44:47], v2 offset:20480
    s_mov_b32 s11, 0
    buffer_store_dwordx4 v[24:27], v5, s[60:63], s11 offen sc1
    s_waitcnt vmcnt(6)
    s_barrier
    s_add_u32 m0, s9, -49152
    s_add_u32 s10, s72, 516352
    buffer_load_dwordx4 v6, s[56:59], s10 offen lds
    s_add_u32 m0, s9, -40960
    s_add_u32 s10, s72, 590016
    buffer_load_dwordx4 v6, s[56:59], s10 offen lds
    s_add_u32 m0, s9, 0
    s_add_u32 s10, s72, 590080
    buffer_load_dwordx4 v6, s[56:59], s10 offen lds
    s_waitcnt lgkmcnt(3)
    v_mfma_f32_32x32x16_bf16 v[128:143], v[32:35], v[48:51], v[128:143]
    ds_read_b128 v[32:35], v1 offset:24576
    v_cvt_pk_bf16_f32 v28, v120, v121
    v_cvt_pk_bf16_f32 v29, v122, v123
    s_waitcnt lgkmcnt(3)
    v_mfma_f32_32x32x16_bf16 v[128:143], v[36:39], v[52:55], v[128:143]
    ds_read_b128 v[36:39], v2 offset:24576
    v_cvt_pk_bf16_f32 v30, v124, v125
    v_cvt_pk_bf16_f32 v31, v126, v127
    s_waitcnt lgkmcnt(3)
    v_mfma_f32_32x32x16_bf16 v[128:143], v[40:43], v[56:59], v[128:143]
    ds_read_b128 v[40:43], v1 offset:28672
    s_mov_b32 s11, 16384
    buffer_store_dwordx4 v[28:31], v5, s[60:63], s11 offen sc1
    s_waitcnt lgkmcnt(3)
    v_mfma_f32_32x32x16_bf16 v[128:143], v[44:47], v[60:63], v[128:143]
    ds_read_b128 v[44:47], v2 offset:28672
    s_waitcnt lgkmcnt(3)
    v_mfma_f32_32x32x16_bf16 v[144:159], v[32:35], v[64:67], v[144:159]
    ds_read_b128 v[32:35], v1 offset:32768
    s_waitcnt lgkmcnt(3)
    v_mfma_f32_32x32x16_bf16 v[144:159], v[36:39], v[68:71], v[144:159]
    ds_read_b128 v[36:39], v2 offset:32768
    s_nop 6
    v_cvt_pk_bf16_f32 v24, v128, v129
    v_cvt_pk_bf16_f32 v25, v130, v131
    s_waitcnt lgkmcnt(3)
    v_mfma_f32_32x32x16_bf16 v[144:159], v[40:43], v[72:75], v[144:159]
    ds_read_b128 v[40:43], v1 offset:36864
    v_cvt_pk_bf16_f32 v26, v132, v133
    v_cvt_pk_bf16_f32 v27, v134, v135
    s_waitcnt lgkmcnt(3)
    v_mfma_f32_32x32x16_bf16 v[144:159], v[44:47], v[76:79], v[144:159]
    ds_read_b128 v[44:47], v2 offset:36864
    s_mov_b32 s11, 65536
    buffer_store_dwordx4 v[24:27], v5, s[60:63], s11 offen sc1
    s_waitcnt vmcnt(7)
    s_barrier
    v_subrev_u32 v3, 98304, v1
    v_subrev_u32 v4, 98304, v2
    s_waitcnt lgkmcnt(3)
    v_mfma_f32_32x32x16_bf16 v[144:159], v[32:35], v[48:51], v[144:159]
    ds_read_b128 v[32:35], v1 offset:40960
    v_cvt_pk_bf16_f32 v28, v136, v137
    v_cvt_pk_bf16_f32 v29, v138, v139
    s_waitcnt lgkmcnt(3)
    v_mfma_f32_32x32x16_bf16 v[144:159], v[36:39], v[52:55], v[144:159]
    ds_read_b128 v[36:39], v2 offset:40960
    v_cvt_pk_bf16_f32 v30, v140, v141
    v_cvt_pk_bf16_f32 v31, v142, v143
    s_waitcnt lgkmcnt(3)
    v_mfma_f32_32x32x16_bf16 v[144:159], v[40:43], v[56:59], v[144:159]
    ds_read_b128 v[40:43], v1 offset:45056
    s_mov_b32 s11, 81920
    buffer_store_dwordx4 v[28:31], v5, s[60:63], s11 offen sc1
    s_waitcnt lgkmcnt(3)
    v_mfma_f32_32x32x16_bf16 v[144:159], v[44:47], v[60:63], v[144:159]
    ds_read_b128 v[44:47], v2 offset:45056
    s_waitcnt lgkmcnt(3)
    v_mfma_f32_32x32x16_bf16 v[160:175], v[32:35], v[64:67], v[160:175]
    ds_read_b128 v[32:35], v1 offset:49152
    s_waitcnt lgkmcnt(3)
    v_mfma_f32_32x32x16_bf16 v[160:175], v[36:39], v[68:71], v[160:175]
    ds_read_b128 v[36:39], v2 offset:49152
    s_nop 6
    v_cvt_pk_bf16_f32 v24, v144, v145
    v_cvt_pk_bf16_f32 v25, v146, v147
    s_waitcnt lgkmcnt(3)
    v_mfma_f32_32x32x16_bf16 v[160:175], v[40:43], v[72:75], v[160:175]
    ds_read_b128 v[40:43], v1 offset:53248
    v_cvt_pk_bf16_f32 v26, v148, v149
    v_cvt_pk_bf16_f32 v27, v150, v151
    s_waitcnt lgkmcnt(3)
    v_mfma_f32_32x32x16_bf16 v[160:175], v[44:47], v[76:79], v[160:175]
    ds_read_b128 v[44:47], v2 offset:53248
    s_mov_b32 s11, 131072
    buffer_store_dwordx4 v[24:27], v5, s[60:63], s11 offen sc1
    s_barrier
    s_waitcnt lgkmcnt(3)
    v_mfma_f32_32x32x16_bf16 v[160:175], v[32:35], v[48:51], v[160:175]
    ds_read_b128 v[32:35], v1 offset:57344
    v_cvt_pk_bf16_f32 v28, v152, v153
    v_cvt_pk_bf16_f32 v29, v154, v155
    s_waitcnt lgkmcnt(3)
    v_mfma_f32_32x32x16_bf16 v[160:175], v[36:39], v[52:55], v[160:175]
    ds_read_b128 v[36:39], v2 offset:57344
    v_cvt_pk_bf16_f32 v30, v156, v157
    v_cvt_pk_bf16_f32 v31, v158, v159
    s_waitcnt lgkmcnt(3)
    v_mfma_f32_32x32x16_bf16 v[160:175], v[40:43], v[56:59], v[160:175]
    ds_read_b128 v[40:43], v1 offset:61440
    s_mov_b32 s11, 147456
    buffer_store_dwordx4 v[28:31], v5, s[60:63], s11 offen sc1
    s_waitcnt lgkmcnt(3)
    v_mfma_f32_32x32x16_bf16 v[160:175], v[44:47], v[60:63], v[160:175]
    ds_read_b128 v[44:47], v2 offset:61440
    s_waitcnt lgkmcnt(3)
    v_mfma_f32_32x32x16_bf16 v[176:191], v[32:35], v[64:67], v[176:191]
    ds_read_b128 v[32:35], v3 offset:0
    s_waitcnt lgkmcnt(3)
    v_mfma_f32_32x32x16_bf16 v[176:191], v[36:39], v[68:71], v[176:191]
    ds_read_b128 v[36:39], v4 offset:0
    s_nop 6
    v_cvt_pk_bf16_f32 v24, v160, v161
    v_cvt_pk_bf16_f32 v25, v162, v163
    s_waitcnt lgkmcnt(3)
    v_mfma_f32_32x32x16_bf16 v[176:191], v[40:43], v[72:75], v[176:191]
    ds_read_b128 v[40:43], v3 offset:4096
    v_cvt_pk_bf16_f32 v26, v164, v165
    v_cvt_pk_bf16_f32 v27, v166, v167
    s_waitcnt lgkmcnt(3)
    v_mfma_f32_32x32x16_bf16 v[176:191], v[44:47], v[76:79], v[176:191]
    ds_read_b128 v[44:47], v4 offset:4096
    s_mov_b32 s11, 196608
    buffer_store_dwordx4 v[24:27], v5, s[60:63], s11 offen sc1
    s_waitcnt vmcnt(5)
    s_barrier
    s_mov_b32 s83, 65536
.clp_21:
    s_and_b32 s11, s7, 3
    s_lshl_b32 s11, s11, 3
    v_lshrrev_b32 v14, s11, v14
    v_and_b32 v14, 0xff, v14
    v_cmp_gt_u32 vcc, 12, v14
    s_cbranch_vccz .cok_20
    buffer_load_dword v14, v15, s[68:71], 0 offen sc1
    s_waitcnt vmcnt(0)
    s_sub_u32 s83, s83, 1
    s_cmp_lg_u32 s83, 0
    s_cbranch_scc1 .clp_21
.cok_20:
    v_mov_b32 v13, 1
    buffer_store_dword v13, v12, s[60:63], 0 offen sc1
    s_waitcnt lgkmcnt(3)
    v_mfma_f32_32x32x16_bf16 v[176:191], v[32:35], v[48:51], v[176:191]
    ds_read_b128 v[32:35], v3 offset:8192
    v_cvt_pk_bf16_f32 v28, v168, v169
    v_cvt_pk_bf16_f32 v29, v170, v171
    s_waitcnt lgkmcnt(3)
    v_mfma_f32_32x32x16_bf16 v[176:191], v[36:39], v[52:55], v[176:191]
    ds_read_b128 v[36:39], v4 offset:8192
    v_cvt_pk_bf16_f32 v30, v172, v173
    v_cvt_pk_bf16_f32 v31, v174, v175
    s_waitcnt lgkmcnt(3)
    v_mfma_f32_32x32x16_bf16 v[176:191], v[40:43], v[56:59], v[176:191]
    ds_read_b128 v[40:43], v3 offset:12288
    s_mov_b32 s11, 212992
    buffer_store_dwordx4 v[28:31], v5, s[60:63], s11 offen sc1
    s_waitcnt lgkmcnt(3)
    v_mfma_f32_32x32x16_bf16 v[176:191], v[44:47], v[60:63], v[176:191]
    ds_read_b128 v[44:47], v4 offset:12288
    s_waitcnt lgkmcnt(3)
    v_mfma_f32_32x32x16_bf16 v[192:207], v[32:35], v[64:67], v[192:207]
    ds_read_b128 v[32:35], v3 offset:16384
    s_waitcnt lgkmcnt(3)
    v_mfma_f32_32x32x16_bf16 v[192:207], v[36:39], v[68:71], v[192:207]
    ds_read_b128 v[36:39], v4 offset:16384
    s_nop 6
    v_cvt_pk_bf16_f32 v24, v176, v177
    v_cvt_pk_bf16_f32 v25, v178, v179
    s_waitcnt lgkmcnt(3)
    v_mfma_f32_32x32x16_bf16 v[192:207], v[40:43], v[72:75], v[192:207]
    ds_read_b128 v[40:43], v3 offset:20480
    v_cvt_pk_bf16_f32 v26, v180, v181
    v_cvt_pk_bf16_f32 v27, v182, v183
    s_waitcnt lgkmcnt(3)
    v_mfma_f32_32x32x16_bf16 v[192:207], v[44:47], v[76:79], v[192:207]
    ds_read_b128 v[44:47], v4 offset:20480
    s_mov_b32 s11, 262144
    buffer_store_dwordx4 v[24:27], v5, s[60:63], s11 offen sc1
    s_waitcnt vmcnt(6)
    s_barrier
    v_mov_b32 v13, 2
    buffer_store_dword v13, v12, s[60:63], 0 offen sc1
    s_waitcnt lgkmcnt(3)
    v_mfma_f32_32x32x16_bf16 v[192:207], v[32:35], v[48:51], v[192:207]
    ds_read_b128 v[32:35], v3 offset:24576
    v_cvt_pk_bf16_f32 v28, v184, v185
    v_cvt_pk_bf16_f32 v29, v186, v187
    s_waitcnt lgkmcnt(3)
    v_mfma_f32_32x32x16_bf16 v[192:207], v[36:39], v[52:55], v[192:207]
    ds_read_b128 v[36:39], v4 offset:24576
    v_cvt_pk_bf16_f32 v30, v188, v189
    v_cvt_pk_bf16_f32 v31, v190, v191
    s_waitcnt lgkmcnt(3)
    v_mfma_f32_32x32x16_bf16 v[192:207], v[40:43], v[56:59], v[192:207]
    ds_read_b128 v[40:43], v3 offset:28672
    s_mov_b32 s11, 278528
    buffer_store_dwordx4 v[28:31], v5, s[60:63], s11 offen sc1
    s_waitcnt lgkmcnt(3)
    v_mfma_f32_32x32x16_bf16 v[192:207], v[44:47], v[60:63], v[192:207]
    ds_read_b128 v[44:47], v4 offset:28672
    s_waitcnt lgkmcnt(3)
    v_mfma_f32_32x32x16_bf16 v[208:223], v[32:35], v[64:67], v[208:223]
    ds_read_b128 v[32:35], v3 offset:32768
    s_waitcnt lgkmcnt(3)
    v_mfma_f32_32x32x16_bf16 v[208:223], v[36:39], v[68:71], v[208:223]
    ds_read_b128 v[36:39], v4 offset:32768
    s_nop 6
    v_cvt_pk_bf16_f32 v24, v192, v193
    v_cvt_pk_bf16_f32 v25, v194, v195
    s_waitcnt lgkmcnt(3)
    v_mfma_f32_32x32x16_bf16 v[208:223], v[40:43], v[72:75], v[208:223]
    ds_read_b128 v[40:43], v3 offset:36864
    v_cvt_pk_bf16_f32 v26, v196, v197
    v_cvt_pk_bf16_f32 v27, v198, v199
    s_waitcnt lgkmcnt(3)
    v_mfma_f32_32x32x16_bf16 v[208:223], v[44:47], v[76:79], v[208:223]
    ds_read_b128 v[44:47], v4 offset:36864
    s_mov_b32 s11, 327680
    buffer_store_dwordx4 v[24:27], v5, s[60:63], s11 offen sc1
    s_waitcnt vmcnt(7)
    s_barrier
    v_mov_b32 v13, 3
    buffer_store_dword v13, v12, s[60:63], 0 offen sc1
    s_waitcnt lgkmcnt(3)
    v_mfma_f32_32x32x16_bf16 v[208:223], v[32:35], v[48:51], v[208:223]
    ds_read_b128 v[32:35], v3 offset:40960
    v_cvt_pk_bf16_f32 v28, v200, v201
    v_cvt_pk_bf16_f32 v29, v202, v203
    s_waitcnt lgkmcnt(3)
    v_mfma_f32_32x32x16_bf16 v[208:223], v[36:39], v[52:55], v[208:223]
    ds_read_b128 v[36:39], v4 offset:40960
    v_cvt_pk_bf16_f32 v30, v204, v205
    v_cvt_pk_bf16_f32 v31, v206, v207
    s_waitcnt lgkmcnt(3)
    v_mfma_f32_32x32x16_bf16 v[208:223], v[40:43], v[56:59], v[208:223]
    ds_read_b128 v[40:43], v3 offset:45056
    s_mov_b32 s11, 344064
    buffer_store_dwordx4 v[28:31], v5, s[60:63], s11 offen sc1
    s_waitcnt lgkmcnt(3)
    v_mfma_f32_32x32x16_bf16 v[208:223], v[44:47], v[60:63], v[208:223]
    ds_read_b128 v[44:47], v4 offset:45056
    s_waitcnt lgkmcnt(3)
    v_mfma_f32_32x32x16_bf16 v[224:239], v[32:35], v[64:67], v[224:239]
    ds_read_b128 v[32:35], v3 offset:49152
    s_waitcnt lgkmcnt(3)
    v_mfma_f32_32x32x16_bf16 v[224:239], v[36:39], v[68:71], v[224:239]
    ds_read_b128 v[36:39], v4 offset:49152
    s_nop 6
    v_cvt_pk_bf16_f32 v24, v208, v209
    v_cvt_pk_bf16_f32 v25, v210, v211
    s_waitcnt lgkmcnt(3)
    v_mfma_f32_32x32x16_bf16 v[224:239], v[40:43], v[72:75], v[224:239]
    ds_read_b128 v[40:43], v3 offset:53248
    v_cvt_pk_bf16_f32 v26, v212, v213
    v_cvt_pk_bf16_f32 v27, v214, v215
    s_waitcnt lgkmcnt(3)
    v_mfma_f32_32x32x16_bf16 v[224:239], v[44:47], v[76:79], v[224:239]
    ds_read_b128 v[44:47], v4 offset:53248
    s_mov_b32 s11, 393216
    buffer_store_dwordx4 v[24:27], v5, s[60:63], s11 offen sc1
    s_waitcnt vmcnt(7)
    s_barrier
    v_mov_b32 v13, 4
    buffer_store_dword v13, v12, s[60:63], 0 offen sc1
    s_waitcnt lgkmcnt(3)
    v_mfma_f32_32x32x16_bf16 v[224:239], v[32:35], v[48:51], v[224:239]
    ds_read_b128 v[32:35], v3 offset:57344
    v_cvt_pk_bf16_f32 v28, v216, v217
    v_cvt_pk_bf16_f32 v29, v218, v219
    s_waitcnt lgkmcnt(3)
    v_mfma_f32_32x32x16_bf16 v[224:239], v[36:39], v[52:55], v[224:239]
    ds_read_b128 v[36:39], v4 offset:57344
    v_cvt_pk_bf16_f32 v30, v220, v221
    v_cvt_pk_bf16_f32 v31, v222, v223
    s_waitcnt lgkmcnt(3)
    v_mfma_f32_32x32x16_bf16 v[224:239], v[40:43], v[56:59], v[224:239]
    ds_read_b128 v[40:43], v3 offset:61440
    s_mov_b32 s11, 409600
    buffer_store_dwordx4 v[28:31], v5, s[60:63], s11 offen sc1
    s_waitcnt lgkmcnt(3)
    v_mfma_f32_32x32x16_bf16 v[224:239], v[44:47], v[60:63], v[224:239]
    ds_read_b128 v[44:47], v4 offset:61440
    s_waitcnt lgkmcnt(3)
    v_mfma_f32_32x32x16_bf16 v[240:255], v[32:35], v[64:67], v[240:255]
    ds_read_b128 v[32:35], v1 offset:0
    s_waitcnt lgkmcnt(3)
    v_mfma_f32_32x32x16_bf16 v[240:255], v[36:39], v[68:71], v[240:255]
    ds_read_b128 v[36:39], v2 offset:0
    s_nop 6
    v_cvt_pk_bf16_f32 v24, v224, v225
    v_cvt_pk_bf16_f32 v25, v226, v227
    s_waitcnt lgkmcnt(3)
    v_mfma_f32_32x32x16_bf16 v[240:255], v[40:43], v[72:75], v[240:255]
    ds_read_b128 v[40:43], v1 offset:4096
    v_cvt_pk_bf16_f32 v26, v228, v229
    v_cvt_pk_bf16_f32 v27, v230, v231
    s_waitcnt lgkmcnt(3)
    v_mfma_f32_32x32x16_bf16 v[240:255], v[44:47], v[76:79], v[240:255]
    ds_read_b128 v[44:47], v2 offset:4096
    s_mov_b32 s11, 458752
    buffer_store_dwordx4 v[24:27], v5, s[60:63], s11 offen sc1
    s_waitcnt vmcnt(7)
    s_barrier
    v_mov_b32 v13, 5
    buffer_store_dword v13, v12, s[60:63], 0 offen sc1
    s_waitcnt lgkmcnt(3)
    v_mfma_f32_32x32x16_bf16 v[240:255], v[32:35], v[48:51], v[240:255]
    v_cvt_pk_bf16_f32 v28, v232, v233
    v_cvt_pk_bf16_f32 v29, v234, v235
    s_waitcnt lgkmcnt(2)
    v_mfma_f32_32x32x16_bf16 v[240:255], v[36:39], v[52:55], v[240:255]
    v_cvt_pk_bf16_f32 v30, v236, v237
    v_cvt_pk_bf16_f32 v31, v238, v239
    s_waitcnt lgkmcnt(1)
    v_mfma_f32_32x32x16_bf16 v[240:255], v[40:43], v[56:59], v[240:255]
    s_mov_b32 s11, 475136
    buffer_store_dwordx4 v[28:31], v5, s[60:63], s11 offen sc1
    s_waitcnt lgkmcnt(0)
    v_mfma_f32_32x32x16_bf16 v[240:255], v[44:47], v[60:63], v[240:255]
    s_nop 7
    s_nop 5
    v_cvt_pk_bf16_f32 v24, v240, v241
    v_cvt_pk_bf16_f32 v25, v242, v243
    v_cvt_pk_bf16_f32 v26, v244, v245
    v_cvt_pk_bf16_f32 v27, v246, v247
    s_mov_b32 s11, 524288
    buffer_store_dwordx4 v[24:27], v5, s[60:63], s11 offen sc1
    v_cvt_pk_bf16_f32 v28, v248, v249
    v_cvt_pk_bf16_f32 v29, v250, v251
    v_cvt_pk_bf16_f32 v30, v252, v253
    v_cvt_pk_bf16_f32 v31, v254, v255
    s_mov_b32 s11, 540672
    buffer_store_dwordx4 v[28:31], v5, s[60:63], s11 offen sc1
    s_waitcnt vmcnt(0)
    s_barrier
    v_mov_b32 v13, 9
    buffer_store_dword v13, v12, s[60:63], 0 offen sc1
    s_endpgm
.Lssm_nt4:
    s_waitcnt vmcnt(2)
    s_barrier
    s_and_b32 s88, s8, 1
    s_lshl_b32 s88, s88, 4
    s_add_u32 s88, s88, s7
    s_lshl_b32 s89, s88, 2
    s_add_u32 s90, s89, s77
    s_add_u32 s89, s89, s5
    s_lshl_b32 s88, s88, 3
    s_add_u32 s88, s88, s4
    s_mov_b32 s64, s36
    s_and_b32 s65, s37, 0xffff
    s_mov_b32 s66, 5308416
    s_mov_b32 s67, 0x00020000
    s_mov_b32 s84, s40
    s_and_b32 s85, s41, 0xffff
    s_mov_b32 s86, 5308416
    s_mov_b32 s87, 0x00020000
    s_add_u32 s10, s15, 384
    s_add_u32 m0, s74, 32768
    s_nop 0
    buffer_load_dwordx4 v6, s[52:55], s10 offen lds
    s_add_u32 m0, s74, 33792
    s_nop 0
    buffer_load_dwordx4 v7, s[52:55], s10 offen lds
    s_waitcnt lgkmcnt(3)
    v_mfma_f32_32x32x16_bf16 v[80:95], v[112:115], v[32:35], 0
    s_mul_i32 s75, s90, 41
    s_waitcnt lgkmcnt(2)
    v_mfma_f32_32x32x16_bf16 v[96:111], v[112:115], v[36:39], 0
    ds_read_b128 v[32:35], v3 offset:49152
    ds_read_b128 v[36:39], v3 offset:53248
    v_lshlrev_b32 v48, 16, v48
    s_add_u32 s75, s75, 0
    s_waitcnt lgkmcnt(3)
    v_mfma_f32_32x32x16_bf16 v[80:95], v[116:119], v[40:43], v[80:95]
    v_lshlrev_b32 v49, 16, v49
    v_lshlrev_b32 v50, 16, v50
    v_add_u32 v24, s75, v0
    s_waitcnt lgkmcnt(2)
    v_mfma_f32_32x32x16_bf16 v[96:111], v[116:119], v[44:47], v[96:111]
    ds_read_b128 v[40:43], v4 offset:49152
    ds_read_b128 v[44:47], v4 offset:53248
    v_mul_f32 v50, 0x3fb8aa3b, v50
    v_exp_f32 v50, v50
    v_lshlrev_b32 v24, 7, v24
    s_waitcnt lgkmcnt(3)
    v_mfma_f32_32x32x16_bf16 v[80:95], v[120:123], v[32:35], v[80:95]
    v_mul_f32 v67, v48, v48
    v_cvt_pk_bf16_f32 v50, v50, v50
    v_cmp_gt_u32 vcc, 41, v0
    s_waitcnt lgkmcnt(2)
    v_mfma_f32_32x32x16_bf16 v[96:111], v[120:123], v[36:39], v[96:111]
    ds_read_b128 v[32:35], v1 offset:0
    ds_read_b128 v[36:39], v1 offset:4096
    v_fma_f32 v67, v49, v49, v67
    v_lshlrev_b32 v50, 16, v50
    v_mov_b32 v25, 0x40000000
    s_waitcnt lgkmcnt(3)
    v_mfma_f32_32x32x16_bf16 v[80:95], v[124:127], v[40:43], v[80:95]
    v_rcp_f32 v66, v67
    v_mul_f32 v60, v50, v48
    v_cndmask_b32 v24, v25, v24, vcc
    s_waitcnt lgkmcnt(2)
    v_mfma_f32_32x32x16_bf16 v[96:111], v[124:127], v[44:47], v[96:111]
    ds_read_b128 v[40:43], v2 offset:0
    ds_read_b128 v[44:47], v2 offset:4096
    v_mul_f32 v61, v50, v49
    v_mul_f32 v60, 0x3fb8aa3b, v60
    buffer_load_dword v25, v24, s[52:55], 0 offen
    s_waitcnt vmcnt(3)
    s_barrier
    s_add_u32 s10, s15, 512
    s_add_u32 m0, s74, 49152
    s_nop 0
    buffer_load_dwordx4 v6, s[52:55], s10 offen lds
    s_add_u32 m0, s74, 50176
    s_nop 0
    buffer_load_dwordx4 v7, s[52:55], s10 offen lds
    s_waitcnt lgkmcnt(3)
    v_mfma_f32_32x32x16_bf16 v[80:95], v[128:131], v[32:35], v[80:95]
    v_mul_f32 v61, 0.15915494, v61
    v_exp_f32 v60, v60
    s_mul_i32 s75, s89, 41
    s_waitcnt lgkmcnt(2)
    v_mfma_f32_32x32x16_bf16 v[96:111], v[128:131], v[36:39], v[96:111]
    ds_read_b128 v[32:35], v3 offset:0
    ds_read_b128 v[36:39], v3 offset:4096
    v_rndne_f32 v62, v61
    v_sub_f32 v61, v61, v62
    s_add_u32 s75, s75, 0
    s_waitcnt lgkmcnt(3)
    v_mfma_f32_32x32x16_bf16 v[80:95], v[132:135], v[40:43], v[80:95]
    v_fma_f32 v65, -v67, v66, 2.0
    v_sin_f32 v62, v61
    v_add_u32 v26, s75, v0
    s_waitcnt lgkmcnt(2)
    v_mfma_f32_32x32x16_bf16 v[96:111], v[132:135], v[44:47], v[96:111]
    ds_read_b128 v[40:43], v4 offset:0
    ds_read_b128 v[44:47], v4 offset:4096
    v_cos_f32 v63, v61
    v_mul_f32 v66, v66, v65
    v_lshlrev_b32 v26, 7, v26
    s_waitcnt lgkmcnt(3)
    v_mfma_f32_32x32x16_bf16 v[80:95], v[136:139], v[32:35], v[80:95]
    v_add_f32 v66, v66, v66
    v_mul_f32 v9, v60, v62
    v_cmp_gt_u32 vcc, 41, v0
    s_waitcnt lgkmcnt(2)
    v_mfma_f32_32x32x16_bf16 v[96:111], v[136:139], v[36:39], v[96:111]
    ds_read_b128 v[32:35], v1 offset:16384
    ds_read_b128 v[36:39], v1 offset:20480
    v_mul_f32 v8, v60, v63
    v_add_f32 v60, -1.0, v8
    v_mov_b32 v27, 0x40000000
    s_waitcnt lgkmcnt(3)
    v_mfma_f32_32x32x16_bf16 v[80:95], v[140:143], v[40:43], v[80:95]
    v_mul_f32 v61, v60, v48
    v_mul_f32 v62, v9, v48
    v_cndmask_b32 v26, v27, v26, vcc
    s_waitcnt lgkmcnt(2)
    v_mfma_f32_32x32x16_bf16 v[96:111], v[140:143], v[44:47], v[96:111]
    ds_read_b128 v[40:43], v2 offset:16384
    ds_read_b128 v[44:47], v2 offset:20480
    v_fma_f32 v61, v9, v49, v61
    v_fma_f32 v62, -v60, v49, v62
    buffer_load_dword v27, v26, s[56:59], 0 offen
    s_waitcnt vmcnt(4)
    s_barrier
    s_add_u32 s10, s15, 640
    s_add_u32 m0, s74, 0
    s_nop 0
    buffer_load_dwordx4 v6, s[52:55], s10 offen lds
    s_add_u32 m0, s74, 1024
    s_nop 0
    buffer_load_dwordx4 v7, s[52:55], s10 offen lds
    s_waitcnt lgkmcnt(3)
    v_mfma_f32_32x32x16_bf16 v[80:95], v[144:147], v[32:35], v[80:95]
    v_mul_f32 v10, v61, v66
    v_mul_f32 v11, v62, v66
    s_mul_i32 s75, s88, 162
    s_waitcnt lgkmcnt(2)
    v_mfma_f32_32x32x16_bf16 v[96:111], v[144:147], v[36:39], v[96:111]
    ds_read_b128 v[32:35], v3 offset:16384
    ds_read_b128 v[36:39], v3 offset:20480
    v_lshlrev_b32 v51, 16, v51
    v_lshlrev_b32 v52, 16, v52
    s_add_u32 s75, s75, 0
    s_waitcnt lgkmcnt(3)
    v_mfma_f32_32x32x16_bf16 v[80:95], v[148:151], v[40:43], v[80:95]
    v_lshlrev_b32 v53, 16, v53
    v_mul_f32 v53, 0x3fb8aa3b, v53
    v_add_u32 v24, s75, v0
    s_waitcnt lgkmcnt(2)
    v_mfma_f32_32x32x16_bf16 v[96:111], v[148:151], v[44:47], v[96:111]
    ds_read_b128 v[40:43], v4 offset:16384
    ds_read_b128 v[44:47], v4 offset:20480
    v_exp_f32 v53, v53
    v_mul_f32 v67, v51, v51
    v_cvt_pk_bf16_f32 v53, v53, v53
    v_lshlrev_b32 v24, 7, v24
    s_waitcnt lgkmcnt(3)
    v_mfma_f32_32x32x16_bf16 v[80:95], v[152:155], v[32:35], v[80:95]
    v_fma_f32 v67, v52, v52, v67
    v_lshlrev_b32 v53, 16, v53
    v_cmp_gt_u32 vcc, 54, v0
    s_waitcnt lgkmcnt(2)
    v_mfma_f32_32x32x16_bf16 v[96:111], v[152:155], v[36:39], v[96:111]
    ds_read_b128 v[32:35], v1 offset:32768
    ds_read_b128 v[36:39], v1 offset:36864
    v_rcp_f32 v66, v67
    v_mul_f32 v60, v53, v51
    v_mul_f32 v61, v53, v52
    v_mov_b32 v25, 0x40000000
    s_waitcnt lgkmcnt(3)
    v_mfma_f32_32x32x16_bf16 v[80:95], v[156:159], v[40:43], v[80:95]
    v_mul_f32 v60, 0x3fb8aa3b, v60
    v_mul_f32 v61, 0.15915494, v61
    v_cndmask_b32 v24, v25, v24, vcc
    s_waitcnt lgkmcnt(2)
    v_mfma_f32_32x32x16_bf16 v[96:111], v[156:159], v[44:47], v[96:111]
    ds_read_b128 v[40:43], v2 offset:32768
    ds_read_b128 v[44:47], v2 offset:36864
    v_exp_f32 v60, v60
    v_rndne_f32 v62, v61
    v_sub_f32 v61, v61, v62
    buffer_load_dword v25, v24, s[84:87], 0 offen
    s_waitcnt vmcnt(4)
    s_barrier
    s_add_u32 s10, s15, 768
    s_add_u32 m0, s74, 16384
    s_nop 0
    buffer_load_dwordx4 v6, s[52:55], s10 offen lds
    s_add_u32 m0, s74, 17408
    s_nop 0
    buffer_load_dwordx4 v7, s[52:55], s10 offen lds
    s_waitcnt lgkmcnt(3)
    v_mfma_f32_32x32x16_bf16 v[80:95], v[160:163], v[32:35], v[80:95]
    v_fma_f32 v65, -v67, v66, 2.0
    v_sin_f32 v62, v61
    s_mul_i32 s75, s88, 162
    s_waitcnt lgkmcnt(2)
    v_mfma_f32_32x32x16_bf16 v[96:111], v[160:163], v[36:39], v[96:111]
    ds_read_b128 v[32:35], v3 offset:32768
    ds_read_b128 v[36:39], v3 offset:36864
    v_cos_f32 v63, v61
    v_mul_f32 v66, v66, v65
    s_add_u32 s75, s75, 54
    s_waitcnt lgkmcnt(3)
    v_mfma_f32_32x32x16_bf16 v[80:95], v[164:167], v[40:43], v[80:95]
    v_add_f32 v66, v66, v66
    v_mul_f32 v69, v60, v62
    v_mul_f32 v68, v60, v63
    v_add_u32 v26, s75, v0
    s_waitcnt lgkmcnt(2)
    v_mfma_f32_32x32x16_bf16 v[96:111], v[164:167], v[44:47], v[96:111]
    ds_read_b128 v[40:43], v4 offset:32768
    ds_read_b128 v[44:47], v4 offset:36864
    v_add_f32 v60, -1.0, v68
    v_mul_f32 v61, v60, v51
    v_lshlrev_b32 v26, 7, v26
    s_waitcnt lgkmcnt(3)
    v_mfma_f32_32x32x16_bf16 v[80:95], v[168:171], v[32:35], v[80:95]
    v_mul_f32 v62, v69, v51
    v_fma_f32 v61, v69, v52, v61
    v_fma_f32 v62, -v60, v52, v62
    v_cmp_gt_u32 vcc, 54, v0
    s_waitcnt lgkmcnt(2)
    v_mfma_f32_32x32x16_bf16 v[96:111], v[168:171], v[36:39], v[96:111]
    ds_read_b128 v[32:35], v1 offset:49152
    ds_read_b128 v[36:39], v1 offset:53248
    v_mul_f32 v70, v61, v66
    v_mul_f32 v71, v62, v66
    v_mov_b32 v27, 0x40000000
    s_waitcnt lgkmcnt(3)
    v_mfma_f32_32x32x16_bf16 v[80:95], v[172:175], v[40:43], v[80:95]
    s_lshl_b32 s11, s6, 9
    s_add_u32 s11, s11, 90112
    v_and_b32 v60, 31, v0
    v_cndmask_b32 v26, v27, v26, vcc
    s_waitcnt lgkmcnt(2)
    v_mfma_f32_32x32x16_bf16 v[96:111], v[172:175], v[44:47], v[96:111]
    ds_read_b128 v[40:43], v2 offset:49152
    ds_read_b128 v[44:47], v2 offset:53248
    v_lshlrev_b32 v60, 4, v60
    v_add_u32 v60, s11, v60
    buffer_load_dword v27, v26, s[84:87], 0 offen
    s_waitcnt vmcnt(4)
    s_barrier
    s_add_u32 s10, s15, 896
    s_add_u32 m0, s74, 32768
    s_nop 0
    buffer_load_dwordx4 v6, s[52:55], s10 offen lds
    s_add_u32 m0, s74, 33792
    s_nop 0
    buffer_load_dwordx4 v7, s[52:55], s10 offen lds
    s_waitcnt lgkmcnt(3)
    v_mfma_f32_32x32x16_bf16 v[80:95], v[176:179], v[32:35], v[80:95]
    ds_write_b128 v60, v[68:71] offset:0
    s_nop 1
    s_mul_i32 s75, s88, 162
    s_waitcnt lgkmcnt(3)
    v_mfma_f32_32x32x16_bf16 v[96:111], v[176:179], v[36:39], v[96:111]
    ds_read_b128 v[32:35], v3 offset:49152
    ds_read_b128 v[36:39], v3 offset:53248
    v_lshlrev_b32 v54, 16, v54
    v_lshlrev_b32 v55, 16, v55
    s_add_u32 s75, s75, 108
    s_waitcnt lgkmcnt(4)
    v_mfma_f32_32x32x16_bf16 v[80:95], v[180:183], v[40:43], v[80:95]
    v_lshlrev_b32 v56, 16, v56
    v_mul_f32 v56, 0x3fb8aa3b, v56
    v_add_u32 v24, s75, v0
    s_waitcnt lgkmcnt(3)
    v_mfma_f32_32x32x16_bf16 v[96:111], v[180:183], v[44:47], v[96:111]
    ds_read_b128 v[40:43], v4 offset:49152
    ds_read_b128 v[44:47], v4 offset:53248
    v_exp_f32 v56, v56
    v_mul_f32 v67, v54, v54
    v_cvt_pk_bf16_f32 v56, v56, v56
    v_lshlrev_b32 v24, 7, v24
    s_waitcnt lgkmcnt(3)
    v_mfma_f32_32x32x16_bf16 v[80:95], v[184:187], v[32:35], v[80:95]
    v_fma_f32 v67, v55, v55, v67
    v_lshlrev_b32 v56, 16, v56
    v_cmp_gt_u32 vcc, 54, v0
    s_waitcnt lgkmcnt(2)
    v_mfma_f32_32x32x16_bf16 v[96:111], v[184:187], v[36:39], v[96:111]
    ds_read_b128 v[32:35], v1 offset:0
    ds_read_b128 v[36:39], v1 offset:4096
    v_rcp_f32 v66, v67
    v_mul_f32 v60, v56, v54
    v_mul_f32 v61, v56, v55
    v_mov_b32 v25, 0x40000000
    s_waitcnt lgkmcnt(3)
    v_mfma_f32_32x32x16_bf16 v[80:95], v[188:191], v[40:43], v[80:95]
    v_mul_f32 v60, 0x3fb8aa3b, v60
    v_mul_f32 v61, 0.15915494, v61
    v_cndmask_b32 v24, v25, v24, vcc
    s_waitcnt lgkmcnt(2)
    v_mfma_f32_32x32x16_bf16 v[96:111], v[188:191], v[44:47], v[96:111]
    ds_read_b128 v[40:43], v2 offset:0
    ds_read_b128 v[44:47], v2 offset:4096
    v_exp_f32 v60, v60
    v_rndne_f32 v62, v61
    v_sub_f32 v61, v61, v62
    buffer_load_dword v25, v24, s[84:87], 0 offen
    s_waitcnt vmcnt(4)
    s_barrier
    s_add_u32 s10, s15, 1024
    s_add_u32 m0, s74, 49152
    s_nop 0
    buffer_load_dwordx4 v6, s[52:55], s10 offen lds
    s_add_u32 m0, s74, 50176
    s_nop 0
    buffer_load_dwordx4 v7, s[52:55], s10 offen lds
    s_waitcnt lgkmcnt(3)
    v_mfma_f32_32x32x16_bf16 v[80:95], v[192:195], v[32:35], v[80:95]
    v_fma_f32 v65, -v67, v66, 2.0
    v_sin_f32 v62, v61
    s_waitcnt lgkmcnt(2)
    v_mfma_f32_32x32x16_bf16 v[96:111], v[192:195], v[36:39], v[96:111]
    ds_read_b128 v[32:35], v3 offset:0
    ds_read_b128 v[36:39], v3 offset:4096
    v_cos_f32 v63, v61
    v_mul_f32 v66, v66, v65
    s_waitcnt lgkmcnt(3)
    v_mfma_f32_32x32x16_bf16 v[80:95], v[196:199], v[40:43], v[80:95]
    v_add_f32 v66, v66, v66
    v_mul_f32 v69, v60, v62
    v_mul_f32 v68, v60, v63
    s_waitcnt lgkmcnt(2)
    v_mfma_f32_32x32x16_bf16 v[96:111], v[196:199], v[44:47], v[96:111]
    ds_read_b128 v[40:43], v4 offset:0
    ds_read_b128 v[44:47], v4 offset:4096
    v_add_f32 v60, -1.0, v68
    v_mul_f32 v61, v60, v54
    s_waitcnt lgkmcnt(3)
    v_mfma_f32_32x32x16_bf16 v[80:95], v[200:203], v[32:35], v[80:95]
    v_mul_f32 v62, v69, v54
    v_fma_f32 v61, v69, v55, v61
    v_fma_f32 v62, -v60, v55, v62
    s_waitcnt lgkmcnt(2)
    v_mfma_f32_32x32x16_bf16 v[96:111], v[200:203], v[36:39], v[96:111]
    ds_read_b128 v[32:35], v1 offset:16384
    ds_read_b128 v[36:39], v1 offset:20480
    v_mul_f32 v70, v61, v66
    v_mul_f32 v71, v62, v66
    s_waitcnt lgkmcnt(3)
    v_mfma_f32_32x32x16_bf16 v[80:95], v[204:207], v[40:43], v[80:95]
    s_lshl_b32 s11, s6, 9
    s_add_u32 s11, s11, 90112
    v_and_b32 v60, 31, v0
    s_waitcnt lgkmcnt(2)
    v_mfma_f32_32x32x16_bf16 v[96:111], v[204:207], v[44:47], v[96:111]
    ds_read_b128 v[40:43], v2 offset:16384
    ds_read_b128 v[44:47], v2 offset:20480
    v_lshlrev_b32 v60, 4, v60
    v_add_u32 v60, s11, v60
    s_waitcnt vmcnt(3)
    s_barrier
    s_add_u32 s10, s15, 73728
    s_add_u32 m0, s74, 0
    s_nop 0
    buffer_load_dwordx4 v6, s[52:55], s10 offen lds
    s_add_u32 m0, s74, 1024
    s_nop 0
    buffer_load_dwordx4 v7, s[52:55], s10 offen lds
    s_waitcnt lgkmcnt(3)
    v_mfma_f32_32x32x16_bf16 v[80:95], v[208:211], v[32:35], v[80:95]
    ds_write_b128 v60, v[68:71] offset:1024
    s_nop 1
    s_waitcnt lgkmcnt(3)
    v_mfma_f32_32x32x16_bf16 v[96:111], v[208:211], v[36:39], v[96:111]
    ds_read_b128 v[32:35], v3 offset:16384
    ds_read_b128 v[36:39], v3 offset:20480
    s_waitcnt lgkmcnt(4)
    v_mfma_f32_32x32x16_bf16 v[80:95], v[212:215], v[40:43], v[80:95]
    s_waitcnt lgkmcnt(3)
    v_mfma_f32_32x32x16_bf16 v[96:111], v[212:215], v[44:47], v[96:111]
    ds_read_b128 v[40:43], v4 offset:16384
    ds_read_b128 v[44:47], v4 offset:20480
    s_waitcnt lgkmcnt(3)
    v_mfma_f32_32x32x16_bf16 v[80:95], v[216:219], v[32:35], v[80:95]
    s_waitcnt lgkmcnt(2)
    v_mfma_f32_32x32x16_bf16 v[96:111], v[216:219], v[36:39], v[96:111]
    ds_read_b128 v[32:35], v1 offset:32768
    ds_read_b128 v[36:39], v1 offset:36864
    s_waitcnt lgkmcnt(3)
    v_mfma_f32_32x32x16_bf16 v[80:95], v[220:223], v[40:43], v[80:95]
    s_waitcnt lgkmcnt(2)
    v_mfma_f32_32x32x16_bf16 v[96:111], v[220:223], v[44:47], v[96:111]
    ds_read_b128 v[40:43], v2 offset:32768
    ds_read_b128 v[44:47], v2 offset:36864
    s_waitcnt vmcnt(2)
    s_barrier
    s_add_u32 s10, s15, 73856
    s_add_u32 m0, s74, 16384
    s_nop 0
    buffer_load_dwordx4 v6, s[52:55], s10 offen lds
    s_add_u32 m0, s74, 17408
    s_nop 0
    buffer_load_dwordx4 v7, s[52:55], s10 offen lds
    s_waitcnt lgkmcnt(3)
    v_mfma_f32_32x32x16_bf16 v[80:95], v[224:227], v[32:35], v[80:95]
    s_waitcnt lgkmcnt(2)
    v_mfma_f32_32x32x16_bf16 v[96:111], v[224:227], v[36:39], v[96:111]
    ds_read_b128 v[32:35], v3 offset:32768
    ds_read_b128 v[36:39], v3 offset:36864
    s_waitcnt lgkmcnt(3)
    v_mfma_f32_32x32x16_bf16 v[80:95], v[228:231], v[40:43], v[80:95]
    s_waitcnt lgkmcnt(2)
    v_mfma_f32_32x32x16_bf16 v[96:111], v[228:231], v[44:47], v[96:111]
    ds_read_b128 v[40:43], v4 offset:32768
    ds_read_b128 v[44:47], v4 offset:36864
    s_waitcnt lgkmcnt(3)
    v_mfma_f32_32x32x16_bf16 v[80:95], v[232:235], v[32:35], v[80:95]
    s_waitcnt lgkmcnt(2)
    v_mfma_f32_32x32x16_bf16 v[96:111], v[232:235], v[36:39], v[96:111]
    ds_read_b128 v[32:35], v1 offset:49152
    ds_read_b128 v[36:39], v1 offset:53248
    s_waitcnt lgkmcnt(3)
    v_mfma_f32_32x32x16_bf16 v[80:95], v[236:239], v[40:43], v[80:95]
    s_waitcnt lgkmcnt(2)
    v_mfma_f32_32x32x16_bf16 v[96:111], v[236:239], v[44:47], v[96:111]
    ds_read_b128 v[40:43], v2 offset:49152
    ds_read_b128 v[44:47], v2 offset:53248
    s_waitcnt vmcnt(2)
    s_barrier
    s_add_u32 s10, s15, 73984
    s_add_u32 m0, s74, 32768
    s_nop 0
    buffer_load_dwordx4 v6, s[52:55], s10 offen lds
    s_add_u32 m0, s74, 33792
    s_nop 0
    buffer_load_dwordx4 v7, s[52:55], s10 offen lds
    s_waitcnt lgkmcnt(3)
    v_mfma_f32_32x32x16_bf16 v[80:95], v[240:243], v[32:35], v[80:95]
    s_waitcnt lgkmcnt(2)
    v_mfma_f32_32x32x16_bf16 v[96:111], v[240:243], v[36:39], v[96:111]
    ds_read_b128 v[32:35], v3 offset:49152
    ds_read_b128 v[36:39], v3 offset:53248
    s_waitcnt lgkmcnt(3)
    v_mfma_f32_32x32x16_bf16 v[80:95], v[244:247], v[40:43], v[80:95]
    s_waitcnt lgkmcnt(2)
    v_mfma_f32_32x32x16_bf16 v[96:111], v[244:247], v[44:47], v[96:111]
    ds_read_b128 v[40:43], v4 offset:49152
    ds_read_b128 v[44:47], v4 offset:53248
    s_waitcnt lgkmcnt(3)
    v_mfma_f32_32x32x16_bf16 v[80:95], v[248:251], v[32:35], v[80:95]
    s_waitcnt lgkmcnt(2)
    v_mfma_f32_32x32x16_bf16 v[96:111], v[248:251], v[36:39], v[96:111]
    ds_read_b128 v[32:35], v1 offset:0
    ds_read_b128 v[36:39], v1 offset:4096
    s_waitcnt lgkmcnt(3)
    v_mfma_f32_32x32x16_bf16 v[80:95], v[252:255], v[40:43], v[80:95]
    s_waitcnt lgkmcnt(2)
    v_mfma_f32_32x32x16_bf16 v[96:111], v[252:255], v[44:47], v[96:111]
    ds_read_b128 v[40:43], v2 offset:0
    ds_read_b128 v[44:47], v2 offset:4096
    s_waitcnt vmcnt(2)
    s_barrier
    s_add_u32 s10, s15, 74112
    s_add_u32 m0, s74, 49152
    s_nop 0
    buffer_load_dwordx4 v6, s[52:55], s10 offen lds
    s_add_u32 m0, s74, 50176
    s_nop 0
    buffer_load_dwordx4 v7, s[52:55], s10 offen lds
    s_waitcnt lgkmcnt(3)
    v_mfma_f32_32x32x16_bf16 v[48:63], v[112:115], v[32:35], 0
    s_waitcnt lgkmcnt(2)
    v_mfma_f32_32x32x16_bf16 v[64:79], v[112:115], v[36:39], 0
    ds_read_b128 v[32:35], v3 offset:0
    ds_read_b128 v[36:39], v3 offset:4096
    s_lshl_b32 s11, s5, 7
    s_add_u32 s11, s11, 92160
    v_lshrrev_b32 v30, 5, v0
    v_lshl_add_u32 v5, v30, 6, s11
    ds_read_b128 v[14:17], v5 offset:0
    ds_read_b128 v[18:21], v5 offset:16
    ds_read_b128 v[22:25], v5 offset:32
    s_lshl_b32 s11, s6, 12
    s_lshl_b32 s73, s5, 9
    s_add_u32 s11, s11, s73
    s_add_u32 s11, s11, 81920
    v_and_b32 v31, 31, v0
    v_lshlrev_b32 v31, 3, v31
    v_lshrrev_b32 v30, 5, v0
    v_lshl_add_u32 v31, v30, 8, v31
    v_add_u32 v31, s11, v31
    s_waitcnt lgkmcnt(6)
    v_mfma_f32_32x32x16_bf16 v[48:63], v[116:119], v[40:43], v[48:63]
    s_waitcnt lgkmcnt(2)
    v_mul_f32 v80, v14, v80
    v_mul_f32 v96, v14, v96
    v_mul_f32 v81, v15, v81
    v_mul_f32 v97, v15, v97
    v_mul_f32 v82, v16, v82
    v_mul_f32 v98, v16, v98
    v_mul_f32 v83, v17, v83
    v_mul_f32 v99, v17, v99
    ds_read_b128 v[14:17], v5 offset:48
    s_waitcnt lgkmcnt(2)
    v_mul_f32 v84, v18, v84
    v_mul_f32 v100, v18, v100
    v_mul_f32 v85, v19, v85
    v_mul_f32 v101, v19, v101
    v_mul_f32 v86, v20, v86
    v_mfma_f32_32x32x16_bf16 v[64:79], v[116:119], v[44:47], v[64:79]
    ds_read_b128 v[40:43], v4 offset:0
    ds_read_b128 v[44:47], v4 offset:4096
    v_mul_f32 v102, v20, v102
    v_mul_f32 v87, v21, v87
    v_mul_f32 v103, v21, v103
    s_waitcnt lgkmcnt(3)
    v_mul_f32 v88, v22, v88
    v_mul_f32 v104, v22, v104
    v_mul_f32 v89, v23, v89
    v_mul_f32 v105, v23, v105
    v_mul_f32 v90, v24, v90
    v_mul_f32 v106, v24, v106
    v_mul_f32 v91, v25, v91
    v_mul_f32 v107, v25, v107
    s_waitcnt lgkmcnt(2)
    v_mul_f32 v92, v14, v92
    v_mul_f32 v108, v14, v108
    v_mul_f32 v93, v15, v93
    v_mfma_f32_32x32x16_bf16 v[48:63], v[120:123], v[32:35], v[48:63]
    v_mul_f32 v109, v15, v109
    v_mul_f32 v94, v16, v94
    v_mul_f32 v110, v16, v110
    v_mul_f32 v95, v17, v95
    v_mul_f32 v111, v17, v111
    v_fma_f32 v28, v8, v80, v81
    v_fma_f32 v29, v8, v96, v97
    v_fma_f32 v28, -v9, v96, v28
    v_fma_f32 v29, v9, v80, v29
    v_fma_f32 v26, v8, v28, v82
    v_fma_f32 v27, v8, v29, v98
    v_fma_f32 v26, -v9, v29, v26
    v_fma_f32 v27, v9, v28, v27
    v_fma_f32 v28, v8, v26, v83
    v_fma_f32 v29, v8, v27, v99
    v_fma_f32 v28, -v9, v27, v28
    v_fma_f32 v29, v9, v26, v29
    v_mfma_f32_32x32x16_bf16 v[64:79], v[120:123], v[36:39], v[64:79]
    ds_read_b128 v[32:35], v1 offset:16384
    ds_read_b128 v[36:39], v1 offset:20480
    v_fma_f32 v26, v8, v28, v84
    v_fma_f32 v27, v8, v29, v100
    v_fma_f32 v26, -v9, v29, v26
    v_fma_f32 v27, v9, v28, v27
    v_fma_f32 v28, v8, v26, v85
    v_fma_f32 v29, v8, v27, v101
    v_fma_f32 v28, -v9, v27, v28
    v_fma_f32 v29, v9, v26, v29
    v_fma_f32 v26, v8, v28, v86
    v_fma_f32 v27, v8, v29, v102
    v_fma_f32 v26, -v9, v29, v26
    v_fma_f32 v27, v9, v28, v27
    v_fma_f32 v28, v8, v26, v87
    v_fma_f32 v29, v8, v27, v103
    v_fma_f32 v28, -v9, v27, v28
    v_fma_f32 v29, v9, v26, v29
    s_waitcnt lgkmcnt(3)
    v_mfma_f32_32x32x16_bf16 v[48:63], v[124:127], v[40:43], v[48:63]
    v_fma_f32 v26, v8, v28, v88
    v_fma_f32 v27, v8, v29, v104
    v_fma_f32 v26, -v9, v29, v26
    v_fma_f32 v27, v9, v28, v27
    v_fma_f32 v28, v8, v26, v89
    v_fma_f32 v29, v8, v27, v105
    v_fma_f32 v28, -v9, v27, v28
    v_fma_f32 v29, v9, v26, v29
    v_fma_f32 v26, v8, v28, v90
    v_fma_f32 v27, v8, v29, v106
    v_fma_f32 v26, -v9, v29, v26
    v_fma_f32 v27, v9, v28, v27
    v_fma_f32 v28, v8, v26, v91
    v_fma_f32 v29, v8, v27, v107
    v_fma_f32 v28, -v9, v27, v28
    v_fma_f32 v29, v9, v26, v29
    v_fma_f32 v26, v8, v28, v92
    s_waitcnt lgkmcnt(2)
    v_mfma_f32_32x32x16_bf16 v[64:79], v[124:127], v[44:47], v[64:79]
    ds_read_b128 v[40:43], v2 offset:16384
    ds_read_b128 v[44:47], v2 offset:20480
    v_fma_f32 v27, v8, v29, v108
    v_fma_f32 v26, -v9, v29, v26
    v_fma_f32 v27, v9, v28, v27
    v_fma_f32 v28, v8, v26, v93
    v_fma_f32 v29, v8, v27, v109
    v_fma_f32 v28, -v9, v27, v28
    v_fma_f32 v29, v9, v26, v29
    v_fma_f32 v26, v8, v28, v94
    v_fma_f32 v27, v8, v29, v110
    v_fma_f32 v26, -v9, v29, v26
    v_fma_f32 v27, v9, v28, v27
    v_fma_f32 v28, v8, v26, v95
    v_fma_f32 v29, v8, v27, v111
    v_fma_f32 v28, -v9, v27, v28
    v_fma_f32 v29, v9, v26, v29
    ds_write_b64 v31, v[28:29] offset:1792
    s_waitcnt lgkmcnt(0)
    s_waitcnt vmcnt(2)
    s_barrier
    s_add_u32 s10, s15, 74240
    s_add_u32 m0, s74, 0
    s_nop 0
    buffer_load_dwordx4 v6, s[52:55], s10 offen lds
    s_add_u32 m0, s74, 1024
    s_nop 0
    buffer_load_dwordx4 v7, s[52:55], s10 offen lds
    v_mfma_f32_32x32x16_bf16 v[48:63], v[128:131], v[32:35], v[48:63]
    ds_read_b64 v[14:15], v31 offset:0
    ds_read_b64 v[16:17], v31 offset:256
    ds_read_b64 v[18:19], v31 offset:512
    ds_read_b64 v[20:21], v31 offset:768
    ds_read_b64 v[22:23], v31 offset:1024
    ds_read_b64 v[24:25], v31 offset:1280
    ds_read_b64 v[26:27], v31 offset:1536
    v_mul_f32 v12, v9, v9
    v_mul_f32 v5, v8, v9
    v_mfma_f32_32x32x16_bf16 v[64:79], v[128:131], v[36:39], v[64:79]
    ds_read_b128 v[32:35], v3 offset:16384
    ds_read_b128 v[36:39], v3 offset:20480
    v_fma_f32 v30, v8, v8, -v12
    v_add_f32 v5, v5, v5
    v_mul_f32 v12, v5, v5
    v_mul_f32 v5, v30, v5
    v_fma_f32 v30, v30, v30, -v12
    v_add_f32 v5, v5, v5
    v_mul_f32 v12, v5, v5
    v_mul_f32 v5, v30, v5
    v_mfma_f32_32x32x16_bf16 v[48:63], v[132:135], v[40:43], v[48:63]
    v_fma_f32 v30, v30, v30, -v12
    v_add_f32 v5, v5, v5
    v_mul_f32 v12, v5, v5
    v_mul_f32 v5, v30, v5
    v_fma_f32 v30, v30, v30, -v12
    v_add_f32 v5, v5, v5
    s_waitcnt lgkmcnt(7)
    v_fma_f32 v16, v30, v14, v16
    v_fma_f32 v17, v30, v15, v17
    v_mfma_f32_32x32x16_bf16 v[64:79], v[132:135], v[44:47], v[64:79]
    ds_read_b128 v[40:43], v4 offset:16384
    ds_read_b128 v[44:47], v4 offset:20480
    v_fma_f32 v16, -v5, v15, v16
    v_fma_f32 v17, v5, v14, v17
    s_waitcnt lgkmcnt(8)
    v_fma_f32 v18, v30, v16, v18
    v_fma_f32 v19, v30, v17, v19
    v_fma_f32 v18, -v5, v17, v18
    v_fma_f32 v19, v5, v16, v19
    s_waitcnt lgkmcnt(7)
    s_waitcnt lgkmcnt(3)
    v_mfma_f32_32x32x16_bf16 v[48:63], v[136:139], v[32:35], v[48:63]
    v_fma_f32 v20, v30, v18, v20
    v_fma_f32 v21, v30, v19, v21
    v_fma_f32 v20, -v5, v19, v20
    v_fma_f32 v21, v5, v18, v21
    v_fma_f32 v22, v30, v20, v22
    v_fma_f32 v23, v30, v21, v23
    v_fma_f32 v22, -v5, v21, v22
    v_fma_f32 v23, v5, v20, v23
    s_waitcnt lgkmcnt(2)
    v_mfma_f32_32x32x16_bf16 v[64:79], v[136:139], v[36:39], v[64:79]
    ds_read_b128 v[32:35], v1 offset:32768
    ds_read_b128 v[36:39], v1 offset:36864
    v_fma_f32 v24, v30, v22, v24
    v_fma_f32 v25, v30, v23, v25
    v_fma_f32 v24, -v5, v23, v24
    v_fma_f32 v25, v5, v22, v25
    v_fma_f32 v12, v30, v24, v26
    v_fma_f32 v13, v30, v25, v27
    s_waitcnt lgkmcnt(3)
    v_mfma_f32_32x32x16_bf16 v[48:63], v[140:143], v[40:43], v[48:63]
    v_fma_f32 v12, -v5, v25, v12
    v_fma_f32 v13, v5, v24, v13
    v_fma_f32 v28, v30, v12, v28
    v_fma_f32 v29, v30, v13, v29
    v_fma_f32 v28, -v5, v13, v28
    v_fma_f32 v29, v5, v12, v29
    s_mul_i32 s11, s7, 4608
    s_add_u32 s73, s78, s6
    s_lshl_b32 s73, s73, 8
    s_waitcnt lgkmcnt(2)
    v_mfma_f32_32x32x16_bf16 v[64:79], v[140:143], v[44:47], v[64:79]
    ds_read_b128 v[40:43], v2 offset:32768
    ds_read_b128 v[44:47], v2 offset:36864
    s_add_u32 s11, s11, s73
    s_add_u32 s11, s11, -256
    s_cmp_eq_u32 s5, 3
    s_cselect_b32 s11, s11, 0x100000
    v_lshlrev_b32 v30, 3, v0
    v_add_u32 v30, s11, v30
    v_mov_b32 v5, 0x100000
    v_cndmask_b32 v30, v5, v30, s[96:97]
    s_waitcnt vmcnt(2)
    s_barrier
    buffer_store_dwordx2 v[28:29], v30, s[48:51], 0 offen sc1
    s_add_u32 s10, s15, 74368
    s_add_u32 m0, s74, 16384
    s_nop 0
    buffer_load_dwordx4 v6, s[52:55], s10 offen lds
    s_add_u32 m0, s74, 17408
    s_nop 0
    buffer_load_dwordx4 v7, s[52:55], s10 offen lds
    s_waitcnt lgkmcnt(3)
    v_mfma_f32_32x32x16_bf16 v[48:63], v[144:147], v[32:35], v[48:63]
    s_waitcnt lgkmcnt(2)
    v_mfma_f32_32x32x16_bf16 v[64:79], v[144:147], v[36:39], v[64:79]
    ds_read_b128 v[32:35], v3 offset:32768
    ds_read_b128 v[36:39], v3 offset:36864
    s_waitcnt lgkmcnt(3)
    v_mfma_f32_32x32x16_bf16 v[48:63], v[148:151], v[40:43], v[48:63]
    s_waitcnt lgkmcnt(2)
    v_mfma_f32_32x32x16_bf16 v[64:79], v[148:151], v[44:47], v[64:79]
    ds_read_b128 v[40:43], v4 offset:32768
    ds_read_b128 v[44:47], v4 offset:36864
    s_waitcnt lgkmcnt(3)
    v_mfma_f32_32x32x16_bf16 v[48:63], v[152:155], v[32:35], v[48:63]
    s_waitcnt lgkmcnt(2)
    v_mfma_f32_32x32x16_bf16 v[64:79], v[152:155], v[36:39], v[64:79]
    ds_read_b128 v[32:35], v1 offset:49152
    ds_read_b128 v[36:39], v1 offset:53248
    s_waitcnt lgkmcnt(3)
    v_mfma_f32_32x32x16_bf16 v[48:63], v[156:159], v[40:43], v[48:63]
    s_waitcnt lgkmcnt(2)
    v_mfma_f32_32x32x16_bf16 v[64:79], v[156:159], v[44:47], v[64:79]
    ds_read_b128 v[40:43], v2 offset:49152
    ds_read_b128 v[44:47], v2 offset:53248
    s_waitcnt vmcnt(3)
    s_barrier
    s_add_u32 s10, s15, 74496
    s_add_u32 m0, s74, 32768
    s_nop 0
    buffer_load_dwordx4 v6, s[52:55], s10 offen lds
    s_add_u32 m0, s74, 33792
    s_nop 0
    buffer_load_dwordx4 v7, s[52:55], s10 offen lds
    s_waitcnt lgkmcnt(3)
    v_mfma_f32_32x32x16_bf16 v[48:63], v[160:163], v[32:35], v[48:63]
    s_waitcnt lgkmcnt(2)
    v_mfma_f32_32x32x16_bf16 v[64:79], v[160:163], v[36:39], v[64:79]
    ds_read_b128 v[32:35], v3 offset:49152
    ds_read_b128 v[36:39], v3 offset:53248
    s_waitcnt lgkmcnt(3)
    v_mfma_f32_32x32x16_bf16 v[48:63], v[164:167], v[40:43], v[48:63]
    s_waitcnt lgkmcnt(2)
    v_mfma_f32_32x32x16_bf16 v[64:79], v[164:167], v[44:47], v[64:79]
    ds_read_b128 v[40:43], v4 offset:49152
    ds_read_b128 v[44:47], v4 offset:53248
    s_waitcnt lgkmcnt(3)
    v_mfma_f32_32x32x16_bf16 v[48:63], v[168:171], v[32:35], v[48:63]
    s_waitcnt lgkmcnt(2)
    v_mfma_f32_32x32x16_bf16 v[64:79], v[168:171], v[36:39], v[64:79]
    ds_read_b128 v[32:35], v1 offset:0
    ds_read_b128 v[36:39], v1 offset:4096
    s_waitcnt lgkmcnt(3)
    v_mfma_f32_32x32x16_bf16 v[48:63], v[172:175], v[40:43], v[48:63]
    s_waitcnt lgkmcnt(2)
    v_mfma_f32_32x32x16_bf16 v[64:79], v[172:175], v[44:47], v[64:79]
    ds_read_b128 v[40:43], v2 offset:0
    ds_read_b128 v[44:47], v2 offset:4096
    s_waitcnt vmcnt(2)
    s_barrier
    s_lshl_b32 s11, s8, 4
    s_add_u32 s11, s11, s7
    s_lshl_b32 s11, s11, 2
    s_cmp_eq_u32 s4, 3
    s_cselect_b32 s11, s11, 0x1000
    s_cmp_eq_u32 s7, 15
    s_cselect_b32 s11, 0x1000, s11
    v_lshlrev_b32 v30, 12, v0
    v_add_u32 v30, s11, v30
    v_mov_b32 v31, 1
    buffer_store_dword v31, v30, s[68:71], 0 offen sc1
    s_add_u32 s10, s15, 74624
    s_add_u32 m0, s74, 49152
    s_nop 0
    buffer_load_dwordx4 v6, s[52:55], s10 offen lds
    s_add_u32 m0, s74, 50176
    s_nop 0
    buffer_load_dwordx4 v7, s[52:55], s10 offen lds
    s_waitcnt lgkmcnt(3)
    v_mfma_f32_32x32x16_bf16 v[48:63], v[176:179], v[32:35], v[48:63]
    s_waitcnt lgkmcnt(2)
    v_mfma_f32_32x32x16_bf16 v[64:79], v[176:179], v[36:39], v[64:79]
    ds_read_b128 v[32:35], v3 offset:0
    ds_read_b128 v[36:39], v3 offset:4096
    s_waitcnt lgkmcnt(3)
    v_mfma_f32_32x32x16_bf16 v[48:63], v[180:183], v[40:43], v[48:63]
    s_waitcnt lgkmcnt(2)
    v_mfma_f32_32x32x16_bf16 v[64:79], v[180:183], v[44:47], v[64:79]
    ds_read_b128 v[40:43], v4 offset:0
    ds_read_b128 v[44:47], v4 offset:4096
    s_waitcnt lgkmcnt(3)
    v_mfma_f32_32x32x16_bf16 v[48:63], v[184:187], v[32:35], v[48:63]
    s_waitcnt lgkmcnt(2)
    v_mfma_f32_32x32x16_bf16 v[64:79], v[184:187], v[36:39], v[64:79]
    ds_read_b128 v[32:35], v1 offset:16384
    ds_read_b128 v[36:39], v1 offset:20480
    s_waitcnt lgkmcnt(3)
    v_mfma_f32_32x32x16_bf16 v[48:63], v[188:191], v[40:43], v[48:63]
    s_waitcnt lgkmcnt(2)
    v_mfma_f32_32x32x16_bf16 v[64:79], v[188:191], v[44:47], v[64:79]
    ds_read_b128 v[40:43], v2 offset:16384
    ds_read_b128 v[44:47], v2 offset:20480
    s_waitcnt vmcnt(3)
    s_barrier
    s_add_u32 s10, s15, 74752
    s_add_u32 m0, s74, 0
    s_nop 0
    buffer_load_dwordx4 v6, s[52:55], s10 offen lds
    s_add_u32 m0, s74, 1024
    s_nop 0
    buffer_load_dwordx4 v7, s[52:55], s10 offen lds
    s_waitcnt lgkmcnt(3)
    v_mfma_f32_32x32x16_bf16 v[48:63], v[192:195], v[32:35], v[48:63]
    s_waitcnt lgkmcnt(2)
    v_mfma_f32_32x32x16_bf16 v[64:79], v[192:195], v[36:39], v[64:79]
    ds_read_b128 v[32:35], v3 offset:16384
    ds_read_b128 v[36:39], v3 offset:20480
    s_waitcnt lgkmcnt(3)
    v_mfma_f32_32x32x16_bf16 v[48:63], v[196:199], v[40:43], v[48:63]
    s_waitcnt lgkmcnt(2)
    v_mfma_f32_32x32x16_bf16 v[64:79], v[196:199], v[44:47], v[64:79]
    ds_read_b128 v[40:43], v4 offset:16384
    ds_read_b128 v[44:47], v4 offset:20480
    s_waitcnt lgkmcnt(3)
    v_mfma_f32_32x32x16_bf16 v[48:63], v[200:203], v[32:35], v[48:63]
    s_waitcnt lgkmcnt(2)
    v_mfma_f32_32x32x16_bf16 v[64:79], v[200:203], v[36:39], v[64:79]
    ds_read_b128 v[32:35], v1 offset:32768
    ds_read_b128 v[36:39], v1 offset:36864
    s_waitcnt lgkmcnt(3)
    v_mfma_f32_32x32x16_bf16 v[48:63], v[204:207], v[40:43], v[48:63]
    s_waitcnt lgkmcnt(2)
    v_mfma_f32_32x32x16_bf16 v[64:79], v[204:207], v[44:47], v[64:79]
    ds_read_b128 v[40:43], v2 offset:32768
    ds_read_b128 v[44:47], v2 offset:36864
    s_lshl_b32 s11, s5, 4
    v_lshrrev_b32 v6, 2, v0
    v_add_u32 v6, s11, v6
    v_mul_u32_u24 v6, 0x480, v6
    v_lshrrev_b32 v7, 4, v0
    v_xor_b32 v7, v7, v0
    v_and_b32 v7, 3, v7
    v_lshl_add_u32 v6, v7, 4, v6
    s_waitcnt vmcnt(2)
    s_barrier
    v_and_b32 v31, 15, v0
    s_lshl_b32 s11, s8, 6
    v_lshlrev_b32 v31, 2, v31
    v_add_u32 v31, s11, v31
    buffer_load_dword v30, v31, s[68:71], 0 offen sc1
    s_add_u32 m0, s9, 16384
    s_add_u32 s10, s72, 0
    buffer_load_dwordx4 v6, s[56:59], s10 offen lds
    s_add_u32 m0, s9, 24576
    s_add_u32 s10, s72, 73728
    buffer_load_dwordx4 v6, s[56:59], s10 offen lds
    s_waitcnt lgkmcnt(3)
    v_mfma_f32_32x32x16_bf16 v[48:63], v[208:211], v[32:35], v[48:63]
    s_waitcnt lgkmcnt(2)
    v_mfma_f32_32x32x16_bf16 v[64:79], v[208:211], v[36:39], v[64:79]
    ds_read_b128 v[32:35], v3 offset:32768
    ds_read_b128 v[36:39], v3 offset:36864
    s_waitcnt lgkmcnt(3)
    v_mfma_f32_32x32x16_bf16 v[48:63], v[212:215], v[40:43], v[48:63]
    s_waitcnt lgkmcnt(2)
    v_mfma_f32_32x32x16_bf16 v[64:79], v[212:215], v[44:47], v[64:79]
    ds_read_b128 v[40:43], v4 offset:32768
    ds_read_b128 v[44:47], v4 offset:36864
    s_waitcnt lgkmcnt(3)
    v_mfma_f32_32x32x16_bf16 v[48:63], v[216:219], v[32:35], v[48:63]
    s_waitcnt lgkmcnt(2)
    v_mfma_f32_32x32x16_bf16 v[64:79], v[216:219], v[36:39], v[64:79]
    ds_read_b128 v[32:35], v1 offset:49152
    ds_read_b128 v[36:39], v1 offset:53248
    s_waitcnt lgkmcnt(3)
    v_mfma_f32_32x32x16_bf16 v[48:63], v[220:223], v[40:43], v[48:63]
    s_waitcnt lgkmcnt(2)
    v_mfma_f32_32x32x16_bf16 v[64:79], v[220:223], v[44:47], v[64:79]
    ds_read_b128 v[40:43], v2 offset:49152
    ds_read_b128 v[44:47], v2 offset:53248
    s_waitcnt vmcnt(3)
    s_barrier
    s_waitcnt vmcnt(2)
    v_cmp_gt_u32 vcc, 1, v30
    s_and_b64 vcc, vcc, s[94:95]
    s_cbranch_scc0 .pok_22
    s_mov_b32 s83, 65536
.plp_23:
    buffer_load_dword v30, v31, s[68:71], 0 offen sc1
    s_waitcnt vmcnt(0)
    v_cmp_gt_u32 vcc, 1, v30
    s_and_b64 vcc, vcc, s[94:95]
    s_cbranch_scc0 .pok_22
    s_sub_u32 s83, s83, 1
    s_cmp_lg_u32 s83, 0
    s_cbranch_scc1 .plp_23
.pok_22:
    s_sub_u32 s11, s7, 1
    s_mul_i32 s11, s11, 4608
    s_add_u32 s73, s78, s6
    s_lshl_b32 s73, s73, 8
    s_add_u32 s11, s11, s73
    s_add_u32 s11, s11, 0
    v_and_b32 v30, 31, v0
    v_lshlrev_b32 v30, 3, v30
    v_lshrrev_b32 v31, 5, v0
    v_mul_u32_u24 v31, 4608, v31
    v_sub_u32 v30, v30, v31
    v_add_u32 v30, s11, v30
    v_subrev_u32 v28, 64512, v30
    buffer_load_dwordx2 v[28:29], v28, s[48:51], 0 offen sc1
    v_subrev_u32 v26, 55296, v30
    buffer_load_dwordx2 v[26:27], v26, s[48:51], 0 offen sc1
    v_subrev_u32 v24, 46080, v30
    buffer_load_dwordx2 v[24:25], v24, s[48:51], 0 offen sc1
    v_subrev_u32 v22, 36864, v30
    buffer_load_dwordx2 v[22:23], v22, s[48:51], 0 offen sc1
    v_subrev_u32 v20, 27648, v30
    buffer_load_dwordx2 v[20:21], v20, s[48:51], 0 offen sc1
    v_subrev_u32 v18, 18432, v30
    buffer_load_dwordx2 v[18:19], v18, s[48:51], 0 offen sc1
    v_subrev_u32 v16, 9216, v30
    buffer_load_dwordx2 v[16:17], v16, s[48:51], 0 offen sc1
    v_subrev_u32 v14, 0, v30
    buffer_load_dwordx2 v[14:15], v14, s[48:51], 0 offen sc1
    s_add_u32 m0, s9, 32768
    s_add_u32 s10, s72, 147456
    buffer_load_dwordx4 v6, s[56:59], s10 offen lds
    s_add_u32 m0, s9, 40960
    s_add_u32 s10, s72, 221184
    buffer_load_dwordx4 v6, s[56:59], s10 offen lds
    s_waitcnt lgkmcnt(3)
    v_mfma_f32_32x32x16_bf16 v[48:63], v[224:227], v[32:35], v[48:63]
    v_mul_f32 v5, v9, v9
    v_mul_f32 v31, v8, v9
    v_fma_f32 v30, v8, v8, -v5
    v_add_f32 v31, v31, v31
    v_mul_f32 v5, v31, v31
    s_waitcnt lgkmcnt(2)
    v_mfma_f32_32x32x16_bf16 v[64:79], v[224:227], v[36:39], v[64:79]
    ds_read_b128 v[32:35], v3 offset:49152
    ds_read_b128 v[36:39], v3 offset:53248
    v_mul_f32 v31, v30, v31
    v_fma_f32 v30, v30, v30, -v5
    v_add_f32 v31, v31, v31
    v_mul_f32 v5, v31, v31
    v_mul_f32 v31, v30, v31
    s_waitcnt lgkmcnt(3)
    v_mfma_f32_32x32x16_bf16 v[48:63], v[228:231], v[40:43], v[48:63]
    v_fma_f32 v30, v30, v30, -v5
    v_add_f32 v31, v31, v31
    v_mul_f32 v5, v31, v31
    v_mul_f32 v31, v30, v31
    s_waitcnt lgkmcnt(2)
    v_mfma_f32_32x32x16_bf16 v[64:79], v[228:231], v[44:47], v[64:79]
    ds_read_b128 v[40:43], v4 offset:49152
    ds_read_b128 v[44:47], v4 offset:53248
    v_fma_f32 v30, v30, v30, -v5
    v_add_f32 v31, v31, v31
    v_mul_f32 v5, v31, v31
    v_mul_f32 v31, v30, v31
    v_fma_f32 v30, v30, v30, -v5
    s_waitcnt lgkmcnt(3)
    v_mfma_f32_32x32x16_bf16 v[48:63], v[232:235], v[32:35], v[48:63]
    v_add_f32 v31, v31, v31
    v_mul_f32 v5, v31, v31
    v_mul_f32 v31, v30, v31
    v_fma_f32 v30, v30, v30, -v5
    s_waitcnt lgkmcnt(2)
    v_mfma_f32_32x32x16_bf16 v[64:79], v[232:235], v[36:39], v[64:79]
    ds_read_b128 v[32:35], v1 offset:0
    ds_read_b128 v[36:39], v1 offset:4096
    v_add_f32 v31, v31, v31
    v_mul_f32 v5, v31, v31
    v_mul_f32 v31, v30, v31
    v_fma_f32 v30, v30, v30, -v5
    v_add_f32 v31, v31, v31
    s_waitcnt lgkmcnt(3)
    v_mfma_f32_32x32x16_bf16 v[48:63], v[236:239], v[40:43], v[48:63]
    v_mul_f32 v5, v31, v31
    v_mul_f32 v31, v30, v31
    v_fma_f32 v30, v30, v30, -v5
    v_add_f32 v31, v31, v31
    s_waitcnt lgkmcnt(2)
    v_mfma_f32_32x32x16_bf16 v[64:79], v[236:239], v[44:47], v[64:79]
    ds_read_b128 v[40:43], v2 offset:0
    ds_read_b128 v[44:47], v2 offset:4096
    s_waitcnt vmcnt(10)
    s_barrier
    s_lshl_b32 s11, s6, 11
    s_add_u32 s11, s11, 98304
    v_bfe_u32 v1, v0, 2, 2
    v_lshrrev_b32 v2, 5, v0
    v_xor_b32 v1, v1, v2
    v_and_b32 v2, 31, v0
    v_lshlrev_b32 v2, 6, v2
    v_add_u32 v2, s11, v2
    v_lshl_add_u32 v1, v1, 4, v2
    v_xor_b32 v2, 32, v1
    s_add_u32 m0, s9, 49152
    s_add_u32 s10, s72, 294912
    buffer_load_dwordx4 v6, s[56:59], s10 offen lds
    s_add_u32 m0, s9, 57344
    s_add_u32 s10, s72, 368640
    buffer_load_dwordx4 v6, s[56:59], s10 offen lds
    s_waitcnt lgkmcnt(3)
    v_mfma_f32_32x32x16_bf16 v[48:63], v[240:243], v[32:35], v[48:63]
    s_waitcnt vmcnt(10)
    v_fma_f32 v26, v30, v28, v26
    v_fma_f32 v27, v30, v29, v27
    v_fma_f32 v26, -v31, v29, v26
    v_fma_f32 v27, v31, v28, v27
    s_waitcnt vmcnt(9)
    v_fma_f32 v24, v30, v26, v24
    v_fma_f32 v25, v30, v27, v25
    v_fma_f32 v24, -v31, v27, v24
    v_fma_f32 v25, v31, v26, v25
    s_waitcnt vmcnt(8)
    v_fma_f32 v22, v30, v24, v22
    v_fma_f32 v23, v30, v25, v23
    v_fma_f32 v22, -v31, v25, v22
    v_fma_f32 v23, v31, v24, v23
    s_waitcnt vmcnt(7)
    v_fma_f32 v20, v30, v22, v20
    v_fma_f32 v21, v30, v23, v21
    v_fma_f32 v20, -v31, v23, v20
    v_fma_f32 v21, v31, v22, v21
    s_waitcnt vmcnt(6)
    v_fma_f32 v18, v30, v20, v18
    v_fma_f32 v19, v30, v21, v19
    v_fma_f32 v18, -v31, v21, v18
    v_fma_f32 v19, v31, v20, v19
    s_waitcnt vmcnt(5)
    v_fma_f32 v16, v30, v18, v16
    v_fma_f32 v17, v30, v19, v17
    v_fma_f32 v16, -v31, v19, v16
    v_fma_f32 v17, v31, v18, v17
    s_waitcnt vmcnt(4)
    v_fma_f32 v14, v30, v16, v14
    v_fma_f32 v15, v30, v17, v15
    s_waitcnt lgkmcnt(2)
    v_mfma_f32_32x32x16_bf16 v[64:79], v[240:243], v[36:39], v[64:79]
    ds_read_b128 v[32:35], v3 offset:0
    ds_read_b128 v[36:39], v3 offset:4096
    v_fma_f32 v14, -v31, v17, v14
    v_fma_f32 v15, v31, v16, v15
    v_mul_f32 v5, v9, v9
    v_mul_f32 v17, v8, v9
    v_fma_f32 v16, v8, v8, -v5
    v_add_f32 v17, v17, v17
    v_mul_f32 v5, v17, v17
    v_mul_f32 v17, v16, v17
    v_fma_f32 v16, v16, v16, -v5
    v_add_f32 v17, v17, v17
    v_mul_f32 v5, v17, v17
    v_mul_f32 v17, v16, v17
    v_fma_f32 v16, v16, v16, -v5
    v_add_f32 v17, v17, v17
    v_mul_f32 v5, v17, v17
    v_mul_f32 v17, v16, v17
    v_fma_f32 v16, v16, v16, -v5
    v_add_f32 v17, v17, v17
    v_mul_f32 v5, v17, v17
    v_mul_f32 v19, v16, v17
    v_fma_f32 v18, v16, v16, -v5
    v_add_f32 v19, v19, v19
    v_mul_f32 v5, v19, v19
    v_mul_f32 v21, v18, v19
    v_fma_f32 v20, v18, v18, -v5
    v_add_f32 v21, v21, v21
    v_mul_f32 v5, v21, v21
    v_mul_f32 v23, v20, v21
    v_fma_f32 v22, v20, v20, -v5
    v_add_f32 v23, v23, v23
    v_mul_f32 v24, v22, v14
    v_mul_f32 v25, v22, v15
    s_waitcnt lgkmcnt(3)
    v_mfma_f32_32x32x16_bf16 v[48:63], v[244:247], v[40:43], v[48:63]
    v_fma_f32 v24, -v23, v15, v24
    v_fma_f32 v25, v23, v14, v25
    v_cndmask_b32 v14, v14, v24, s[96:97]
    v_cndmask_b32 v15, v15, v25, s[96:97]
    v_mov_b32 v24, v14
    v_mov_b32 v25, v15
    v_cndmask_b32 v16, 1.0, v16, s[96:97]
    v_cndmask_b32 v17, 0, v17, s[96:97]
    v_permlane32_swap_b32 v14, v24
    v_permlane32_swap_b32 v15, v25
    v_cndmask_b32 v18, 1.0, v18, s[98:99]
    v_cndmask_b32 v19, 0, v19, s[98:99]
    v_cndmask_b32 v20, 1.0, v20, s[100:101]
    v_cndmask_b32 v21, 0, v21, s[100:101]
    v_add_f32 v14, v14, v24
    v_add_f32 v15, v15, v25
    v_mul_f32 v22, v16, v18
    v_mul_f32 v23, v16, v19
    v_fma_f32 v22, -v17, v19, v22
    v_fma_f32 v23, v17, v18, v23
    v_mul_f32 v16, v22, v20
    v_mul_f32 v17, v22, v21
    v_fma_f32 v16, -v23, v21, v16
    v_fma_f32 v17, v23, v20, v17
    v_fma_f32 v12, v16, v14, v12
    v_fma_f32 v13, v16, v15, v13
    v_fma_f32 v12, -v17, v15, v12
    v_fma_f32 v13, v17, v14, v13
    v_and_b32 v30, 3, v0
    v_xor_b32 v30, s5, v30
    v_lshlrev_b32 v30, 6, v30
    v_and_b32 v31, 31, v0
    s_waitcnt lgkmcnt(2)
    v_mfma_f32_32x32x16_bf16 v[64:79], v[244:247], v[44:47], v[64:79]
    ds_read_b128 v[40:43], v4 offset:0
    ds_read_b128 v[44:47], v4 offset:4096
    v_lshl_add_u32 v30, v31, 8, v30
    v_lshrrev_b32 v31, 5, v0
    v_lshl_add_u32 v30, v31, 5, v30
    s_lshl_b32 s11, s6, 14
    s_add_u32 s11, s11, 0
    v_add_u32 v31, s11, v30
    v_fma_f32 v80, v8, v12, v80
    v_fma_f32 v96, v8, v13, v96
    v_fma_f32 v80, -v9, v13, v80
    v_fma_f32 v96, v9, v12, v96
    v_mul_f32 v30, v10, v80
    v_mul_f32 v5, -v10, v96
    v_fma_f32 v30, -v11, v96, v30
    v_fma_f32 v5, -v11, v80, v5
    v_fma_f32 v81, v8, v80, v81
    v_fma_f32 v97, v8, v96, v97
    v_fma_f32 v81, -v9, v96, v81
    v_fma_f32 v97, v9, v80, v97
    v_mul_f32 v12, v10, v81
    v_mul_f32 v13, -v10, v97
    v_fma_f32 v12, -v11, v97, v12
    v_fma_f32 v13, -v11, v81, v13
    v_cvt_pk_bf16_f32 v14, v30, v12
    v_cvt_pk_bf16_f32 v18, v5, v13
    v_fma_f32 v82, v8, v81, v82
    v_fma_f32 v98, v8, v97, v98
    v_fma_f32 v82, -v9, v97, v82
    v_fma_f32 v98, v9, v81, v98
    v_mul_f32 v30, v10, v82
    v_mul_f32 v5, -v10, v98
    v_fma_f32 v30, -v11, v98, v30
    v_fma_f32 v5, -v11, v82, v5
    s_waitcnt lgkmcnt(3)
    v_mfma_f32_32x32x16_bf16 v[48:63], v[248:251], v[32:35], v[48:63]
    v_fma_f32 v83, v8, v82, v83
    v_fma_f32 v99, v8, v98, v99
    v_fma_f32 v83, -v9, v98, v83
    v_fma_f32 v99, v9, v82, v99
    v_mul_f32 v12, v10, v83
    v_mul_f32 v13, -v10, v99
    v_fma_f32 v12, -v11, v99, v12
    v_fma_f32 v13, -v11, v83, v13
    v_cvt_pk_bf16_f32 v15, v30, v12
    v_cvt_pk_bf16_f32 v19, v5, v13
    v_fma_f32 v84, v8, v83, v84
    v_fma_f32 v100, v8, v99, v100
    v_fma_f32 v84, -v9, v99, v84
    v_fma_f32 v100, v9, v83, v100
    v_mul_f32 v30, v10, v84
    v_mul_f32 v5, -v10, v100
    v_fma_f32 v30, -v11, v100, v30
    v_fma_f32 v5, -v11, v84, v5
    v_fma_f32 v85, v8, v84, v85
    v_fma_f32 v101, v8, v100, v101
    v_fma_f32 v85, -v9, v100, v85
    v_fma_f32 v101, v9, v84, v101
    v_mul_f32 v12, v10, v85
    v_mul_f32 v13, -v10, v101
    v_fma_f32 v12, -v11, v101, v12
    v_fma_f32 v13, -v11, v85, v13
    v_cvt_pk_bf16_f32 v16, v30, v12
    v_cvt_pk_bf16_f32 v20, v5, v13
    v_fma_f32 v86, v8, v85, v86
    v_fma_f32 v102, v8, v101, v102
    v_fma_f32 v86, -v9, v101, v86
    v_fma_f32 v102, v9, v85, v102
    s_waitcnt lgkmcnt(2)
    v_mfma_f32_32x32x16_bf16 v[64:79], v[248:251], v[36:39], v[64:79]
    ds_read_b128 v[32:35], v1 offset:16384
    ds_read_b128 v[36:39], v2 offset:16384
    v_mul_f32 v30, v10, v86
    v_mul_f32 v5, -v10, v102
    v_fma_f32 v30, -v11, v102, v30
    v_fma_f32 v5, -v11, v86, v5
    v_fma_f32 v87, v8, v86, v87
    v_fma_f32 v103, v8, v102, v103
    v_fma_f32 v87, -v9, v102, v87
    v_fma_f32 v103, v9, v86, v103
    v_mul_f32 v12, v10, v87
    v_mul_f32 v13, -v10, v103
    v_fma_f32 v12, -v11, v103, v12
    v_fma_f32 v13, -v11, v87, v13
    v_cvt_pk_bf16_f32 v17, v30, v12
    v_cvt_pk_bf16_f32 v21, v5, v13
    ds_write_b128 v31, v[14:17] offset:0
    ds_write_b128 v31, v[18:21] offset:8192
    v_fma_f32 v88, v8, v87, v88
    v_fma_f32 v104, v8, v103, v104
    v_fma_f32 v88, -v9, v103, v88
    v_fma_f32 v104, v9, v87, v104
    v_mul_f32 v30, v10, v88
    v_mul_f32 v5, -v10, v104
    v_fma_f32 v30, -v11, v104, v30
    v_fma_f32 v5, -v11, v88, v5
    v_fma_f32 v89, v8, v88, v89
    v_fma_f32 v105, v8, v104, v105
    v_fma_f32 v89, -v9, v104, v89
    v_fma_f32 v105, v9, v88, v105
    v_mul_f32 v12, v10, v89
    v_mul_f32 v13, -v10, v105
    v_fma_f32 v12, -v11, v105, v12
    v_fma_f32 v13, -v11, v89, v13
    s_waitcnt lgkmcnt(5)
    v_mfma_f32_32x32x16_bf16 v[48:63], v[252:255], v[40:43], v[48:63]
    v_cvt_pk_bf16_f32 v22, v30, v12
    v_cvt_pk_bf16_f32 v26, v5, v13
    v_fma_f32 v90, v8, v89, v90
    v_fma_f32 v106, v8, v105, v106
    v_fma_f32 v90, -v9, v105, v90
    v_fma_f32 v106, v9, v89, v106
    v_mul_f32 v30, v10, v90
    v_mul_f32 v5, -v10, v106
    v_fma_f32 v30, -v11, v106, v30
    v_fma_f32 v5, -v11, v90, v5
    v_fma_f32 v91, v8, v90, v91
    v_fma_f32 v107, v8, v106, v107
    v_fma_f32 v91, -v9, v106, v91
    v_fma_f32 v107, v9, v90, v107
    v_mul_f32 v12, v10, v91
    v_mul_f32 v13, -v10, v107
    v_fma_f32 v12, -v11, v107, v12
    v_fma_f32 v13, -v11, v91, v13
    v_cvt_pk_bf16_f32 v23, v30, v12
    v_cvt_pk_bf16_f32 v27, v5, v13
    v_fma_f32 v92, v8, v91, v92
    v_fma_f32 v108, v8, v107, v108
    v_fma_f32 v92, -v9, v107, v92
    v_fma_f32 v108, v9, v91, v108
    v_mul_f32 v30, v10, v92
    v_mul_f32 v5, -v10, v108
    v_fma_f32 v30, -v11, v108, v30
    v_fma_f32 v5, -v11, v92, v5
    v_fma_f32 v93, v8, v92, v93
    v_fma_f32 v109, v8, v108, v109
    v_fma_f32 v93, -v9, v108, v93
    v_fma_f32 v109, v9, v92, v109
    s_waitcnt lgkmcnt(4)
    v_mfma_f32_32x32x16_bf16 v[64:79], v[252:255], v[44:47], v[64:79]
    ds_read_b128 v[40:43], v1 offset:20480
    ds_read_b128 v[44:47], v2 offset:20480
    v_mul_f32 v12, v10, v93
    v_mul_f32 v13, -v10, v109
    v_fma_f32 v12, -v11, v109, v12
    v_fma_f32 v13, -v11, v93, v13
    v_cvt_pk_bf16_f32 v24, v30, v12
    v_cvt_pk_bf16_f32 v28, v5, v13
    v_fma_f32 v94, v8, v93, v94
    v_fma_f32 v110, v8, v109, v110
    v_fma_f32 v94, -v9, v109, v94
    v_fma_f32 v110, v9, v93, v110
    v_mul_f32 v30, v10, v94
    v_mul_f32 v5, -v10, v110
    v_fma_f32 v30, -v11, v110, v30
    v_fma_f32 v5, -v11, v94, v5
    v_fma_f32 v95, v8, v94, v95
    v_fma_f32 v111, v8, v110, v111
    v_fma_f32 v95, -v9, v110, v95
    v_fma_f32 v111, v9, v94, v111
    v_mul_f32 v12, v10, v95
    v_mul_f32 v13, -v10, v111
    v_fma_f32 v12, -v11, v111, v12
    v_fma_f32 v13, -v11, v95, v13
    v_cvt_pk_bf16_f32 v25, v30, v12
    v_cvt_pk_bf16_f32 v29, v5, v13
    ds_write_b128 v31, v[22:25] offset:16
    ds_write_b128 v31, v[26:29] offset:8208
    s_lshl_b32 s11, s6, 9
    s_add_u32 s11, s11, 90112
    v_and_b32 v30, 31, v0
    v_lshlrev_b32 v30, 4, v30
    v_add_u32 v30, s11, v30
    ds_read_b128 v[8:11], v30 offset:0
    s_waitcnt lgkmcnt(1)
    s_waitcnt vmcnt(2)
    s_barrier
    v_bfe_u32 v4, v0, 2, 2
    v_xor_b32 v3, s5, v4
    v_lshlrev_b32 v3, 6, v3
    v_lshl_add_u32 v3, v4, 8, v3
    v_lshrrev_b32 v4, 5, v0
    v_lshl_add_u32 v3, v4, 11, v3
    v_bfe_u32 v4, v0, 4, 1
    v_lshl_add_u32 v3, v4, 5, v3
    v_and_b32 v4, 3, v0
    v_lshl_add_u32 v3, v4, 3, v3
    v_add_u32 v4, 0x10000, v3
    ds_read_b64_tr_b16 v[80:81], v3 offset:0
    ds_read_b64_tr_b16 v[82:83], v3 offset:1024
    ds_read_b64_tr_b16 v[84:85], v3 offset:4096
    ds_read_b64_tr_b16 v[86:87], v3 offset:5120
    ds_read_b64_tr_b16 v[88:89], v3 offset:8192
    ds_read_b64_tr_b16 v[90:91], v3 offset:9216
    ds_read_b64_tr_b16 v[92:93], v3 offset:12288
    ds_read_b64_tr_b16 v[94:95], v3 offset:13312
    s_add_u32 m0, s9, 0
    s_add_u32 s10, s72, 442368
    buffer_load_dwordx4 v6, s[56:59], s10 offen lds
    s_add_u32 m0, s9, 8192
    s_add_u32 s10, s72, 516096
    buffer_load_dwordx4 v6, s[56:59], s10 offen lds
    s_waitcnt lgkmcnt(6)
    v_mfma_f32_32x32x16_bf16 v[112:127], v[32:35], v[80:83], 0
    ds_read_b128 v[32:35], v1 offset:24576
    s_waitcnt lgkmcnt(5)
    v_mfma_f32_32x32x16_bf16 v[112:127], v[36:39], v[84:87], v[112:127]
    ds_read_b128 v[36:39], v2 offset:24576
    s_lshl_b32 s11, s5, 7
    s_add_u32 s11, s11, 92160
    v_lshrrev_b32 v30, 5, v0
    v_lshl_add_u32 v5, v30, 6, s11
    ds_read_b128 v[14:17], v5 offset:0
    ds_read_b128 v[18:21], v5 offset:16
    ds_read_b128 v[22:25], v5 offset:32
    s_lshl_b32 s11, s6, 12
    s_lshl_b32 s73, s5, 9
    s_add_u32 s11, s11, s73
    s_add_u32 s11, s11, 81920
    v_and_b32 v31, 31, v0
    v_lshlrev_b32 v31, 3, v31
    v_lshrrev_b32 v30, 5, v0
    v_lshl_add_u32 v31, v30, 8, v31
    v_add_u32 v31, s11, v31
    s_waitcnt lgkmcnt(7)
    v_mfma_f32_32x32x16_bf16 v[112:127], v[40:43], v[88:91], v[112:127]
    ds_read_b128 v[40:43], v1 offset:28672
    s_waitcnt lgkmcnt(3)
    v_mul_f32 v48, v14, v48
    v_mul_f32 v64, v14, v64
    v_mul_f32 v49, v15, v49
    v_mul_f32 v65, v15, v65
    v_mul_f32 v50, v16, v50
    v_mul_f32 v66, v16, v66
    v_mul_f32 v51, v17, v51
    v_mul_f32 v67, v17, v67
    ds_read_b128 v[14:17], v5 offset:48
    s_waitcnt lgkmcnt(3)
    v_mul_f32 v52, v18, v52
    v_mul_f32 v68, v18, v68
    v_mul_f32 v53, v19, v53
    v_mul_f32 v69, v19, v69
    v_mfma_f32_32x32x16_bf16 v[112:127], v[44:47], v[92:95], v[112:127]
    ds_read_b128 v[44:47], v2 offset:28672
    v_mul_f32 v54, v20, v54
    v_mul_f32 v70, v20, v70
    v_mul_f32 v55, v21, v55
    v_mul_f32 v71, v21, v71
    s_waitcnt lgkmcnt(3)
    v_mul_f32 v56, v22, v56
    v_mul_f32 v72, v22, v72
    v_mul_f32 v57, v23, v57
    v_mul_f32 v73, v23, v73
    v_mul_f32 v58, v24, v58
    v_mul_f32 v74, v24, v74
    v_mul_f32 v59, v25, v59
    v_mul_f32 v75, v25, v75
    s_waitcnt lgkmcnt(1)
    v_mul_f32 v60, v14, v60
    v_mul_f32 v76, v14, v76
    v_mul_f32 v61, v15, v61
    v_mfma_f32_32x32x16_bf16 v[128:143], v[32:35], v[80:83], 0
    ds_read_b128 v[32:35], v1 offset:32768
    v_mul_f32 v77, v15, v77
    v_mul_f32 v62, v16, v62
    v_mul_f32 v78, v16, v78
    v_mul_f32 v63, v17, v63
    v_mul_f32 v79, v17, v79
    v_fma_f32 v28, v8, v48, v49
    v_fma_f32 v29, v8, v64, v65
    v_fma_f32 v28, -v9, v64, v28
    v_fma_f32 v29, v9, v48, v29
    v_fma_f32 v26, v8, v28, v50
    v_fma_f32 v27, v8, v29, v66
    v_fma_f32 v26, -v9, v29, v26
    v_fma_f32 v27, v9, v28, v27
    v_fma_f32 v28, v8, v26, v51
    v_fma_f32 v29, v8, v27, v67
    v_fma_f32 v28, -v9, v27, v28
    v_mfma_f32_32x32x16_bf16 v[128:143], v[36:39], v[84:87], v[128:143]
    ds_read_b128 v[36:39], v2 offset:32768
    v_fma_f32 v29, v9, v26, v29
    v_fma_f32 v26, v8, v28, v52
    v_fma_f32 v27, v8, v29, v68
    v_fma_f32 v26, -v9, v29, v26
    v_fma_f32 v27, v9, v28, v27
    v_fma_f32 v28, v8, v26, v53
    v_fma_f32 v29, v8, v27, v69
    v_fma_f32 v28, -v9, v27, v28
    v_fma_f32 v29, v9, v26, v29
    v_fma_f32 v26, v8, v28, v54
    v_fma_f32 v27, v8, v29, v70
    v_fma_f32 v26, -v9, v29, v26
    v_fma_f32 v27, v9, v28, v27
    v_fma_f32 v28, v8, v26, v55
    v_fma_f32 v29, v8, v27, v71
    v_fma_f32 v28, -v9, v27, v28
    v_fma_f32 v29, v9, v26, v29
    v_mfma_f32_32x32x16_bf16 v[128:143], v[40:43], v[88:91], v[128:143]
    ds_read_b128 v[40:43], v1 offset:36864
    v_fma_f32 v26, v8, v28, v56
    v_fma_f32 v27, v8, v29, v72
    v_fma_f32 v26, -v9, v29, v26
    v_fma_f32 v27, v9, v28, v27
    v_fma_f32 v28, v8, v26, v57
    v_fma_f32 v29, v8, v27, v73
    v_fma_f32 v28, -v9, v27, v28
    v_fma_f32 v29, v9, v26, v29
    v_fma_f32 v26, v8, v28, v58
    v_fma_f32 v27, v8, v29, v74
    v_fma_f32 v26, -v9, v29, v26
    v_fma_f32 v27, v9, v28, v27
    v_fma_f32 v28, v8, v26, v59
    v_fma_f32 v29, v8, v27, v75
    v_fma_f32 v28, -v9, v27, v28
    v_fma_f32 v29, v9, v26, v29
    v_fma_f32 v26, v8, v28, v60
    s_waitcnt lgkmcnt(3)
    v_mfma_f32_32x32x16_bf16 v[128:143], v[44:47], v[92:95], v[128:143]
    ds_read_b128 v[44:47], v2 offset:36864
    v_fma_f32 v27, v8, v29, v76
    v_fma_f32 v26, -v9, v29, v26
    v_fma_f32 v27, v9, v28, v27
    v_fma_f32 v28, v8, v26, v61
    v_fma_f32 v29, v8, v27, v77
    v_fma_f32 v28, -v9, v27, v28
    v_fma_f32 v29, v9, v26, v29
    v_fma_f32 v26, v8, v28, v62
    v_fma_f32 v27, v8, v29, v78
    v_fma_f32 v26, -v9, v29, v26
    v_fma_f32 v27, v9, v28, v27
    v_fma_f32 v28, v8, v26, v63
    v_fma_f32 v29, v8, v27, v79
    v_fma_f32 v28, -v9, v27, v28
    v_fma_f32 v29, v9, v26, v29
    ds_write_b64 v31, v[28:29] offset:1792
    s_waitcnt lgkmcnt(0)
    s_waitcnt vmcnt(2)
    s_barrier
    s_add_u32 m0, s9, 16384
    s_add_u32 s10, s72, 589824
    buffer_load_dwordx4 v6, s[56:59], s10 offen lds
    s_add_u32 m0, s9, 24576
    s_add_u32 s10, s72, 64
    buffer_load_dwordx4 v6, s[56:59], s10 offen lds
    v_mfma_f32_32x32x16_bf16 v[144:159], v[32:35], v[80:83], 0
    ds_read_b128 v[32:35], v1 offset:40960
    ds_read_b64 v[14:15], v31 offset:0
    ds_read_b64 v[16:17], v31 offset:256
    ds_read_b64 v[18:19], v31 offset:512
    ds_read_b64 v[20:21], v31 offset:768
    ds_read_b64 v[22:23], v31 offset:1024
    ds_read_b64 v[24:25], v31 offset:1280
    ds_read_b64 v[26:27], v31 offset:1536
    v_mul_f32 v12, v9, v9
    v_mul_f32 v5, v8, v9
    v_mfma_f32_32x32x16_bf16 v[144:159], v[36:39], v[84:87], v[144:159]
    ds_read_b128 v[36:39], v2 offset:40960
    v_fma_f32 v30, v8, v8, -v12
    v_add_f32 v5, v5, v5
    v_mul_f32 v12, v5, v5
    v_mul_f32 v5, v30, v5
    v_fma_f32 v30, v30, v30, -v12
    v_add_f32 v5, v5, v5
    v_mul_f32 v12, v5, v5
    v_mul_f32 v5, v30, v5
    v_mfma_f32_32x32x16_bf16 v[144:159], v[40:43], v[88:91], v[144:159]
    ds_read_b128 v[40:43], v1 offset:45056
    v_fma_f32 v30, v30, v30, -v12
    v_add_f32 v5, v5, v5
    v_mul_f32 v12, v5, v5
    v_mul_f32 v5, v30, v5
    v_fma_f32 v30, v30, v30, -v12
    v_add_f32 v5, v5, v5
    s_waitcnt lgkmcnt(7)
    v_fma_f32 v16, v30, v14, v16
    v_fma_f32 v17, v30, v15, v17
    v_mfma_f32_32x32x16_bf16 v[144:159], v[44:47], v[92:95], v[144:159]
    ds_read_b128 v[44:47], v2 offset:45056
    v_fma_f32 v16, -v5, v15, v16
    v_fma_f32 v17, v5, v14, v17
    s_waitcnt lgkmcnt(7)
    v_fma_f32 v18, v30, v16, v18
    v_fma_f32 v19, v30, v17, v19
    v_fma_f32 v18, -v5, v17, v18
    v_fma_f32 v19, v5, v16, v19
    s_waitcnt lgkmcnt(6)
    v_mfma_f32_32x32x16_bf16 v[160:175], v[32:35], v[80:83], 0
    ds_read_b128 v[32:35], v1 offset:49152
    v_fma_f32 v20, v30, v18, v20
    v_fma_f32 v21, v30, v19, v21
    v_fma_f32 v20, -v5, v19, v20
    v_fma_f32 v21, v5, v18, v21
    s_waitcnt lgkmcnt(6)
    v_fma_f32 v22, v30, v20, v22
    v_fma_f32 v23, v30, v21, v23
    v_fma_f32 v22, -v5, v21, v22
    v_fma_f32 v23, v5, v20, v23
    s_waitcnt lgkmcnt(3)
    v_mfma_f32_32x32x16_bf16 v[160:175], v[36:39], v[84:87], v[160:175]
    ds_read_b128 v[36:39], v2 offset:49152
    v_fma_f32 v24, v30, v22, v24
    v_fma_f32 v25, v30, v23, v25
    v_fma_f32 v24, -v5, v23, v24
    v_fma_f32 v25, v5, v22, v25
    v_fma_f32 v12, v30, v24, v26
    v_fma_f32 v13, v30, v25, v27
    s_waitcnt lgkmcnt(3)
    v_mfma_f32_32x32x16_bf16 v[160:175], v[40:43], v[88:91], v[160:175]
    ds_read_b128 v[40:43], v1 offset:53248
    v_fma_f32 v12, -v5, v25, v12
    v_fma_f32 v13, v5, v24, v13
    v_fma_f32 v28, v30, v12, v28
    v_fma_f32 v29, v30, v13, v29
    v_fma_f32 v28, -v5, v13, v28
    v_fma_f32 v29, v5, v12, v29
    s_mul_i32 s11, s7, 4608
    s_add_u32 s73, s78, s6
    s_lshl_b32 s73, s73, 8
    s_waitcnt lgkmcnt(3)
    v_mfma_f32_32x32x16_bf16 v[160:175], v[44:47], v[92:95], v[160:175]
    ds_read_b128 v[44:47], v2 offset:53248
    s_add_u32 s11, s11, s73
    s_add_u32 s11, s11, 256
    s_cmp_eq_u32 s5, 3
    s_cselect_b32 s11, s11, 0x100000
    v_lshlrev_b32 v30, 3, v0
    v_add_u32 v30, s11, v30
    v_mov_b32 v5, 0x100000
    v_cndmask_b32 v30, v5, v30, s[96:97]
    s_waitcnt vmcnt(2)
    s_barrier
    buffer_store_dwordx2 v[28:29], v30, s[48:51], 0 offen sc1
    s_add_u32 m0, s9, 32768
    s_add_u32 s10, s72, 73792
    buffer_load_dwordx4 v6, s[56:59], s10 offen lds
    s_add_u32 m0, s9, 40960
    s_add_u32 s10, s72, 147520
    buffer_load_dwordx4 v6, s[56:59], s10 offen lds
    s_waitcnt lgkmcnt(3)
    v_mfma_f32_32x32x16_bf16 v[176:191], v[32:35], v[80:83], 0
    ds_read_b128 v[32:35], v1 offset:57344
    s_waitcnt lgkmcnt(3)
    v_mfma_f32_32x32x16_bf16 v[176:191], v[36:39], v[84:87], v[176:191]
    ds_read_b128 v[36:39], v2 offset:57344
    s_waitcnt lgkmcnt(3)
    v_mfma_f32_32x32x16_bf16 v[176:191], v[40:43], v[88:91], v[176:191]
    ds_read_b128 v[40:43], v1 offset:61440
    s_waitcnt lgkmcnt(3)
    v_mfma_f32_32x32x16_bf16 v[176:191], v[44:47], v[92:95], v[176:191]
    ds_read_b128 v[44:47], v2 offset:61440
    s_waitcnt lgkmcnt(3)
    v_mfma_f32_32x32x16_bf16 v[192:207], v[32:35], v[80:83], 0
    ds_read_b128 v[32:35], v1 offset:0
    s_waitcnt lgkmcnt(3)
    v_mfma_f32_32x32x16_bf16 v[192:207], v[36:39], v[84:87], v[192:207]
    ds_read_b128 v[36:39], v2 offset:0
    s_waitcnt lgkmcnt(3)
    v_mfma_f32_32x32x16_bf16 v[192:207], v[40:43], v[88:91], v[192:207]
    ds_read_b128 v[40:43], v1 offset:4096
    s_waitcnt lgkmcnt(3)
    v_mfma_f32_32x32x16_bf16 v[192:207], v[44:47], v[92:95], v[192:207]
    ds_read_b128 v[44:47], v2 offset:4096
    s_waitcnt vmcnt(3)
    s_barrier
    s_add_u32 m0, s9, 49152
    s_add_u32 s10, s72, 221248
    buffer_load_dwordx4 v6, s[56:59], s10 offen lds
    s_add_u32 m0, s9, 57344
    s_add_u32 s10, s72, 294976
    buffer_load_dwordx4 v6, s[56:59], s10 offen lds
    s_waitcnt lgkmcnt(3)
    v_mfma_f32_32x32x16_bf16 v[208:223], v[32:35], v[80:83], 0
    ds_read_b128 v[32:35], v1 offset:8192
    s_waitcnt lgkmcnt(3)
    v_mfma_f32_32x32x16_bf16 v[208:223], v[36:39], v[84:87], v[208:223]
    ds_read_b128 v[36:39], v2 offset:8192
    s_waitcnt lgkmcnt(3)
    v_mfma_f32_32x32x16_bf16 v[208:223], v[40:43], v[88:91], v[208:223]
    ds_read_b128 v[40:43], v1 offset:12288
    s_waitcnt lgkmcnt(3)
    v_mfma_f32_32x32x16_bf16 v[208:223], v[44:47], v[92:95], v[208:223]
    ds_read_b128 v[44:47], v2 offset:12288
    s_waitcnt lgkmcnt(3)
    v_mfma_f32_32x32x16_bf16 v[224:239], v[32:35], v[80:83], 0
    ds_read_b128 v[32:35], v1 offset:16384
    ds_read_b64_tr_b16 v[96:97], v3 offset:16384
    ds_read_b64_tr_b16 v[98:99], v3 offset:17408
    s_waitcnt lgkmcnt(5)
    v_mfma_f32_32x32x16_bf16 v[224:239], v[36:39], v[84:87], v[224:239]
    ds_read_b128 v[36:39], v2 offset:16384
    ds_read_b64_tr_b16 v[100:101], v3 offset:20480
    ds_read_b64_tr_b16 v[102:103], v3 offset:21504
    s_waitcnt lgkmcnt(7)
    v_mfma_f32_32x32x16_bf16 v[224:239], v[40:43], v[88:91], v[224:239]
    ds_read_b128 v[40:43], v1 offset:20480
    ds_read_b64_tr_b16 v[104:105], v3 offset:24576
    ds_read_b64_tr_b16 v[106:107], v3 offset:25600
    s_waitcnt lgkmcnt(9)
    v_mfma_f32_32x32x16_bf16 v[224:239], v[44:47], v[92:95], v[224:239]
    ds_read_b128 v[44:47], v2 offset:20480
    ds_read_b64_tr_b16 v[108:109], v3 offset:28672
    ds_read_b64_tr_b16 v[110:111], v3 offset:29696
    s_waitcnt vmcnt(2)
    s_barrier
    s_lshl_b32 s11, s8, 4
    s_add_u32 s11, s11, s7
    s_lshl_b32 s11, s11, 2
    s_cmp_eq_u32 s4, 3
    s_cselect_b32 s11, s11, 0x1000
    s_cmp_eq_u32 s7, 15
    s_cselect_b32 s11, 0x1000, s11
    v_lshlrev_b32 v30, 12, v0
    v_add_u32 v30, s11, v30
    v_mov_b32 v31, 2
    buffer_store_dword v31, v30, s[68:71], 0 offen sc1
    s_add_u32 m0, s9, 0
    s_add_u32 s10, s72, 368704
    buffer_load_dwordx4 v6, s[56:59], s10 offen lds
    s_add_u32 m0, s9, 8192
    s_add_u32 s10, s72, 442432
    buffer_load_dwordx4 v6, s[56:59], s10 offen lds
    s_waitcnt lgkmcnt(11)
    v_mfma_f32_32x32x16_bf16 v[240:255], v[32:35], v[80:83], 0
    ds_read_b128 v[32:35], v1 offset:24576
    s_waitcnt lgkmcnt(9)
    v_mfma_f32_32x32x16_bf16 v[240:255], v[36:39], v[84:87], v[240:255]
    ds_read_b128 v[36:39], v2 offset:24576
    s_waitcnt lgkmcnt(7)
    v_mfma_f32_32x32x16_bf16 v[240:255], v[40:43], v[88:91], v[240:255]
    ds_read_b128 v[40:43], v1 offset:28672
    s_waitcnt lgkmcnt(5)
    v_mfma_f32_32x32x16_bf16 v[240:255], v[44:47], v[92:95], v[240:255]
    ds_read_b128 v[44:47], v2 offset:28672
    s_waitcnt lgkmcnt(3)
    v_mfma_f32_32x32x16_bf16 v[112:127], v[32:35], v[96:99], v[112:127]
    ds_read_b128 v[32:35], v1 offset:32768
    s_waitcnt lgkmcnt(3)
    v_mfma_f32_32x32x16_bf16 v[112:127], v[36:39], v[100:103], v[112:127]
    ds_read_b128 v[36:39], v2 offset:32768
    s_waitcnt lgkmcnt(3)
    v_mfma_f32_32x32x16_bf16 v[112:127], v[40:43], v[104:107], v[112:127]
    ds_read_b128 v[40:43], v1 offset:36864
    s_waitcnt lgkmcnt(3)
    v_mfma_f32_32x32x16_bf16 v[112:127], v[44:47], v[108:111], v[112:127]
    ds_read_b128 v[44:47], v2 offset:36864
    s_waitcnt vmcnt(3)
    s_barrier
    s_add_u32 m0, s9, 16384
    s_add_u32 s10, s72, 516160
    buffer_load_dwordx4 v6, s[56:59], s10 offen lds
    s_add_u32 m0, s9, 24576
    s_add_u32 s10, s72, 589888
    buffer_load_dwordx4 v6, s[56:59], s10 offen lds
    s_waitcnt lgkmcnt(3)
    v_mfma_f32_32x32x16_bf16 v[128:143], v[32:35], v[96:99], v[128:143]
    ds_read_b128 v[32:35], v1 offset:40960
    s_waitcnt lgkmcnt(3)
    v_mfma_f32_32x32x16_bf16 v[128:143], v[36:39], v[100:103], v[128:143]
    ds_read_b128 v[36:39], v2 offset:40960
    s_waitcnt lgkmcnt(3)
    v_mfma_f32_32x32x16_bf16 v[128:143], v[40:43], v[104:107], v[128:143]
    ds_read_b128 v[40:43], v1 offset:45056
    s_waitcnt lgkmcnt(3)
    v_mfma_f32_32x32x16_bf16 v[128:143], v[44:47], v[108:111], v[128:143]
    ds_read_b128 v[44:47], v2 offset:45056
    s_waitcnt lgkmcnt(3)
    v_mfma_f32_32x32x16_bf16 v[144:159], v[32:35], v[96:99], v[144:159]
    ds_read_b128 v[32:35], v1 offset:49152
    s_waitcnt lgkmcnt(3)
    v_mfma_f32_32x32x16_bf16 v[144:159], v[36:39], v[100:103], v[144:159]
    ds_read_b128 v[36:39], v2 offset:49152
    s_waitcnt lgkmcnt(3)
    v_mfma_f32_32x32x16_bf16 v[144:159], v[40:43], v[104:107], v[144:159]
    ds_read_b128 v[40:43], v1 offset:53248
    s_waitcnt lgkmcnt(3)
    v_mfma_f32_32x32x16_bf16 v[144:159], v[44:47], v[108:111], v[144:159]
    ds_read_b128 v[44:47], v2 offset:53248
    s_waitcnt vmcnt(2)
    s_barrier
    v_and_b32 v31, 15, v0
    s_lshl_b32 s11, s8, 6
    v_lshlrev_b32 v31, 2, v31
    v_add_u32 v31, s11, v31
    buffer_load_dword v30, v31, s[68:71], 0 offen sc1
    s_add_u32 m0, s9, 32768
    s_add_u32 s10, s72, 128
    buffer_load_dwordx4 v6, s[56:59], s10 offen lds
    s_add_u32 m0, s9, 40960
    s_add_u32 s10, s72, 192
    buffer_load_dwordx4 v6, s[56:59], s10 offen lds
    s_add_u32 m0, s9, -98304
    s_add_u32 s10, s72, 295040
    buffer_load_dwordx4 v6, s[56:59], s10 offen lds
    s_add_u32 m0, s9, -90112
    s_add_u32 s10, s72, 295104
    buffer_load_dwordx4 v6, s[56:59], s10 offen lds
    s_waitcnt lgkmcnt(3)
    v_mfma_f32_32x32x16_bf16 v[160:175], v[32:35], v[96:99], v[160:175]
    ds_read_b128 v[32:35], v1 offset:57344
    s_waitcnt lgkmcnt(3)
    v_mfma_f32_32x32x16_bf16 v[160:175], v[36:39], v[100:103], v[160:175]
    ds_read_b128 v[36:39], v2 offset:57344
    s_waitcnt lgkmcnt(3)
    v_mfma_f32_32x32x16_bf16 v[160:175], v[40:43], v[104:107], v[160:175]
    ds_read_b128 v[40:43], v1 offset:61440
    s_waitcnt lgkmcnt(3)
    v_mfma_f32_32x32x16_bf16 v[160:175], v[44:47], v[108:111], v[160:175]
    ds_read_b128 v[44:47], v2 offset:61440
    s_waitcnt lgkmcnt(3)
    v_mfma_f32_32x32x16_bf16 v[176:191], v[32:35], v[96:99], v[176:191]
    ds_read_b128 v[32:35], v1 offset:0
    s_waitcnt lgkmcnt(3)
    v_mfma_f32_32x32x16_bf16 v[176:191], v[36:39], v[100:103], v[176:191]
    ds_read_b128 v[36:39], v2 offset:0
    s_waitcnt lgkmcnt(3)
    v_mfma_f32_32x32x16_bf16 v[176:191], v[40:43], v[104:107], v[176:191]
    ds_read_b128 v[40:43], v1 offset:4096
    s_waitcnt lgkmcnt(3)
    v_mfma_f32_32x32x16_bf16 v[176:191], v[44:47], v[108:111], v[176:191]
    ds_read_b128 v[44:47], v2 offset:4096
    s_waitcnt vmcnt(5)
    s_barrier
    s_waitcnt vmcnt(4)
    v_cmp_gt_u32 vcc, 2, v30
    s_and_b64 vcc, vcc, s[94:95]
    s_cbranch_scc0 .pok_24
    s_mov_b32 s83, 65536
.plp_25:
    buffer_load_dword v30, v31, s[68:71], 0 offen sc1
    s_waitcnt vmcnt(0)
    v_cmp_gt_u32 vcc, 2, v30
    s_and_b64 vcc, vcc, s[94:95]
    s_cbranch_scc0 .pok_24
    s_sub_u32 s83, s83, 1
    s_cmp_lg_u32 s83, 0
    s_cbranch_scc1 .plp_25
.pok_24:
    s_sub_u32 s11, s7, 1
    s_mul_i32 s11, s11, 4608
    s_add_u32 s73, s78, s6
    s_lshl_b32 s73, s73, 8
    s_add_u32 s11, s11, s73
    s_add_u32 s11, s11, 512
    v_and_b32 v30, 31, v0
    v_lshlrev_b32 v30, 3, v30
    v_lshrrev_b32 v31, 5, v0
    v_mul_u32_u24 v31, 4608, v31
    v_sub_u32 v30, v30, v31
    v_add_u32 v30, s11, v30
    v_subrev_u32 v28, 64512, v30
    buffer_load_dwordx2 v[28:29], v28, s[48:51], 0 offen sc1
    v_subrev_u32 v26, 55296, v30
    buffer_load_dwordx2 v[26:27], v26, s[48:51], 0 offen sc1
    v_subrev_u32 v24, 46080, v30
    buffer_load_dwordx2 v[24:25], v24, s[48:51], 0 offen sc1
    v_subrev_u32 v22, 36864, v30
    buffer_load_dwordx2 v[22:23], v22, s[48:51], 0 offen sc1
    v_subrev_u32 v20, 27648, v30
    buffer_load_dwordx2 v[20:21], v20, s[48:51], 0 offen sc1
    v_subrev_u32 v18, 18432, v30
    buffer_load_dwordx2 v[18:19], v18, s[48:51], 0 offen sc1
    v_subrev_u32 v16, 9216, v30
    buffer_load_dwordx2 v[16:17], v16, s[48:51], 0 offen sc1
    v_subrev_u32 v14, 0, v30
    buffer_load_dwordx2 v[14:15], v14, s[48:51], 0 offen sc1
    s_add_u32 m0, s9, 49152
    s_add_u32 s10, s72, 73856
    buffer_load_dwordx4 v6, s[56:59], s10 offen lds
    s_add_u32 m0, s9, 57344
    s_add_u32 s10, s72, 73920
    buffer_load_dwordx4 v6, s[56:59], s10 offen lds
    s_add_u32 m0, s9, -81920
    s_add_u32 s10, s72, 368768
    buffer_load_dwordx4 v6, s[56:59], s10 offen lds
    s_add_u32 m0, s9, -73728
    s_add_u32 s10, s72, 368832
    buffer_load_dwordx4 v6, s[56:59], s10 offen lds
    s_waitcnt lgkmcnt(3)
    v_mfma_f32_32x32x16_bf16 v[192:207], v[32:35], v[96:99], v[192:207]
    ds_read_b128 v[32:35], v1 offset:8192
    v_mul_f32 v5, v9, v9
    v_mul_f32 v31, v8, v9
    v_fma_f32 v30, v8, v8, -v5
    v_add_f32 v31, v31, v31
    v_mul_f32 v5, v31, v31
    s_waitcnt lgkmcnt(3)
    v_mfma_f32_32x32x16_bf16 v[192:207], v[36:39], v[100:103], v[192:207]
    ds_read_b128 v[36:39], v2 offset:8192
    v_mul_f32 v31, v30, v31
    v_fma_f32 v30, v30, v30, -v5
    v_add_f32 v31, v31, v31
    v_mul_f32 v5, v31, v31
    v_mul_f32 v31, v30, v31
    s_waitcnt lgkmcnt(3)
    v_mfma_f32_32x32x16_bf16 v[192:207], v[40:43], v[104:107], v[192:207]
    ds_read_b128 v[40:43], v1 offset:12288
    v_fma_f32 v30, v30, v30, -v5
    v_add_f32 v31, v31, v31
    v_mul_f32 v5, v31, v31
    v_mul_f32 v31, v30, v31
    s_waitcnt lgkmcnt(3)
    v_mfma_f32_32x32x16_bf16 v[192:207], v[44:47], v[108:111], v[192:207]
    ds_read_b128 v[44:47], v2 offset:12288
    v_fma_f32 v30, v30, v30, -v5
    v_add_f32 v31, v31, v31
    v_mul_f32 v5, v31, v31
    v_mul_f32 v31, v30, v31
    v_fma_f32 v30, v30, v30, -v5
    s_waitcnt lgkmcnt(3)
    v_mfma_f32_32x32x16_bf16 v[208:223], v[32:35], v[96:99], v[208:223]
    ds_read_b128 v[32:35], v1 offset:16384
    v_add_f32 v31, v31, v31
    v_mul_f32 v5, v31, v31
    v_mul_f32 v31, v30, v31
    v_fma_f32 v30, v30, v30, -v5
    s_waitcnt lgkmcnt(3)
    v_mfma_f32_32x32x16_bf16 v[208:223], v[36:39], v[100:103], v[208:223]
    ds_read_b128 v[36:39], v2 offset:16384
    v_add_f32 v31, v31, v31
    v_mul_f32 v5, v31, v31
    v_mul_f32 v31, v30, v31
    v_fma_f32 v30, v30, v30, -v5
    v_add_f32 v31, v31, v31
    s_waitcnt lgkmcnt(3)
    v_mfma_f32_32x32x16_bf16 v[208:223], v[40:43], v[104:107], v[208:223]
    ds_read_b128 v[40:43], v1 offset:20480
    v_mul_f32 v5, v31, v31
    v_mul_f32 v31, v30, v31
    v_fma_f32 v30, v30, v30, -v5
    v_add_f32 v31, v31, v31
    s_waitcnt lgkmcnt(3)
    v_mfma_f32_32x32x16_bf16 v[208:223], v[44:47], v[108:111], v[208:223]
    ds_read_b128 v[44:47], v2 offset:20480
    s_waitcnt vmcnt(14)
    s_barrier
    s_add_u32 m0, s9, 0
    s_add_u32 s10, s72, 147584
    buffer_load_dwordx4 v6, s[56:59], s10 offen lds
    s_add_u32 m0, s9, 8192
    s_add_u32 s10, s72, 147648
    buffer_load_dwordx4 v6, s[56:59], s10 offen lds
    s_waitcnt lgkmcnt(3)
    v_mfma_f32_32x32x16_bf16 v[224:239], v[32:35], v[96:99], v[224:239]
    ds_read_b128 v[32:35], v1 offset:24576
    s_waitcnt vmcnt(12)
    v_fma_f32 v26, v30, v28, v26
    v_fma_f32 v27, v30, v29, v27
    v_fma_f32 v26, -v31, v29, v26
    v_fma_f32 v27, v31, v28, v27
    s_waitcnt vmcnt(11)
    v_fma_f32 v24, v30, v26, v24
    v_fma_f32 v25, v30, v27, v25
    v_fma_f32 v24, -v31, v27, v24
    v_fma_f32 v25, v31, v26, v25
    s_waitcnt vmcnt(10)
    v_fma_f32 v22, v30, v24, v22
    v_fma_f32 v23, v30, v25, v23
    v_fma_f32 v22, -v31, v25, v22
    v_fma_f32 v23, v31, v24, v23
    s_waitcnt vmcnt(9)
    v_fma_f32 v20, v30, v22, v20
    v_fma_f32 v21, v30, v23, v21
    v_fma_f32 v20, -v31, v23, v20
    v_fma_f32 v21, v31, v22, v21
    s_waitcnt vmcnt(8)
    v_fma_f32 v18, v30, v20, v18
    v_fma_f32 v19, v30, v21, v19
    v_fma_f32 v18, -v31, v21, v18
    v_fma_f32 v19, v31, v20, v19
    s_waitcnt vmcnt(7)
    v_fma_f32 v16, v30, v18, v16
    v_fma_f32 v17, v30, v19, v17
    v_fma_f32 v16, -v31, v19, v16
    v_fma_f32 v17, v31, v18, v17
    s_waitcnt vmcnt(6)
    v_fma_f32 v14, v30, v16, v14
    s_waitcnt lgkmcnt(3)
    v_mfma_f32_32x32x16_bf16 v[224:239], v[36:39], v[100:103], v[224:239]
    ds_read_b128 v[36:39], v2 offset:24576
    v_fma_f32 v15, v30, v17, v15
    v_fma_f32 v14, -v31, v17, v14
    v_fma_f32 v15, v31, v16, v15
    v_mul_f32 v5, v9, v9
    v_mul_f32 v17, v8, v9
    v_fma_f32 v16, v8, v8, -v5
    v_add_f32 v17, v17, v17
    v_mul_f32 v5, v17, v17
    v_mul_f32 v17, v16, v17
    v_fma_f32 v16, v16, v16, -v5
    v_add_f32 v17, v17, v17
    v_mul_f32 v5, v17, v17
    v_mul_f32 v17, v16, v17
    v_fma_f32 v16, v16, v16, -v5
    v_add_f32 v17, v17, v17
    v_mul_f32 v5, v17, v17
    v_mul_f32 v17, v16, v17
    v_fma_f32 v16, v16, v16, -v5
    v_add_f32 v17, v17, v17
    v_mul_f32 v5, v17, v17
    v_mul_f32 v19, v16, v17
    v_fma_f32 v18, v16, v16, -v5
    v_add_f32 v19, v19, v19
    v_mul_f32 v5, v19, v19
    v_mul_f32 v21, v18, v19
    v_fma_f32 v20, v18, v18, -v5
    v_add_f32 v21, v21, v21
    v_mul_f32 v5, v21, v21
    v_mul_f32 v23, v20, v21
    v_fma_f32 v22, v20, v20, -v5
    v_add_f32 v23, v23, v23
    s_waitcnt lgkmcnt(3)
    v_mfma_f32_32x32x16_bf16 v[224:239], v[40:43], v[104:107], v[224:239]
    ds_read_b128 v[40:43], v1 offset:28672
    v_mul_f32 v24, v22, v14
    v_mul_f32 v25, v22, v15
    v_fma_f32 v24, -v23, v15, v24
    v_fma_f32 v25, v23, v14, v25
    v_cndmask_b32 v14, v14, v24, s[96:97]
    v_cndmask_b32 v15, v15, v25, s[96:97]
    v_mov_b32 v24, v14
    v_mov_b32 v25, v15
    v_cndmask_b32 v16, 1.0, v16, s[96:97]
    v_cndmask_b32 v17, 0, v17, s[96:97]
    v_permlane32_swap_b32 v14, v24
    v_permlane32_swap_b32 v15, v25
    v_cndmask_b32 v18, 1.0, v18, s[98:99]
    v_cndmask_b32 v19, 0, v19, s[98:99]
    v_cndmask_b32 v20, 1.0, v20, s[100:101]
    v_cndmask_b32 v21, 0, v21, s[100:101]
    v_add_f32 v14, v14, v24
    v_add_f32 v15, v15, v25
    v_mul_f32 v22, v16, v18
    v_mul_f32 v23, v16, v19
    v_fma_f32 v22, -v17, v19, v22
    v_fma_f32 v23, v17, v18, v23
    v_mul_f32 v16, v22, v20
    v_mul_f32 v17, v22, v21
    v_fma_f32 v16, -v23, v21, v16
    v_fma_f32 v17, v23, v20, v17
    v_fma_f32 v12, v16, v14, v12
    v_fma_f32 v13, v16, v15, v13
    v_fma_f32 v12, -v17, v15, v12
    v_fma_f32 v13, v17, v14, v13
    v_and_b32 v30, 3, v0
    v_xor_b32 v30, s5, v30
    s_waitcnt lgkmcnt(3)
    v_mfma_f32_32x32x16_bf16 v[224:239], v[44:47], v[108:111], v[224:239]
    ds_read_b128 v[44:47], v2 offset:28672
    v_lshlrev_b32 v30, 6, v30
    v_and_b32 v31, 31, v0
    v_lshl_add_u32 v30, v31, 8, v30
    v_lshrrev_b32 v31, 5, v0
    v_lshl_add_u32 v30, v31, 5, v30
    s_lshl_b32 s11, s6, 14
    s_add_u32 s11, s11, 32768
    v_add_u32 v31, s11, v30
    v_fma_f32 v48, v8, v12, v48
    v_fma_f32 v64, v8, v13, v64
    v_fma_f32 v48, -v9, v13, v48
    v_fma_f32 v64, v9, v12, v64
    v_mul_f32 v30, v10, v48
    v_mul_f32 v5, -v10, v64
    v_fma_f32 v30, -v11, v64, v30
    v_fma_f32 v5, -v11, v48, v5
    v_fma_f32 v49, v8, v48, v49
    v_fma_f32 v65, v8, v64, v65
    v_fma_f32 v49, -v9, v64, v49
    v_fma_f32 v65, v9, v48, v65
    v_mul_f32 v12, v10, v49
    v_mul_f32 v13, -v10, v65
    v_fma_f32 v12, -v11, v65, v12
    v_fma_f32 v13, -v11, v49, v13
    v_cvt_pk_bf16_f32 v14, v30, v12
    v_cvt_pk_bf16_f32 v18, v5, v13
    v_fma_f32 v50, v8, v49, v50
    v_fma_f32 v66, v8, v65, v66
    v_fma_f32 v50, -v9, v65, v50
    v_fma_f32 v66, v9, v49, v66
    v_mul_f32 v30, v10, v50
    s_waitcnt lgkmcnt(3)
    v_mfma_f32_32x32x16_bf16 v[240:255], v[32:35], v[96:99], v[240:255]
    ds_read_b128 v[32:35], v1 offset:32768
    v_mul_f32 v5, -v10, v66
    v_fma_f32 v30, -v11, v66, v30
    v_fma_f32 v5, -v11, v50, v5
    v_fma_f32 v51, v8, v50, v51
    v_fma_f32 v67, v8, v66, v67
    v_fma_f32 v51, -v9, v66, v51
    v_fma_f32 v67, v9, v50, v67
    v_mul_f32 v12, v10, v51
    v_mul_f32 v13, -v10, v67
    v_fma_f32 v12, -v11, v67, v12
    v_fma_f32 v13, -v11, v51, v13
    v_cvt_pk_bf16_f32 v15, v30, v12
    v_cvt_pk_bf16_f32 v19, v5, v13
    v_fma_f32 v52, v8, v51, v52
    v_fma_f32 v68, v8, v67, v68
    v_fma_f32 v52, -v9, v67, v52
    v_fma_f32 v68, v9, v51, v68
    v_mul_f32 v30, v10, v52
    v_mul_f32 v5, -v10, v68
    v_fma_f32 v30, -v11, v68, v30
    v_fma_f32 v5, -v11, v52, v5
    v_fma_f32 v53, v8, v52, v53
    v_fma_f32 v69, v8, v68, v69
    v_fma_f32 v53, -v9, v68, v53
    v_fma_f32 v69, v9, v52, v69
    v_mul_f32 v12, v10, v53
    v_mul_f32 v13, -v10, v69
    v_fma_f32 v12, -v11, v69, v12
    v_fma_f32 v13, -v11, v53, v13
    v_cvt_pk_bf16_f32 v16, v30, v12
    v_cvt_pk_bf16_f32 v20, v5, v13
    s_waitcnt lgkmcnt(3)
    v_mfma_f32_32x32x16_bf16 v[240:255], v[36:39], v[100:103], v[240:255]
    ds_read_b128 v[36:39], v2 offset:32768
    v_fma_f32 v54, v8, v53, v54
    v_fma_f32 v70, v8, v69, v70
    v_fma_f32 v54, -v9, v69, v54
    v_fma_f32 v70, v9, v53, v70
    v_mul_f32 v30, v10, v54
    v_mul_f32 v5, -v10, v70
    v_fma_f32 v30, -v11, v70, v30
    v_fma_f32 v5, -v11, v54, v5
    v_fma_f32 v55, v8, v54, v55
    v_fma_f32 v71, v8, v70, v71
    v_fma_f32 v55, -v9, v70, v55
    v_fma_f32 v71, v9, v54, v71
    v_mul_f32 v12, v10, v55
    v_mul_f32 v13, -v10, v71
    v_fma_f32 v12, -v11, v71, v12
    v_fma_f32 v13, -v11, v55, v13
    v_cvt_pk_bf16_f32 v17, v30, v12
    v_cvt_pk_bf16_f32 v21, v5, v13
    ds_write_b128 v31, v[14:17] offset:0
    ds_write_b128 v31, v[18:21] offset:8192
    v_fma_f32 v56, v8, v55, v56
    v_fma_f32 v72, v8, v71, v72
    v_fma_f32 v56, -v9, v71, v56
    v_fma_f32 v72, v9, v55, v72
    v_mul_f32 v30, v10, v56
    v_mul_f32 v5, -v10, v72
    v_fma_f32 v30, -v11, v72, v30
    v_fma_f32 v5, -v11, v56, v5
    v_fma_f32 v57, v8, v56, v57
    v_fma_f32 v73, v8, v72, v73
    v_fma_f32 v57, -v9, v72, v57
    v_fma_f32 v73, v9, v56, v73
    s_waitcnt lgkmcnt(5)
    v_mfma_f32_32x32x16_bf16 v[240:255], v[40:43], v[104:107], v[240:255]
    ds_read_b128 v[40:43], v1 offset:36864
    v_mul_f32 v12, v10, v57
    v_mul_f32 v13, -v10, v73
    v_fma_f32 v12, -v11, v73, v12
    v_fma_f32 v13, -v11, v57, v13
    v_cvt_pk_bf16_f32 v22, v30, v12
    v_cvt_pk_bf16_f32 v26, v5, v13
    v_fma_f32 v58, v8, v57, v58
    v_fma_f32 v74, v8, v73, v74
    v_fma_f32 v58, -v9, v73, v58
    v_fma_f32 v74, v9, v57, v74
    v_mul_f32 v30, v10, v58
    v_mul_f32 v5, -v10, v74
    v_fma_f32 v30, -v11, v74, v30
    v_fma_f32 v5, -v11, v58, v5
    v_fma_f32 v59, v8, v58, v59
    v_fma_f32 v75, v8, v74, v75
    v_fma_f32 v59, -v9, v74, v59
    v_fma_f32 v75, v9, v58, v75
    v_mul_f32 v12, v10, v59
    v_mul_f32 v13, -v10, v75
    v_fma_f32 v12, -v11, v75, v12
    v_fma_f32 v13, -v11, v59, v13
    v_cvt_pk_bf16_f32 v23, v30, v12
    v_cvt_pk_bf16_f32 v27, v5, v13
    v_fma_f32 v60, v8, v59, v60
    v_fma_f32 v76, v8, v75, v76
    v_fma_f32 v60, -v9, v75, v60
    v_fma_f32 v76, v9, v59, v76
    v_mul_f32 v30, v10, v60
    v_mul_f32 v5, -v10, v76
    v_fma_f32 v30, -v11, v76, v30
    s_waitcnt lgkmcnt(5)
    v_mfma_f32_32x32x16_bf16 v[240:255], v[44:47], v[108:111], v[240:255]
    ds_read_b128 v[44:47], v2 offset:36864
    v_fma_f32 v5, -v11, v60, v5
    v_fma_f32 v61, v8, v60, v61
    v_fma_f32 v77, v8, v76, v77
    v_fma_f32 v61, -v9, v76, v61
    v_fma_f32 v77, v9, v60, v77
    v_mul_f32 v12, v10, v61
    v_mul_f32 v13, -v10, v77
    v_fma_f32 v12, -v11, v77, v12
    v_fma_f32 v13, -v11, v61, v13
    v_cvt_pk_bf16_f32 v24, v30, v12
    v_cvt_pk_bf16_f32 v28, v5, v13
    v_fma_f32 v62, v8, v61, v62
    v_fma_f32 v78, v8, v77, v78
    v_fma_f32 v62, -v9, v77, v62
    v_fma_f32 v78, v9, v61, v78
    v_mul_f32 v30, v10, v62
    v_mul_f32 v5, -v10, v78
    v_fma_f32 v30, -v11, v78, v30
    v_fma_f32 v5, -v11, v62, v5
    v_fma_f32 v63, v8, v62, v63
    v_fma_f32 v79, v8, v78, v79
    v_fma_f32 v63, -v9, v78, v63
    v_fma_f32 v79, v9, v62, v79
    v_mul_f32 v12, v10, v63
    v_mul_f32 v13, -v10, v79
    v_fma_f32 v12, -v11, v79, v12
    v_fma_f32 v13, -v11, v63, v13
    v_cvt_pk_bf16_f32 v25, v30, v12
    v_cvt_pk_bf16_f32 v29, v5, v13
    ds_write_b128 v31, v[22:25] offset:16
    ds_write_b128 v31, v[26:29] offset:8208
    s_waitcnt lgkmcnt(0)
    s_waitcnt vmcnt(4)
    s_barrier
    ds_read_b64_tr_b16 v[80:81], v3 offset:32768
    ds_read_b64_tr_b16 v[82:83], v3 offset:33792
    ds_read_b64_tr_b16 v[84:85], v3 offset:36864
    ds_read_b64_tr_b16 v[86:87], v3 offset:37888
    ds_read_b64_tr_b16 v[88:89], v3 offset:40960
    ds_read_b64_tr_b16 v[90:91], v3 offset:41984
    ds_read_b64_tr_b16 v[92:93], v3 offset:45056
    ds_read_b64_tr_b16 v[94:95], v3 offset:46080
    ds_read_b64_tr_b16 v[96:97], v3 offset:49152
    ds_read_b64_tr_b16 v[98:99], v3 offset:50176
    ds_read_b64_tr_b16 v[100:101], v3 offset:53248
    ds_read_b64_tr_b16 v[102:103], v3 offset:54272
    ds_read_b64_tr_b16 v[104:105], v3 offset:57344
    ds_read_b64_tr_b16 v[106:107], v3 offset:58368
    ds_read_b64_tr_b16 v[108:109], v3 offset:61440
    ds_read_b64_tr_b16 v[110:111], v3 offset:62464
    s_add_u32 m0, s9, 16384
    s_add_u32 s10, s72, 221312
    buffer_load_dwordx4 v6, s[56:59], s10 offen lds
    s_add_u32 m0, s9, 24576
    s_add_u32 s10, s72, 221376
    buffer_load_dwordx4 v6, s[56:59], s10 offen lds
    s_waitcnt lgkmcnt(14)
    v_mfma_f32_32x32x16_bf16 v[112:127], v[32:35], v[80:83], v[112:127]
    ds_read_b128 v[32:35], v1 offset:40960
    s_waitcnt lgkmcnt(13)
    v_mfma_f32_32x32x16_bf16 v[112:127], v[36:39], v[84:87], v[112:127]
    ds_read_b128 v[36:39], v2 offset:40960
    s_waitcnt lgkmcnt(12)
    v_mfma_f32_32x32x16_bf16 v[112:127], v[40:43], v[88:91], v[112:127]
    ds_read_b128 v[40:43], v1 offset:45056
    s_waitcnt lgkmcnt(11)
    v_mfma_f32_32x32x16_bf16 v[112:127], v[44:47], v[92:95], v[112:127]
    ds_read_b128 v[44:47], v2 offset:45056
    s_waitcnt lgkmcnt(3)
    v_mfma_f32_32x32x16_bf16 v[112:127], v[32:35], v[96:99], v[112:127]
    ds_read_b128 v[32:35], v1 offset:49152
    s_lshl_b32 s11, s7, 2
    s_add_u32 s11, s11, s5
    s_mul_i32 s11, s11, 18
    s_add_u32 s11, s11, s6
    s_lshl_b32 s11, s11, 5
    s_add_u32 s11, s11, s79
    s_lshl_b32 s11, s11, 10
    s_add_u32 s11, s11, 1048576
    v_and_b32 v5, 15, v0
    v_lshl_add_u32 v5, v5, 4, s11
    v_bfe_u32 v24, v0, 4, 1
    v_lshl_add_u32 v5, v24, 9, v5
    v_lshrrev_b32 v24, 5, v0
    v_lshl_add_u32 v5, v24, 8, v5
    s_waitcnt lgkmcnt(3)
    v_mfma_f32_32x32x16_bf16 v[112:127], v[36:39], v[100:103], v[112:127]
    ds_read_b128 v[36:39], v2 offset:49152
    s_mul_i32 s11, s7, 1536
    s_lshl2_add_u32 s11, s79, s11
    s_add_u32 s11, s11, 262144
    s_cmp_eq_u32 s4, 0
    s_cselect_b32 s11, s11, 0x40000000
    s_waitcnt lgkmcnt(3)
    v_mfma_f32_32x32x16_bf16 v[112:127], v[40:43], v[104:107], v[112:127]
    ds_read_b128 v[40:43], v1 offset:53248
    v_lshl_add_u32 v12, v0, 7, s11
    v_cmp_gt_u32 vcc, 12, v0
    v_mov_b32 v13, 0x40000000
    v_cndmask_b32 v12, v13, v12, vcc
    s_lshr_b32 s11, s7, 2
    s_waitcnt lgkmcnt(3)
    v_mfma_f32_32x32x16_bf16 v[112:127], v[44:47], v[108:111], v[112:127]
    ds_read_b128 v[44:47], v2 offset:53248
    s_lshl_b32 s11, s11, 6
    s_add_u32 s11, s11, 60
    v_mov_b32 v15, s11
    buffer_load_dword v14, v15, s[68:71], 0 offen sc1
    s_waitcnt vmcnt(3)
    s_barrier
    s_add_u32 m0, s9, -65536
    s_add_u32 s10, s72, 442496
    buffer_load_dwordx4 v6, s[56:59], s10 offen lds
    s_add_u32 m0, s9, -57344
    s_add_u32 s10, s72, 442560
    buffer_load_dwordx4 v6, s[56:59], s10 offen lds
    s_add_u32 m0, s9, -49152
    s_add_u32 s10, s72, 516224
    buffer_load_dwordx4 v6, s[56:59], s10 offen lds
    s_add_u32 m0, s9, -40960
    s_add_u32 s10, s72, 516288
    buffer_load_dwordx4 v6, s[56:59], s10 offen lds
    s_add_u32 m0, s9, 32768
    s_add_u32 s10, s72, 589952
    buffer_load_dwordx4 v6, s[56:59], s10 offen lds
    s_add_u32 m0, s9, 40960
    s_add_u32 s10, s72, 590016
    buffer_load_dwordx4 v6, s[56:59], s10 offen lds
    s_waitcnt lgkmcnt(3)
    v_mfma_f32_32x32x16_bf16 v[128:143], v[32:35], v[80:83], v[128:143]
    ds_read_b128 v[32:35], v1 offset:57344
    s_waitcnt lgkmcnt(3)
    v_mfma_f32_32x32x16_bf16 v[128:143], v[36:39], v[84:87], v[128:143]
    ds_read_b128 v[36:39], v2 offset:57344
    v_cvt_pk_bf16_f32 v24, v112, v113
    v_cvt_pk_bf16_f32 v25, v114, v115
    s_waitcnt lgkmcnt(3)
    v_mfma_f32_32x32x16_bf16 v[128:143], v[40:43], v[88:91], v[128:143]
    ds_read_b128 v[40:43], v1 offset:61440
    v_cvt_pk_bf16_f32 v26, v116, v117
    v_cvt_pk_bf16_f32 v27, v118, v119
    s_waitcnt lgkmcnt(3)
    v_mfma_f32_32x32x16_bf16 v[128:143], v[44:47], v[92:95], v[128:143]
    ds_read_b128 v[44:47], v2 offset:61440
    s_mov_b32 s11, 0
    buffer_store_dwordx4 v[24:27], v5, s[60:63], s11 offen sc1
    s_waitcnt lgkmcnt(3)
    v_mfma_f32_32x32x16_bf16 v[128:143], v[32:35], v[96:99], v[128:143]
    ds_read_b128 v[32:35], v1 offset:0
    v_cvt_pk_bf16_f32 v28, v120, v121
    v_cvt_pk_bf16_f32 v29, v122, v123
    s_waitcnt lgkmcnt(3)
    v_mfma_f32_32x32x16_bf16 v[128:143], v[36:39], v[100:103], v[128:143]
    ds_read_b128 v[36:39], v2 offset:0
    v_cvt_pk_bf16_f32 v30, v124, v125
    v_cvt_pk_bf16_f32 v31, v126, v127
    s_waitcnt lgkmcnt(3)
    v_mfma_f32_32x32x16_bf16 v[128:143], v[40:43], v[104:107], v[128:143]
    ds_read_b128 v[40:43], v1 offset:4096
    s_mov_b32 s11, 16384
    buffer_store_dwordx4 v[28:31], v5, s[60:63], s11 offen sc1
    s_waitcnt lgkmcnt(3)
    v_mfma_f32_32x32x16_bf16 v[128:143], v[44:47], v[108:111], v[128:143]
    ds_read_b128 v[44:47], v2 offset:4096
    s_waitcnt vmcnt(9)
    s_barrier
    v_subrev_u32 v3, 98304, v1
    v_subrev_u32 v4, 98304, v2
    s_waitcnt lgkmcnt(3)
    v_mfma_f32_32x32x16_bf16 v[144:159], v[32:35], v[80:83], v[144:159]
    ds_read_b128 v[32:35], v1 offset:8192
    s_waitcnt lgkmcnt(3)
    v_mfma_f32_32x32x16_bf16 v[144:159], v[36:39], v[84:87], v[144:159]
    ds_read_b128 v[36:39], v2 offset:8192
    s_nop 2
    v_cvt_pk_bf16_f32 v24, v128, v129
    v_cvt_pk_bf16_f32 v25, v130, v131
    s_waitcnt lgkmcnt(3)
    v_mfma_f32_32x32x16_bf16 v[144:159], v[40:43], v[88:91], v[144:159]
    ds_read_b128 v[40:43], v1 offset:12288
    v_cvt_pk_bf16_f32 v26, v132, v133
    v_cvt_pk_bf16_f32 v27, v134, v135
    s_waitcnt lgkmcnt(3)
    v_mfma_f32_32x32x16_bf16 v[144:159], v[44:47], v[92:95], v[144:159]
    ds_read_b128 v[44:47], v2 offset:12288
    s_mov_b32 s11, 65536
    buffer_store_dwordx4 v[24:27], v5, s[60:63], s11 offen sc1
    s_waitcnt lgkmcnt(3)
    v_mfma_f32_32x32x16_bf16 v[144:159], v[32:35], v[96:99], v[144:159]
    ds_read_b128 v[32:35], v1 offset:16384
    v_cvt_pk_bf16_f32 v28, v136, v137
    v_cvt_pk_bf16_f32 v29, v138, v139
    s_waitcnt lgkmcnt(3)
    v_mfma_f32_32x32x16_bf16 v[144:159], v[36:39], v[100:103], v[144:159]
    ds_read_b128 v[36:39], v2 offset:16384
    v_cvt_pk_bf16_f32 v30, v140, v141
    v_cvt_pk_bf16_f32 v31, v142, v143
    s_waitcnt lgkmcnt(3)
    v_mfma_f32_32x32x16_bf16 v[144:159], v[40:43], v[104:107], v[144:159]
    ds_read_b128 v[40:43], v1 offset:20480
    s_mov_b32 s11, 81920
    buffer_store_dwordx4 v[28:31], v5, s[60:63], s11 offen sc1
    s_waitcnt lgkmcnt(3)
    v_mfma_f32_32x32x16_bf16 v[144:159], v[44:47], v[108:111], v[144:159]
    ds_read_b128 v[44:47], v2 offset:20480
    s_barrier
    s_waitcnt lgkmcnt(3)
    v_mfma_f32_32x32x16_bf16 v[160:175], v[32:35], v[80:83], v[160:175]
    ds_read_b128 v[32:35], v1 offset:24576
    s_waitcnt lgkmcnt(3)
    v_mfma_f32_32x32x16_bf16 v[160:175], v[36:39], v[84:87], v[160:175]
    ds_read_b128 v[36:39], v2 offset:24576
    s_nop 5
    v_cvt_pk_bf16_f32 v24, v144, v145
    v_cvt_pk_bf16_f32 v25, v146, v147
    s_waitcnt lgkmcnt(3)
    v_mfma_f32_32x32x16_bf16 v[160:175], v[40:43], v[88:91], v[160:175]
    ds_read_b128 v[40:43], v1 offset:28672
    v_cvt_pk_bf16_f32 v26, v148, v149
    v_cvt_pk_bf16_f32 v27, v150, v151
    s_waitcnt lgkmcnt(3)
    v_mfma_f32_32x32x16_bf16 v[160:175], v[44:47], v[92:95], v[160:175]
    ds_read_b128 v[44:47], v2 offset:28672
    s_mov_b32 s11, 131072
    buffer_store_dwordx4 v[24:27], v5, s[60:63], s11 offen sc1
    s_waitcnt lgkmcnt(3)
    v_mfma_f32_32x32x16_bf16 v[160:175], v[32:35], v[96:99], v[160:175]
    ds_read_b128 v[32:35], v3 offset:0
    v_cvt_pk_bf16_f32 v28, v152, v153
    v_cvt_pk_bf16_f32 v29, v154, v155
    s_waitcnt lgkmcnt(3)
    v_mfma_f32_32x32x16_bf16 v[160:175], v[36:39], v[100:103], v[160:175]
    ds_read_b128 v[36:39], v4 offset:0
    v_cvt_pk_bf16_f32 v30, v156, v157
    v_cvt_pk_bf16_f32 v31, v158, v159
    s_waitcnt lgkmcnt(3)
    v_mfma_f32_32x32x16_bf16 v[160:175], v[40:43], v[104:107], v[160:175]
    ds_read_b128 v[40:43], v3 offset:4096
    s_mov_b32 s11, 147456
    buffer_store_dwordx4 v[28:31], v5, s[60:63], s11 offen sc1
    s_waitcnt lgkmcnt(3)
    v_mfma_f32_32x32x16_bf16 v[160:175], v[44:47], v[108:111], v[160:175]
    ds_read_b128 v[44:47], v4 offset:4096
    s_waitcnt vmcnt(4)
    s_barrier
    s_mov_b32 s83, 65536
.clp_27:
    s_and_b32 s11, s7, 3
    s_lshl_b32 s11, s11, 3
    v_lshrrev_b32 v14, s11, v14
    v_and_b32 v14, 0xff, v14
    v_cmp_gt_u32 vcc, 12, v14
    s_cbranch_vccz .cok_26
    buffer_load_dword v14, v15, s[68:71], 0 offen sc1
    s_waitcnt vmcnt(0)
    s_sub_u32 s83, s83, 1
    s_cmp_lg_u32 s83, 0
    s_cbranch_scc1 .clp_27
.cok_26:
    v_mov_b32 v13, 1
    buffer_store_dword v13, v12, s[60:63], 0 offen sc1
    s_waitcnt lgkmcnt(3)
    v_mfma_f32_32x32x16_bf16 v[176:191], v[32:35], v[80:83], v[176:191]
    ds_read_b128 v[32:35], v3 offset:8192
    s_waitcnt lgkmcnt(3)
    v_mfma_f32_32x32x16_bf16 v[176:191], v[36:39], v[84:87], v[176:191]
    ds_read_b128 v[36:39], v4 offset:8192
    v_cvt_pk_bf16_f32 v24, v160, v161
    v_cvt_pk_bf16_f32 v25, v162, v163
    s_waitcnt lgkmcnt(3)
    v_mfma_f32_32x32x16_bf16 v[176:191], v[40:43], v[88:91], v[176:191]
    ds_read_b128 v[40:43], v3 offset:12288
    v_cvt_pk_bf16_f32 v26, v164, v165
    v_cvt_pk_bf16_f32 v27, v166, v167
    s_waitcnt lgkmcnt(3)
    v_mfma_f32_32x32x16_bf16 v[176:191], v[44:47], v[92:95], v[176:191]
    ds_read_b128 v[44:47], v4 offset:12288
    s_mov_b32 s11, 196608
    buffer_store_dwordx4 v[24:27], v5, s[60:63], s11 offen sc1
    s_waitcnt lgkmcnt(3)
    v_mfma_f32_32x32x16_bf16 v[176:191], v[32:35], v[96:99], v[176:191]
    ds_read_b128 v[32:35], v3 offset:16384
    v_cvt_pk_bf16_f32 v28, v168, v169
    v_cvt_pk_bf16_f32 v29, v170, v171
    s_waitcnt lgkmcnt(3)
    v_mfma_f32_32x32x16_bf16 v[176:191], v[36:39], v[100:103], v[176:191]
    ds_read_b128 v[36:39], v4 offset:16384
    v_cvt_pk_bf16_f32 v30, v172, v173
    v_cvt_pk_bf16_f32 v31, v174, v175
    s_waitcnt lgkmcnt(3)
    v_mfma_f32_32x32x16_bf16 v[176:191], v[40:43], v[104:107], v[176:191]
    ds_read_b128 v[40:43], v3 offset:20480
    s_mov_b32 s11, 212992
    buffer_store_dwordx4 v[28:31], v5, s[60:63], s11 offen sc1
    s_waitcnt lgkmcnt(3)
    v_mfma_f32_32x32x16_bf16 v[176:191], v[44:47], v[108:111], v[176:191]
    ds_read_b128 v[44:47], v4 offset:20480
    s_waitcnt vmcnt(5)
    s_barrier
    v_mov_b32 v13, 2
    buffer_store_dword v13, v12, s[60:63], 0 offen sc1
    s_waitcnt lgkmcnt(3)
    v_mfma_f32_32x32x16_bf16 v[192:207], v[32:35], v[80:83], v[192:207]
    ds_read_b128 v[32:35], v3 offset:24576
    s_waitcnt lgkmcnt(3)
    v_mfma_f32_32x32x16_bf16 v[192:207], v[36:39], v[84:87], v[192:207]
    ds_read_b128 v[36:39], v4 offset:24576
    s_nop 2
    v_cvt_pk_bf16_f32 v24, v176, v177
    v_cvt_pk_bf16_f32 v25, v178, v179
    s_waitcnt lgkmcnt(3)
    v_mfma_f32_32x32x16_bf16 v[192:207], v[40:43], v[88:91], v[192:207]
    ds_read_b128 v[40:43], v3 offset:28672
    v_cvt_pk_bf16_f32 v26, v180, v181
    v_cvt_pk_bf16_f32 v27, v182, v183
    s_waitcnt lgkmcnt(3)
    v_mfma_f32_32x32x16_bf16 v[192:207], v[44:47], v[92:95], v[192:207]
    ds_read_b128 v[44:47], v4 offset:28672
    s_mov_b32 s11, 262144
    buffer_store_dwordx4 v[24:27], v5, s[60:63], s11 offen sc1
    s_waitcnt lgkmcnt(3)
    v_mfma_f32_32x32x16_bf16 v[192:207], v[32:35], v[96:99], v[192:207]
    ds_read_b128 v[32:35], v3 offset:32768
    v_cvt_pk_bf16_f32 v28, v184, v185
    v_cvt_pk_bf16_f32 v29, v186, v187
    s_waitcnt lgkmcnt(3)
    v_mfma_f32_32x32x16_bf16 v[192:207], v[36:39], v[100:103], v[192:207]
    ds_read_b128 v[36:39], v4 offset:32768
    v_cvt_pk_bf16_f32 v30, v188, v189
    v_cvt_pk_bf16_f32 v31, v190, v191
    s_waitcnt lgkmcnt(3)
    v_mfma_f32_32x32x16_bf16 v[192:207], v[40:43], v[104:107], v[192:207]
    ds_read_b128 v[40:43], v3 offset:36864
    s_mov_b32 s11, 278528
    buffer_store_dwordx4 v[28:31], v5, s[60:63], s11 offen sc1
    s_waitcnt lgkmcnt(3)
    v_mfma_f32_32x32x16_bf16 v[192:207], v[44:47], v[108:111], v[192:207]
    ds_read_b128 v[44:47], v4 offset:36864
    s_waitcnt vmcnt(6)
    s_barrier
    v_mov_b32 v13, 3
    buffer_store_dword v13, v12, s[60:63], 0 offen sc1
    s_waitcnt lgkmcnt(3)
    v_mfma_f32_32x32x16_bf16 v[208:223], v[32:35], v[80:83], v[208:223]
    ds_read_b128 v[32:35], v3 offset:40960
    s_waitcnt lgkmcnt(3)
    v_mfma_f32_32x32x16_bf16 v[208:223], v[36:39], v[84:87], v[208:223]
    ds_read_b128 v[36:39], v4 offset:40960
    s_nop 2
    v_cvt_pk_bf16_f32 v24, v192, v193
    v_cvt_pk_bf16_f32 v25, v194, v195
    s_waitcnt lgkmcnt(3)
    v_mfma_f32_32x32x16_bf16 v[208:223], v[40:43], v[88:91], v[208:223]
    ds_read_b128 v[40:43], v3 offset:45056
    v_cvt_pk_bf16_f32 v26, v196, v197
    v_cvt_pk_bf16_f32 v27, v198, v199
    s_waitcnt lgkmcnt(3)
    v_mfma_f32_32x32x16_bf16 v[208:223], v[44:47], v[92:95], v[208:223]
    ds_read_b128 v[44:47], v4 offset:45056
    s_mov_b32 s11, 327680
    buffer_store_dwordx4 v[24:27], v5, s[60:63], s11 offen sc1
    s_waitcnt lgkmcnt(3)
    v_mfma_f32_32x32x16_bf16 v[208:223], v[32:35], v[96:99], v[208:223]
    ds_read_b128 v[32:35], v3 offset:49152
    v_cvt_pk_bf16_f32 v28, v200, v201
    v_cvt_pk_bf16_f32 v29, v202, v203
    s_waitcnt lgkmcnt(3)
    v_mfma_f32_32x32x16_bf16 v[208:223], v[36:39], v[100:103], v[208:223]
    ds_read_b128 v[36:39], v4 offset:49152
    v_cvt_pk_bf16_f32 v30, v204, v205
    v_cvt_pk_bf16_f32 v31, v206, v207
    s_waitcnt lgkmcnt(3)
    v_mfma_f32_32x32x16_bf16 v[208:223], v[40:43], v[104:107], v[208:223]
    ds_read_b128 v[40:43], v3 offset:53248
    s_mov_b32 s11, 344064
    buffer_store_dwordx4 v[28:31], v5, s[60:63], s11 offen sc1
    s_waitcnt lgkmcnt(3)
    v_mfma_f32_32x32x16_bf16 v[208:223], v[44:47], v[108:111], v[208:223]
    ds_read_b128 v[44:47], v4 offset:53248
    s_waitcnt vmcnt(6)
    s_barrier
    v_mov_b32 v13, 4
    buffer_store_dword v13, v12, s[60:63], 0 offen sc1
    s_waitcnt lgkmcnt(3)
    v_mfma_f32_32x32x16_bf16 v[224:239], v[32:35], v[80:83], v[224:239]
    ds_read_b128 v[32:35], v3 offset:57344
    s_waitcnt lgkmcnt(3)
    v_mfma_f32_32x32x16_bf16 v[224:239], v[36:39], v[84:87], v[224:239]
    ds_read_b128 v[36:39], v4 offset:57344
    s_nop 2
    v_cvt_pk_bf16_f32 v24, v208, v209
    v_cvt_pk_bf16_f32 v25, v210, v211
    s_waitcnt lgkmcnt(3)
    v_mfma_f32_32x32x16_bf16 v[224:239], v[40:43], v[88:91], v[224:239]
    ds_read_b128 v[40:43], v3 offset:61440
    v_cvt_pk_bf16_f32 v26, v212, v213
    v_cvt_pk_bf16_f32 v27, v214, v215
    s_waitcnt lgkmcnt(3)
    v_mfma_f32_32x32x16_bf16 v[224:239], v[44:47], v[92:95], v[224:239]
    ds_read_b128 v[44:47], v4 offset:61440
    s_mov_b32 s11, 393216
    buffer_store_dwordx4 v[24:27], v5, s[60:63], s11 offen sc1
    s_waitcnt lgkmcnt(3)
    v_mfma_f32_32x32x16_bf16 v[224:239], v[32:35], v[96:99], v[224:239]
    ds_read_b128 v[32:35], v1 offset:32768
    v_cvt_pk_bf16_f32 v28, v216, v217
    v_cvt_pk_bf16_f32 v29, v218, v219
    s_waitcnt lgkmcnt(3)
    v_mfma_f32_32x32x16_bf16 v[224:239], v[36:39], v[100:103], v[224:239]
    ds_read_b128 v[36:39], v2 offset:32768
    v_cvt_pk_bf16_f32 v30, v220, v221
    v_cvt_pk_bf16_f32 v31, v222, v223
    s_waitcnt lgkmcnt(3)
    v_mfma_f32_32x32x16_bf16 v[224:239], v[40:43], v[104:107], v[224:239]
    ds_read_b128 v[40:43], v1 offset:36864
    s_mov_b32 s11, 409600
    buffer_store_dwordx4 v[28:31], v5, s[60:63], s11 offen sc1
    s_waitcnt lgkmcnt(3)
    v_mfma_f32_32x32x16_bf16 v[224:239], v[44:47], v[108:111], v[224:239]
    ds_read_b128 v[44:47], v2 offset:36864
    s_waitcnt vmcnt(6)
    s_barrier
    v_mov_b32 v13, 5
    buffer_store_dword v13, v12, s[60:63], 0 offen sc1
    s_waitcnt lgkmcnt(3)
    v_mfma_f32_32x32x16_bf16 v[240:255], v[32:35], v[80:83], v[240:255]
    ds_read_b128 v[32:35], v1 offset:40960
    s_waitcnt lgkmcnt(3)
    v_mfma_f32_32x32x16_bf16 v[240:255], v[36:39], v[84:87], v[240:255]
    ds_read_b128 v[36:39], v2 offset:40960
    s_nop 2
    v_cvt_pk_bf16_f32 v24, v224, v225
    v_cvt_pk_bf16_f32 v25, v226, v227
    s_waitcnt lgkmcnt(3)
    v_mfma_f32_32x32x16_bf16 v[240:255], v[40:43], v[88:91], v[240:255]
    ds_read_b128 v[40:43], v1 offset:45056
    v_cvt_pk_bf16_f32 v26, v228, v229
    v_cvt_pk_bf16_f32 v27, v230, v231
    s_waitcnt lgkmcnt(3)
    v_mfma_f32_32x32x16_bf16 v[240:255], v[44:47], v[92:95], v[240:255]
    ds_read_b128 v[44:47], v2 offset:45056
    s_mov_b32 s11, 458752
    buffer_store_dwordx4 v[24:27], v5, s[60:63], s11 offen sc1
    s_waitcnt lgkmcnt(3)
    v_mfma_f32_32x32x16_bf16 v[240:255], v[32:35], v[96:99], v[240:255]
    v_cvt_pk_bf16_f32 v28, v232, v233
    v_cvt_pk_bf16_f32 v29, v234, v235
    s_waitcnt lgkmcnt(2)
    v_mfma_f32_32x32x16_bf16 v[240:255], v[36:39], v[100:103], v[240:255]
    v_cvt_pk_bf16_f32 v30, v236, v237
    v_cvt_pk_bf16_f32 v31, v238, v239
    s_waitcnt lgkmcnt(1)
    v_mfma_f32_32x32x16_bf16 v[240:255], v[40:43], v[104:107], v[240:255]
    s_mov_b32 s11, 475136
    buffer_store_dwordx4 v[28:31], v5, s[60:63], s11 offen sc1
    s_waitcnt lgkmcnt(0)
    v_mfma_f32_32x32x16_bf16 v[240:255], v[44:47], v[108:111], v[240:255]
    s_nop 7
    s_nop 5
    v_cvt_pk_bf16_f32 v24, v240, v241
    v_cvt_pk_bf16_f32 v25, v242, v243
    v_cvt_pk_bf16_f32 v26, v244, v245
    v_cvt_pk_bf16_f32 v27, v246, v247
    s_mov_b32 s11, 524288
    buffer_store_dwordx4 v[24:27], v5, s[60:63], s11 offen sc1
    v_cvt_pk_bf16_f32 v28, v248, v249
    v_cvt_pk_bf16_f32 v29, v250, v251
    v_cvt_pk_bf16_f32 v30, v252, v253
    v_cvt_pk_bf16_f32 v31, v254, v255
    s_mov_b32 s11, 540672
    buffer_store_dwordx4 v[28:31], v5, s[60:63], s11 offen sc1
    s_waitcnt vmcnt(0)
    s_barrier
    v_mov_b32 v13, 9
    buffer_store_dword v13, v12, s[60:63], 0 offen sc1
    s_endpgm
.Lk1_end:
    s_endpgm
.Lcode_end:
.section .rodata,"a"
.p2align 6
.amdhsa_kernel recurrent_scan__ssm_conv_s5__dense_activation_mish__prompt_kernel
  .amdhsa_next_free_vgpr 256
  .amdhsa_next_free_sgpr 102
  .amdhsa_accum_offset 256
  .amdhsa_group_segment_fixed_size 0
  .amdhsa_kernarg_size 128
  .amdhsa_user_sgpr_count 2
  .amdhsa_user_sgpr_kernarg_segment_ptr 1
  .amdhsa_system_sgpr_workgroup_id_x 1
.end_amdhsa_kernel
```
